```python
import torch

def _softmax(x, axis=-1):
    return torch.softmax(x, dim=axis)
def _gelu(x):
    return torch.nn.functional.gelu(x, approximate="tanh")
def _silu(x):
    return torch.nn.functional.silu(x)
def _sigmoid(x):
    return torch.sigmoid(x)
def _layernorm(x, axis=-1, eps=1e-5):
    m = x.mean(dim=axis, keepdim=True)
    v = x.var(dim=axis, keepdim=True, unbiased=False)
    return (x - m) / torch.sqrt(v + eps)
def _scatter_add(tgt, idx, src, axis=0):
    return tgt.clone().index_add_(axis, idx, src)
def _segment_sum(src, seg, n):
    out = torch.zeros((n,) + src.shape[1:], dtype=src.dtype)
    return out.index_add_(0, seg, src)
def _pad(x, pw):
    flat = tuple(v for pair in reversed(pw) for v in pair)
    return torch.nn.functional.pad(x, flat)

kernel_name = 'recurrent_scan__mha_block_cached__glu_gated_reglu__prompt'

def setup_inputs():

    _w = (lambda a: (lambda t: t.to(torch.bfloat16) if t.is_floating_point() else t)(torch.as_tensor(a)))
    def _A_setup():
        B, Sq, D = 1, 2048, 640
        H, Sk, Dh = 32, 2048, 128
        return {
            "x": _w((lambda *s: torch.randn(*s, dtype=torch.bfloat16) * 0.05)(B, Sq, D)),
            "k_cache": _w((lambda *s: torch.randn(*s, dtype=torch.bfloat16) * 1.6)(B, H, Sk, Dh)),
            "v_cache": _w((lambda *s: torch.randn(*s, dtype=torch.bfloat16) * 1.6)(B, H, Sk, Dh)),
            "wq": _w((lambda *s: torch.randn(*s, dtype=torch.bfloat16) * 1.6)(D, H * Dh) * (D ** -0.5)),
            "wo": _w((lambda *s: torch.randn(*s, dtype=torch.bfloat16) * 1.6)(H * Dh, D) * ((H * Dh) ** -0.5)),
        }
    _A_in = _A_setup()

    def _B_setup():
        B, S, D, F = 1, 2048, 640, 1728
        return {
            "x": _w((lambda *s: torch.randn(*s, dtype=torch.bfloat16) * 0.05)(B, S, D)),
            "W_gate": _w((lambda *s: torch.randn(*s, dtype=torch.bfloat16) * 0.2)(D, F) * (2.0 / D) ** 0.5),
            "W_up": _w((lambda *s: torch.randn(*s, dtype=torch.bfloat16) * 0.2)(D, F) * (2.0 / D) ** 0.5),
            "W_down": _w((lambda *s: torch.randn(*s, dtype=torch.bfloat16) * 0.2)(F, D) * (1.0 / F) ** 0.5),
        }
    _B_in = _B_setup()

    return {
        "A_x": _A_in["x"],
        "A_k_cache": _A_in["k_cache"],
        "A_v_cache": _A_in["v_cache"],
        "A_wq": _A_in["wq"],
        "A_wo": _A_in["wo"],
        "B_x": _B_in["x"],
        "B_W_gate": _B_in["W_gate"],
        "B_W_up": _B_in["W_up"],
        "B_W_down": _B_in["W_down"],
    }

def reference(A_x, A_k_cache, A_v_cache, A_wq, A_wo, B_x, B_W_gate, B_W_up, B_W_down):
    def _A_ref(x, k_cache, v_cache, wq, wo):
        B, Sq, D = x.shape
        H, Dh = 32, 128
        q = (lambda x, *d: x.permute(*d))((x @ wq).reshape(B, Sq, H, Dh), 0, 2, 1, 3)
        scores = torch.einsum("bhqd,bhkd->bhqk", q, k_cache) * (Dh ** -0.5)
        p = _softmax(scores, axis=-1)
        o = torch.einsum("bhqk,bhkd->bhqd", p, v_cache)
        return (lambda x, *d: x.permute(*d))(o, 0, 2, 1, 3).reshape(B, Sq, H * Dh) @ wo

    def _B_ref(x, W_gate, W_up, W_down):
        gate = torch.einsum("bsd,df->bsf", x, W_gate)
        up = torch.einsum("bsd,df->bsf", x, W_up)
        gate = gate * (lambda x, dt: x.to(dt))(gate > 0, gate.dtype)
        h = gate * up
        return torch.einsum("bsf,fd->bsd", h, W_down)

    x = A_x
    xn = _layernorm(x, axis=-1)
    s = _A_ref(xn, A_k_cache, A_v_cache, A_wq, A_wo)
    g = _silu(_B_ref(xn, B_W_gate, B_W_up, B_W_down))
    return x + s * g
```

```asm
; @launch grid=(256,1,1) block=(256,1,1) lds=163840
.amdgcn_target "amdgcn-amd-amdhsa--gfx950"
.text
.globl recurrent_scan__mha_block_cached__glu_gated_reglu__prompt_kernel
.p2align 8
.type recurrent_scan__mha_block_cached__glu_gated_reglu__prompt_kernel,@function
recurrent_scan__mha_block_cached__glu_gated_reglu__prompt_kernel:
s_cmp_ge_u32 s2, 256
s_cbranch_scc1 K_END
s_load_dwordx8 s[44:51], s[0:1], 0
s_load_dwordx8 s[52:59], s[0:1], 32
s_load_dwordx8 s[60:67], s[0:1], 64
v_and_b32 v1, 63, v0
v_lshrrev_b32 v40, 6, v0
v_lshlrev_b32 v2, 4, v1
v_readfirstlane_b32 s68, v40
s_and_b32 s80, s2, 7
s_lshr_b32 s81, s2, 3
s_and_b32 s3, s81, 3
s_lshr_b32 s70, s81, 2
s_lshl_b32 s69, s80, 2
s_add_u32 s69, s69, s3
s_lshl_b32 s71, s3, 3
s_add_u32 s71, s71, s80
s_mov_b32 s79, 0
s_lshl_b32 s75, s68, 12
s_lshl_b32 s77, s68, 11
s_getpc_b64 s[84:85]
CODE0:
s_lshr_b32 s91, s2, 3
s_lshl2_add_u32 s91, s91, s68
s_mul_i32 s91, s91, 640
v_min_u32 v8, 4, v1
v_lshlrev_b32 v8, 7, v8
v_add_u32 v8, s91, v8
v_min_u32 v8, CODE1-CODE0-4, v8
global_load_dword v36, v8, s[84:85]
v_bfe_u32 v40, v1, 1, 3
v_lshrrev_b32 v41, 4, v1
v_and_b32 v42, 1, v1
v_mul_u32_u24 v43, 1280, v40
v_lshl_add_u32 v43, v41, 4, v43
v_lshl_add_u32 v43, v42, 3, v43
s_lshl_b32 s80, s70, 5
s_add_u32 s80, s80, s69
s_mul_i32 s80, s80, 10240
s_mul_i32 s81, s68, 320
s_waitcnt lgkmcnt(0)
s_add_u32 s36, s44, s80
s_addc_u32 s37, s45, 0
s_mov_b32 s38, 10240
s_mov_b32 s39, 0x20000
buffer_load_dwordx2 v[64:65], v43, s[36:39], s81 offen offset:0
buffer_load_dwordx2 v[66:67], v43, s[36:39], s81 offen offset:64
buffer_load_dwordx2 v[68:69], v43, s[36:39], s81 offen offset:128
buffer_load_dwordx2 v[70:71], v43, s[36:39], s81 offen offset:192
buffer_load_dwordx2 v[72:73], v43, s[36:39], s81 offen offset:256
s_add_u32 s82, s66, 36765696
s_addc_u32 s83, s67, 0
s_load_dword s92, s[82:83], 0
v_lshrrev_b32 v52, 4, v1
v_lshlrev_b32 v53, 2, v52
v_and_b32 v54, 15, v1
v_xor_b32 v53, v53, v54
v_lshlrev_b32 v52, 13, v52
v_lshl_add_u32 v3, v53, 4, v52
v_add_u32 v4, 31744, v3
v_lshrrev_b32 v52, 3, v1
v_bfe_u32 v53, v1, 4, 1
v_lshlrev_b32 v53, 1, v53
s_and_b32 s80, s68, 1
s_lshl_b32 s80, s80, 2
v_or_b32 v53, s80, v53
v_and_b32 v54, 7, v1
v_xor_b32 v53, v53, v54
v_mul_u32_u24 v52, 3456, v52
v_lshl_add_u32 v5, v53, 4, v52
s_lshl_b32 s80, s69, 8
s_sub_u32 s81, 5242880, s80
s_add_u32 s12, s50, s80
s_addc_u32 s13, s51, 0
s_mov_b32 s14, s81
s_mov_b32 s15, 0x20000
s_lshl_b32 s80, s71, 7
s_sub_u32 s81, 2213888, s80
s_cmp_lt_u32 s71, 27
s_cselect_b32 s81, s81, 0
s_add_u32 s16, s56, s80
s_addc_u32 s17, s57, 0
s_mov_b32 s18, s81
s_mov_b32 s19, 0x20000
s_sub_u32 s16, s16, 2048
s_subb_u32 s17, s17, 0
s_lshl_b32 s80, s71, 7
s_sub_u32 s81, 2214912, s80
s_cmp_lt_u32 s71, 27
s_cselect_b32 s81, s81, 0
s_add_u32 s20, s58, s80
s_addc_u32 s21, s59, 0
s_mov_b32 s22, s81
s_mov_b32 s23, 0x20000
s_sub_u32 s20, s20, 3072
s_subb_u32 s21, s21, 0
s_lshl_b32 s73, s68, 16
s_mul_i32 s74, s68, 27648
s_lshl2_add_u32 s80, s70, s68
s_add_u32 s80, s80, 32
v_lshrrev_b32 v62, 1, v1
v_min_u32 v62, 3, v62
v_lshlrev_b32 v62, 5, v62
v_add_u32 v62, s80, v62
v_and_b32 v63, 1, v1
v_lshlrev_b32 v63, 7, v63
v_lshl_add_u32 v63, v62, 13, v63
v_mul_u32_u24 v62, 3456, v62
s_add_u32 m0, s75, 65536
s_nop 0
buffer_load_dwordx4 v3, s[12:15], s73 offen lds
buffer_load_dwordx4 v4, s[12:15], s73 offen offset:1024 lds
buffer_load_dwordx4 v5, s[16:19], s74 offen offset:2048 lds
buffer_load_dwordx4 v5, s[20:23], s74 offen offset:3072 lds
s_add_u32 s73, s73, 262144
s_add_u32 s74, s74, 110592
buffer_load_dword v37, v63, s[12:15], 0 offen
buffer_load_dword v38, v62, s[16:19], 0 offen offset:2048
buffer_load_dword v18, v62, s[20:23], 0 offen offset:3072
s_add_u32 s4, s66, 36700160
s_addc_u32 s5, s67, 0
s_mov_b32 s6, 69632
s_mov_b32 s7, 0x20000
s_lshl_b32 s94, s70, 5
s_add_u32 s94, s94, s69
s_lshl_b32 s94, s94, 7
v_min_u32 v39, 31, v1
v_lshlrev_b32 v39, 7, v39
s_lshl_b32 s72, s70, 12
v_and_b32 v43, 15, v1
v_lshlrev_b32 v43, 3, v43
v_lshl_add_u32 v43, v41, 8, v43
s_lshr_b32 s80, s69, 3
s_lshl2_add_u32 s80, s70, s80
s_mul_i32 s80, s80, 81920
s_bfe_u32 s81, s69, 0x20001
s_lshl_b32 s81, s81, 10
s_add_u32 s80, s80, s81
s_and_b32 s81, s69, 1
s_lshl_b32 s81, s81, 7
s_add_u32 s80, s80, s81
s_add_u32 s80, s80, 33558528
s_add_u32 s84, s66, s80
s_addc_u32 s85, s67, 0
s_mov_b32 s86, 81920
s_mov_b32 s87, 0x20000
s_mul_i32 s80, s68, 20480
v_lshlrev_b32 v44, 5, v40
v_add_u32 v44, 155648, v44
s_lshl_b32 s81, s68, 3
v_add_u32 v45, s81, v44
s_waitcnt vmcnt(7)
v_lshlrev_b32 v74, 16, v64
v_and_b32 v75, 0xffff0000, v64
v_lshlrev_b32 v76, 16, v65
v_and_b32 v77, 0xffff0000, v65
v_lshlrev_b32 v78, 16, v66
v_and_b32 v79, 0xffff0000, v66
v_lshlrev_b32 v80, 16, v67
v_and_b32 v81, 0xffff0000, v67
v_lshlrev_b32 v82, 16, v68
v_and_b32 v83, 0xffff0000, v68
v_lshlrev_b32 v84, 16, v69
v_and_b32 v85, 0xffff0000, v69
v_lshlrev_b32 v86, 16, v70
v_and_b32 v87, 0xffff0000, v70
v_lshlrev_b32 v88, 16, v71
v_and_b32 v89, 0xffff0000, v71
v_lshlrev_b32 v90, 16, v72
v_and_b32 v91, 0xffff0000, v72
v_lshlrev_b32 v92, 16, v73
v_and_b32 v93, 0xffff0000, v73
v_pk_add_f32 v[46:47], v[74:75], v[76:77]
v_pk_add_f32 v[48:49], v[78:79], v[80:81]
v_pk_add_f32 v[46:47], v[46:47], v[82:83]
v_pk_add_f32 v[48:49], v[48:49], v[84:85]
v_pk_add_f32 v[46:47], v[46:47], v[86:87]
v_pk_add_f32 v[48:49], v[48:49], v[88:89]
v_pk_add_f32 v[46:47], v[46:47], v[90:91]
v_pk_add_f32 v[48:49], v[48:49], v[92:93]
v_pk_add_f32 v[46:47], v[46:47], v[48:49]
v_add_f32 v46, v46, v47
s_nop 1
v_add_f32_dpp v46, v46, v46 quad_perm:[1,0,3,2] row_mask:0xf bank_mask:0xf
v_mov_b32 v47, v46
s_nop 1
v_permlane32_swap_b32 v46, v47
v_add_f32 v46, v46, v47
v_mov_b32 v47, v46
s_nop 1
v_permlane16_swap_b32 v46, v47
v_add_f32 v46, v46, v47
v_mul_f32 v48, 0xbbcccccd, v46
v_mul_f32 v49, 0xbbcccccd, v46
v_pk_add_f32 v[74:75], v[74:75], v[48:49]
v_pk_add_f32 v[76:77], v[76:77], v[48:49]
v_pk_add_f32 v[78:79], v[78:79], v[48:49]
v_pk_add_f32 v[80:81], v[80:81], v[48:49]
v_pk_add_f32 v[82:83], v[82:83], v[48:49]
v_pk_add_f32 v[84:85], v[84:85], v[48:49]
v_pk_add_f32 v[86:87], v[86:87], v[48:49]
v_pk_add_f32 v[88:89], v[88:89], v[48:49]
v_pk_add_f32 v[90:91], v[90:91], v[48:49]
v_pk_add_f32 v[92:93], v[92:93], v[48:49]
v_pk_mul_f32 v[46:47], v[74:75], v[74:75]
v_pk_mul_f32 v[50:51], v[76:77], v[76:77]
v_pk_fma_f32 v[46:47], v[78:79], v[78:79], v[46:47]
v_pk_fma_f32 v[50:51], v[80:81], v[80:81], v[50:51]
v_pk_fma_f32 v[46:47], v[82:83], v[82:83], v[46:47]
v_pk_fma_f32 v[50:51], v[84:85], v[84:85], v[50:51]
v_pk_fma_f32 v[46:47], v[86:87], v[86:87], v[46:47]
v_pk_fma_f32 v[50:51], v[88:89], v[88:89], v[50:51]
v_pk_fma_f32 v[46:47], v[90:91], v[90:91], v[46:47]
v_pk_fma_f32 v[50:51], v[92:93], v[92:93], v[50:51]
v_pk_add_f32 v[46:47], v[46:47], v[50:51]
v_add_f32 v46, v46, v47
s_nop 1
v_add_f32_dpp v46, v46, v46 quad_perm:[1,0,3,2] row_mask:0xf bank_mask:0xf
v_mov_b32 v47, v46
s_nop 1
v_permlane32_swap_b32 v46, v47
v_add_f32 v46, v46, v47
v_mov_b32 v47, v46
s_nop 1
v_permlane16_swap_b32 v46, v47
v_add_f32 v46, v46, v47
v_mov_b32 v49, v46
ds_write_b64 v45, v[48:49]
s_waitcnt lgkmcnt(0)
s_barrier
ds_read_b128 v[52:55], v44
ds_read_b128 v[56:59], v44 offset:16
s_waitcnt lgkmcnt(0)
v_pk_add_f32 v[46:47], v[52:53], v[54:55]
v_pk_add_f32 v[50:51], v[56:57], v[58:59]
v_pk_add_f32 v[46:47], v[46:47], v[50:51]
v_mul_f32 v46, 0x3e800000, v46
v_sub_f32 v52, v52, v46
v_sub_f32 v54, v54, v46
v_sub_f32 v56, v56, v46
v_sub_f32 v58, v58, v46
v_mul_f32 v53, v52, v52
v_fmac_f32 v53, v54, v54
v_fmac_f32 v53, v56, v56
v_fmac_f32 v53, v58, v58
v_fmac_f32 v47, 0x43200000, v53
v_mov_b32 v52, 0x3a21369a
v_fmac_f32 v52, 0x3dc4cb26, v47
v_rsq_f32 v52, v52
v_sub_f32 v48, v46, v48
v_mov_b32 v53, v52
v_mul_f32 v49, v48, v52
v_mul_f32 v48, v48, v52
v_pk_fma_f32 v[74:75], v[74:75], v[52:53], v[48:49]
v_pk_fma_f32 v[76:77], v[76:77], v[52:53], v[48:49]
v_cvt_pk_bf16_f32 v64, v74, v75
v_cvt_pk_bf16_f32 v65, v76, v77
buffer_store_dwordx2 v[64:65], v43, s[84:87], s80 offen sc1
s_add_u32 s80, s80, 4096
v_pk_fma_f32 v[78:79], v[78:79], v[52:53], v[48:49]
v_pk_fma_f32 v[80:81], v[80:81], v[52:53], v[48:49]
v_cvt_pk_bf16_f32 v66, v78, v79
v_cvt_pk_bf16_f32 v67, v80, v81
buffer_store_dwordx2 v[66:67], v43, s[84:87], s80 offen sc1
s_add_u32 s80, s80, 4096
v_pk_fma_f32 v[82:83], v[82:83], v[52:53], v[48:49]
v_pk_fma_f32 v[84:85], v[84:85], v[52:53], v[48:49]
v_cvt_pk_bf16_f32 v68, v82, v83
v_cvt_pk_bf16_f32 v69, v84, v85
buffer_store_dwordx2 v[68:69], v43, s[84:87], s80 offen sc1
s_add_u32 s80, s80, 4096
v_pk_fma_f32 v[86:87], v[86:87], v[52:53], v[48:49]
v_pk_fma_f32 v[88:89], v[88:89], v[52:53], v[48:49]
v_cvt_pk_bf16_f32 v70, v86, v87
v_cvt_pk_bf16_f32 v71, v88, v89
buffer_store_dwordx2 v[70:71], v43, s[84:87], s80 offen sc1
s_add_u32 s80, s80, 4096
v_pk_fma_f32 v[90:91], v[90:91], v[52:53], v[48:49]
v_pk_fma_f32 v[92:93], v[92:93], v[52:53], v[48:49]
v_cvt_pk_bf16_f32 v72, v90, v91
v_cvt_pk_bf16_f32 v73, v92, v93
buffer_store_dwordx2 v[72:73], v43, s[84:87], s80 offen sc1
s_mul_i32 s93, s92, 0x9e3779b1
s_add_u32 s93, s93, 0x7f4a7c15
s_waitcnt vmcnt(0)
s_barrier
s_cmp_lg_u32 s68, 0
s_cbranch_scc1 NOFL1
s_add_u32 s87, s93, 1
s_mov_b64 exec, 1
v_mov_b32 v36, s87
buffer_store_dword v36, off, s[4:7], s94 sc1
s_mov_b64 exec, -1
NOFL1:
s_add_u32 m0, s75, 81920
s_nop 0
buffer_load_dwordx4 v3, s[12:15], s73 offen lds
buffer_load_dwordx4 v4, s[12:15], s73 offen offset:1024 lds
buffer_load_dwordx4 v5, s[16:19], s74 offen offset:2048 lds
buffer_load_dwordx4 v5, s[20:23], s74 offen offset:3072 lds
s_add_u32 s73, s73, 262144
s_add_u32 s74, s74, 110592
s_add_u32 m0, s75, 98304
s_nop 0
buffer_load_dwordx4 v3, s[12:15], s73 offen lds
buffer_load_dwordx4 v4, s[12:15], s73 offen offset:1024 lds
buffer_load_dwordx4 v5, s[16:19], s74 offen offset:2048 lds
buffer_load_dwordx4 v5, s[20:23], s74 offen offset:3072 lds
s_add_u32 s73, s73, 262144
s_add_u32 s74, s74, 110592
s_add_u32 m0, s75, 114688
s_nop 0
buffer_load_dwordx4 v3, s[12:15], s73 offen lds
buffer_load_dwordx4 v4, s[12:15], s73 offen offset:1024 lds
buffer_load_dwordx4 v5, s[16:19], s74 offen offset:2048 lds
buffer_load_dwordx4 v5, s[20:23], s74 offen offset:3072 lds
s_add_u32 s73, s73, 262144
s_add_u32 s74, s74, 110592
s_add_u32 m0, s75, 0
s_nop 0
buffer_load_dwordx4 v3, s[12:15], s73 offen lds
buffer_load_dwordx4 v4, s[12:15], s73 offen offset:1024 lds
buffer_load_dwordx4 v5, s[16:19], s74 offen offset:2048 lds
buffer_load_dwordx4 v5, s[20:23], s74 offen offset:3072 lds
s_add_u32 s73, s73, 262144
s_add_u32 s74, s74, 110592
s_lshl2_add_u32 s81, s70, s68
s_mul_i32 s80, s81, 749568
s_add_u32 s32, s66, s80
s_addc_u32 s33, s67, 0
s_mov_b32 s34, 745472
s_mov_b32 s35, 0x20000
s_mul_i32 s80, s81, 81920
s_add_u32 s80, s80, 33558528
s_add_u32 s8, s66, s80
s_addc_u32 s9, s67, 0
s_mov_b32 s10, 81920
s_mov_b32 s11, 0x20000
s_mov_b64 s[54:55], s[46:47]
s_mov_b64 s[56:57], s[48:49]
v_bfe_u32 v52, v1, 2, 2
v_lshrrev_b32 v53, 4, v1
v_and_b32 v54, 3, v1
v_lshlrev_b32 v55, 12, v53
v_mul_u32_u24 v56, 320, v52
v_add_u32 v56, v56, v55
v_lshl_add_u32 v56, v54, 4, v56
v_xor_b32 v10, 0, v56
v_xor_b32 v11, 64, v56
v_xor_b32 v12, 128, v56
v_xor_b32 v13, 192, v56
v_lshl_add_u32 v56, v52, 7, v55
v_lshl_add_u32 v56, v54, 3, v56
v_bfe_u32 v57, v1, 3, 2
v_lshl_add_u32 v56, v57, 5, v56
v_xor_b32 v14, 0, v56
v_xor_b32 v15, 32, v56
v_xor_b32 v16, 64, v56
v_xor_b32 v17, 96, v56
s_lshl_b32 s80, s69, 19
s_add_u32 s24, s54, s80
s_addc_u32 s25, s55, 0
s_mov_b32 s26, 524288
s_mov_b32 s27, 0x20000
s_add_u32 s28, s56, s80
s_addc_u32 s29, s57, 0
s_mov_b32 s30, 557056
s_mov_b32 s31, 0x20000
s_sub_u32 s28, s28, 32768
s_subb_u32 s29, s29, 0
v_lshrrev_b32 v52, 4, v1
s_lshl_b32 s80, s68, 3
v_add_u32 v52, s80, v52
v_and_b32 v53, 15, v1
v_lshlrev_b32 v54, 8, v52
v_add_u32 v55, 0, v52
v_and_b32 v56, 15, v55
v_xor_b32 v56, v56, v53
v_lshl_add_u32 v32, v56, 4, v54
v_and_b32 v56, 7, v55
v_lshlrev_b32 v56, 1, v56
v_xor_b32 v56, v56, v53
v_lshl_add_u32 v34, v56, 4, v54
v_add_u32 v55, 4, v52
v_and_b32 v56, 15, v55
v_xor_b32 v56, v56, v53
v_lshl_add_u32 v33, v56, 4, v54
v_and_b32 v56, 7, v55
v_lshlrev_b32 v56, 1, v56
v_xor_b32 v56, v56, v53
v_lshl_add_u32 v35, v56, 4, v54
v_and_b32 v52, 15, v1
v_lshrrev_b32 v53, 4, v1
v_xor_b32 v53, v53, v52
v_lshlrev_b32 v52, 8, v52
v_lshl_add_u32 v52, v53, 4, v52
v_xor_b32 v20, 0, v52
v_xor_b32 v21, 64, v52
v_xor_b32 v22, 128, v52
v_xor_b32 v23, 192, v52
v_lshrrev_b32 v52, 2, v1
v_and_b32 v53, 7, v52
v_lshlrev_b32 v52, 8, v52
v_lshl_add_u32 v52, v53, 5, v52
v_and_b32 v53, 3, v1
v_lshl_add_u32 v52, v53, 3, v52
v_add_u32 v52, 65536, v52
v_xor_b32 v24, 0, v52
v_xor_b32 v25, 32, v52
v_xor_b32 v26, 64, v52
v_xor_b32 v27, 96, v52
v_xor_b32 v28, 128, v52
v_xor_b32 v29, 160, v52
v_xor_b32 v30, 192, v52
v_xor_b32 v31, 224, v52
v_add_u32 v44, 65536, v10
v_add_u32 v45, 65536, v11
v_add_u32 v46, 65536, v12
v_add_u32 v47, 65536, v13
v_add_u32 v48, 65536, v14
v_add_u32 v49, 65536, v15
v_add_u32 v50, 65536, v16
v_add_u32 v51, 65536, v17
v_mov_b32 v6, 156160
v_mov_b32 v52, 0
v_mov_b32 v53, 0
v_mov_b32 v54, 0
v_mov_b32 v55, 0
ds_write_b128 v6, v[52:55]
s_cmp_lg_u32 s68, 0
s_cbranch_scc1 SPUN_XN
buffer_load_dword v36, v39, s[4:7], s72 offen sc1
s_waitcnt vmcnt(0)
s_mov_b32 s87, 0
s_add_u32 s86, s93, 1
SPIN_XN:
v_subrev_u32 v36, s86, v36
v_cmp_lt_u32 vcc, 3, v36
s_add_u32 s87, s87, 1
s_cmp_eq_u64 vcc, 0
s_cbranch_scc1 SPUN_XN
s_cmp_ge_u32 s87, 0x40000
s_cbranch_scc1 SPUN_XN
s_sleep 2
buffer_load_dword v36, v39, s[4:7], s72 offen sc1
s_waitcnt vmcnt(0)
s_branch SPIN_XN
SPUN_XN:
s_barrier
s_cmp_ge_u32 s71, 27
s_cbranch_scc1 LIGHT
s_mov_b32 s72, 0
buffer_load_dwordx4 a[64:67], v2, s[8:11], s72 offen offset:0 sc1
buffer_load_dwordx4 a[68:71], v2, s[8:11], s72 offen offset:1024 sc1
buffer_load_dwordx4 a[72:75], v2, s[8:11], s72 offen offset:2048 sc1
buffer_load_dwordx4 a[76:79], v2, s[8:11], s72 offen offset:3072 sc1
s_add_u32 s72, s72, 4096
buffer_load_dwordx4 a[80:83], v2, s[8:11], s72 offen offset:0 sc1
buffer_load_dwordx4 a[84:87], v2, s[8:11], s72 offen offset:1024 sc1
buffer_load_dwordx4 a[88:91], v2, s[8:11], s72 offen offset:2048 sc1
buffer_load_dwordx4 a[92:95], v2, s[8:11], s72 offen offset:3072 sc1
s_add_u32 s72, s72, 4096
ds_read_b64_tr_b16 a[192:193], v44 offset:0
ds_read_b64_tr_b16 a[194:195], v44 offset:1024
ds_read_b64_tr_b16 a[196:197], v44 offset:8
ds_read_b64_tr_b16 a[198:199], v44 offset:1032
ds_read_b64_tr_b16 a[200:201], v45 offset:0
ds_read_b64_tr_b16 a[202:203], v45 offset:1024
ds_read_b64_tr_b16 a[204:205], v45 offset:8
ds_read_b64_tr_b16 a[206:207], v45 offset:1032
ds_read_b64_tr_b16 a[208:209], v46 offset:0
ds_read_b64_tr_b16 a[210:211], v46 offset:1024
ds_read_b64_tr_b16 a[212:213], v46 offset:8
ds_read_b64_tr_b16 a[214:215], v46 offset:1032
s_waitcnt vmcnt(4) lgkmcnt(0)
v_mfma_f32_16x16x32_bf16 v[64:67], a[192:195], a[64:67], 0
ds_read_b64_tr_b16 a[216:217], v47 offset:0
v_mfma_f32_16x16x32_bf16 v[68:71], a[192:195], a[68:71], 0
buffer_load_dwordx4 a[96:99], v2, s[8:11], s72 offen offset:0 sc1
v_mfma_f32_16x16x32_bf16 v[72:75], a[192:195], a[72:75], 0
ds_read_b64_tr_b16 a[218:219], v47 offset:1024
v_mfma_f32_16x16x32_bf16 v[76:79], a[192:195], a[76:79], 0
v_mfma_f32_16x16x32_bf16 v[140:143], a[196:199], a[76:79], 0
ds_read_b64_tr_b16 a[220:221], v47 offset:8
v_mfma_f32_16x16x32_bf16 v[136:139], a[196:199], a[72:75], 0
v_mfma_f32_16x16x32_bf16 v[132:135], a[196:199], a[68:71], 0
ds_read_b64_tr_b16 a[222:223], v47 offset:1032
v_mfma_f32_16x16x32_bf16 v[128:131], a[196:199], a[64:67], 0
buffer_load_dwordx4 a[100:103], v2, s[8:11], s72 offen offset:1024 sc1
v_mfma_f32_16x16x32_bf16 v[80:83], a[200:203], a[64:67], 0
ds_read_b64_tr_b16 a[192:193], v48 offset:3072
v_mfma_f32_16x16x32_bf16 v[84:87], a[200:203], a[68:71], 0
v_mfma_f32_16x16x32_bf16 v[88:91], a[200:203], a[72:75], 0
ds_read_b64_tr_b16 a[194:195], v48 offset:3584
v_mfma_f32_16x16x32_bf16 v[92:95], a[200:203], a[76:79], 0
v_mfma_f32_16x16x32_bf16 v[156:159], a[204:207], a[76:79], 0
ds_read_b64_tr_b16 a[196:197], v48 offset:2048
v_mfma_f32_16x16x32_bf16 v[152:155], a[204:207], a[72:75], 0
buffer_load_dwordx4 a[104:107], v2, s[8:11], s72 offen offset:2048 sc1
v_mfma_f32_16x16x32_bf16 v[148:151], a[204:207], a[68:71], 0
ds_read_b64_tr_b16 a[198:199], v48 offset:2560
v_mfma_f32_16x16x32_bf16 v[144:147], a[204:207], a[64:67], 0
v_mfma_f32_16x16x32_bf16 v[96:99], a[208:211], a[64:67], 0
ds_read_b64_tr_b16 a[200:201], v49 offset:3072
v_mfma_f32_16x16x32_bf16 v[100:103], a[208:211], a[68:71], 0
v_mfma_f32_16x16x32_bf16 v[104:107], a[208:211], a[72:75], 0
ds_read_b64_tr_b16 a[202:203], v49 offset:3584
v_mfma_f32_16x16x32_bf16 v[108:111], a[208:211], a[76:79], 0
buffer_load_dwordx4 a[108:111], v2, s[8:11], s72 offen offset:3072 sc1
v_mfma_f32_16x16x32_bf16 v[172:175], a[212:215], a[76:79], 0
s_add_u32 s72, s72, 4096
ds_read_b64_tr_b16 a[204:205], v49 offset:2048
v_mfma_f32_16x16x32_bf16 v[168:171], a[212:215], a[72:75], 0
v_mfma_f32_16x16x32_bf16 v[164:167], a[212:215], a[68:71], 0
ds_read_b64_tr_b16 a[206:207], v49 offset:2560
v_mfma_f32_16x16x32_bf16 v[160:163], a[212:215], a[64:67], 0
s_waitcnt lgkmcnt(4)
v_mfma_f32_16x16x32_bf16 v[112:115], a[216:219], a[64:67], 0
ds_read_b64_tr_b16 a[208:209], v50 offset:3072
v_mfma_f32_16x16x32_bf16 v[116:119], a[216:219], a[68:71], 0
buffer_load_dwordx4 a[112:115], v2, s[8:11], s72 offen offset:0 sc1
v_mfma_f32_16x16x32_bf16 v[120:123], a[216:219], a[72:75], 0
ds_read_b64_tr_b16 a[210:211], v50 offset:3584
v_mfma_f32_16x16x32_bf16 v[124:127], a[216:219], a[76:79], 0
v_mfma_f32_16x16x32_bf16 v[188:191], a[220:223], a[76:79], 0
ds_read_b64_tr_b16 a[212:213], v50 offset:2048
v_mfma_f32_16x16x32_bf16 v[184:187], a[220:223], a[72:75], 0
v_mfma_f32_16x16x32_bf16 v[180:183], a[220:223], a[68:71], 0
ds_read_b64_tr_b16 a[214:215], v50 offset:2560
v_mfma_f32_16x16x32_bf16 v[176:179], a[220:223], a[64:67], 0
buffer_load_dwordx4 a[116:119], v2, s[8:11], s72 offen offset:1024 sc1
v_mfma_f32_16x16x32_bf16 a[0:3], a[192:195], a[64:67], 0
ds_read_b64_tr_b16 a[216:217], v51 offset:3072
v_mfma_f32_16x16x32_bf16 a[4:7], a[192:195], a[68:71], 0
v_mfma_f32_16x16x32_bf16 a[8:11], a[192:195], a[72:75], 0
ds_read_b64_tr_b16 a[218:219], v51 offset:3584
v_mfma_f32_16x16x32_bf16 a[12:15], a[192:195], a[76:79], 0
v_mfma_f32_16x16x32_bf16 v[204:207], a[196:199], a[76:79], 0
ds_read_b64_tr_b16 a[220:221], v51 offset:2048
v_mfma_f32_16x16x32_bf16 v[200:203], a[196:199], a[72:75], 0
buffer_load_dwordx4 a[120:123], v2, s[8:11], s72 offen offset:2048 sc1
v_mfma_f32_16x16x32_bf16 v[196:199], a[196:199], a[68:71], 0
s_waitcnt lgkmcnt(4)
ds_read_b64_tr_b16 a[222:223], v51 offset:2560
v_mfma_f32_16x16x32_bf16 v[192:195], a[196:199], a[64:67], 0
s_waitcnt vmcnt(7)
s_barrier
v_mfma_f32_16x16x32_bf16 a[16:19], a[200:203], a[64:67], 0
ds_read_b64_tr_b16 a[192:193], v44 offset:16384
v_mfma_f32_16x16x32_bf16 a[20:23], a[200:203], a[68:71], 0
v_mfma_f32_16x16x32_bf16 a[24:27], a[200:203], a[72:75], 0
ds_read_b64_tr_b16 a[194:195], v44 offset:17408
v_mfma_f32_16x16x32_bf16 a[28:31], a[200:203], a[76:79], 0
buffer_load_dwordx4 a[124:127], v2, s[8:11], s72 offen offset:3072 sc1
v_mfma_f32_16x16x32_bf16 v[220:223], a[204:207], a[76:79], 0
s_add_u32 s72, s72, 4096
ds_read_b64_tr_b16 a[196:197], v44 offset:16392
v_mfma_f32_16x16x32_bf16 v[216:219], a[204:207], a[72:75], 0
s_mov_b32 s80, 1048576
v_mfma_f32_16x16x32_bf16 v[212:215], a[204:207], a[68:71], 0
ds_read_b64_tr_b16 a[198:199], v44 offset:17416
v_mfma_f32_16x16x32_bf16 v[208:211], a[204:207], a[64:67], 0
v_mfma_f32_16x16x32_bf16 a[32:35], a[208:211], a[64:67], 0
ds_read_b64_tr_b16 a[200:201], v45 offset:16384
v_mfma_f32_16x16x32_bf16 a[36:39], a[208:211], a[68:71], 0
buffer_load_dword v18, v63, s[12:15], s80 offen
v_mfma_f32_16x16x32_bf16 a[40:43], a[208:211], a[72:75], 0
s_mov_b32 s80, 442368
ds_read_b64_tr_b16 a[202:203], v45 offset:17408
v_mfma_f32_16x16x32_bf16 a[44:47], a[208:211], a[76:79], 0
s_waitcnt lgkmcnt(4)
v_mfma_f32_16x16x32_bf16 v[236:239], a[212:215], a[76:79], 0
ds_read_b64_tr_b16 a[204:205], v45 offset:16392
v_mfma_f32_16x16x32_bf16 v[232:235], a[212:215], a[72:75], 0
v_mfma_f32_16x16x32_bf16 v[228:231], a[212:215], a[68:71], 0
ds_read_b64_tr_b16 a[206:207], v45 offset:17416
v_mfma_f32_16x16x32_bf16 v[224:227], a[212:215], a[64:67], 0
buffer_load_dword v18, v62, s[16:19], s80 offen offset:2048
v_mfma_f32_16x16x32_bf16 a[48:51], a[216:219], a[64:67], 0
ds_read_b64_tr_b16 a[208:209], v46 offset:16384
v_mfma_f32_16x16x32_bf16 a[52:55], a[216:219], a[68:71], 0
v_mfma_f32_16x16x32_bf16 a[56:59], a[216:219], a[72:75], 0
ds_read_b64_tr_b16 a[210:211], v46 offset:17408
v_mfma_f32_16x16x32_bf16 a[60:63], a[216:219], a[76:79], 0
v_mfma_f32_16x16x32_bf16 v[252:255], a[220:223], a[76:79], 0
ds_read_b64_tr_b16 a[212:213], v46 offset:16392
v_mfma_f32_16x16x32_bf16 v[248:251], a[220:223], a[72:75], 0
buffer_load_dword v18, v62, s[20:23], s80 offen offset:3072
v_mfma_f32_16x16x32_bf16 v[244:247], a[220:223], a[68:71], 0
ds_read_b64_tr_b16 a[214:215], v46 offset:17416
v_mfma_f32_16x16x32_bf16 v[240:243], a[220:223], a[64:67], 0
v_mfma_f32_16x16x32_bf16 v[64:67], a[192:195], a[80:83], v[64:67]
ds_read_b64_tr_b16 a[216:217], v47 offset:16384
v_mfma_f32_16x16x32_bf16 v[68:71], a[192:195], a[84:87], v[68:71]
v_mfma_f32_16x16x32_bf16 v[72:75], a[192:195], a[88:91], v[72:75]
s_waitcnt lgkmcnt(4)
ds_read_b64_tr_b16 a[218:219], v47 offset:17408
v_mfma_f32_16x16x32_bf16 v[76:79], a[192:195], a[92:95], v[76:79]
buffer_load_dwordx4 a[128:131], v2, s[8:11], s72 offen offset:0 sc1
v_mfma_f32_16x16x32_bf16 v[140:143], a[196:199], a[92:95], v[140:143]
ds_read_b64_tr_b16 a[220:221], v47 offset:16392
v_mfma_f32_16x16x32_bf16 v[136:139], a[196:199], a[88:91], v[136:139]
v_mfma_f32_16x16x32_bf16 v[132:135], a[196:199], a[84:87], v[132:135]
ds_read_b64_tr_b16 a[222:223], v47 offset:17416
v_mfma_f32_16x16x32_bf16 v[128:131], a[196:199], a[80:83], v[128:131]
v_mfma_f32_16x16x32_bf16 v[80:83], a[200:203], a[80:83], v[80:83]
ds_read_b64_tr_b16 a[192:193], v48 offset:19456
v_mfma_f32_16x16x32_bf16 v[84:87], a[200:203], a[84:87], v[84:87]
buffer_load_dwordx4 a[132:135], v2, s[8:11], s72 offen offset:1024 sc1
v_mfma_f32_16x16x32_bf16 v[88:91], a[200:203], a[88:91], v[88:91]
ds_read_b64_tr_b16 a[194:195], v48 offset:19968
v_mfma_f32_16x16x32_bf16 v[92:95], a[200:203], a[92:95], v[92:95]
v_mfma_f32_16x16x32_bf16 v[156:159], a[204:207], a[92:95], v[156:159]
ds_read_b64_tr_b16 a[196:197], v48 offset:18432
v_mfma_f32_16x16x32_bf16 v[152:155], a[204:207], a[88:91], v[152:155]
v_mfma_f32_16x16x32_bf16 v[148:151], a[204:207], a[84:87], v[148:151]
s_waitcnt lgkmcnt(4)
ds_read_b64_tr_b16 a[198:199], v48 offset:18944
v_mfma_f32_16x16x32_bf16 v[144:147], a[204:207], a[80:83], v[144:147]
buffer_load_dwordx4 a[136:139], v2, s[8:11], s72 offen offset:2048 sc1
v_mfma_f32_16x16x32_bf16 v[96:99], a[208:211], a[80:83], v[96:99]
ds_read_b64_tr_b16 a[200:201], v49 offset:19456
v_mfma_f32_16x16x32_bf16 v[100:103], a[208:211], a[84:87], v[100:103]
v_mfma_f32_16x16x32_bf16 v[104:107], a[208:211], a[88:91], v[104:107]
ds_read_b64_tr_b16 a[202:203], v49 offset:19968
v_mfma_f32_16x16x32_bf16 v[108:111], a[208:211], a[92:95], v[108:111]
v_mfma_f32_16x16x32_bf16 v[172:175], a[212:215], a[92:95], v[172:175]
ds_read_b64_tr_b16 a[204:205], v49 offset:18432
v_mfma_f32_16x16x32_bf16 v[168:171], a[212:215], a[88:91], v[168:171]
buffer_load_dwordx4 a[140:143], v2, s[8:11], s72 offen offset:3072 sc1
v_mfma_f32_16x16x32_bf16 v[164:167], a[212:215], a[84:87], v[164:167]
s_add_u32 s72, s72, 4096
ds_read_b64_tr_b16 a[206:207], v49 offset:18944
v_mfma_f32_16x16x32_bf16 v[160:163], a[212:215], a[80:83], v[160:163]
s_add_u32 m0, s75, 16384
v_mfma_f32_16x16x32_bf16 v[112:115], a[216:219], a[80:83], v[112:115]
ds_read_b64_tr_b16 a[208:209], v50 offset:19456
v_mfma_f32_16x16x32_bf16 v[116:119], a[216:219], a[84:87], v[116:119]
v_mfma_f32_16x16x32_bf16 v[120:123], a[216:219], a[88:91], v[120:123]
s_waitcnt lgkmcnt(4)
ds_read_b64_tr_b16 a[210:211], v50 offset:19968
v_mfma_f32_16x16x32_bf16 v[124:127], a[216:219], a[92:95], v[124:127]
buffer_load_dwordx4 v3, s[12:15], s73 offen lds
v_mfma_f32_16x16x32_bf16 v[188:191], a[220:223], a[92:95], v[188:191]
ds_read_b64_tr_b16 a[212:213], v50 offset:18432
v_mfma_f32_16x16x32_bf16 v[184:187], a[220:223], a[88:91], v[184:187]
v_mfma_f32_16x16x32_bf16 v[180:183], a[220:223], a[84:87], v[180:183]
ds_read_b64_tr_b16 a[214:215], v50 offset:18944
v_mfma_f32_16x16x32_bf16 v[176:179], a[220:223], a[80:83], v[176:179]
v_mfma_f32_16x16x32_bf16 a[0:3], a[192:195], a[80:83], a[0:3]
ds_read_b64_tr_b16 a[216:217], v51 offset:19456
v_mfma_f32_16x16x32_bf16 a[4:7], a[192:195], a[84:87], a[4:7]
buffer_load_dwordx4 v4, s[12:15], s73 offen offset:1024 lds
v_mfma_f32_16x16x32_bf16 a[8:11], a[192:195], a[88:91], a[8:11]
ds_read_b64_tr_b16 a[218:219], v51 offset:19968
v_mfma_f32_16x16x32_bf16 a[12:15], a[192:195], a[92:95], a[12:15]
v_mfma_f32_16x16x32_bf16 v[204:207], a[196:199], a[92:95], v[204:207]
ds_read_b64_tr_b16 a[220:221], v51 offset:18432
v_mfma_f32_16x16x32_bf16 v[200:203], a[196:199], a[88:91], v[200:203]
v_mfma_f32_16x16x32_bf16 v[196:199], a[196:199], a[84:87], v[196:199]
s_waitcnt lgkmcnt(4)
ds_read_b64_tr_b16 a[222:223], v51 offset:18944
v_mfma_f32_16x16x32_bf16 v[192:195], a[196:199], a[80:83], v[192:195]
s_waitcnt vmcnt(9)
s_barrier
v_mfma_f32_16x16x32_bf16 a[16:19], a[200:203], a[80:83], a[16:19]
ds_read_b64_tr_b16 a[192:193], v44 offset:32768
v_mfma_f32_16x16x32_bf16 a[20:23], a[200:203], a[84:87], a[20:23]
buffer_load_dwordx4 v5, s[16:19], s74 offen offset:2048 lds
v_mfma_f32_16x16x32_bf16 a[24:27], a[200:203], a[88:91], a[24:27]
ds_read_b64_tr_b16 a[194:195], v44 offset:33792
v_mfma_f32_16x16x32_bf16 a[28:31], a[200:203], a[92:95], a[28:31]
v_mfma_f32_16x16x32_bf16 v[220:223], a[204:207], a[92:95], v[220:223]
ds_read_b64_tr_b16 a[196:197], v44 offset:49152
v_mfma_f32_16x16x32_bf16 v[216:219], a[204:207], a[88:91], v[216:219]
v_mfma_f32_16x16x32_bf16 v[212:215], a[204:207], a[84:87], v[212:215]
ds_read_b64_tr_b16 a[198:199], v44 offset:50176
v_mfma_f32_16x16x32_bf16 v[208:211], a[204:207], a[80:83], v[208:211]
buffer_load_dwordx4 v5, s[20:23], s74 offen offset:3072 lds
v_mfma_f32_16x16x32_bf16 a[32:35], a[208:211], a[80:83], a[32:35]
s_add_u32 s73, s73, 262144
s_add_u32 s74, s74, 110592
ds_read_b64_tr_b16 a[200:201], v44 offset:32776
v_mfma_f32_16x16x32_bf16 a[36:39], a[208:211], a[84:87], a[36:39]
s_mov_b32 s80, 2097152
v_mfma_f32_16x16x32_bf16 a[40:43], a[208:211], a[88:91], a[40:43]
ds_read_b64_tr_b16 a[202:203], v44 offset:33800
v_mfma_f32_16x16x32_bf16 a[44:47], a[208:211], a[92:95], a[44:47]
s_waitcnt lgkmcnt(4)
v_mfma_f32_16x16x32_bf16 v[236:239], a[212:215], a[92:95], v[236:239]
ds_read_b64_tr_b16 a[204:205], v44 offset:49160
v_mfma_f32_16x16x32_bf16 v[232:235], a[212:215], a[88:91], v[232:235]
buffer_load_dword v18, v63, s[12:15], s80 offen
v_mfma_f32_16x16x32_bf16 v[228:231], a[212:215], a[84:87], v[228:231]
s_mov_b32 s80, 884736
ds_read_b64_tr_b16 a[206:207], v44 offset:50184
v_mfma_f32_16x16x32_bf16 v[224:227], a[212:215], a[80:83], v[224:227]
v_mfma_f32_16x16x32_bf16 a[48:51], a[216:219], a[80:83], a[48:51]
ds_read_b64_tr_b16 a[208:209], v45 offset:32768
v_mfma_f32_16x16x32_bf16 a[52:55], a[216:219], a[84:87], a[52:55]
v_mfma_f32_16x16x32_bf16 a[56:59], a[216:219], a[88:91], a[56:59]
ds_read_b64_tr_b16 a[210:211], v45 offset:33792
v_mfma_f32_16x16x32_bf16 a[60:63], a[216:219], a[92:95], a[60:63]
buffer_load_dword v18, v62, s[16:19], s80 offen offset:2048
v_mfma_f32_16x16x32_bf16 v[252:255], a[220:223], a[92:95], v[252:255]
ds_read_b64_tr_b16 a[212:213], v45 offset:49152
v_mfma_f32_16x16x32_bf16 v[248:251], a[220:223], a[88:91], v[248:251]
v_mfma_f32_16x16x32_bf16 v[244:247], a[220:223], a[84:87], v[244:247]
ds_read_b64_tr_b16 a[214:215], v45 offset:50176
v_mfma_f32_16x16x32_bf16 v[240:243], a[220:223], a[80:83], v[240:243]
v_mfma_f32_16x16x32_bf16 v[64:67], a[192:195], a[96:99], v[64:67]
s_waitcnt lgkmcnt(4)
ds_read_b64_tr_b16 a[216:217], v45 offset:32776
v_mfma_f32_16x16x32_bf16 v[64:67], a[196:199], a[112:115], v[64:67]
buffer_load_dword v18, v62, s[20:23], s80 offen offset:3072
v_mfma_f32_16x16x32_bf16 v[68:71], a[196:199], a[116:119], v[68:71]
ds_read_b64_tr_b16 a[218:219], v45 offset:33800
v_mfma_f32_16x16x32_bf16 v[68:71], a[192:195], a[100:103], v[68:71]
v_mfma_f32_16x16x32_bf16 v[72:75], a[192:195], a[104:107], v[72:75]
ds_read_b64_tr_b16 a[220:221], v45 offset:49160
v_mfma_f32_16x16x32_bf16 v[72:75], a[196:199], a[120:123], v[72:75]
v_mfma_f32_16x16x32_bf16 v[76:79], a[196:199], a[124:127], v[76:79]
ds_read_b64_tr_b16 a[222:223], v45 offset:50184
v_mfma_f32_16x16x32_bf16 v[76:79], a[192:195], a[108:111], v[76:79]
buffer_load_dwordx4 a[144:147], v2, s[8:11], s72 offen offset:0 sc1
v_mfma_f32_16x16x32_bf16 v[140:143], a[204:207], a[124:127], v[140:143]
ds_read_b64_tr_b16 a[192:193], v46 offset:32768
v_mfma_f32_16x16x32_bf16 v[140:143], a[200:203], a[108:111], v[140:143]
v_mfma_f32_16x16x32_bf16 v[136:139], a[200:203], a[104:107], v[136:139]
ds_read_b64_tr_b16 a[194:195], v46 offset:33792
v_mfma_f32_16x16x32_bf16 v[136:139], a[204:207], a[120:123], v[136:139]
v_mfma_f32_16x16x32_bf16 v[132:135], a[204:207], a[116:119], v[132:135]
ds_read_b64_tr_b16 a[196:197], v46 offset:49152
v_mfma_f32_16x16x32_bf16 v[132:135], a[200:203], a[100:103], v[132:135]
buffer_load_dwordx4 a[148:151], v2, s[8:11], s72 offen offset:1024 sc1
v_mfma_f32_16x16x32_bf16 v[128:131], a[200:203], a[96:99], v[128:131]
ds_read_b64_tr_b16 a[198:199], v46 offset:50176
v_mfma_f32_16x16x32_bf16 v[128:131], a[204:207], a[112:115], v[128:131]
s_waitcnt lgkmcnt(4)
v_mfma_f32_16x16x32_bf16 v[80:83], a[208:211], a[96:99], v[80:83]
ds_read_b64_tr_b16 a[200:201], v46 offset:32776
v_mfma_f32_16x16x32_bf16 v[80:83], a[212:215], a[112:115], v[80:83]
v_mfma_f32_16x16x32_bf16 v[84:87], a[212:215], a[116:119], v[84:87]
ds_read_b64_tr_b16 a[202:203], v46 offset:33800
v_mfma_f32_16x16x32_bf16 v[84:87], a[208:211], a[100:103], v[84:87]
buffer_load_dwordx4 a[152:155], v2, s[8:11], s72 offen offset:2048 sc1
v_mfma_f32_16x16x32_bf16 v[88:91], a[208:211], a[104:107], v[88:91]
ds_read_b64_tr_b16 a[204:205], v46 offset:49160
v_mfma_f32_16x16x32_bf16 v[88:91], a[212:215], a[120:123], v[88:91]
v_mfma_f32_16x16x32_bf16 v[92:95], a[212:215], a[124:127], v[92:95]
ds_read_b64_tr_b16 a[206:207], v46 offset:50184
v_mfma_f32_16x16x32_bf16 v[92:95], a[208:211], a[108:111], v[92:95]
v_mfma_f32_16x16x32_bf16 v[156:159], a[220:223], a[124:127], v[156:159]
ds_read_b64_tr_b16 a[208:209], v47 offset:32768
v_mfma_f32_16x16x32_bf16 v[156:159], a[216:219], a[108:111], v[156:159]
buffer_load_dwordx4 a[156:159], v2, s[8:11], s72 offen offset:3072 sc1
v_mfma_f32_16x16x32_bf16 v[152:155], a[216:219], a[104:107], v[152:155]
s_add_u32 s72, s72, 4096
ds_read_b64_tr_b16 a[210:211], v47 offset:33792
v_mfma_f32_16x16x32_bf16 v[152:155], a[220:223], a[120:123], v[152:155]
s_add_u32 m0, s75, 32768
v_mfma_f32_16x16x32_bf16 v[148:151], a[220:223], a[116:119], v[148:151]
ds_read_b64_tr_b16 a[212:213], v47 offset:49152
v_mfma_f32_16x16x32_bf16 v[148:151], a[216:219], a[100:103], v[148:151]
v_mfma_f32_16x16x32_bf16 v[144:147], a[216:219], a[96:99], v[144:147]
s_waitcnt lgkmcnt(4)
ds_read_b64_tr_b16 a[214:215], v47 offset:50176
v_mfma_f32_16x16x32_bf16 v[144:147], a[220:223], a[112:115], v[144:147]
buffer_load_dwordx4 v3, s[12:15], s73 offen lds
v_mfma_f32_16x16x32_bf16 v[96:99], a[192:195], a[96:99], v[96:99]
ds_read_b64_tr_b16 a[216:217], v47 offset:32776
v_mfma_f32_16x16x32_bf16 v[96:99], a[196:199], a[112:115], v[96:99]
v_mfma_f32_16x16x32_bf16 v[100:103], a[196:199], a[116:119], v[100:103]
ds_read_b64_tr_b16 a[218:219], v47 offset:33800
v_mfma_f32_16x16x32_bf16 v[100:103], a[192:195], a[100:103], v[100:103]
v_mfma_f32_16x16x32_bf16 v[104:107], a[192:195], a[104:107], v[104:107]
ds_read_b64_tr_b16 a[220:221], v47 offset:49160
v_mfma_f32_16x16x32_bf16 v[104:107], a[196:199], a[120:123], v[104:107]
buffer_load_dwordx4 v4, s[12:15], s73 offen offset:1024 lds
v_mfma_f32_16x16x32_bf16 v[108:111], a[196:199], a[124:127], v[108:111]
ds_read_b64_tr_b16 a[222:223], v47 offset:50184
v_mfma_f32_16x16x32_bf16 v[108:111], a[192:195], a[108:111], v[108:111]
s_waitcnt lgkmcnt(4)
v_mfma_f32_16x16x32_bf16 v[172:175], a[204:207], a[124:127], v[172:175]
ds_read_b64_tr_b16 a[192:193], v48 offset:35840
v_mfma_f32_16x16x32_bf16 v[172:175], a[200:203], a[108:111], v[172:175]
v_mfma_f32_16x16x32_bf16 v[168:171], a[200:203], a[104:107], v[168:171]
ds_read_b64_tr_b16 a[194:195], v48 offset:36352
v_mfma_f32_16x16x32_bf16 v[168:171], a[204:207], a[120:123], v[168:171]
buffer_load_dwordx4 v5, s[16:19], s74 offen offset:2048 lds
v_mfma_f32_16x16x32_bf16 v[164:167], a[204:207], a[116:119], v[164:167]
ds_read_b64_tr_b16 a[196:197], v48 offset:52224
v_mfma_f32_16x16x32_bf16 v[164:167], a[200:203], a[100:103], v[164:167]
v_mfma_f32_16x16x32_bf16 v[160:163], a[200:203], a[96:99], v[160:163]
ds_read_b64_tr_b16 a[198:199], v48 offset:52736
v_mfma_f32_16x16x32_bf16 v[160:163], a[204:207], a[112:115], v[160:163]
v_mfma_f32_16x16x32_bf16 v[112:115], a[208:211], a[96:99], v[112:115]
ds_read_b64_tr_b16 a[200:201], v48 offset:34816
v_mfma_f32_16x16x32_bf16 v[112:115], a[212:215], a[112:115], v[112:115]
buffer_load_dwordx4 v5, s[20:23], s74 offen offset:3072 lds
v_mfma_f32_16x16x32_bf16 v[116:119], a[212:215], a[116:119], v[116:119]
s_add_u32 s73, s73, 262144
s_add_u32 s74, s74, 110592
ds_read_b64_tr_b16 a[202:203], v48 offset:35328
v_mfma_f32_16x16x32_bf16 v[116:119], a[208:211], a[100:103], v[116:119]
v_mfma_f32_16x16x32_bf16 v[120:123], a[208:211], a[104:107], v[120:123]
ds_read_b64_tr_b16 a[204:205], v48 offset:51200
v_mfma_f32_16x16x32_bf16 v[120:123], a[212:215], a[120:123], v[120:123]
v_mfma_f32_16x16x32_bf16 v[124:127], a[212:215], a[124:127], v[124:127]
s_waitcnt lgkmcnt(4)
ds_read_b64_tr_b16 a[206:207], v48 offset:51712
v_mfma_f32_16x16x32_bf16 v[124:127], a[208:211], a[108:111], v[124:127]
buffer_load_dwordx4 a[160:163], v2, s[8:11], s72 offen offset:0 sc1
v_mfma_f32_16x16x32_bf16 v[188:191], a[220:223], a[124:127], v[188:191]
ds_read_b64_tr_b16 a[208:209], v49 offset:35840
v_mfma_f32_16x16x32_bf16 v[188:191], a[216:219], a[108:111], v[188:191]
v_mfma_f32_16x16x32_bf16 v[184:187], a[216:219], a[104:107], v[184:187]
ds_read_b64_tr_b16 a[210:211], v49 offset:36352
v_mfma_f32_16x16x32_bf16 v[184:187], a[220:223], a[120:123], v[184:187]
v_mfma_f32_16x16x32_bf16 v[180:183], a[220:223], a[116:119], v[180:183]
ds_read_b64_tr_b16 a[212:213], v49 offset:52224
v_mfma_f32_16x16x32_bf16 v[180:183], a[216:219], a[100:103], v[180:183]
buffer_load_dwordx4 a[164:167], v2, s[8:11], s72 offen offset:1024 sc1
v_mfma_f32_16x16x32_bf16 v[176:179], a[216:219], a[96:99], v[176:179]
ds_read_b64_tr_b16 a[214:215], v49 offset:52736
v_mfma_f32_16x16x32_bf16 v[176:179], a[220:223], a[112:115], v[176:179]
v_mfma_f32_16x16x32_bf16 a[0:3], a[192:195], a[96:99], a[0:3]
s_waitcnt lgkmcnt(4)
ds_read_b64_tr_b16 a[216:217], v49 offset:34816
v_mfma_f32_16x16x32_bf16 a[0:3], a[196:199], a[112:115], a[0:3]
v_mfma_f32_16x16x32_bf16 a[4:7], a[196:199], a[116:119], a[4:7]
ds_read_b64_tr_b16 a[218:219], v49 offset:35328
v_mfma_f32_16x16x32_bf16 a[4:7], a[192:195], a[100:103], a[4:7]
buffer_load_dwordx4 a[168:171], v2, s[8:11], s72 offen offset:2048 sc1
v_mfma_f32_16x16x32_bf16 a[8:11], a[192:195], a[104:107], a[8:11]
ds_read_b64_tr_b16 a[220:221], v49 offset:51200
v_mfma_f32_16x16x32_bf16 a[8:11], a[196:199], a[120:123], a[8:11]
v_mfma_f32_16x16x32_bf16 a[12:15], a[196:199], a[124:127], a[12:15]
ds_read_b64_tr_b16 a[222:223], v49 offset:51712
v_mfma_f32_16x16x32_bf16 a[12:15], a[192:195], a[108:111], a[12:15]
v_mfma_f32_16x16x32_bf16 v[204:207], a[204:207], a[124:127], v[204:207]
ds_read_b64_tr_b16 a[192:193], v50 offset:35840
v_mfma_f32_16x16x32_bf16 v[204:207], a[200:203], a[108:111], v[204:207]
buffer_load_dwordx4 a[172:175], v2, s[8:11], s72 offen offset:3072 sc1
v_mfma_f32_16x16x32_bf16 v[200:203], a[200:203], a[104:107], v[200:203]
s_add_u32 s72, s72, 4096
ds_read_b64_tr_b16 a[194:195], v50 offset:36352
v_mfma_f32_16x16x32_bf16 v[200:203], a[204:207], a[120:123], v[200:203]
s_add_u32 m0, s75, 49152
v_mfma_f32_16x16x32_bf16 v[196:199], a[204:207], a[116:119], v[196:199]
ds_read_b64_tr_b16 a[196:197], v50 offset:52224
v_mfma_f32_16x16x32_bf16 v[196:199], a[200:203], a[100:103], v[196:199]
v_mfma_f32_16x16x32_bf16 v[192:195], a[200:203], a[96:99], v[192:195]
s_waitcnt lgkmcnt(4)
ds_read_b64_tr_b16 a[198:199], v50 offset:52736
v_mfma_f32_16x16x32_bf16 v[192:195], a[204:207], a[112:115], v[192:195]
buffer_load_dwordx4 v3, s[12:15], s73 offen lds
v_mfma_f32_16x16x32_bf16 a[16:19], a[208:211], a[96:99], a[16:19]
ds_read_b64_tr_b16 a[200:201], v50 offset:34816
v_mfma_f32_16x16x32_bf16 a[16:19], a[212:215], a[112:115], a[16:19]
v_mfma_f32_16x16x32_bf16 a[20:23], a[212:215], a[116:119], a[20:23]
ds_read_b64_tr_b16 a[202:203], v50 offset:35328
v_mfma_f32_16x16x32_bf16 a[20:23], a[208:211], a[100:103], a[20:23]
v_mfma_f32_16x16x32_bf16 a[24:27], a[208:211], a[104:107], a[24:27]
ds_read_b64_tr_b16 a[204:205], v50 offset:51200
v_mfma_f32_16x16x32_bf16 a[24:27], a[212:215], a[120:123], a[24:27]
buffer_load_dwordx4 v4, s[12:15], s73 offen offset:1024 lds
v_mfma_f32_16x16x32_bf16 a[28:31], a[212:215], a[124:127], a[28:31]
ds_read_b64_tr_b16 a[206:207], v50 offset:51712
v_mfma_f32_16x16x32_bf16 a[28:31], a[208:211], a[108:111], a[28:31]
s_waitcnt lgkmcnt(4)
v_mfma_f32_16x16x32_bf16 v[220:223], a[220:223], a[124:127], v[220:223]
ds_read_b64_tr_b16 a[208:209], v51 offset:35840
v_mfma_f32_16x16x32_bf16 v[220:223], a[216:219], a[108:111], v[220:223]
v_mfma_f32_16x16x32_bf16 v[216:219], a[216:219], a[104:107], v[216:219]
ds_read_b64_tr_b16 a[210:211], v51 offset:36352
v_mfma_f32_16x16x32_bf16 v[216:219], a[220:223], a[120:123], v[216:219]
buffer_load_dwordx4 v5, s[16:19], s74 offen offset:2048 lds
v_mfma_f32_16x16x32_bf16 v[212:215], a[220:223], a[116:119], v[212:215]
ds_read_b64_tr_b16 a[212:213], v51 offset:52224
v_mfma_f32_16x16x32_bf16 v[212:215], a[216:219], a[100:103], v[212:215]
v_mfma_f32_16x16x32_bf16 v[208:211], a[216:219], a[96:99], v[208:211]
ds_read_b64_tr_b16 a[214:215], v51 offset:52736
v_mfma_f32_16x16x32_bf16 v[208:211], a[220:223], a[112:115], v[208:211]
v_mfma_f32_16x16x32_bf16 a[32:35], a[192:195], a[96:99], a[32:35]
ds_read_b64_tr_b16 a[216:217], v51 offset:34816
v_mfma_f32_16x16x32_bf16 a[32:35], a[196:199], a[112:115], a[32:35]
buffer_load_dwordx4 v5, s[20:23], s74 offen offset:3072 lds
v_mfma_f32_16x16x32_bf16 a[36:39], a[196:199], a[116:119], a[36:39]
s_add_u32 s73, s73, 262144
s_add_u32 s74, s74, 110592
ds_read_b64_tr_b16 a[218:219], v51 offset:35328
v_mfma_f32_16x16x32_bf16 a[36:39], a[192:195], a[100:103], a[36:39]
v_mfma_f32_16x16x32_bf16 a[40:43], a[192:195], a[104:107], a[40:43]
ds_read_b64_tr_b16 a[220:221], v51 offset:51200
v_mfma_f32_16x16x32_bf16 a[40:43], a[196:199], a[120:123], a[40:43]
v_mfma_f32_16x16x32_bf16 a[44:47], a[196:199], a[124:127], a[44:47]
s_waitcnt lgkmcnt(4)
ds_read_b64_tr_b16 a[222:223], v51 offset:51712
v_mfma_f32_16x16x32_bf16 a[44:47], a[192:195], a[108:111], a[44:47]
s_waitcnt vmcnt(12)
s_barrier
v_mfma_f32_16x16x32_bf16 v[236:239], a[204:207], a[124:127], v[236:239]
ds_read_b64_tr_b16 a[192:193], v10 offset:0
v_mfma_f32_16x16x32_bf16 v[236:239], a[200:203], a[108:111], v[236:239]
buffer_load_dwordx4 a[176:179], v2, s[8:11], s72 offen offset:0 sc1
v_mfma_f32_16x16x32_bf16 v[232:235], a[200:203], a[104:107], v[232:235]
ds_read_b64_tr_b16 a[194:195], v10 offset:1024
v_mfma_f32_16x16x32_bf16 v[232:235], a[204:207], a[120:123], v[232:235]
v_mfma_f32_16x16x32_bf16 v[228:231], a[204:207], a[116:119], v[228:231]
ds_read_b64_tr_b16 a[196:197], v10 offset:16384
v_mfma_f32_16x16x32_bf16 v[228:231], a[200:203], a[100:103], v[228:231]
v_mfma_f32_16x16x32_bf16 v[224:227], a[200:203], a[96:99], v[224:227]
ds_read_b64_tr_b16 a[198:199], v10 offset:17408
v_mfma_f32_16x16x32_bf16 v[224:227], a[204:207], a[112:115], v[224:227]
buffer_load_dwordx4 a[180:183], v2, s[8:11], s72 offen offset:1024 sc1
v_mfma_f32_16x16x32_bf16 a[48:51], a[208:211], a[96:99], a[48:51]
s_waitcnt lgkmcnt(4)
ds_read_b64_tr_b16 a[200:201], v10 offset:8
v_mfma_f32_16x16x32_bf16 a[48:51], a[212:215], a[112:115], a[48:51]
v_mfma_f32_16x16x32_bf16 a[52:55], a[212:215], a[116:119], a[52:55]
ds_read_b64_tr_b16 a[202:203], v10 offset:1032
v_mfma_f32_16x16x32_bf16 a[52:55], a[208:211], a[100:103], a[52:55]
v_mfma_f32_16x16x32_bf16 a[56:59], a[208:211], a[104:107], a[56:59]
ds_read_b64_tr_b16 a[204:205], v10 offset:16392
v_mfma_f32_16x16x32_bf16 a[56:59], a[212:215], a[120:123], a[56:59]
buffer_load_dwordx4 a[184:187], v2, s[8:11], s72 offen offset:2048 sc1
v_mfma_f32_16x16x32_bf16 a[60:63], a[212:215], a[124:127], a[60:63]
ds_read_b64_tr_b16 a[206:207], v10 offset:17416
v_mfma_f32_16x16x32_bf16 a[60:63], a[208:211], a[108:111], a[60:63]
v_mfma_f32_16x16x32_bf16 v[252:255], a[220:223], a[124:127], v[252:255]
ds_read_b64_tr_b16 a[208:209], v11 offset:0
v_mfma_f32_16x16x32_bf16 v[252:255], a[216:219], a[108:111], v[252:255]
v_mfma_f32_16x16x32_bf16 v[248:251], a[216:219], a[104:107], v[248:251]
ds_read_b64_tr_b16 a[210:211], v11 offset:1024
v_mfma_f32_16x16x32_bf16 v[248:251], a[220:223], a[120:123], v[248:251]
buffer_load_dwordx4 a[188:191], v2, s[8:11], s72 offen offset:3072 sc1
v_mfma_f32_16x16x32_bf16 v[244:247], a[220:223], a[116:119], v[244:247]
s_add_u32 s72, s72, 4096
ds_read_b64_tr_b16 a[212:213], v11 offset:16384
v_mfma_f32_16x16x32_bf16 v[244:247], a[216:219], a[100:103], v[244:247]
s_add_u32 m0, s75, 65536
v_mfma_f32_16x16x32_bf16 v[240:243], a[216:219], a[96:99], v[240:243]
ds_read_b64_tr_b16 a[214:215], v11 offset:17408
v_mfma_f32_16x16x32_bf16 v[240:243], a[220:223], a[112:115], v[240:243]
s_waitcnt lgkmcnt(4)
v_mfma_f32_16x16x32_bf16 v[64:67], a[192:195], a[128:131], v[64:67]
ds_read_b64_tr_b16 a[216:217], v11 offset:8
v_mfma_f32_16x16x32_bf16 v[64:67], a[196:199], a[144:147], v[64:67]
buffer_load_dwordx4 v3, s[12:15], s73 offen lds
v_mfma_f32_16x16x32_bf16 v[68:71], a[196:199], a[148:151], v[68:71]
ds_read_b64_tr_b16 a[218:219], v11 offset:1032
v_mfma_f32_16x16x32_bf16 v[68:71], a[192:195], a[132:135], v[68:71]
v_mfma_f32_16x16x32_bf16 v[72:75], a[192:195], a[136:139], v[72:75]
ds_read_b64_tr_b16 a[220:221], v11 offset:16392
v_mfma_f32_16x16x32_bf16 v[72:75], a[196:199], a[152:155], v[72:75]
v_mfma_f32_16x16x32_bf16 v[76:79], a[196:199], a[156:159], v[76:79]
ds_read_b64_tr_b16 a[222:223], v11 offset:17416
v_mfma_f32_16x16x32_bf16 v[76:79], a[192:195], a[140:143], v[76:79]
buffer_load_dwordx4 v4, s[12:15], s73 offen offset:1024 lds
v_mfma_f32_16x16x32_bf16 v[140:143], a[204:207], a[156:159], v[140:143]
ds_read_b64_tr_b16 a[192:193], v12 offset:0
v_mfma_f32_16x16x32_bf16 v[140:143], a[200:203], a[140:143], v[140:143]
v_mfma_f32_16x16x32_bf16 v[136:139], a[200:203], a[136:139], v[136:139]
ds_read_b64_tr_b16 a[194:195], v12 offset:1024
v_mfma_f32_16x16x32_bf16 v[136:139], a[204:207], a[152:155], v[136:139]
v_mfma_f32_16x16x32_bf16 v[132:135], a[204:207], a[148:151], v[132:135]
ds_read_b64_tr_b16 a[196:197], v12 offset:16384
v_mfma_f32_16x16x32_bf16 v[132:135], a[200:203], a[132:135], v[132:135]
buffer_load_dwordx4 v5, s[16:19], s74 offen offset:2048 lds
v_mfma_f32_16x16x32_bf16 v[128:131], a[200:203], a[128:131], v[128:131]
ds_read_b64_tr_b16 a[198:199], v12 offset:17408
v_mfma_f32_16x16x32_bf16 v[128:131], a[204:207], a[144:147], v[128:131]
s_waitcnt lgkmcnt(4)
v_mfma_f32_16x16x32_bf16 v[80:83], a[208:211], a[128:131], v[80:83]
ds_read_b64_tr_b16 a[200:201], v12 offset:8
v_mfma_f32_16x16x32_bf16 v[80:83], a[212:215], a[144:147], v[80:83]
v_mfma_f32_16x16x32_bf16 v[84:87], a[212:215], a[148:151], v[84:87]
ds_read_b64_tr_b16 a[202:203], v12 offset:1032
v_mfma_f32_16x16x32_bf16 v[84:87], a[208:211], a[132:135], v[84:87]
buffer_load_dwordx4 v5, s[20:23], s74 offen offset:3072 lds
v_mfma_f32_16x16x32_bf16 v[88:91], a[208:211], a[136:139], v[88:91]
s_add_u32 s73, s73, 262144
s_add_u32 s74, s74, 110592
ds_read_b64_tr_b16 a[204:205], v12 offset:16392
v_mfma_f32_16x16x32_bf16 v[88:91], a[212:215], a[152:155], v[88:91]
v_mfma_f32_16x16x32_bf16 v[92:95], a[212:215], a[156:159], v[92:95]
ds_read_b64_tr_b16 a[206:207], v12 offset:17416
v_mfma_f32_16x16x32_bf16 v[92:95], a[208:211], a[140:143], v[92:95]
v_mfma_f32_16x16x32_bf16 v[156:159], a[220:223], a[156:159], v[156:159]
ds_read_b64_tr_b16 a[208:209], v13 offset:0
v_mfma_f32_16x16x32_bf16 v[156:159], a[216:219], a[140:143], v[156:159]
buffer_load_dwordx4 a[64:67], v2, s[8:11], s72 offen offset:0 sc1
v_mfma_f32_16x16x32_bf16 v[152:155], a[216:219], a[136:139], v[152:155]
ds_read_b64_tr_b16 a[210:211], v13 offset:1024
v_mfma_f32_16x16x32_bf16 v[152:155], a[220:223], a[152:155], v[152:155]
v_mfma_f32_16x16x32_bf16 v[148:151], a[220:223], a[148:151], v[148:151]
ds_read_b64_tr_b16 a[212:213], v13 offset:16384
v_mfma_f32_16x16x32_bf16 v[148:151], a[216:219], a[132:135], v[148:151]
v_mfma_f32_16x16x32_bf16 v[144:147], a[216:219], a[128:131], v[144:147]
s_waitcnt lgkmcnt(4)
ds_read_b64_tr_b16 a[214:215], v13 offset:17408
v_mfma_f32_16x16x32_bf16 v[144:147], a[220:223], a[144:147], v[144:147]
buffer_load_dwordx4 a[68:71], v2, s[8:11], s72 offen offset:1024 sc1
v_mfma_f32_16x16x32_bf16 v[96:99], a[192:195], a[128:131], v[96:99]
ds_read_b64_tr_b16 a[216:217], v13 offset:8
v_mfma_f32_16x16x32_bf16 v[96:99], a[196:199], a[144:147], v[96:99]
v_mfma_f32_16x16x32_bf16 v[100:103], a[196:199], a[148:151], v[100:103]
ds_read_b64_tr_b16 a[218:219], v13 offset:1032
v_mfma_f32_16x16x32_bf16 v[100:103], a[192:195], a[132:135], v[100:103]
v_mfma_f32_16x16x32_bf16 v[104:107], a[192:195], a[136:139], v[104:107]
ds_read_b64_tr_b16 a[220:221], v13 offset:16392
v_mfma_f32_16x16x32_bf16 v[104:107], a[196:199], a[152:155], v[104:107]
buffer_load_dwordx4 a[72:75], v2, s[8:11], s72 offen offset:2048 sc1
v_mfma_f32_16x16x32_bf16 v[108:111], a[196:199], a[156:159], v[108:111]
ds_read_b64_tr_b16 a[222:223], v13 offset:17416
v_mfma_f32_16x16x32_bf16 v[108:111], a[192:195], a[140:143], v[108:111]
s_waitcnt lgkmcnt(4)
v_mfma_f32_16x16x32_bf16 v[172:175], a[204:207], a[156:159], v[172:175]
ds_read_b64_tr_b16 a[192:193], v14 offset:3072
v_mfma_f32_16x16x32_bf16 v[172:175], a[200:203], a[140:143], v[172:175]
v_mfma_f32_16x16x32_bf16 v[168:171], a[200:203], a[136:139], v[168:171]
ds_read_b64_tr_b16 a[194:195], v14 offset:3584
v_mfma_f32_16x16x32_bf16 v[168:171], a[204:207], a[152:155], v[168:171]
buffer_load_dwordx4 a[76:79], v2, s[8:11], s72 offen offset:3072 sc1
v_mfma_f32_16x16x32_bf16 v[164:167], a[204:207], a[148:151], v[164:167]
s_add_u32 s72, s72, 4096
ds_read_b64_tr_b16 a[196:197], v14 offset:19456
v_lshrrev_b32 v8, 4, v1
v_mfma_f32_16x16x32_bf16 v[164:167], a[200:203], a[132:135], v[164:167]
s_mov_b32 s80, 3145728
v_xor_b32 v8, v8, v1
v_bfe_u32 v8, v8, 1, 1
v_mfma_f32_16x16x32_bf16 v[160:163], a[200:203], a[128:131], v[160:163]
ds_read_b64_tr_b16 a[198:199], v14 offset:19968
v_subrev_u32 v8, 1, v8
v_mfma_f32_16x16x32_bf16 v[160:163], a[204:207], a[144:147], v[160:163]
v_and_b32 v8, 0x3f803f80, v8
v_mov_b32 v56, v8
v_mfma_f32_16x16x32_bf16 v[112:115], a[208:211], a[128:131], v[112:115]
ds_read_b64_tr_b16 a[200:201], v14 offset:2048
v_mov_b32 v57, v8
v_mfma_f32_16x16x32_bf16 v[112:115], a[212:215], a[144:147], v[112:115]
buffer_load_dword v18, v63, s[12:15], s80 offen
v_mfma_f32_16x16x32_bf16 v[116:119], a[212:215], a[148:151], v[116:119]
s_mov_b32 s80, 1327104
ds_read_b64_tr_b16 a[202:203], v14 offset:2560
v_mov_b32 v58, v8
v_mfma_f32_16x16x32_bf16 v[116:119], a[208:211], a[132:135], v[116:119]
v_mov_b32 v59, v8
v_and_b32 v7, 1, v1
v_mfma_f32_16x16x32_bf16 v[120:123], a[208:211], a[136:139], v[120:123]
ds_read_b64_tr_b16 a[204:205], v14 offset:18432
v_mul_u32_u24 v7, 0xaaaa, v7
v_mfma_f32_16x16x32_bf16 v[120:123], a[212:215], a[152:155], v[120:123]
v_or_b32 v7, 0x4444, v7
v_mfma_f32_16x16x32_bf16 v[124:127], a[212:215], a[156:159], v[124:127]
s_waitcnt lgkmcnt(4)
ds_read_b64_tr_b16 a[206:207], v14 offset:18944
v_mfma_f32_16x16x32_bf16 v[124:127], a[208:211], a[140:143], v[124:127]
buffer_load_dword v18, v62, s[16:19], s80 offen offset:2048
v_mfma_f32_16x16x32_bf16 v[188:191], a[220:223], a[156:159], v[188:191]
ds_read_b64_tr_b16 a[208:209], v15 offset:3072
v_mfma_f32_16x16x32_bf16 v[188:191], a[216:219], a[140:143], v[188:191]
v_mfma_f32_16x16x32_bf16 v[184:187], a[216:219], a[136:139], v[184:187]
ds_read_b64_tr_b16 a[210:211], v15 offset:3584
v_mfma_f32_16x16x32_bf16 v[184:187], a[220:223], a[152:155], v[184:187]
v_mfma_f32_16x16x32_bf16 v[180:183], a[220:223], a[148:151], v[180:183]
ds_read_b64_tr_b16 a[212:213], v15 offset:19456
v_mfma_f32_16x16x32_bf16 v[180:183], a[216:219], a[132:135], v[180:183]
buffer_load_dword v18, v62, s[20:23], s80 offen offset:3072
v_mfma_f32_16x16x32_bf16 v[176:179], a[216:219], a[128:131], v[176:179]
s_add_u32 m0, s75, 81920
ds_read_b64_tr_b16 a[214:215], v15 offset:19968
v_mfma_f32_16x16x32_bf16 v[176:179], a[220:223], a[144:147], v[176:179]
v_mfma_f32_16x16x32_bf16 a[0:3], a[192:195], a[128:131], a[0:3]
s_waitcnt lgkmcnt(4)
ds_read_b64_tr_b16 a[216:217], v15 offset:2048
v_mfma_f32_16x16x32_bf16 a[0:3], a[196:199], a[144:147], a[0:3]
v_mfma_f32_16x16x32_bf16 a[4:7], a[196:199], a[148:151], a[4:7]
ds_read_b64_tr_b16 a[218:219], v15 offset:2560
v_mfma_f32_16x16x32_bf16 a[4:7], a[192:195], a[132:135], a[4:7]
buffer_load_dwordx4 v3, s[12:15], s73 offen lds
v_mfma_f32_16x16x32_bf16 a[8:11], a[192:195], a[136:139], a[8:11]
ds_read_b64_tr_b16 a[220:221], v15 offset:18432
v_mfma_f32_16x16x32_bf16 a[8:11], a[196:199], a[152:155], a[8:11]
v_mfma_f32_16x16x32_bf16 a[12:15], a[196:199], a[156:159], a[12:15]
ds_read_b64_tr_b16 a[222:223], v15 offset:18944
v_mfma_f32_16x16x32_bf16 a[12:15], a[192:195], a[140:143], a[12:15]
v_mfma_f32_16x16x32_bf16 v[204:207], a[204:207], a[156:159], v[204:207]
ds_read_b64_tr_b16 a[192:193], v16 offset:3072
v_mfma_f32_16x16x32_bf16 v[204:207], a[200:203], a[140:143], v[204:207]
buffer_load_dwordx4 v4, s[12:15], s73 offen offset:1024 lds
v_mfma_f32_16x16x32_bf16 v[200:203], a[200:203], a[136:139], v[200:203]
ds_read_b64_tr_b16 a[194:195], v16 offset:3584
v_mfma_f32_16x16x32_bf16 v[200:203], a[204:207], a[152:155], v[200:203]
v_mfma_f32_16x16x32_bf16 v[196:199], a[204:207], a[148:151], v[196:199]
ds_read_b64_tr_b16 a[196:197], v16 offset:19456
v_mfma_f32_16x16x32_bf16 v[196:199], a[200:203], a[132:135], v[196:199]
v_mfma_f32_16x16x32_bf16 v[192:195], a[200:203], a[128:131], v[192:195]
s_waitcnt lgkmcnt(4)
ds_read_b64_tr_b16 a[198:199], v16 offset:19968
v_mfma_f32_16x16x32_bf16 v[192:195], a[204:207], a[144:147], v[192:195]
buffer_load_dwordx4 v5, s[16:19], s74 offen offset:2048 lds
v_mfma_f32_16x16x32_bf16 a[16:19], a[208:211], a[128:131], a[16:19]
ds_read_b64_tr_b16 a[200:201], v16 offset:2048
v_mfma_f32_16x16x32_bf16 a[16:19], a[212:215], a[144:147], a[16:19]
v_mfma_f32_16x16x32_bf16 a[20:23], a[212:215], a[148:151], a[20:23]
ds_read_b64_tr_b16 a[202:203], v16 offset:2560
v_mfma_f32_16x16x32_bf16 a[20:23], a[208:211], a[132:135], a[20:23]
v_mfma_f32_16x16x32_bf16 a[24:27], a[208:211], a[136:139], a[24:27]
ds_read_b64_tr_b16 a[204:205], v16 offset:18432
v_mfma_f32_16x16x32_bf16 a[24:27], a[212:215], a[152:155], a[24:27]
buffer_load_dwordx4 v5, s[20:23], s74 offen offset:3072 lds
v_mfma_f32_16x16x32_bf16 a[28:31], a[212:215], a[156:159], a[28:31]
s_add_u32 s73, s73, 262144
s_add_u32 s74, s74, 110592
ds_read_b64_tr_b16 a[206:207], v16 offset:18944
v_mfma_f32_16x16x32_bf16 a[28:31], a[208:211], a[140:143], a[28:31]
s_waitcnt lgkmcnt(4)
v_mfma_f32_16x16x32_bf16 v[220:223], a[220:223], a[156:159], v[220:223]
ds_read_b64_tr_b16 a[208:209], v17 offset:3072
v_mfma_f32_16x16x32_bf16 v[220:223], a[216:219], a[140:143], v[220:223]
v_mfma_f32_16x16x32_bf16 v[216:219], a[216:219], a[136:139], v[216:219]
ds_read_b64_tr_b16 a[210:211], v17 offset:3584
v_mfma_f32_16x16x32_bf16 v[216:219], a[220:223], a[152:155], v[216:219]
buffer_load_dwordx4 a[80:83], v2, s[8:11], s72 offen offset:0 sc1
v_mfma_f32_16x16x32_bf16 v[212:215], a[220:223], a[148:151], v[212:215]
ds_read_b64_tr_b16 a[212:213], v17 offset:19456
v_mfma_f32_16x16x32_bf16 v[212:215], a[216:219], a[132:135], v[212:215]
v_mfma_f32_16x16x32_bf16 v[208:211], a[216:219], a[128:131], v[208:211]
ds_read_b64_tr_b16 a[214:215], v17 offset:19968
v_mfma_f32_16x16x32_bf16 v[208:211], a[220:223], a[144:147], v[208:211]
v_mfma_f32_16x16x32_bf16 a[32:35], a[192:195], a[128:131], a[32:35]
ds_read_b64_tr_b16 a[216:217], v17 offset:2048
v_mfma_f32_16x16x32_bf16 a[32:35], a[196:199], a[144:147], a[32:35]
buffer_load_dwordx4 a[84:87], v2, s[8:11], s72 offen offset:1024 sc1
v_mfma_f32_16x16x32_bf16 a[36:39], a[196:199], a[148:151], a[36:39]
ds_read_b64_tr_b16 a[218:219], v17 offset:2560
v_mfma_f32_16x16x32_bf16 a[36:39], a[192:195], a[132:135], a[36:39]
v_mfma_f32_16x16x32_bf16 a[40:43], a[192:195], a[136:139], a[40:43]
ds_read_b64_tr_b16 a[220:221], v17 offset:18432
v_mfma_f32_16x16x32_bf16 a[40:43], a[196:199], a[152:155], a[40:43]
v_mfma_f32_16x16x32_bf16 a[44:47], a[196:199], a[156:159], a[44:47]
s_waitcnt lgkmcnt(4)
ds_read_b64_tr_b16 a[222:223], v17 offset:18944
v_mfma_f32_16x16x32_bf16 a[44:47], a[192:195], a[140:143], a[44:47]
s_waitcnt vmcnt(17)
s_barrier
v_mfma_f32_16x16x32_bf16 v[236:239], a[204:207], a[156:159], v[236:239]
ds_read_b64_tr_b16 a[192:193], v10 offset:32768
v_mfma_f32_16x16x32_bf16 v[236:239], a[200:203], a[140:143], v[236:239]
buffer_load_dwordx4 a[88:91], v2, s[8:11], s72 offen offset:2048 sc1
v_mfma_f32_16x16x32_bf16 v[232:235], a[200:203], a[136:139], v[232:235]
ds_read_b64_tr_b16 a[194:195], v10 offset:33792
v_mfma_f32_16x16x32_bf16 v[232:235], a[204:207], a[152:155], v[232:235]
v_mfma_f32_16x16x32_bf16 v[228:231], a[204:207], a[148:151], v[228:231]
ds_read_b64_tr_b16 a[196:197], v10 offset:49152
v_mfma_f32_16x16x32_bf16 v[228:231], a[200:203], a[132:135], v[228:231]
v_mfma_f32_16x16x32_bf16 v[224:227], a[200:203], a[128:131], v[224:227]
s_waitcnt lgkmcnt(4)
ds_read_b64_tr_b16 a[198:199], v10 offset:50176
v_mfma_f32_16x16x32_bf16 v[224:227], a[204:207], a[144:147], v[224:227]
buffer_load_dwordx4 a[92:95], v2, s[8:11], s72 offen offset:3072 sc1
v_mfma_f32_16x16x32_bf16 a[48:51], a[208:211], a[128:131], a[48:51]
s_add_u32 s72, s72, 4096
ds_read_b64_tr_b16 a[200:201], v10 offset:32776
v_mfma_f32_16x16x32_bf16 a[48:51], a[212:215], a[144:147], a[48:51]
s_add_u32 m0, s75, 98304
v_mfma_f32_16x16x32_bf16 a[52:55], a[212:215], a[148:151], a[52:55]
ds_read_b64_tr_b16 a[202:203], v10 offset:33800
v_mfma_f32_16x16x32_bf16 a[52:55], a[208:211], a[132:135], a[52:55]
v_mfma_f32_16x16x32_bf16 a[56:59], a[208:211], a[136:139], a[56:59]
ds_read_b64_tr_b16 a[204:205], v10 offset:49160
v_mfma_f32_16x16x32_bf16 a[56:59], a[212:215], a[152:155], a[56:59]
buffer_load_dwordx4 v3, s[12:15], s73 offen lds
v_mfma_f32_16x16x32_bf16 a[60:63], a[212:215], a[156:159], a[60:63]
ds_read_b64_tr_b16 a[206:207], v10 offset:50184
v_mfma_f32_16x16x32_bf16 a[60:63], a[208:211], a[140:143], a[60:63]
s_waitcnt lgkmcnt(4)
v_mfma_f32_16x16x32_bf16 v[252:255], a[220:223], a[156:159], v[252:255]
ds_read_b64_tr_b16 a[208:209], v11 offset:32768
v_mfma_f32_16x16x32_bf16 v[252:255], a[216:219], a[140:143], v[252:255]
v_mfma_f32_16x16x32_bf16 v[248:251], a[216:219], a[136:139], v[248:251]
ds_read_b64_tr_b16 a[210:211], v11 offset:33792
v_mfma_f32_16x16x32_bf16 v[248:251], a[220:223], a[152:155], v[248:251]
buffer_load_dwordx4 v4, s[12:15], s73 offen offset:1024 lds
v_mfma_f32_16x16x32_bf16 v[244:247], a[220:223], a[148:151], v[244:247]
ds_read_b64_tr_b16 a[212:213], v11 offset:49152
v_mfma_f32_16x16x32_bf16 v[244:247], a[216:219], a[132:135], v[244:247]
v_mfma_f32_16x16x32_bf16 v[240:243], a[216:219], a[128:131], v[240:243]
ds_read_b64_tr_b16 a[214:215], v11 offset:50176
v_mfma_f32_16x16x32_bf16 v[240:243], a[220:223], a[144:147], v[240:243]
v_mfma_f32_16x16x32_bf16 v[64:67], a[192:195], a[160:163], v[64:67]
ds_read_b64_tr_b16 a[216:217], v11 offset:32776
v_mfma_f32_16x16x32_bf16 v[64:67], a[196:199], a[176:179], v[64:67]
buffer_load_dwordx4 v5, s[16:19], s74 offen offset:2048 lds
v_mfma_f32_16x16x32_bf16 v[68:71], a[196:199], a[180:183], v[68:71]
ds_read_b64_tr_b16 a[218:219], v11 offset:33800
v_mfma_f32_16x16x32_bf16 v[68:71], a[192:195], a[164:167], v[68:71]
v_mfma_f32_16x16x32_bf16 v[72:75], a[192:195], a[168:171], v[72:75]
ds_read_b64_tr_b16 a[220:221], v11 offset:49160
v_mfma_f32_16x16x32_bf16 v[72:75], a[196:199], a[184:187], v[72:75]
v_mfma_f32_16x16x32_bf16 v[76:79], a[196:199], a[188:191], v[76:79]
s_waitcnt lgkmcnt(4)
ds_read_b64_tr_b16 a[222:223], v11 offset:50184
v_mfma_f32_16x16x32_bf16 v[76:79], a[192:195], a[172:175], v[76:79]
buffer_load_dwordx4 v5, s[20:23], s74 offen offset:3072 lds
v_mfma_f32_16x16x32_bf16 v[140:143], a[204:207], a[188:191], v[140:143]
s_add_u32 s73, s73, 262144
s_add_u32 s74, s74, 110592
ds_read_b64_tr_b16 a[192:193], v12 offset:32768
v_mfma_f32_16x16x32_bf16 v[140:143], a[200:203], a[172:175], v[140:143]
v_mfma_f32_16x16x32_bf16 v[136:139], a[200:203], a[168:171], v[136:139]
ds_read_b64_tr_b16 a[194:195], v12 offset:33792
v_mfma_f32_16x16x32_bf16 v[136:139], a[204:207], a[184:187], v[136:139]
v_mfma_f32_16x16x32_bf16 v[132:135], a[204:207], a[180:183], v[132:135]
ds_read_b64_tr_b16 a[196:197], v12 offset:49152
v_mfma_f32_16x16x32_bf16 v[132:135], a[200:203], a[164:167], v[132:135]
buffer_load_dwordx4 a[96:99], v2, s[8:11], s72 offen offset:0 sc1
v_mfma_f32_16x16x32_bf16 v[128:131], a[200:203], a[160:163], v[128:131]
ds_read_b64_tr_b16 a[198:199], v12 offset:50176
v_mfma_f32_16x16x32_bf16 v[128:131], a[204:207], a[176:179], v[128:131]
v_mfma_f32_16x16x32_bf16 v[80:83], a[208:211], a[160:163], v[80:83]
s_waitcnt lgkmcnt(4)
ds_read_b64_tr_b16 a[200:201], v12 offset:32776
v_mfma_f32_16x16x32_bf16 v[80:83], a[212:215], a[176:179], v[80:83]
v_mfma_f32_16x16x32_bf16 v[84:87], a[212:215], a[180:183], v[84:87]
ds_read_b64_tr_b16 a[202:203], v12 offset:33800
v_mfma_f32_16x16x32_bf16 v[84:87], a[208:211], a[164:167], v[84:87]
buffer_load_dwordx4 a[100:103], v2, s[8:11], s72 offen offset:1024 sc1
v_mfma_f32_16x16x32_bf16 v[88:91], a[208:211], a[168:171], v[88:91]
ds_read_b64_tr_b16 a[204:205], v12 offset:49160
v_mfma_f32_16x16x32_bf16 v[88:91], a[212:215], a[184:187], v[88:91]
v_mfma_f32_16x16x32_bf16 v[92:95], a[212:215], a[188:191], v[92:95]
ds_read_b64_tr_b16 a[206:207], v12 offset:50184
v_mfma_f32_16x16x32_bf16 v[92:95], a[208:211], a[172:175], v[92:95]
v_mfma_f32_16x16x32_bf16 v[156:159], a[220:223], a[188:191], v[156:159]
ds_read_b64_tr_b16 a[208:209], v13 offset:32768
v_mfma_f32_16x16x32_bf16 v[156:159], a[216:219], a[172:175], v[156:159]
buffer_load_dwordx4 a[104:107], v2, s[8:11], s72 offen offset:2048 sc1
v_mfma_f32_16x16x32_bf16 v[152:155], a[216:219], a[168:171], v[152:155]
ds_read_b64_tr_b16 a[210:211], v13 offset:33792
v_mfma_f32_16x16x32_bf16 v[152:155], a[220:223], a[184:187], v[152:155]
v_mfma_f32_16x16x32_bf16 v[148:151], a[220:223], a[180:183], v[148:151]
ds_read_b64_tr_b16 a[212:213], v13 offset:49152
v_mfma_f32_16x16x32_bf16 v[148:151], a[216:219], a[164:167], v[148:151]
v_mfma_f32_16x16x32_bf16 v[144:147], a[216:219], a[160:163], v[144:147]
s_waitcnt lgkmcnt(4)
ds_read_b64_tr_b16 a[214:215], v13 offset:50176
v_mfma_f32_16x16x32_bf16 v[144:147], a[220:223], a[176:179], v[144:147]
buffer_load_dwordx4 a[108:111], v2, s[8:11], s72 offen offset:3072 sc1
v_mfma_f32_16x16x32_bf16 v[96:99], a[192:195], a[160:163], v[96:99]
s_add_u32 s72, s72, 4096
ds_read_b64_tr_b16 a[216:217], v13 offset:32776
v_mfma_f32_16x16x32_bf16 v[96:99], a[196:199], a[176:179], v[96:99]
s_add_u32 m0, s75, 114688
v_mfma_f32_16x16x32_bf16 v[100:103], a[196:199], a[180:183], v[100:103]
ds_read_b64_tr_b16 a[218:219], v13 offset:33800
v_mfma_f32_16x16x32_bf16 v[100:103], a[192:195], a[164:167], v[100:103]
v_mfma_f32_16x16x32_bf16 v[104:107], a[192:195], a[168:171], v[104:107]
ds_read_b64_tr_b16 a[220:221], v13 offset:49160
v_mfma_f32_16x16x32_bf16 v[104:107], a[196:199], a[184:187], v[104:107]
buffer_load_dwordx4 v3, s[12:15], s73 offen lds
v_mfma_f32_16x16x32_bf16 v[108:111], a[196:199], a[188:191], v[108:111]
ds_read_b64_tr_b16 a[222:223], v13 offset:50184
v_mfma_f32_16x16x32_bf16 v[108:111], a[192:195], a[172:175], v[108:111]
s_waitcnt lgkmcnt(4)
v_mfma_f32_16x16x32_bf16 v[172:175], a[204:207], a[188:191], v[172:175]
ds_read_b64_tr_b16 a[192:193], v14 offset:35840
v_mfma_f32_16x16x32_bf16 v[172:175], a[200:203], a[172:175], v[172:175]
v_mfma_f32_16x16x32_bf16 v[168:171], a[200:203], a[168:171], v[168:171]
ds_read_b64_tr_b16 a[194:195], v14 offset:36352
v_mfma_f32_16x16x32_bf16 v[168:171], a[204:207], a[184:187], v[168:171]
buffer_load_dwordx4 v4, s[12:15], s73 offen offset:1024 lds
v_mfma_f32_16x16x32_bf16 v[164:167], a[204:207], a[180:183], v[164:167]
ds_read_b64_tr_b16 a[196:197], v14 offset:52224
v_mfma_f32_16x16x32_bf16 v[164:167], a[200:203], a[164:167], v[164:167]
v_mfma_f32_16x16x32_bf16 v[160:163], a[200:203], a[160:163], v[160:163]
ds_read_b64_tr_b16 a[198:199], v14 offset:52736
v_mfma_f32_16x16x32_bf16 v[160:163], a[204:207], a[176:179], v[160:163]
v_mfma_f32_16x16x32_bf16 v[112:115], a[208:211], a[160:163], v[112:115]
ds_read_b64_tr_b16 a[200:201], v14 offset:34816
v_mfma_f32_16x16x32_bf16 v[112:115], a[212:215], a[176:179], v[112:115]
buffer_load_dwordx4 v5, s[16:19], s74 offen offset:2048 lds
v_mfma_f32_16x16x32_bf16 v[116:119], a[212:215], a[180:183], v[116:119]
ds_read_b64_tr_b16 a[202:203], v14 offset:35328
v_mfma_f32_16x16x32_bf16 v[116:119], a[208:211], a[164:167], v[116:119]
v_mfma_f32_16x16x32_bf16 v[120:123], a[208:211], a[168:171], v[120:123]
ds_read_b64_tr_b16 a[204:205], v14 offset:51200
v_mfma_f32_16x16x32_bf16 v[120:123], a[212:215], a[184:187], v[120:123]
v_mfma_f32_16x16x32_bf16 v[124:127], a[212:215], a[188:191], v[124:127]
s_waitcnt lgkmcnt(4)
ds_read_b64_tr_b16 a[206:207], v14 offset:51712
v_mfma_f32_16x16x32_bf16 v[124:127], a[208:211], a[172:175], v[124:127]
buffer_load_dwordx4 v5, s[20:23], s74 offen offset:3072 lds
v_mfma_f32_16x16x32_bf16 v[188:191], a[220:223], a[188:191], v[188:191]
s_add_u32 s73, s73, 262144
s_add_u32 s74, s74, 110592
ds_read_b64_tr_b16 a[208:209], v15 offset:35840
v_mfma_f32_16x16x32_bf16 v[188:191], a[216:219], a[172:175], v[188:191]
v_mfma_f32_16x16x32_bf16 v[184:187], a[216:219], a[168:171], v[184:187]
ds_read_b64_tr_b16 a[210:211], v15 offset:36352
v_mfma_f32_16x16x32_bf16 v[184:187], a[220:223], a[184:187], v[184:187]
v_mfma_f32_16x16x32_bf16 v[180:183], a[220:223], a[180:183], v[180:183]
ds_read_b64_tr_b16 a[212:213], v15 offset:52224
v_mfma_f32_16x16x32_bf16 v[180:183], a[216:219], a[164:167], v[180:183]
buffer_load_dwordx4 a[112:115], v2, s[8:11], s72 offen offset:0 sc1
v_mfma_f32_16x16x32_bf16 v[176:179], a[216:219], a[160:163], v[176:179]
ds_read_b64_tr_b16 a[214:215], v15 offset:52736
v_mfma_f32_16x16x32_bf16 v[176:179], a[220:223], a[176:179], v[176:179]
v_mfma_f32_16x16x32_bf16 a[0:3], a[192:195], a[160:163], a[0:3]
s_waitcnt lgkmcnt(4)
ds_read_b64_tr_b16 a[216:217], v15 offset:34816
v_mfma_f32_16x16x32_bf16 a[0:3], a[196:199], a[176:179], a[0:3]
v_mfma_f32_16x16x32_bf16 a[4:7], a[196:199], a[180:183], a[4:7]
ds_read_b64_tr_b16 a[218:219], v15 offset:35328
v_mfma_f32_16x16x32_bf16 a[4:7], a[192:195], a[164:167], a[4:7]
buffer_load_dwordx4 a[116:119], v2, s[8:11], s72 offen offset:1024 sc1
v_mfma_f32_16x16x32_bf16 a[8:11], a[192:195], a[168:171], a[8:11]
ds_read_b64_tr_b16 a[220:221], v15 offset:51200
v_mfma_f32_16x16x32_bf16 a[8:11], a[196:199], a[184:187], a[8:11]
v_mfma_f32_16x16x32_bf16 a[12:15], a[196:199], a[188:191], a[12:15]
ds_read_b64_tr_b16 a[222:223], v15 offset:51712
v_mfma_f32_16x16x32_bf16 a[12:15], a[192:195], a[172:175], a[12:15]
v_mfma_f32_16x16x32_bf16 v[204:207], a[204:207], a[188:191], v[204:207]
ds_read_b64_tr_b16 a[192:193], v16 offset:35840
v_mfma_f32_16x16x32_bf16 v[204:207], a[200:203], a[172:175], v[204:207]
buffer_load_dwordx4 a[120:123], v2, s[8:11], s72 offen offset:2048 sc1
v_mfma_f32_16x16x32_bf16 v[200:203], a[200:203], a[168:171], v[200:203]
ds_read_b64_tr_b16 a[194:195], v16 offset:36352
v_mfma_f32_16x16x32_bf16 v[200:203], a[204:207], a[184:187], v[200:203]
v_mfma_f32_16x16x32_bf16 v[196:199], a[204:207], a[180:183], v[196:199]
ds_read_b64_tr_b16 a[196:197], v16 offset:52224
v_mfma_f32_16x16x32_bf16 v[196:199], a[200:203], a[164:167], v[196:199]
v_mfma_f32_16x16x32_bf16 v[192:195], a[200:203], a[160:163], v[192:195]
s_waitcnt lgkmcnt(4)
ds_read_b64_tr_b16 a[198:199], v16 offset:52736
v_mfma_f32_16x16x32_bf16 v[192:195], a[204:207], a[176:179], v[192:195]
buffer_load_dwordx4 a[124:127], v2, s[8:11], s72 offen offset:3072 sc1
v_mfma_f32_16x16x32_bf16 a[16:19], a[208:211], a[160:163], a[16:19]
s_add_u32 s72, s72, 4096
ds_read_b64_tr_b16 a[200:201], v16 offset:34816
v_mfma_f32_16x16x32_bf16 a[16:19], a[212:215], a[176:179], a[16:19]
v_mfma_f32_16x16x32_bf16 a[20:23], a[212:215], a[180:183], a[20:23]
ds_read_b64_tr_b16 a[202:203], v16 offset:35328
v_mfma_f32_16x16x32_bf16 a[20:23], a[208:211], a[164:167], a[20:23]
v_mfma_f32_16x16x32_bf16 a[24:27], a[208:211], a[168:171], a[24:27]
ds_read_b64_tr_b16 a[204:205], v16 offset:51200
v_mfma_f32_16x16x32_bf16 a[24:27], a[212:215], a[184:187], a[24:27]
v_mfma_f32_16x16x32_bf16 a[28:31], a[212:215], a[188:191], a[28:31]
ds_read_b64_tr_b16 a[206:207], v16 offset:51712
v_mfma_f32_16x16x32_bf16 a[28:31], a[208:211], a[172:175], a[28:31]
s_waitcnt lgkmcnt(4)
v_mfma_f32_16x16x32_bf16 v[220:223], a[220:223], a[188:191], v[220:223]
ds_read_b64_tr_b16 a[208:209], v17 offset:35840
v_mfma_f32_16x16x32_bf16 v[220:223], a[216:219], a[172:175], v[220:223]
v_mfma_f32_16x16x32_bf16 v[216:219], a[216:219], a[168:171], v[216:219]
ds_read_b64_tr_b16 a[210:211], v17 offset:36352
v_mfma_f32_16x16x32_bf16 v[216:219], a[220:223], a[184:187], v[216:219]
v_mfma_f32_16x16x32_bf16 v[212:215], a[220:223], a[180:183], v[212:215]
ds_read_b64_tr_b16 a[212:213], v17 offset:52224
v_mfma_f32_16x16x32_bf16 v[212:215], a[216:219], a[164:167], v[212:215]
v_mfma_f32_16x16x32_bf16 v[208:211], a[216:219], a[160:163], v[208:211]
ds_read_b64_tr_b16 a[214:215], v17 offset:52736
v_mfma_f32_16x16x32_bf16 v[208:211], a[220:223], a[176:179], v[208:211]
s_mov_b32 s80, 4194304
v_mfma_f32_16x16x32_bf16 a[32:35], a[192:195], a[160:163], a[32:35]
ds_read_b64_tr_b16 a[216:217], v17 offset:34816
v_mfma_f32_16x16x32_bf16 a[32:35], a[196:199], a[176:179], a[32:35]
buffer_load_dword v18, v63, s[12:15], s80 offen
v_mfma_f32_16x16x32_bf16 a[36:39], a[196:199], a[180:183], a[36:39]
s_mov_b32 s80, 1769472
ds_read_b64_tr_b16 a[218:219], v17 offset:35328
v_mfma_f32_16x16x32_bf16 a[36:39], a[192:195], a[164:167], a[36:39]
v_mfma_f32_16x16x32_bf16 a[40:43], a[192:195], a[168:171], a[40:43]
ds_read_b64_tr_b16 a[220:221], v17 offset:51200
v_mfma_f32_16x16x32_bf16 a[40:43], a[196:199], a[184:187], a[40:43]
v_mfma_f32_16x16x32_bf16 a[44:47], a[196:199], a[188:191], a[44:47]
s_waitcnt lgkmcnt(4)
ds_read_b64_tr_b16 a[222:223], v17 offset:51712
v_mfma_f32_16x16x32_bf16 a[44:47], a[192:195], a[172:175], a[44:47]
s_waitcnt vmcnt(17)
s_barrier
v_mfma_f32_16x16x32_bf16 v[236:239], a[204:207], a[188:191], v[236:239]
ds_read_b64_tr_b16 a[192:193], v44 offset:0
v_mfma_f32_16x16x32_bf16 v[236:239], a[200:203], a[172:175], v[236:239]
buffer_load_dword v18, v62, s[16:19], s80 offen offset:2048
v_mfma_f32_16x16x32_bf16 v[232:235], a[200:203], a[168:171], v[232:235]
ds_read_b64_tr_b16 a[194:195], v44 offset:1024
v_mfma_f32_16x16x32_bf16 v[232:235], a[204:207], a[184:187], v[232:235]
v_mfma_f32_16x16x32_bf16 v[228:231], a[204:207], a[180:183], v[228:231]
ds_read_b64_tr_b16 a[196:197], v44 offset:16384
v_mfma_f32_16x16x32_bf16 v[228:231], a[200:203], a[164:167], v[228:231]
v_mfma_f32_16x16x32_bf16 v[224:227], a[200:203], a[160:163], v[224:227]
s_waitcnt lgkmcnt(4)
ds_read_b64_tr_b16 a[198:199], v44 offset:17408
v_mfma_f32_16x16x32_bf16 v[224:227], a[204:207], a[176:179], v[224:227]
buffer_load_dword v18, v62, s[20:23], s80 offen offset:3072
v_mfma_f32_16x16x32_bf16 a[48:51], a[208:211], a[160:163], a[48:51]
s_add_u32 m0, s75, 0
ds_read_b64_tr_b16 a[200:201], v44 offset:8
v_mfma_f32_16x16x32_bf16 a[48:51], a[212:215], a[176:179], a[48:51]
v_mfma_f32_16x16x32_bf16 a[52:55], a[212:215], a[180:183], a[52:55]
ds_read_b64_tr_b16 a[202:203], v44 offset:1032
v_mfma_f32_16x16x32_bf16 a[52:55], a[208:211], a[164:167], a[52:55]
v_mfma_f32_16x16x32_bf16 a[56:59], a[208:211], a[168:171], a[56:59]
ds_read_b64_tr_b16 a[204:205], v44 offset:16392
v_mfma_f32_16x16x32_bf16 a[56:59], a[212:215], a[184:187], a[56:59]
buffer_load_dwordx4 v3, s[12:15], s73 offen lds
v_mfma_f32_16x16x32_bf16 a[60:63], a[212:215], a[188:191], a[60:63]
ds_read_b64_tr_b16 a[206:207], v44 offset:17416
v_mfma_f32_16x16x32_bf16 a[60:63], a[208:211], a[172:175], a[60:63]
s_waitcnt lgkmcnt(4)
v_mfma_f32_16x16x32_bf16 v[252:255], a[220:223], a[188:191], v[252:255]
ds_read_b64_tr_b16 a[208:209], v45 offset:0
v_mfma_f32_16x16x32_bf16 v[252:255], a[216:219], a[172:175], v[252:255]
v_mfma_f32_16x16x32_bf16 v[248:251], a[216:219], a[168:171], v[248:251]
ds_read_b64_tr_b16 a[210:211], v45 offset:1024
v_mfma_f32_16x16x32_bf16 v[248:251], a[220:223], a[184:187], v[248:251]
buffer_load_dwordx4 v4, s[12:15], s73 offen offset:1024 lds
v_mfma_f32_16x16x32_bf16 v[244:247], a[220:223], a[180:183], v[244:247]
ds_read_b64_tr_b16 a[212:213], v45 offset:16384
v_mfma_f32_16x16x32_bf16 v[244:247], a[216:219], a[164:167], v[244:247]
v_mfma_f32_16x16x32_bf16 v[240:243], a[216:219], a[160:163], v[240:243]
ds_read_b64_tr_b16 a[214:215], v45 offset:17408
v_mfma_f32_16x16x32_bf16 v[240:243], a[220:223], a[176:179], v[240:243]
v_mfma_f32_16x16x32_bf16 v[64:67], a[192:195], a[64:67], v[64:67]
ds_read_b64_tr_b16 a[216:217], v45 offset:8
v_mfma_f32_16x16x32_bf16 v[64:67], a[196:199], a[80:83], v[64:67]
buffer_load_dwordx4 v5, s[16:19], s74 offen offset:2048 lds
v_mfma_f32_16x16x32_bf16 v[68:71], a[196:199], a[84:87], v[68:71]
ds_read_b64_tr_b16 a[218:219], v45 offset:1032
v_mfma_f32_16x16x32_bf16 v[68:71], a[192:195], a[68:71], v[68:71]
v_mfma_f32_16x16x32_bf16 v[72:75], a[192:195], a[72:75], v[72:75]
ds_read_b64_tr_b16 a[220:221], v45 offset:16392
v_mfma_f32_16x16x32_bf16 v[72:75], a[196:199], a[88:91], v[72:75]
v_mfma_f32_16x16x32_bf16 v[76:79], a[196:199], a[92:95], v[76:79]
s_waitcnt lgkmcnt(4)
ds_read_b64_tr_b16 a[222:223], v45 offset:17416
v_mfma_f32_16x16x32_bf16 v[76:79], a[192:195], a[76:79], v[76:79]
buffer_load_dwordx4 v5, s[20:23], s74 offen offset:3072 lds
v_mfma_f32_16x16x32_bf16 v[140:143], a[204:207], a[92:95], v[140:143]
s_add_u32 s73, s73, 262144
s_add_u32 s74, s74, 110592
ds_read_b64_tr_b16 a[192:193], v46 offset:0
v_mfma_f32_16x16x32_bf16 v[140:143], a[200:203], a[76:79], v[140:143]
v_mfma_f32_16x16x32_bf16 v[136:139], a[200:203], a[72:75], v[136:139]
ds_read_b64_tr_b16 a[194:195], v46 offset:1024
v_mfma_f32_16x16x32_bf16 v[136:139], a[204:207], a[88:91], v[136:139]
v_mfma_f32_16x16x32_bf16 v[132:135], a[204:207], a[84:87], v[132:135]
ds_read_b64_tr_b16 a[196:197], v46 offset:16384
v_mfma_f32_16x16x32_bf16 v[132:135], a[200:203], a[68:71], v[132:135]
buffer_load_dwordx4 a[128:131], v2, s[8:11], s72 offen offset:0 sc1
v_mfma_f32_16x16x32_bf16 v[128:131], a[200:203], a[64:67], v[128:131]
ds_read_b64_tr_b16 a[198:199], v46 offset:17408
v_mfma_f32_16x16x32_bf16 v[128:131], a[204:207], a[80:83], v[128:131]
v_mfma_f32_16x16x32_bf16 v[80:83], a[208:211], a[64:67], v[80:83]
s_waitcnt lgkmcnt(4)
ds_read_b64_tr_b16 a[200:201], v46 offset:8
v_mfma_f32_16x16x32_bf16 v[80:83], a[212:215], a[80:83], v[80:83]
v_mfma_f32_16x16x32_bf16 v[84:87], a[212:215], a[84:87], v[84:87]
ds_read_b64_tr_b16 a[202:203], v46 offset:1032
v_mfma_f32_16x16x32_bf16 v[84:87], a[208:211], a[68:71], v[84:87]
buffer_load_dwordx4 a[132:135], v2, s[8:11], s72 offen offset:1024 sc1
v_mfma_f32_16x16x32_bf16 v[88:91], a[208:211], a[72:75], v[88:91]
ds_read_b64_tr_b16 a[204:205], v46 offset:16392
v_mfma_f32_16x16x32_bf16 v[88:91], a[212:215], a[88:91], v[88:91]
v_mfma_f32_16x16x32_bf16 v[92:95], a[212:215], a[92:95], v[92:95]
ds_read_b64_tr_b16 a[206:207], v46 offset:17416
v_mfma_f32_16x16x32_bf16 v[92:95], a[208:211], a[76:79], v[92:95]
v_mfma_f32_16x16x32_bf16 v[156:159], a[220:223], a[92:95], v[156:159]
ds_read_b64_tr_b16 a[208:209], v47 offset:0
v_mfma_f32_16x16x32_bf16 v[156:159], a[216:219], a[76:79], v[156:159]
buffer_load_dwordx4 a[136:139], v2, s[8:11], s72 offen offset:2048 sc1
v_mfma_f32_16x16x32_bf16 v[152:155], a[216:219], a[72:75], v[152:155]
ds_read_b64_tr_b16 a[210:211], v47 offset:1024
v_mfma_f32_16x16x32_bf16 v[152:155], a[220:223], a[88:91], v[152:155]
v_mfma_f32_16x16x32_bf16 v[148:151], a[220:223], a[84:87], v[148:151]
ds_read_b64_tr_b16 a[212:213], v47 offset:16384
v_mfma_f32_16x16x32_bf16 v[148:151], a[216:219], a[68:71], v[148:151]
v_mfma_f32_16x16x32_bf16 v[144:147], a[216:219], a[64:67], v[144:147]
s_waitcnt lgkmcnt(4)
ds_read_b64_tr_b16 a[214:215], v47 offset:17408
v_mfma_f32_16x16x32_bf16 v[144:147], a[220:223], a[80:83], v[144:147]
buffer_load_dwordx4 a[140:143], v2, s[8:11], s72 offen offset:3072 sc1
v_mfma_f32_16x16x32_bf16 v[96:99], a[192:195], a[64:67], v[96:99]
s_add_u32 s72, s72, 4096
ds_read_b64_tr_b16 a[216:217], v47 offset:8
v_mfma_f32_16x16x32_bf16 v[96:99], a[196:199], a[80:83], v[96:99]
s_add_u32 m0, s75, 16384
v_mfma_f32_16x16x32_bf16 v[100:103], a[196:199], a[84:87], v[100:103]
ds_read_b64_tr_b16 a[218:219], v47 offset:1032
v_mfma_f32_16x16x32_bf16 v[100:103], a[192:195], a[68:71], v[100:103]
v_mfma_f32_16x16x32_bf16 v[104:107], a[192:195], a[72:75], v[104:107]
ds_read_b64_tr_b16 a[220:221], v47 offset:16392
v_mfma_f32_16x16x32_bf16 v[104:107], a[196:199], a[88:91], v[104:107]
buffer_load_dwordx4 v3, s[12:15], s73 offen lds
v_mfma_f32_16x16x32_bf16 v[108:111], a[196:199], a[92:95], v[108:111]
ds_read_b64_tr_b16 a[222:223], v47 offset:17416
v_mfma_f32_16x16x32_bf16 v[108:111], a[192:195], a[76:79], v[108:111]
s_waitcnt lgkmcnt(4)
v_mfma_f32_16x16x32_bf16 v[172:175], a[204:207], a[92:95], v[172:175]
ds_read_b64_tr_b16 a[192:193], v48 offset:3072
v_mfma_f32_16x16x32_bf16 v[172:175], a[200:203], a[76:79], v[172:175]
v_mfma_f32_16x16x32_bf16 v[168:171], a[200:203], a[72:75], v[168:171]
ds_read_b64_tr_b16 a[194:195], v48 offset:3584
v_mfma_f32_16x16x32_bf16 v[168:171], a[204:207], a[88:91], v[168:171]
buffer_load_dwordx4 v4, s[12:15], s73 offen offset:1024 lds
v_mfma_f32_16x16x32_bf16 v[164:167], a[204:207], a[84:87], v[164:167]
ds_read_b64_tr_b16 a[196:197], v48 offset:19456
v_mfma_f32_16x16x32_bf16 v[164:167], a[200:203], a[68:71], v[164:167]
v_mfma_f32_16x16x32_bf16 v[160:163], a[200:203], a[64:67], v[160:163]
ds_read_b64_tr_b16 a[198:199], v48 offset:19968
v_mfma_f32_16x16x32_bf16 v[160:163], a[204:207], a[80:83], v[160:163]
v_mfma_f32_16x16x32_bf16 v[112:115], a[208:211], a[64:67], v[112:115]
ds_read_b64_tr_b16 a[200:201], v48 offset:2048
v_mfma_f32_16x16x32_bf16 v[112:115], a[212:215], a[80:83], v[112:115]
buffer_load_dwordx4 v5, s[16:19], s74 offen offset:2048 lds
v_mfma_f32_16x16x32_bf16 v[116:119], a[212:215], a[84:87], v[116:119]
ds_read_b64_tr_b16 a[202:203], v48 offset:2560
v_mfma_f32_16x16x32_bf16 v[116:119], a[208:211], a[68:71], v[116:119]
v_mfma_f32_16x16x32_bf16 v[120:123], a[208:211], a[72:75], v[120:123]
ds_read_b64_tr_b16 a[204:205], v48 offset:18432
v_mfma_f32_16x16x32_bf16 v[120:123], a[212:215], a[88:91], v[120:123]
v_mfma_f32_16x16x32_bf16 v[124:127], a[212:215], a[92:95], v[124:127]
s_waitcnt lgkmcnt(4)
ds_read_b64_tr_b16 a[206:207], v48 offset:18944
v_mfma_f32_16x16x32_bf16 v[124:127], a[208:211], a[76:79], v[124:127]
buffer_load_dwordx4 v5, s[20:23], s74 offen offset:3072 lds
v_mfma_f32_16x16x32_bf16 v[188:191], a[220:223], a[92:95], v[188:191]
s_add_u32 s73, s73, 262144
s_add_u32 s74, s74, 110592
ds_read_b64_tr_b16 a[208:209], v49 offset:3072
v_mfma_f32_16x16x32_bf16 v[188:191], a[216:219], a[76:79], v[188:191]
v_mfma_f32_16x16x32_bf16 v[184:187], a[216:219], a[72:75], v[184:187]
ds_read_b64_tr_b16 a[210:211], v49 offset:3584
v_mfma_f32_16x16x32_bf16 v[184:187], a[220:223], a[88:91], v[184:187]
v_mfma_f32_16x16x32_bf16 v[180:183], a[220:223], a[84:87], v[180:183]
ds_read_b64_tr_b16 a[212:213], v49 offset:19456
v_mfma_f32_16x16x32_bf16 v[180:183], a[216:219], a[68:71], v[180:183]
buffer_load_dwordx4 a[144:147], v2, s[8:11], s72 offen offset:0 sc1
v_mfma_f32_16x16x32_bf16 v[176:179], a[216:219], a[64:67], v[176:179]
ds_read_b64_tr_b16 a[214:215], v49 offset:19968
v_mfma_f32_16x16x32_bf16 v[176:179], a[220:223], a[80:83], v[176:179]
v_mfma_f32_16x16x32_bf16 a[0:3], a[192:195], a[64:67], a[0:3]
s_waitcnt lgkmcnt(4)
ds_read_b64_tr_b16 a[216:217], v49 offset:2048
v_mfma_f32_16x16x32_bf16 a[0:3], a[196:199], a[80:83], a[0:3]
v_mfma_f32_16x16x32_bf16 a[4:7], a[196:199], a[84:87], a[4:7]
ds_read_b64_tr_b16 a[218:219], v49 offset:2560
v_mfma_f32_16x16x32_bf16 a[4:7], a[192:195], a[68:71], a[4:7]
buffer_load_dwordx4 a[148:151], v2, s[8:11], s72 offen offset:1024 sc1
v_mfma_f32_16x16x32_bf16 a[8:11], a[192:195], a[72:75], a[8:11]
ds_read_b64_tr_b16 a[220:221], v49 offset:18432
v_mfma_f32_16x16x32_bf16 a[8:11], a[196:199], a[88:91], a[8:11]
v_mfma_f32_16x16x32_bf16 a[12:15], a[196:199], a[92:95], a[12:15]
ds_read_b64_tr_b16 a[222:223], v49 offset:18944
v_mfma_f32_16x16x32_bf16 a[12:15], a[192:195], a[76:79], a[12:15]
v_mfma_f32_16x16x32_bf16 v[204:207], a[204:207], a[92:95], v[204:207]
ds_read_b64_tr_b16 a[192:193], v50 offset:3072
v_mfma_f32_16x16x32_bf16 v[204:207], a[200:203], a[76:79], v[204:207]
buffer_load_dwordx4 a[152:155], v2, s[8:11], s72 offen offset:2048 sc1
v_mfma_f32_16x16x32_bf16 v[200:203], a[200:203], a[72:75], v[200:203]
ds_read_b64_tr_b16 a[194:195], v50 offset:3584
v_mfma_f32_16x16x32_bf16 v[200:203], a[204:207], a[88:91], v[200:203]
v_mfma_f32_16x16x32_bf16 v[196:199], a[204:207], a[84:87], v[196:199]
ds_read_b64_tr_b16 a[196:197], v50 offset:19456
v_mfma_f32_16x16x32_bf16 v[196:199], a[200:203], a[68:71], v[196:199]
v_mfma_f32_16x16x32_bf16 v[192:195], a[200:203], a[64:67], v[192:195]
s_waitcnt lgkmcnt(4)
ds_read_b64_tr_b16 a[198:199], v50 offset:19968
v_mfma_f32_16x16x32_bf16 v[192:195], a[204:207], a[80:83], v[192:195]
buffer_load_dwordx4 a[156:159], v2, s[8:11], s72 offen offset:3072 sc1
v_mfma_f32_16x16x32_bf16 a[16:19], a[208:211], a[64:67], a[16:19]
s_add_u32 s72, s72, 4096
ds_read_b64_tr_b16 a[200:201], v50 offset:2048
v_mfma_f32_16x16x32_bf16 a[16:19], a[212:215], a[80:83], a[16:19]
s_getpc_b64 s[82:83]
CODE3:
s_add_u32 s82, s82, TAILC0-CODE3-12288
s_addc_u32 s83, s83, 0
v_mfma_f32_16x16x32_bf16 a[20:23], a[212:215], a[84:87], a[20:23]
s_lshr_b32 s80, s2, 3
s_lshl2_add_u32 s80, s80, s68
ds_read_b64_tr_b16 a[202:203], v50 offset:2560
v_mfma_f32_16x16x32_bf16 a[20:23], a[208:211], a[68:71], a[20:23]
s_min_u32 s80, s80, 95
s_lshl_b32 s80, s80, 7
v_mfma_f32_16x16x32_bf16 a[24:27], a[208:211], a[72:75], a[24:27]
ds_read_b64_tr_b16 a[204:205], v50 offset:18432
v_mov_b32 v40, s80
v_mfma_f32_16x16x32_bf16 a[24:27], a[212:215], a[88:91], a[24:27]
global_load_dword v18, v40, s[82:83]
v_mfma_f32_16x16x32_bf16 a[28:31], a[212:215], a[92:95], a[28:31]
ds_read_b64_tr_b16 a[206:207], v50 offset:18944
v_mfma_f32_16x16x32_bf16 a[28:31], a[208:211], a[76:79], a[28:31]
s_waitcnt lgkmcnt(4)
v_mfma_f32_16x16x32_bf16 v[220:223], a[220:223], a[92:95], v[220:223]
ds_read_b64_tr_b16 a[208:209], v51 offset:3072
v_mfma_f32_16x16x32_bf16 v[220:223], a[216:219], a[76:79], v[220:223]
v_mfma_f32_16x16x32_bf16 v[216:219], a[216:219], a[72:75], v[216:219]
ds_read_b64_tr_b16 a[210:211], v51 offset:3584
v_mfma_f32_16x16x32_bf16 v[216:219], a[220:223], a[88:91], v[216:219]
v_mfma_f32_16x16x32_bf16 v[212:215], a[220:223], a[84:87], v[212:215]
ds_read_b64_tr_b16 a[212:213], v51 offset:19456
v_mfma_f32_16x16x32_bf16 v[212:215], a[216:219], a[68:71], v[212:215]
v_mfma_f32_16x16x32_bf16 v[208:211], a[216:219], a[64:67], v[208:211]
ds_read_b64_tr_b16 a[214:215], v51 offset:19968
v_mfma_f32_16x16x32_bf16 v[208:211], a[220:223], a[80:83], v[208:211]
v_mfma_f32_16x16x32_bf16 a[32:35], a[192:195], a[64:67], a[32:35]
ds_read_b64_tr_b16 a[216:217], v51 offset:2048
v_mfma_f32_16x16x32_bf16 a[32:35], a[196:199], a[80:83], a[32:35]
v_mfma_f32_16x16x32_bf16 a[36:39], a[196:199], a[84:87], a[36:39]
ds_read_b64_tr_b16 a[218:219], v51 offset:2560
v_mfma_f32_16x16x32_bf16 a[36:39], a[192:195], a[68:71], a[36:39]
v_mfma_f32_16x16x32_bf16 a[40:43], a[192:195], a[72:75], a[40:43]
ds_read_b64_tr_b16 a[220:221], v51 offset:18432
v_mfma_f32_16x16x32_bf16 a[40:43], a[196:199], a[88:91], a[40:43]
v_mfma_f32_16x16x32_bf16 a[44:47], a[196:199], a[92:95], a[44:47]
s_waitcnt lgkmcnt(4)
ds_read_b64_tr_b16 a[222:223], v51 offset:18944
v_mfma_f32_16x16x32_bf16 a[44:47], a[192:195], a[76:79], a[44:47]
s_waitcnt vmcnt(20)
s_barrier
v_mfma_f32_16x16x32_bf16 v[236:239], a[204:207], a[92:95], v[236:239]
s_add_u32 m0, s75, 32768
ds_read_b64_tr_b16 a[192:193], v44 offset:32768
v_mfma_f32_16x16x32_bf16 v[236:239], a[200:203], a[76:79], v[236:239]
buffer_load_dwordx4 v3, s[12:15], s73 offen lds
v_mfma_f32_16x16x32_bf16 v[232:235], a[200:203], a[72:75], v[232:235]
ds_read_b64_tr_b16 a[194:195], v44 offset:33792
v_mfma_f32_16x16x32_bf16 v[232:235], a[204:207], a[88:91], v[232:235]
v_mfma_f32_16x16x32_bf16 v[228:231], a[204:207], a[84:87], v[228:231]
ds_read_b64_tr_b16 a[196:197], v44 offset:49152
v_mfma_f32_16x16x32_bf16 v[228:231], a[200:203], a[68:71], v[228:231]
v_mfma_f32_16x16x32_bf16 v[224:227], a[200:203], a[64:67], v[224:227]
ds_read_b64_tr_b16 a[198:199], v44 offset:50176
v_mfma_f32_16x16x32_bf16 v[224:227], a[204:207], a[80:83], v[224:227]
buffer_load_dwordx4 v4, s[12:15], s73 offen offset:1024 lds
v_mfma_f32_16x16x32_bf16 a[48:51], a[208:211], a[64:67], a[48:51]
s_waitcnt lgkmcnt(4)
ds_read_b64_tr_b16 a[200:201], v44 offset:32776
v_mfma_f32_16x16x32_bf16 a[48:51], a[212:215], a[80:83], a[48:51]
v_mfma_f32_16x16x32_bf16 a[52:55], a[212:215], a[84:87], a[52:55]
ds_read_b64_tr_b16 a[202:203], v44 offset:33800
v_mfma_f32_16x16x32_bf16 a[52:55], a[208:211], a[68:71], a[52:55]
v_mfma_f32_16x16x32_bf16 a[56:59], a[208:211], a[72:75], a[56:59]
ds_read_b64_tr_b16 a[204:205], v44 offset:49160
v_mfma_f32_16x16x32_bf16 a[56:59], a[212:215], a[88:91], a[56:59]
buffer_load_dwordx4 v5, s[16:19], s74 offen offset:2048 lds
v_mfma_f32_16x16x32_bf16 a[60:63], a[212:215], a[92:95], a[60:63]
ds_read_b64_tr_b16 a[206:207], v44 offset:50184
v_mfma_f32_16x16x32_bf16 a[60:63], a[208:211], a[76:79], a[60:63]
v_mfma_f32_16x16x32_bf16 v[252:255], a[220:223], a[92:95], v[252:255]
ds_read_b64_tr_b16 a[208:209], v45 offset:32768
v_mfma_f32_16x16x32_bf16 v[252:255], a[216:219], a[76:79], v[252:255]
v_mfma_f32_16x16x32_bf16 v[248:251], a[216:219], a[72:75], v[248:251]
ds_read_b64_tr_b16 a[210:211], v45 offset:33792
v_mfma_f32_16x16x32_bf16 v[248:251], a[220:223], a[88:91], v[248:251]
buffer_load_dwordx4 v5, s[20:23], s74 offen offset:3072 lds
v_mfma_f32_16x16x32_bf16 v[244:247], a[220:223], a[84:87], v[244:247]
s_add_u32 s73, s73, 262144
s_add_u32 s74, s74, 110592
ds_read_b64_tr_b16 a[212:213], v45 offset:49152
v_mfma_f32_16x16x32_bf16 v[244:247], a[216:219], a[68:71], v[244:247]
v_mfma_f32_16x16x32_bf16 v[240:243], a[216:219], a[64:67], v[240:243]
ds_read_b64_tr_b16 a[214:215], v45 offset:50176
v_mfma_f32_16x16x32_bf16 v[240:243], a[220:223], a[80:83], v[240:243]
s_waitcnt lgkmcnt(4)
v_mfma_f32_16x16x32_bf16 v[64:67], a[192:195], a[96:99], v[64:67]
ds_read_b64_tr_b16 a[216:217], v45 offset:32776
v_mfma_f32_16x16x32_bf16 v[64:67], a[196:199], a[112:115], v[64:67]
buffer_load_dwordx4 a[160:163], v2, s[8:11], s72 offen offset:0 sc1
v_mfma_f32_16x16x32_bf16 v[68:71], a[196:199], a[116:119], v[68:71]
ds_read_b64_tr_b16 a[218:219], v45 offset:33800
v_mfma_f32_16x16x32_bf16 v[68:71], a[192:195], a[100:103], v[68:71]
v_mfma_f32_16x16x32_bf16 v[72:75], a[192:195], a[104:107], v[72:75]
ds_read_b64_tr_b16 a[220:221], v45 offset:49160
v_mfma_f32_16x16x32_bf16 v[72:75], a[196:199], a[120:123], v[72:75]
v_mfma_f32_16x16x32_bf16 v[76:79], a[196:199], a[124:127], v[76:79]
ds_read_b64_tr_b16 a[222:223], v45 offset:50184
v_mfma_f32_16x16x32_bf16 v[76:79], a[192:195], a[108:111], v[76:79]
buffer_load_dwordx4 a[164:167], v2, s[8:11], s72 offen offset:1024 sc1
v_mfma_f32_16x16x32_bf16 v[140:143], a[204:207], a[124:127], v[140:143]
ds_read_b64_tr_b16 a[192:193], v46 offset:32768
v_mfma_f32_16x16x32_bf16 v[140:143], a[200:203], a[108:111], v[140:143]
v_mfma_f32_16x16x32_bf16 v[136:139], a[200:203], a[104:107], v[136:139]
ds_read_b64_tr_b16 a[194:195], v46 offset:33792
v_mfma_f32_16x16x32_bf16 v[136:139], a[204:207], a[120:123], v[136:139]
v_mfma_f32_16x16x32_bf16 v[132:135], a[204:207], a[116:119], v[132:135]
ds_read_b64_tr_b16 a[196:197], v46 offset:49152
v_mfma_f32_16x16x32_bf16 v[132:135], a[200:203], a[100:103], v[132:135]
buffer_load_dwordx4 a[168:171], v2, s[8:11], s72 offen offset:2048 sc1
v_mfma_f32_16x16x32_bf16 v[128:131], a[200:203], a[96:99], v[128:131]
ds_read_b64_tr_b16 a[198:199], v46 offset:50176
v_mfma_f32_16x16x32_bf16 v[128:131], a[204:207], a[112:115], v[128:131]
s_waitcnt lgkmcnt(4)
v_mfma_f32_16x16x32_bf16 v[80:83], a[208:211], a[96:99], v[80:83]
ds_read_b64_tr_b16 a[200:201], v46 offset:32776
v_mfma_f32_16x16x32_bf16 v[80:83], a[212:215], a[112:115], v[80:83]
v_mfma_f32_16x16x32_bf16 v[84:87], a[212:215], a[116:119], v[84:87]
ds_read_b64_tr_b16 a[202:203], v46 offset:33800
v_mfma_f32_16x16x32_bf16 v[84:87], a[208:211], a[100:103], v[84:87]
buffer_load_dwordx4 a[172:175], v2, s[8:11], s72 offen offset:3072 sc1
v_mfma_f32_16x16x32_bf16 v[88:91], a[208:211], a[104:107], v[88:91]
s_add_u32 s72, s72, 4096
ds_read_b64_tr_b16 a[204:205], v46 offset:49160
v_mfma_f32_16x16x32_bf16 v[88:91], a[212:215], a[120:123], v[88:91]
s_add_u32 m0, s75, 49152
v_mfma_f32_16x16x32_bf16 v[92:95], a[212:215], a[124:127], v[92:95]
ds_read_b64_tr_b16 a[206:207], v46 offset:50184
v_mfma_f32_16x16x32_bf16 v[92:95], a[208:211], a[108:111], v[92:95]
v_mfma_f32_16x16x32_bf16 v[156:159], a[220:223], a[124:127], v[156:159]
ds_read_b64_tr_b16 a[208:209], v47 offset:32768
v_mfma_f32_16x16x32_bf16 v[156:159], a[216:219], a[108:111], v[156:159]
buffer_load_dwordx4 v3, s[12:15], s73 offen lds
v_mfma_f32_16x16x32_bf16 v[152:155], a[216:219], a[104:107], v[152:155]
ds_read_b64_tr_b16 a[210:211], v47 offset:33792
v_mfma_f32_16x16x32_bf16 v[152:155], a[220:223], a[120:123], v[152:155]
v_mfma_f32_16x16x32_bf16 v[148:151], a[220:223], a[116:119], v[148:151]
ds_read_b64_tr_b16 a[212:213], v47 offset:49152
v_mfma_f32_16x16x32_bf16 v[148:151], a[216:219], a[100:103], v[148:151]
v_mfma_f32_16x16x32_bf16 v[144:147], a[216:219], a[96:99], v[144:147]
s_waitcnt lgkmcnt(4)
ds_read_b64_tr_b16 a[214:215], v47 offset:50176
v_mfma_f32_16x16x32_bf16 v[144:147], a[220:223], a[112:115], v[144:147]
buffer_load_dwordx4 v4, s[12:15], s73 offen offset:1024 lds
v_mfma_f32_16x16x32_bf16 v[96:99], a[192:195], a[96:99], v[96:99]
ds_read_b64_tr_b16 a[216:217], v47 offset:32776
v_mfma_f32_16x16x32_bf16 v[96:99], a[196:199], a[112:115], v[96:99]
v_mfma_f32_16x16x32_bf16 v[100:103], a[196:199], a[116:119], v[100:103]
ds_read_b64_tr_b16 a[218:219], v47 offset:33800
v_mfma_f32_16x16x32_bf16 v[100:103], a[192:195], a[100:103], v[100:103]
v_mfma_f32_16x16x32_bf16 v[104:107], a[192:195], a[104:107], v[104:107]
ds_read_b64_tr_b16 a[220:221], v47 offset:49160
v_mfma_f32_16x16x32_bf16 v[104:107], a[196:199], a[120:123], v[104:107]
buffer_load_dwordx4 v5, s[16:19], s74 offen offset:2048 lds
v_mfma_f32_16x16x32_bf16 v[108:111], a[196:199], a[124:127], v[108:111]
ds_read_b64_tr_b16 a[222:223], v47 offset:50184
v_mfma_f32_16x16x32_bf16 v[108:111], a[192:195], a[108:111], v[108:111]
s_waitcnt lgkmcnt(4)
v_mfma_f32_16x16x32_bf16 v[172:175], a[204:207], a[124:127], v[172:175]
ds_read_b64_tr_b16 a[192:193], v48 offset:35840
v_mfma_f32_16x16x32_bf16 v[172:175], a[200:203], a[108:111], v[172:175]
v_mfma_f32_16x16x32_bf16 v[168:171], a[200:203], a[104:107], v[168:171]
ds_read_b64_tr_b16 a[194:195], v48 offset:36352
v_mfma_f32_16x16x32_bf16 v[168:171], a[204:207], a[120:123], v[168:171]
buffer_load_dwordx4 v5, s[20:23], s74 offen offset:3072 lds
v_mfma_f32_16x16x32_bf16 v[164:167], a[204:207], a[116:119], v[164:167]
s_add_u32 s73, s73, 262144
s_add_u32 s74, s74, 110592
ds_read_b64_tr_b16 a[196:197], v48 offset:52224
v_mfma_f32_16x16x32_bf16 v[164:167], a[200:203], a[100:103], v[164:167]
v_mfma_f32_16x16x32_bf16 v[160:163], a[200:203], a[96:99], v[160:163]
ds_read_b64_tr_b16 a[198:199], v48 offset:52736
v_mfma_f32_16x16x32_bf16 v[160:163], a[204:207], a[112:115], v[160:163]
v_mfma_f32_16x16x32_bf16 v[112:115], a[208:211], a[96:99], v[112:115]
ds_read_b64_tr_b16 a[200:201], v48 offset:34816
v_mfma_f32_16x16x32_bf16 v[112:115], a[212:215], a[112:115], v[112:115]
buffer_load_dwordx4 a[176:179], v2, s[8:11], s72 offen offset:0 sc1
v_mfma_f32_16x16x32_bf16 v[116:119], a[212:215], a[116:119], v[116:119]
ds_read_b64_tr_b16 a[202:203], v48 offset:35328
v_mfma_f32_16x16x32_bf16 v[116:119], a[208:211], a[100:103], v[116:119]
v_mfma_f32_16x16x32_bf16 v[120:123], a[208:211], a[104:107], v[120:123]
ds_read_b64_tr_b16 a[204:205], v48 offset:51200
v_mfma_f32_16x16x32_bf16 v[120:123], a[212:215], a[120:123], v[120:123]
v_mfma_f32_16x16x32_bf16 v[124:127], a[212:215], a[124:127], v[124:127]
s_waitcnt lgkmcnt(4)
ds_read_b64_tr_b16 a[206:207], v48 offset:51712
v_mfma_f32_16x16x32_bf16 v[124:127], a[208:211], a[108:111], v[124:127]
buffer_load_dwordx4 a[180:183], v2, s[8:11], s72 offen offset:1024 sc1
v_mfma_f32_16x16x32_bf16 v[188:191], a[220:223], a[124:127], v[188:191]
ds_read_b64_tr_b16 a[208:209], v49 offset:35840
v_mfma_f32_16x16x32_bf16 v[188:191], a[216:219], a[108:111], v[188:191]
v_mfma_f32_16x16x32_bf16 v[184:187], a[216:219], a[104:107], v[184:187]
ds_read_b64_tr_b16 a[210:211], v49 offset:36352
v_mfma_f32_16x16x32_bf16 v[184:187], a[220:223], a[120:123], v[184:187]
v_mfma_f32_16x16x32_bf16 v[180:183], a[220:223], a[116:119], v[180:183]
ds_read_b64_tr_b16 a[212:213], v49 offset:52224
v_mfma_f32_16x16x32_bf16 v[180:183], a[216:219], a[100:103], v[180:183]
buffer_load_dwordx4 a[184:187], v2, s[8:11], s72 offen offset:2048 sc1
v_mfma_f32_16x16x32_bf16 v[176:179], a[216:219], a[96:99], v[176:179]
ds_read_b64_tr_b16 a[214:215], v49 offset:52736
v_mfma_f32_16x16x32_bf16 v[176:179], a[220:223], a[112:115], v[176:179]
v_mfma_f32_16x16x32_bf16 a[0:3], a[192:195], a[96:99], a[0:3]
s_waitcnt lgkmcnt(4)
ds_read_b64_tr_b16 a[216:217], v49 offset:34816
v_mfma_f32_16x16x32_bf16 a[0:3], a[196:199], a[112:115], a[0:3]
v_mfma_f32_16x16x32_bf16 a[4:7], a[196:199], a[116:119], a[4:7]
ds_read_b64_tr_b16 a[218:219], v49 offset:35328
v_mfma_f32_16x16x32_bf16 a[4:7], a[192:195], a[100:103], a[4:7]
buffer_load_dwordx4 a[188:191], v2, s[8:11], s72 offen offset:3072 sc1
v_mfma_f32_16x16x32_bf16 a[8:11], a[192:195], a[104:107], a[8:11]
s_add_u32 s72, s72, 4096
ds_read_b64_tr_b16 a[220:221], v49 offset:51200
v_mfma_f32_16x16x32_bf16 a[8:11], a[196:199], a[120:123], a[8:11]
v_mfma_f32_16x16x32_bf16 a[12:15], a[196:199], a[124:127], a[12:15]
ds_read_b64_tr_b16 a[222:223], v49 offset:51712
v_mfma_f32_16x16x32_bf16 a[12:15], a[192:195], a[108:111], a[12:15]
v_mfma_f32_16x16x32_bf16 v[204:207], a[204:207], a[124:127], v[204:207]
ds_read_b64_tr_b16 a[192:193], v50 offset:35840
v_mfma_f32_16x16x32_bf16 v[204:207], a[200:203], a[108:111], v[204:207]
v_mfma_f32_16x16x32_bf16 v[200:203], a[200:203], a[104:107], v[200:203]
ds_read_b64_tr_b16 a[194:195], v50 offset:36352
v_mfma_f32_16x16x32_bf16 v[200:203], a[204:207], a[120:123], v[200:203]
v_mfma_f32_16x16x32_bf16 v[196:199], a[204:207], a[116:119], v[196:199]
ds_read_b64_tr_b16 a[196:197], v50 offset:52224
v_mfma_f32_16x16x32_bf16 v[196:199], a[200:203], a[100:103], v[196:199]
v_mfma_f32_16x16x32_bf16 v[192:195], a[200:203], a[96:99], v[192:195]
ds_read_b64_tr_b16 a[198:199], v50 offset:52736
v_mfma_f32_16x16x32_bf16 v[192:195], a[204:207], a[112:115], v[192:195]
s_waitcnt lgkmcnt(4)
v_mfma_f32_16x16x32_bf16 a[16:19], a[208:211], a[96:99], a[16:19]
ds_read_b64_tr_b16 a[200:201], v50 offset:34816
v_mfma_f32_16x16x32_bf16 a[16:19], a[212:215], a[112:115], a[16:19]
v_mfma_f32_16x16x32_bf16 a[20:23], a[212:215], a[116:119], a[20:23]
ds_read_b64_tr_b16 a[202:203], v50 offset:35328
v_mfma_f32_16x16x32_bf16 a[20:23], a[208:211], a[100:103], a[20:23]
v_mfma_f32_16x16x32_bf16 a[24:27], a[208:211], a[104:107], a[24:27]
ds_read_b64_tr_b16 a[204:205], v50 offset:51200
v_mfma_f32_16x16x32_bf16 a[24:27], a[212:215], a[120:123], a[24:27]
v_mfma_f32_16x16x32_bf16 a[28:31], a[212:215], a[124:127], a[28:31]
ds_read_b64_tr_b16 a[206:207], v50 offset:51712
v_mfma_f32_16x16x32_bf16 a[28:31], a[208:211], a[108:111], a[28:31]
v_mfma_f32_16x16x32_bf16 v[220:223], a[220:223], a[124:127], v[220:223]
ds_read_b64_tr_b16 a[208:209], v51 offset:35840
v_mfma_f32_16x16x32_bf16 v[220:223], a[216:219], a[108:111], v[220:223]
v_mfma_f32_16x16x32_bf16 v[216:219], a[216:219], a[104:107], v[216:219]
ds_read_b64_tr_b16 a[210:211], v51 offset:36352
v_mfma_f32_16x16x32_bf16 v[216:219], a[220:223], a[120:123], v[216:219]
v_mfma_f32_16x16x32_bf16 v[212:215], a[220:223], a[116:119], v[212:215]
ds_read_b64_tr_b16 a[212:213], v51 offset:52224
v_mfma_f32_16x16x32_bf16 v[212:215], a[216:219], a[100:103], v[212:215]
v_mfma_f32_16x16x32_bf16 v[208:211], a[216:219], a[96:99], v[208:211]
ds_read_b64_tr_b16 a[214:215], v51 offset:52736
v_mfma_f32_16x16x32_bf16 v[208:211], a[220:223], a[112:115], v[208:211]
s_waitcnt lgkmcnt(4)
v_mfma_f32_16x16x32_bf16 a[32:35], a[192:195], a[96:99], a[32:35]
ds_read_b64_tr_b16 a[216:217], v51 offset:34816
v_mfma_f32_16x16x32_bf16 a[32:35], a[196:199], a[112:115], a[32:35]
v_mfma_f32_16x16x32_bf16 a[36:39], a[196:199], a[116:119], a[36:39]
ds_read_b64_tr_b16 a[218:219], v51 offset:35328
v_mfma_f32_16x16x32_bf16 a[36:39], a[192:195], a[100:103], a[36:39]
v_mfma_f32_16x16x32_bf16 a[40:43], a[192:195], a[104:107], a[40:43]
ds_read_b64_tr_b16 a[220:221], v51 offset:51200
v_mfma_f32_16x16x32_bf16 a[40:43], a[196:199], a[120:123], a[40:43]
v_mfma_f32_16x16x32_bf16 a[44:47], a[196:199], a[124:127], a[44:47]
ds_read_b64_tr_b16 a[222:223], v51 offset:51712
v_mfma_f32_16x16x32_bf16 a[44:47], a[192:195], a[108:111], a[44:47]
s_waitcnt vmcnt(17)
s_barrier
v_mfma_f32_16x16x32_bf16 v[236:239], a[204:207], a[124:127], v[236:239]
s_add_u32 m0, s75, 65536
ds_read_b64_tr_b16 a[192:193], v10 offset:0
v_mfma_f32_16x16x32_bf16 v[236:239], a[200:203], a[108:111], v[236:239]
buffer_load_dwordx4 v3, s[12:15], s73 offen lds
v_mfma_f32_16x16x32_bf16 v[232:235], a[200:203], a[104:107], v[232:235]
ds_read_b64_tr_b16 a[194:195], v10 offset:1024
v_mfma_f32_16x16x32_bf16 v[232:235], a[204:207], a[120:123], v[232:235]
v_mfma_f32_16x16x32_bf16 v[228:231], a[204:207], a[116:119], v[228:231]
ds_read_b64_tr_b16 a[196:197], v10 offset:16384
v_mfma_f32_16x16x32_bf16 v[228:231], a[200:203], a[100:103], v[228:231]
v_mfma_f32_16x16x32_bf16 v[224:227], a[200:203], a[96:99], v[224:227]
s_waitcnt lgkmcnt(4)
ds_read_b64_tr_b16 a[198:199], v10 offset:17408
v_mfma_f32_16x16x32_bf16 v[224:227], a[204:207], a[112:115], v[224:227]
buffer_load_dwordx4 v4, s[12:15], s73 offen offset:1024 lds
v_mfma_f32_16x16x32_bf16 a[48:51], a[208:211], a[96:99], a[48:51]
ds_read_b64_tr_b16 a[200:201], v10 offset:8
v_mfma_f32_16x16x32_bf16 a[48:51], a[212:215], a[112:115], a[48:51]
v_mfma_f32_16x16x32_bf16 a[52:55], a[212:215], a[116:119], a[52:55]
ds_read_b64_tr_b16 a[202:203], v10 offset:1032
v_mfma_f32_16x16x32_bf16 a[52:55], a[208:211], a[100:103], a[52:55]
v_mfma_f32_16x16x32_bf16 a[56:59], a[208:211], a[104:107], a[56:59]
ds_read_b64_tr_b16 a[204:205], v10 offset:16392
v_mfma_f32_16x16x32_bf16 a[56:59], a[212:215], a[120:123], a[56:59]
buffer_load_dwordx4 v5, s[16:19], s74 offen offset:2048 lds
v_mfma_f32_16x16x32_bf16 a[60:63], a[212:215], a[124:127], a[60:63]
ds_read_b64_tr_b16 a[206:207], v10 offset:17416
v_mfma_f32_16x16x32_bf16 a[60:63], a[208:211], a[108:111], a[60:63]
s_waitcnt lgkmcnt(4)
v_mfma_f32_16x16x32_bf16 v[252:255], a[220:223], a[124:127], v[252:255]
ds_read_b64_tr_b16 a[208:209], v11 offset:0
v_mfma_f32_16x16x32_bf16 v[252:255], a[216:219], a[108:111], v[252:255]
v_mfma_f32_16x16x32_bf16 v[248:251], a[216:219], a[104:107], v[248:251]
ds_read_b64_tr_b16 a[210:211], v11 offset:1024
v_mfma_f32_16x16x32_bf16 v[248:251], a[220:223], a[120:123], v[248:251]
buffer_load_dwordx4 v5, s[20:23], s74 offen offset:3072 lds
v_mfma_f32_16x16x32_bf16 v[244:247], a[220:223], a[116:119], v[244:247]
s_add_u32 s73, s73, 262144
s_add_u32 s74, s74, 110592
ds_read_b64_tr_b16 a[212:213], v11 offset:16384
v_mfma_f32_16x16x32_bf16 v[244:247], a[216:219], a[100:103], v[244:247]
v_mfma_f32_16x16x32_bf16 v[240:243], a[216:219], a[96:99], v[240:243]
ds_read_b64_tr_b16 a[214:215], v11 offset:17408
v_mfma_f32_16x16x32_bf16 v[240:243], a[220:223], a[112:115], v[240:243]
v_mfma_f32_16x16x32_bf16 v[64:67], a[192:195], a[128:131], v[64:67]
ds_read_b64_tr_b16 a[216:217], v11 offset:8
v_mfma_f32_16x16x32_bf16 v[64:67], a[196:199], a[144:147], v[64:67]
buffer_load_dwordx4 a[64:67], v2, s[8:11], s72 offen offset:0 sc1
v_mfma_f32_16x16x32_bf16 v[68:71], a[196:199], a[148:151], v[68:71]
ds_read_b64_tr_b16 a[218:219], v11 offset:1032
v_mfma_f32_16x16x32_bf16 v[68:71], a[192:195], a[132:135], v[68:71]
v_mfma_f32_16x16x32_bf16 v[72:75], a[192:195], a[136:139], v[72:75]
ds_read_b64_tr_b16 a[220:221], v11 offset:16392
v_mfma_f32_16x16x32_bf16 v[72:75], a[196:199], a[152:155], v[72:75]
v_mfma_f32_16x16x32_bf16 v[76:79], a[196:199], a[156:159], v[76:79]
s_waitcnt lgkmcnt(4)
ds_read_b64_tr_b16 a[222:223], v11 offset:17416
v_mfma_f32_16x16x32_bf16 v[76:79], a[192:195], a[140:143], v[76:79]
buffer_load_dwordx4 a[68:71], v2, s[8:11], s72 offen offset:1024 sc1
v_mfma_f32_16x16x32_bf16 v[140:143], a[204:207], a[156:159], v[140:143]
ds_read_b64_tr_b16 a[192:193], v12 offset:0
v_mfma_f32_16x16x32_bf16 v[140:143], a[200:203], a[140:143], v[140:143]
v_mfma_f32_16x16x32_bf16 v[136:139], a[200:203], a[136:139], v[136:139]
ds_read_b64_tr_b16 a[194:195], v12 offset:1024
v_mfma_f32_16x16x32_bf16 v[136:139], a[204:207], a[152:155], v[136:139]
v_mfma_f32_16x16x32_bf16 v[132:135], a[204:207], a[148:151], v[132:135]
ds_read_b64_tr_b16 a[196:197], v12 offset:16384
v_mfma_f32_16x16x32_bf16 v[132:135], a[200:203], a[132:135], v[132:135]
buffer_load_dwordx4 a[72:75], v2, s[8:11], s72 offen offset:2048 sc1
v_mfma_f32_16x16x32_bf16 v[128:131], a[200:203], a[128:131], v[128:131]
ds_read_b64_tr_b16 a[198:199], v12 offset:17408
v_mfma_f32_16x16x32_bf16 v[128:131], a[204:207], a[144:147], v[128:131]
v_mfma_f32_16x16x32_bf16 v[80:83], a[208:211], a[128:131], v[80:83]
s_waitcnt lgkmcnt(4)
ds_read_b64_tr_b16 a[200:201], v12 offset:8
v_mfma_f32_16x16x32_bf16 v[80:83], a[212:215], a[144:147], v[80:83]
v_mfma_f32_16x16x32_bf16 v[84:87], a[212:215], a[148:151], v[84:87]
ds_read_b64_tr_b16 a[202:203], v12 offset:1032
v_mfma_f32_16x16x32_bf16 v[84:87], a[208:211], a[132:135], v[84:87]
buffer_load_dwordx4 a[76:79], v2, s[8:11], s72 offen offset:3072 sc1
v_mfma_f32_16x16x32_bf16 v[88:91], a[208:211], a[136:139], v[88:91]
s_add_u32 s72, s72, 4096
ds_read_b64_tr_b16 a[204:205], v12 offset:16392
v_mfma_f32_16x16x32_bf16 v[88:91], a[212:215], a[152:155], v[88:91]
v_min_u32 v9, 15, v1
v_mfma_f32_16x16x32_bf16 v[92:95], a[212:215], a[156:159], v[92:95]
ds_read_b64_tr_b16 a[206:207], v12 offset:17416
v_lshlrev_b32 v9, 7, v9
v_mfma_f32_16x16x32_bf16 v[92:95], a[208:211], a[140:143], v[92:95]
s_lshl2_add_u32 s80, s70, s68
s_lshl_b32 s80, s80, 11
v_mfma_f32_16x16x32_bf16 v[156:159], a[220:223], a[156:159], v[156:159]
ds_read_b64_tr_b16 a[208:209], v13 offset:0
v_mfma_f32_16x16x32_bf16 v[156:159], a[216:219], a[140:143], v[156:159]
buffer_load_dword v18, v9, s[24:27], s80 offen
v_mfma_f32_16x16x32_bf16 v[152:155], a[216:219], a[136:139], v[152:155]
s_add_u32 s80, s80, 32768
ds_read_b64_tr_b16 a[210:211], v13 offset:1024
v_mfma_f32_16x16x32_bf16 v[152:155], a[220:223], a[152:155], v[152:155]
v_mfma_f32_16x16x32_bf16 v[148:151], a[220:223], a[148:151], v[148:151]
ds_read_b64_tr_b16 a[212:213], v13 offset:16384
v_mfma_f32_16x16x32_bf16 v[148:151], a[216:219], a[132:135], v[148:151]
v_mfma_f32_16x16x32_bf16 v[144:147], a[216:219], a[128:131], v[144:147]
s_waitcnt lgkmcnt(4)
ds_read_b64_tr_b16 a[214:215], v13 offset:17408
v_mfma_f32_16x16x32_bf16 v[144:147], a[220:223], a[144:147], v[144:147]
buffer_load_dword v18, v9, s[28:31], s80 offen
v_mfma_f32_16x16x32_bf16 v[96:99], a[192:195], a[128:131], v[96:99]
s_add_u32 m0, s75, 81920
ds_read_b64_tr_b16 a[216:217], v13 offset:8
v_mfma_f32_16x16x32_bf16 v[96:99], a[196:199], a[144:147], v[96:99]
v_mfma_f32_16x16x32_bf16 v[100:103], a[196:199], a[148:151], v[100:103]
ds_read_b64_tr_b16 a[218:219], v13 offset:1032
v_mfma_f32_16x16x32_bf16 v[100:103], a[192:195], a[132:135], v[100:103]
v_mfma_f32_16x16x32_bf16 v[104:107], a[192:195], a[136:139], v[104:107]
ds_read_b64_tr_b16 a[220:221], v13 offset:16392
v_mfma_f32_16x16x32_bf16 v[104:107], a[196:199], a[152:155], v[104:107]
buffer_load_dwordx4 v3, s[12:15], s73 offen lds
v_mfma_f32_16x16x32_bf16 v[108:111], a[196:199], a[156:159], v[108:111]
ds_read_b64_tr_b16 a[222:223], v13 offset:17416
v_mfma_f32_16x16x32_bf16 v[108:111], a[192:195], a[140:143], v[108:111]
s_waitcnt lgkmcnt(4)
v_mfma_f32_16x16x32_bf16 v[172:175], a[204:207], a[156:159], v[172:175]
ds_read_b64_tr_b16 a[192:193], v14 offset:3072
v_mfma_f32_16x16x32_bf16 v[172:175], a[200:203], a[140:143], v[172:175]
v_mfma_f32_16x16x32_bf16 v[168:171], a[200:203], a[136:139], v[168:171]
ds_read_b64_tr_b16 a[194:195], v14 offset:3584
v_mfma_f32_16x16x32_bf16 v[168:171], a[204:207], a[152:155], v[168:171]
buffer_load_dwordx4 v4, s[12:15], s73 offen offset:1024 lds
v_mfma_f32_16x16x32_bf16 v[164:167], a[204:207], a[148:151], v[164:167]
ds_read_b64_tr_b16 a[196:197], v14 offset:19456
v_mfma_f32_16x16x32_bf16 v[164:167], a[200:203], a[132:135], v[164:167]
v_mfma_f32_16x16x32_bf16 v[160:163], a[200:203], a[128:131], v[160:163]
ds_read_b64_tr_b16 a[198:199], v14 offset:19968
v_mfma_f32_16x16x32_bf16 v[160:163], a[204:207], a[144:147], v[160:163]
v_mfma_f32_16x16x32_bf16 v[112:115], a[208:211], a[128:131], v[112:115]
ds_read_b64_tr_b16 a[200:201], v14 offset:2048
v_mfma_f32_16x16x32_bf16 v[112:115], a[212:215], a[144:147], v[112:115]
buffer_load_dwordx4 v5, s[16:19], s74 offen offset:2048 lds
v_mfma_f32_16x16x32_bf16 v[116:119], a[212:215], a[148:151], v[116:119]
ds_read_b64_tr_b16 a[202:203], v14 offset:2560
v_mfma_f32_16x16x32_bf16 v[116:119], a[208:211], a[132:135], v[116:119]
v_mfma_f32_16x16x32_bf16 v[120:123], a[208:211], a[136:139], v[120:123]
ds_read_b64_tr_b16 a[204:205], v14 offset:18432
v_mfma_f32_16x16x32_bf16 v[120:123], a[212:215], a[152:155], v[120:123]
v_mfma_f32_16x16x32_bf16 v[124:127], a[212:215], a[156:159], v[124:127]
s_waitcnt lgkmcnt(4)
ds_read_b64_tr_b16 a[206:207], v14 offset:18944
v_mfma_f32_16x16x32_bf16 v[124:127], a[208:211], a[140:143], v[124:127]
buffer_load_dwordx4 v5, s[20:23], s74 offen offset:3072 lds
v_mfma_f32_16x16x32_bf16 v[188:191], a[220:223], a[156:159], v[188:191]
s_add_u32 s73, s73, 262144
s_add_u32 s74, s74, 110592
ds_read_b64_tr_b16 a[208:209], v15 offset:3072
v_mfma_f32_16x16x32_bf16 v[188:191], a[216:219], a[140:143], v[188:191]
v_mfma_f32_16x16x32_bf16 v[184:187], a[216:219], a[136:139], v[184:187]
ds_read_b64_tr_b16 a[210:211], v15 offset:3584
v_mfma_f32_16x16x32_bf16 v[184:187], a[220:223], a[152:155], v[184:187]
v_mfma_f32_16x16x32_bf16 v[180:183], a[220:223], a[148:151], v[180:183]
ds_read_b64_tr_b16 a[212:213], v15 offset:19456
v_mfma_f32_16x16x32_bf16 v[180:183], a[216:219], a[132:135], v[180:183]
buffer_load_dwordx4 a[80:83], v2, s[8:11], s72 offen offset:0 sc1
v_mfma_f32_16x16x32_bf16 v[176:179], a[216:219], a[128:131], v[176:179]
ds_read_b64_tr_b16 a[214:215], v15 offset:19968
v_mfma_f32_16x16x32_bf16 v[176:179], a[220:223], a[144:147], v[176:179]
v_mfma_f32_16x16x32_bf16 a[0:3], a[192:195], a[128:131], a[0:3]
s_waitcnt lgkmcnt(4)
ds_read_b64_tr_b16 a[216:217], v15 offset:2048
v_mfma_f32_16x16x32_bf16 a[0:3], a[196:199], a[144:147], a[0:3]
v_mfma_f32_16x16x32_bf16 a[4:7], a[196:199], a[148:151], a[4:7]
ds_read_b64_tr_b16 a[218:219], v15 offset:2560
v_mfma_f32_16x16x32_bf16 a[4:7], a[192:195], a[132:135], a[4:7]
buffer_load_dwordx4 a[84:87], v2, s[8:11], s72 offen offset:1024 sc1
v_mfma_f32_16x16x32_bf16 a[8:11], a[192:195], a[136:139], a[8:11]
ds_read_b64_tr_b16 a[220:221], v15 offset:18432
v_mfma_f32_16x16x32_bf16 a[8:11], a[196:199], a[152:155], a[8:11]
v_mfma_f32_16x16x32_bf16 a[12:15], a[196:199], a[156:159], a[12:15]
ds_read_b64_tr_b16 a[222:223], v15 offset:18944
v_mfma_f32_16x16x32_bf16 a[12:15], a[192:195], a[140:143], a[12:15]
v_mfma_f32_16x16x32_bf16 v[204:207], a[204:207], a[156:159], v[204:207]
ds_read_b64_tr_b16 a[192:193], v16 offset:3072
v_mfma_f32_16x16x32_bf16 v[204:207], a[200:203], a[140:143], v[204:207]
buffer_load_dwordx4 a[88:91], v2, s[8:11], s72 offen offset:2048 sc1
v_mfma_f32_16x16x32_bf16 v[200:203], a[200:203], a[136:139], v[200:203]
ds_read_b64_tr_b16 a[194:195], v16 offset:3584
v_mfma_f32_16x16x32_bf16 v[200:203], a[204:207], a[152:155], v[200:203]
v_mfma_f32_16x16x32_bf16 v[196:199], a[204:207], a[148:151], v[196:199]
ds_read_b64_tr_b16 a[196:197], v16 offset:19456
v_mfma_f32_16x16x32_bf16 v[196:199], a[200:203], a[132:135], v[196:199]
v_mfma_f32_16x16x32_bf16 v[192:195], a[200:203], a[128:131], v[192:195]
s_waitcnt lgkmcnt(4)
ds_read_b64_tr_b16 a[198:199], v16 offset:19968
v_mfma_f32_16x16x32_bf16 v[192:195], a[204:207], a[144:147], v[192:195]
buffer_load_dwordx4 a[92:95], v2, s[8:11], s72 offen offset:3072 sc1
v_mfma_f32_16x16x32_bf16 a[16:19], a[208:211], a[128:131], a[16:19]
s_add_u32 s72, s72, 4096
ds_read_b64_tr_b16 a[200:201], v16 offset:2048
v_mfma_f32_16x16x32_bf16 a[16:19], a[212:215], a[144:147], a[16:19]
v_mfma_f32_16x16x32_bf16 a[20:23], a[212:215], a[148:151], a[20:23]
ds_read_b64_tr_b16 a[202:203], v16 offset:2560
v_mfma_f32_16x16x32_bf16 a[20:23], a[208:211], a[132:135], a[20:23]
v_mfma_f32_16x16x32_bf16 a[24:27], a[208:211], a[136:139], a[24:27]
ds_read_b64_tr_b16 a[204:205], v16 offset:18432
v_mfma_f32_16x16x32_bf16 a[24:27], a[212:215], a[152:155], a[24:27]
v_mfma_f32_16x16x32_bf16 a[28:31], a[212:215], a[156:159], a[28:31]
ds_read_b64_tr_b16 a[206:207], v16 offset:18944
v_mfma_f32_16x16x32_bf16 a[28:31], a[208:211], a[140:143], a[28:31]
s_waitcnt lgkmcnt(4)
v_mfma_f32_16x16x32_bf16 v[220:223], a[220:223], a[156:159], v[220:223]
ds_read_b64_tr_b16 a[208:209], v17 offset:3072
v_mfma_f32_16x16x32_bf16 v[220:223], a[216:219], a[140:143], v[220:223]
v_mfma_f32_16x16x32_bf16 v[216:219], a[216:219], a[136:139], v[216:219]
ds_read_b64_tr_b16 a[210:211], v17 offset:3584
v_mfma_f32_16x16x32_bf16 v[216:219], a[220:223], a[152:155], v[216:219]
v_mfma_f32_16x16x32_bf16 v[212:215], a[220:223], a[148:151], v[212:215]
ds_read_b64_tr_b16 a[212:213], v17 offset:19456
v_mfma_f32_16x16x32_bf16 v[212:215], a[216:219], a[132:135], v[212:215]
v_mfma_f32_16x16x32_bf16 v[208:211], a[216:219], a[128:131], v[208:211]
ds_read_b64_tr_b16 a[214:215], v17 offset:19968
v_mfma_f32_16x16x32_bf16 v[208:211], a[220:223], a[144:147], v[208:211]
v_mfma_f32_16x16x32_bf16 a[32:35], a[192:195], a[128:131], a[32:35]
ds_read_b64_tr_b16 a[216:217], v17 offset:2048
v_mfma_f32_16x16x32_bf16 a[32:35], a[196:199], a[144:147], a[32:35]
v_mfma_f32_16x16x32_bf16 a[36:39], a[196:199], a[148:151], a[36:39]
ds_read_b64_tr_b16 a[218:219], v17 offset:2560
v_mfma_f32_16x16x32_bf16 a[36:39], a[192:195], a[132:135], a[36:39]
v_mfma_f32_16x16x32_bf16 a[40:43], a[192:195], a[136:139], a[40:43]
ds_read_b64_tr_b16 a[220:221], v17 offset:18432
v_mfma_f32_16x16x32_bf16 a[40:43], a[196:199], a[152:155], a[40:43]
v_mfma_f32_16x16x32_bf16 a[44:47], a[196:199], a[156:159], a[44:47]
s_waitcnt lgkmcnt(4)
ds_read_b64_tr_b16 a[222:223], v17 offset:18944
v_mfma_f32_16x16x32_bf16 a[44:47], a[192:195], a[140:143], a[44:47]
s_waitcnt vmcnt(18)
s_barrier
v_mfma_f32_16x16x32_bf16 v[236:239], a[204:207], a[156:159], v[236:239]
s_add_u32 m0, s75, 98304
ds_read_b64_tr_b16 a[192:193], v10 offset:32768
v_mfma_f32_16x16x32_bf16 v[236:239], a[200:203], a[140:143], v[236:239]
buffer_load_dwordx4 v3, s[12:15], s73 offen lds
v_mfma_f32_16x16x32_bf16 v[232:235], a[200:203], a[136:139], v[232:235]
ds_read_b64_tr_b16 a[194:195], v10 offset:33792
v_mfma_f32_16x16x32_bf16 v[232:235], a[204:207], a[152:155], v[232:235]
v_mfma_f32_16x16x32_bf16 v[228:231], a[204:207], a[148:151], v[228:231]
ds_read_b64_tr_b16 a[196:197], v10 offset:49152
v_mfma_f32_16x16x32_bf16 v[228:231], a[200:203], a[132:135], v[228:231]
v_mfma_f32_16x16x32_bf16 v[224:227], a[200:203], a[128:131], v[224:227]
ds_read_b64_tr_b16 a[198:199], v10 offset:50176
v_mfma_f32_16x16x32_bf16 v[224:227], a[204:207], a[144:147], v[224:227]
buffer_load_dwordx4 v4, s[12:15], s73 offen offset:1024 lds
v_mfma_f32_16x16x32_bf16 a[48:51], a[208:211], a[128:131], a[48:51]
s_waitcnt lgkmcnt(4)
ds_read_b64_tr_b16 a[200:201], v10 offset:32776
v_mfma_f32_16x16x32_bf16 a[48:51], a[212:215], a[144:147], a[48:51]
v_mfma_f32_16x16x32_bf16 a[52:55], a[212:215], a[148:151], a[52:55]
ds_read_b64_tr_b16 a[202:203], v10 offset:33800
v_mfma_f32_16x16x32_bf16 a[52:55], a[208:211], a[132:135], a[52:55]
v_mfma_f32_16x16x32_bf16 a[56:59], a[208:211], a[136:139], a[56:59]
ds_read_b64_tr_b16 a[204:205], v10 offset:49160
v_mfma_f32_16x16x32_bf16 a[56:59], a[212:215], a[152:155], a[56:59]
buffer_load_dwordx4 v5, s[16:19], s74 offen offset:2048 lds
v_mfma_f32_16x16x32_bf16 a[60:63], a[212:215], a[156:159], a[60:63]
ds_read_b64_tr_b16 a[206:207], v10 offset:50184
v_mfma_f32_16x16x32_bf16 a[60:63], a[208:211], a[140:143], a[60:63]
v_mfma_f32_16x16x32_bf16 v[252:255], a[220:223], a[156:159], v[252:255]
ds_read_b64_tr_b16 a[208:209], v11 offset:32768
v_mfma_f32_16x16x32_bf16 v[252:255], a[216:219], a[140:143], v[252:255]
v_mfma_f32_16x16x32_bf16 v[248:251], a[216:219], a[136:139], v[248:251]
ds_read_b64_tr_b16 a[210:211], v11 offset:33792
v_mfma_f32_16x16x32_bf16 v[248:251], a[220:223], a[152:155], v[248:251]
buffer_load_dwordx4 v5, s[20:23], s74 offen offset:3072 lds
v_mfma_f32_16x16x32_bf16 v[244:247], a[220:223], a[148:151], v[244:247]
s_add_u32 s73, s73, 262144
s_add_u32 s74, s74, 110592
ds_read_b64_tr_b16 a[212:213], v11 offset:49152
v_mfma_f32_16x16x32_bf16 v[244:247], a[216:219], a[132:135], v[244:247]
v_mfma_f32_16x16x32_bf16 v[240:243], a[216:219], a[128:131], v[240:243]
ds_read_b64_tr_b16 a[214:215], v11 offset:50176
v_mfma_f32_16x16x32_bf16 v[240:243], a[220:223], a[144:147], v[240:243]
s_waitcnt lgkmcnt(4)
v_mfma_f32_16x16x32_bf16 v[64:67], a[192:195], a[160:163], v[64:67]
ds_read_b64_tr_b16 a[216:217], v11 offset:32776
v_accvgpr_write_b32 a128, 0
v_mfma_f32_16x16x32_bf16 v[64:67], a[196:199], a[176:179], v[64:67]
buffer_load_dwordx4 a[96:99], v2, s[8:11], s72 offen offset:0 sc1
v_mfma_f32_16x16x32_bf16 v[68:71], a[196:199], a[180:183], v[68:71]
ds_read_b64_tr_b16 a[218:219], v11 offset:33800
v_accvgpr_write_b32 a129, 0
v_mfma_f32_16x16x32_bf16 v[68:71], a[192:195], a[164:167], v[68:71]
v_accvgpr_write_b32 a130, 0
v_accvgpr_write_b32 a131, 0
v_mfma_f32_16x16x32_bf16 v[72:75], a[192:195], a[168:171], v[72:75]
ds_read_b64_tr_b16 a[220:221], v11 offset:49160
v_accvgpr_write_b32 a132, 0
v_mfma_f32_16x16x32_bf16 v[72:75], a[196:199], a[184:187], v[72:75]
v_accvgpr_write_b32 a133, 0
v_accvgpr_write_b32 a134, 0
v_mfma_f32_16x16x32_bf16 v[76:79], a[196:199], a[188:191], v[76:79]
ds_read_b64_tr_b16 a[222:223], v11 offset:50184
v_accvgpr_write_b32 a135, 0
v_mfma_f32_16x16x32_bf16 v[76:79], a[192:195], a[172:175], v[76:79]
buffer_load_dwordx4 a[100:103], v2, s[8:11], s72 offen offset:1024 sc1
v_mfma_f32_16x16x32_bf16 v[140:143], a[204:207], a[188:191], v[140:143]
ds_read_b64_tr_b16 a[192:193], v12 offset:32768
v_accvgpr_write_b32 a136, 0
v_mfma_f32_16x16x32_bf16 v[140:143], a[200:203], a[172:175], v[140:143]
v_accvgpr_write_b32 a137, 0
v_accvgpr_write_b32 a138, 0
v_mfma_f32_16x16x32_bf16 v[136:139], a[200:203], a[168:171], v[136:139]
ds_read_b64_tr_b16 a[194:195], v12 offset:33792
v_accvgpr_write_b32 a139, 0
v_mfma_f32_16x16x32_bf16 v[136:139], a[204:207], a[184:187], v[136:139]
v_accvgpr_write_b32 a140, 0
v_accvgpr_write_b32 a141, 0
v_mfma_f32_16x16x32_bf16 v[132:135], a[204:207], a[180:183], v[132:135]
ds_read_b64_tr_b16 a[196:197], v12 offset:49152
v_accvgpr_write_b32 a142, 0
v_mfma_f32_16x16x32_bf16 v[132:135], a[200:203], a[164:167], v[132:135]
buffer_load_dwordx4 a[104:107], v2, s[8:11], s72 offen offset:2048 sc1
v_mfma_f32_16x16x32_bf16 v[128:131], a[200:203], a[160:163], v[128:131]
ds_read_b64_tr_b16 a[198:199], v12 offset:50176
v_accvgpr_write_b32 a143, 0
v_mfma_f32_16x16x32_bf16 v[128:131], a[204:207], a[176:179], v[128:131]
s_waitcnt lgkmcnt(4)
v_accvgpr_write_b32 a144, 0
v_accvgpr_write_b32 a145, 0
v_mfma_f32_16x16x32_bf16 v[80:83], a[208:211], a[160:163], v[80:83]
ds_read_b64_tr_b16 a[200:201], v12 offset:32776
v_accvgpr_write_b32 a146, 0
v_mfma_f32_16x16x32_bf16 v[80:83], a[212:215], a[176:179], v[80:83]
v_accvgpr_write_b32 a147, 0
v_accvgpr_write_b32 a148, 0
v_mfma_f32_16x16x32_bf16 v[84:87], a[212:215], a[180:183], v[84:87]
ds_read_b64_tr_b16 a[202:203], v12 offset:33800
v_accvgpr_write_b32 a149, 0
v_mfma_f32_16x16x32_bf16 v[84:87], a[208:211], a[164:167], v[84:87]
buffer_load_dwordx4 a[108:111], v2, s[8:11], s72 offen offset:3072 sc1
v_mfma_f32_16x16x32_bf16 v[88:91], a[208:211], a[168:171], v[88:91]
s_add_u32 s72, s72, 4096
ds_read_b64_tr_b16 a[204:205], v12 offset:49160
v_accvgpr_write_b32 a150, 0
v_mfma_f32_16x16x32_bf16 v[88:91], a[212:215], a[184:187], v[88:91]
s_add_u32 m0, s75, 114688
v_accvgpr_write_b32 a151, 0
v_accvgpr_write_b32 a152, 0
v_mfma_f32_16x16x32_bf16 v[92:95], a[212:215], a[188:191], v[92:95]
ds_read_b64_tr_b16 a[206:207], v12 offset:50184
v_accvgpr_write_b32 a153, 0
v_mfma_f32_16x16x32_bf16 v[92:95], a[208:211], a[172:175], v[92:95]
v_accvgpr_write_b32 a154, 0
v_accvgpr_write_b32 a155, 0
v_mfma_f32_16x16x32_bf16 v[156:159], a[220:223], a[188:191], v[156:159]
ds_read_b64_tr_b16 a[208:209], v13 offset:32768
v_accvgpr_write_b32 a156, 0
v_mfma_f32_16x16x32_bf16 v[156:159], a[216:219], a[172:175], v[156:159]
buffer_load_dwordx4 v3, s[12:15], s73 offen lds
v_mfma_f32_16x16x32_bf16 v[152:155], a[216:219], a[168:171], v[152:155]
ds_read_b64_tr_b16 a[210:211], v13 offset:33792
v_accvgpr_write_b32 a157, 0
v_mfma_f32_16x16x32_bf16 v[152:155], a[220:223], a[184:187], v[152:155]
v_accvgpr_write_b32 a158, 0
v_accvgpr_write_b32 a159, 0
v_mfma_f32_16x16x32_bf16 v[148:151], a[220:223], a[180:183], v[148:151]
ds_read_b64_tr_b16 a[212:213], v13 offset:49152
v_mfma_f32_16x16x32_bf16 v[148:151], a[216:219], a[164:167], v[148:151]
v_mfma_f32_16x16x32_bf16 v[144:147], a[216:219], a[160:163], v[144:147]
s_waitcnt lgkmcnt(4)
ds_read_b64_tr_b16 a[214:215], v13 offset:50176
v_mfma_f32_16x16x32_bf16 v[144:147], a[220:223], a[176:179], v[144:147]
buffer_load_dwordx4 v4, s[12:15], s73 offen offset:1024 lds
v_mfma_f32_16x16x32_bf16 v[96:99], a[192:195], a[160:163], v[96:99]
ds_read_b64_tr_b16 a[216:217], v13 offset:32776
v_mfma_f32_16x16x32_bf16 v[96:99], a[196:199], a[176:179], v[96:99]
v_mfma_f32_16x16x32_bf16 v[100:103], a[196:199], a[180:183], v[100:103]
ds_read_b64_tr_b16 a[218:219], v13 offset:33800
v_mfma_f32_16x16x32_bf16 v[100:103], a[192:195], a[164:167], v[100:103]
v_mfma_f32_16x16x32_bf16 v[104:107], a[192:195], a[168:171], v[104:107]
ds_read_b64_tr_b16 a[220:221], v13 offset:49160
v_mfma_f32_16x16x32_bf16 v[104:107], a[196:199], a[184:187], v[104:107]
buffer_load_dwordx4 v5, s[16:19], s74 offen offset:2048 lds
v_mfma_f32_16x16x32_bf16 v[108:111], a[196:199], a[188:191], v[108:111]
ds_read_b64_tr_b16 a[222:223], v13 offset:50184
v_mfma_f32_16x16x32_bf16 v[108:111], a[192:195], a[172:175], v[108:111]
s_waitcnt lgkmcnt(4)
v_mfma_f32_16x16x32_bf16 v[172:175], a[204:207], a[188:191], v[172:175]
ds_read_b64_tr_b16 a[192:193], v14 offset:35840
v_mfma_f32_16x16x32_bf16 v[172:175], a[200:203], a[172:175], v[172:175]
v_mfma_f32_16x16x32_bf16 v[168:171], a[200:203], a[168:171], v[168:171]
ds_read_b64_tr_b16 a[194:195], v14 offset:36352
v_mfma_f32_16x16x32_bf16 v[168:171], a[204:207], a[184:187], v[168:171]
buffer_load_dwordx4 v5, s[20:23], s74 offen offset:3072 lds
v_mfma_f32_16x16x32_bf16 v[164:167], a[204:207], a[180:183], v[164:167]
s_add_u32 s73, s73, 262144
s_add_u32 s74, s74, 110592
ds_read_b64_tr_b16 a[196:197], v14 offset:52224
v_mfma_f32_16x16x32_bf16 v[164:167], a[200:203], a[164:167], v[164:167]
v_mfma_f32_16x16x32_bf16 v[160:163], a[200:203], a[160:163], v[160:163]
ds_read_b64_tr_b16 a[198:199], v14 offset:52736
v_mfma_f32_16x16x32_bf16 v[160:163], a[204:207], a[176:179], v[160:163]
v_mfma_f32_16x16x32_bf16 v[112:115], a[208:211], a[160:163], v[112:115]
ds_read_b64_tr_b16 a[200:201], v14 offset:34816
v_mfma_f32_16x16x32_bf16 v[112:115], a[212:215], a[176:179], v[112:115]
buffer_load_dwordx4 a[112:115], v2, s[8:11], s72 offen offset:0 sc1
v_mfma_f32_16x16x32_bf16 v[116:119], a[212:215], a[180:183], v[116:119]
ds_read_b64_tr_b16 a[202:203], v14 offset:35328
v_mfma_f32_16x16x32_bf16 v[116:119], a[208:211], a[164:167], v[116:119]
v_mfma_f32_16x16x32_bf16 v[120:123], a[208:211], a[168:171], v[120:123]
ds_read_b64_tr_b16 a[204:205], v14 offset:51200
v_mfma_f32_16x16x32_bf16 v[120:123], a[212:215], a[184:187], v[120:123]
v_mfma_f32_16x16x32_bf16 v[124:127], a[212:215], a[188:191], v[124:127]
s_waitcnt lgkmcnt(4)
ds_read_b64_tr_b16 a[206:207], v14 offset:51712
v_mfma_f32_16x16x32_bf16 v[124:127], a[208:211], a[172:175], v[124:127]
buffer_load_dwordx4 a[116:119], v2, s[8:11], s72 offen offset:1024 sc1
v_mfma_f32_16x16x32_bf16 v[188:191], a[220:223], a[188:191], v[188:191]
ds_read_b64_tr_b16 a[208:209], v15 offset:35840
v_mfma_f32_16x16x32_bf16 v[188:191], a[216:219], a[172:175], v[188:191]
v_mfma_f32_16x16x32_bf16 v[184:187], a[216:219], a[168:171], v[184:187]
ds_read_b64_tr_b16 a[210:211], v15 offset:36352
v_mfma_f32_16x16x32_bf16 v[184:187], a[220:223], a[184:187], v[184:187]
v_mfma_f32_16x16x32_bf16 v[180:183], a[220:223], a[180:183], v[180:183]
ds_read_b64_tr_b16 a[212:213], v15 offset:52224
v_mfma_f32_16x16x32_bf16 v[180:183], a[216:219], a[164:167], v[180:183]
buffer_load_dwordx4 a[120:123], v2, s[8:11], s72 offen offset:2048 sc1
v_mfma_f32_16x16x32_bf16 v[176:179], a[216:219], a[160:163], v[176:179]
ds_read_b64_tr_b16 a[214:215], v15 offset:52736
v_mfma_f32_16x16x32_bf16 v[176:179], a[220:223], a[176:179], v[176:179]
v_mfma_f32_16x16x32_bf16 a[0:3], a[192:195], a[160:163], a[0:3]
s_waitcnt lgkmcnt(4)
ds_read_b64_tr_b16 a[216:217], v15 offset:34816
v_mfma_f32_16x16x32_bf16 a[0:3], a[196:199], a[176:179], a[0:3]
v_mfma_f32_16x16x32_bf16 a[4:7], a[196:199], a[180:183], a[4:7]
ds_read_b64_tr_b16 a[218:219], v15 offset:35328
v_mfma_f32_16x16x32_bf16 a[4:7], a[192:195], a[164:167], a[4:7]
buffer_load_dwordx4 a[124:127], v2, s[8:11], s72 offen offset:3072 sc1
v_mfma_f32_16x16x32_bf16 a[8:11], a[192:195], a[168:171], a[8:11]
s_add_u32 s72, s72, 4096
ds_read_b64_tr_b16 a[220:221], v15 offset:51200
v_mfma_f32_16x16x32_bf16 a[8:11], a[196:199], a[184:187], a[8:11]
v_mfma_f32_16x16x32_bf16 a[12:15], a[196:199], a[188:191], a[12:15]
s_bfe_u32 s83, s2, 0x10002
ds_read_b64_tr_b16 a[222:223], v15 offset:51712
v_mfma_f32_16x16x32_bf16 a[12:15], a[192:195], a[172:175], a[12:15]
s_lshl_b32 s83, s83, 3
v_mfma_f32_16x16x32_bf16 v[204:207], a[204:207], a[188:191], v[204:207]
s_lshr_b32 s80, s2, 5
ds_read_b64_tr_b16 a[192:193], v16 offset:35840
v_mfma_f32_16x16x32_bf16 v[204:207], a[200:203], a[172:175], v[204:207]
s_add_u32 s83, s83, s80
v_mfma_f32_16x16x32_bf16 v[200:203], a[200:203], a[168:171], v[200:203]
s_bfe_u32 s84, s2, 0x20003
ds_read_b64_tr_b16 a[194:195], v16 offset:36352
v_mfma_f32_16x16x32_bf16 v[200:203], a[204:207], a[184:187], v[200:203]
s_and_b32 s85, s2, 3
v_mfma_f32_16x16x32_bf16 v[196:199], a[204:207], a[180:183], v[196:199]
s_lshr_b32 s80, s85, 1
ds_read_b64_tr_b16 a[196:197], v16 offset:52224
v_mfma_f32_16x16x32_bf16 v[196:199], a[200:203], a[164:167], v[196:199]
s_lshl1_add_u32 s80, s83, s80
v_mfma_f32_16x16x32_bf16 v[192:195], a[200:203], a[160:163], v[192:195]
s_lshl2_add_u32 s80, s80, s68
ds_read_b64_tr_b16 a[198:199], v16 offset:52736
v_mfma_f32_16x16x32_bf16 v[192:195], a[204:207], a[176:179], v[192:195]
s_waitcnt lgkmcnt(4)
v_mfma_f32_16x16x32_bf16 a[16:19], a[208:211], a[160:163], a[16:19]
s_mul_i32 s80, s80, 20480
ds_read_b64_tr_b16 a[200:201], v16 offset:34816
v_mfma_f32_16x16x32_bf16 a[16:19], a[212:215], a[176:179], a[16:19]
s_and_b32 s81, s85, 1
v_mfma_f32_16x16x32_bf16 a[20:23], a[212:215], a[180:183], a[20:23]
s_lshl1_add_u32 s81, s84, s81
ds_read_b64_tr_b16 a[202:203], v16 offset:35328
v_mfma_f32_16x16x32_bf16 a[20:23], a[208:211], a[164:167], a[20:23]
s_mul_i32 s81, s81, 160
v_mfma_f32_16x16x32_bf16 a[24:27], a[208:211], a[168:171], a[24:27]
s_add_u32 s80, s80, s81
ds_read_b64_tr_b16 a[204:205], v16 offset:51200
v_mfma_f32_16x16x32_bf16 a[24:27], a[212:215], a[184:187], a[24:27]
s_add_u32 s20, s44, s80
s_addc_u32 s21, s45, 0
v_mfma_f32_16x16x32_bf16 a[28:31], a[212:215], a[188:191], a[28:31]
s_mov_b32 s22, 19360
ds_read_b64_tr_b16 a[206:207], v16 offset:51712
v_mfma_f32_16x16x32_bf16 a[28:31], a[208:211], a[172:175], a[28:31]
s_mov_b32 s23, 0x20000
v_mfma_f32_16x16x32_bf16 v[220:223], a[220:223], a[188:191], v[220:223]
s_add_u32 s8, s62, s80
s_addc_u32 s9, s63, 0
ds_read_b64_tr_b16 a[208:209], v17 offset:35840
v_mfma_f32_16x16x32_bf16 v[220:223], a[216:219], a[172:175], v[220:223]
s_mov_b32 s10, 19360
v_mfma_f32_16x16x32_bf16 v[216:219], a[216:219], a[168:171], v[216:219]
s_mov_b32 s11, 0x20000
ds_read_b64_tr_b16 a[210:211], v17 offset:36352
v_mfma_f32_16x16x32_bf16 v[216:219], a[220:223], a[184:187], v[216:219]
v_and_b32 v63, 15, v1
v_mfma_f32_16x16x32_bf16 v[212:215], a[220:223], a[180:183], v[212:215]
ds_read_b64_tr_b16 a[212:213], v17 offset:52224
v_mul_u32_u24 v63, 1280, v63
v_mfma_f32_16x16x32_bf16 v[212:215], a[216:219], a[164:167], v[212:215]
v_lshrrev_b32 v52, 4, v1
v_mfma_f32_16x16x32_bf16 v[208:211], a[216:219], a[160:163], v[208:211]
ds_read_b64_tr_b16 a[214:215], v17 offset:52736
v_lshl_add_u32 v63, v52, 3, v63
v_mfma_f32_16x16x32_bf16 v[208:211], a[220:223], a[176:179], v[208:211]
s_waitcnt lgkmcnt(4)
v_mfma_f32_16x16x32_bf16 a[32:35], a[192:195], a[160:163], a[32:35]
s_lshr_b32 s95, s83, 1
ds_read_b64_tr_b16 a[216:217], v17 offset:34816
v_mfma_f32_16x16x32_bf16 a[32:35], a[196:199], a[176:179], a[32:35]
s_lshl2_add_u32 s95, s95, s85
v_mfma_f32_16x16x32_bf16 a[36:39], a[196:199], a[180:183], a[36:39]
s_lshl_b32 s95, s95, 10
ds_read_b64_tr_b16 a[218:219], v17 offset:35328
v_mfma_f32_16x16x32_bf16 a[36:39], a[192:195], a[164:167], a[36:39]
s_mul_i32 s80, s85, 7
v_mfma_f32_16x16x32_bf16 a[40:43], a[192:195], a[168:171], a[40:43]
s_add_u32 s80, s80, 64
ds_read_b64_tr_b16 a[220:221], v17 offset:51200
v_mfma_f32_16x16x32_bf16 a[40:43], a[196:199], a[184:187], a[40:43]
s_lshl_b32 s72, s80, 13
v_mfma_f32_16x16x32_bf16 a[44:47], a[196:199], a[188:191], a[44:47]
s_mul_i32 s74, s80, 20480
ds_read_b64_tr_b16 a[222:223], v17 offset:51712
v_mfma_f32_16x16x32_bf16 a[44:47], a[192:195], a[172:175], a[44:47]
s_waitcnt vmcnt(16)
s_barrier
v_mfma_f32_16x16x32_bf16 v[236:239], a[204:207], a[188:191], v[236:239]
s_add_u32 m0, s77, 0
s_mov_b32 s76, 0
ds_read_b64_tr_b16 a[192:193], v48 offset:3072
v_mfma_f32_16x16x32_bf16 v[236:239], a[200:203], a[172:175], v[236:239]
buffer_load_dwordx4 v32, s[24:27], s76 offen offset:0 sc1 lds
v_mfma_f32_16x16x32_bf16 v[232:235], a[200:203], a[168:171], v[232:235]
s_lshl_b32 s73, s85, 17
ds_read_b64_tr_b16 a[194:195], v48 offset:3584
v_mfma_f32_16x16x32_bf16 v[232:235], a[204:207], a[184:187], v[232:235]
s_mul_i32 s75, s85, 327680
v_mfma_f32_16x16x32_bf16 v[228:231], a[204:207], a[180:183], v[228:231]
s_lshl2_add_u32 s80, s83, s84
ds_read_b64_tr_b16 a[196:197], v48 offset:19456
v_mfma_f32_16x16x32_bf16 v[228:231], a[200:203], a[164:167], v[228:231]
s_mul_i32 s80, s80, 159744
v_mfma_f32_16x16x32_bf16 v[224:227], a[200:203], a[160:163], v[224:227]
s_waitcnt lgkmcnt(4)
ds_read_b64_tr_b16 a[198:199], v48 offset:19968
v_mfma_f32_16x16x32_bf16 v[224:227], a[204:207], a[176:179], v[224:227]
buffer_load_dwordx4 v33, s[24:27], s76 offen offset:1024 sc1 lds
v_mfma_f32_16x16x32_bf16 a[48:51], a[208:211], a[160:163], a[48:51]
s_add_u32 m0, s77, 8192
s_mov_b32 s76, 8192
ds_read_b64_tr_b16 a[200:201], v48 offset:2048
v_mfma_f32_16x16x32_bf16 a[48:51], a[212:215], a[176:179], a[48:51]
s_add_u32 s80, s80, 37748736
v_mfma_f32_16x16x32_bf16 a[52:55], a[212:215], a[180:183], a[52:55]
s_add_u32 s12, s66, s80
s_addc_u32 s13, s67, 0
ds_read_b64_tr_b16 a[202:203], v48 offset:2560
v_mfma_f32_16x16x32_bf16 a[52:55], a[208:211], a[164:167], a[52:55]
s_mov_b32 s14, 147456
v_mfma_f32_16x16x32_bf16 a[56:59], a[208:211], a[168:171], a[56:59]
s_mov_b32 s15, 0x20000
ds_read_b64_tr_b16 a[204:205], v48 offset:18432
v_mfma_f32_16x16x32_bf16 a[56:59], a[212:215], a[184:187], a[56:59]
buffer_load_dwordx4 v32, s[24:27], s76 offen offset:0 sc1 lds
v_mfma_f32_16x16x32_bf16 a[60:63], a[212:215], a[188:191], a[60:63]
s_waitcnt lgkmcnt(4)
ds_read_b64_tr_b16 a[206:207], v48 offset:18944
v_mfma_f32_16x16x32_bf16 a[60:63], a[208:211], a[172:175], a[60:63]
s_waitcnt vmcnt(3)
s_barrier
v_mfma_f32_16x16x32_bf16 v[252:255], a[220:223], a[188:191], v[252:255]
s_and_b32 s80, s68, 2
ds_read_b64_tr_b16 a[208:209], v48 offset:35840
v_mfma_f32_16x16x32_bf16 v[252:255], a[216:219], a[172:175], v[252:255]
s_add_u32 s80, s80, 0
v_mfma_f32_16x16x32_bf16 v[248:251], a[216:219], a[168:171], v[248:251]
s_xor_b32 s81, s80, s85
ds_read_b64_tr_b16 a[210:211], v48 offset:36352
v_mfma_f32_16x16x32_bf16 v[248:251], a[220:223], a[184:187], v[248:251]
buffer_load_dwordx4 v33, s[24:27], s76 offen offset:1024 sc1 lds
v_mfma_f32_16x16x32_bf16 v[244:247], a[220:223], a[180:183], v[244:247]
s_add_u32 m0, s77, 16384
s_mov_b32 s76, 16384
ds_read_b64_tr_b16 a[212:213], v48 offset:52224
v_mfma_f32_16x16x32_bf16 v[244:247], a[216:219], a[164:167], v[244:247]
s_mul_i32 s80, s80, 3
v_mfma_f32_16x16x32_bf16 v[240:243], a[216:219], a[160:163], v[240:243]
s_add_u32 s80, s80, s81
ds_read_b64_tr_b16 a[214:215], v48 offset:52736
v_mfma_f32_16x16x32_bf16 v[240:243], a[220:223], a[176:179], v[240:243]
s_sub_u32 s80, s80, 1
v_mfma_f32_16x16x32_bf16 a[0:3], a[192:195], a[64:67], a[0:3]
s_waitcnt lgkmcnt(4)
ds_read_b64_tr_b16 a[216:217], v48 offset:34816
v_accvgpr_write_b32 a160, 0
v_mfma_f32_16x16x32_bf16 a[0:3], a[196:199], a[80:83], a[0:3]
buffer_load_dwordx4 v32, s[24:27], s76 offen offset:0 sc1 lds
v_mfma_f32_16x16x32_bf16 a[4:7], a[196:199], a[84:87], a[4:7]
s_mul_i32 s80, s80, 12288
ds_read_b64_tr_b16 a[218:219], v48 offset:35328
v_accvgpr_write_b32 a161, 0
v_mfma_f32_16x16x32_bf16 a[4:7], a[192:195], a[68:71], a[4:7]
s_and_b32 s16, s68, 1
v_accvgpr_write_b32 a162, 0
v_accvgpr_write_b32 a163, 0
v_mfma_f32_16x16x32_bf16 a[8:11], a[192:195], a[72:75], a[8:11]
s_mul_i32 s16, s16, 6144
ds_read_b64_tr_b16 a[220:221], v48 offset:51200
v_accvgpr_write_b32 a164, 0
v_mfma_f32_16x16x32_bf16 a[8:11], a[196:199], a[88:91], a[8:11]
s_add_u32 s16, s16, s80
v_accvgpr_write_b32 a165, 0
v_accvgpr_write_b32 a166, 0
v_mfma_f32_16x16x32_bf16 a[12:15], a[196:199], a[92:95], a[12:15]
s_cmp_eq_u32 s81, 0
s_cselect_b32 s16, 0x1000000, s16
ds_read_b64_tr_b16 a[222:223], v48 offset:51712
v_accvgpr_write_b32 a167, 0
v_mfma_f32_16x16x32_bf16 a[12:15], a[192:195], a[76:79], a[12:15]
buffer_load_dwordx4 v33, s[24:27], s76 offen offset:1024 sc1 lds
v_mfma_f32_16x16x32_bf16 v[204:207], a[204:207], a[92:95], v[204:207]
s_add_u32 m0, s77, 24576
s_mov_b32 s76, 24576
ds_read_b64_tr_b16 a[192:193], v49 offset:3072
v_accvgpr_write_b32 a168, 0
v_mfma_f32_16x16x32_bf16 v[204:207], a[200:203], a[76:79], v[204:207]
s_and_b32 s80, s68, 2
v_accvgpr_write_b32 a169, 0
v_accvgpr_write_b32 a170, 0
v_mfma_f32_16x16x32_bf16 v[200:203], a[200:203], a[72:75], v[200:203]
s_add_u32 s80, s80, 1
ds_read_b64_tr_b16 a[194:195], v49 offset:3584
v_accvgpr_write_b32 a171, 0
v_mfma_f32_16x16x32_bf16 v[200:203], a[204:207], a[88:91], v[200:203]
s_xor_b32 s81, s80, s85
v_accvgpr_write_b32 a172, 0
v_accvgpr_write_b32 a173, 0
v_mfma_f32_16x16x32_bf16 v[196:199], a[204:207], a[84:87], v[196:199]
s_mul_i32 s80, s80, 3
ds_read_b64_tr_b16 a[196:197], v49 offset:19456
v_accvgpr_write_b32 a174, 0
v_mfma_f32_16x16x32_bf16 v[196:199], a[200:203], a[68:71], v[196:199]
buffer_load_dwordx4 v32, s[24:27], s76 offen offset:0 sc1 lds
v_mfma_f32_16x16x32_bf16 v[192:195], a[200:203], a[64:67], v[192:195]
s_add_u32 s80, s80, s81
ds_read_b64_tr_b16 a[198:199], v49 offset:19968
v_accvgpr_write_b32 a175, 0
v_mfma_f32_16x16x32_bf16 v[192:195], a[204:207], a[80:83], v[192:195]
s_waitcnt lgkmcnt(4)
v_accvgpr_write_b32 a176, 0
v_accvgpr_write_b32 a177, 0
v_mfma_f32_16x16x32_bf16 a[0:3], a[208:211], a[96:99], a[0:3]
s_sub_u32 s80, s80, 1
ds_read_b64_tr_b16 a[200:201], v49 offset:2048
v_accvgpr_write_b32 a178, 0
v_mfma_f32_16x16x32_bf16 a[0:3], a[212:215], a[112:115], a[0:3]
s_mul_i32 s80, s80, 12288
v_accvgpr_write_b32 a179, 0
v_accvgpr_write_b32 a180, 0
v_mfma_f32_16x16x32_bf16 a[4:7], a[212:215], a[116:119], a[4:7]
s_and_b32 s17, s68, 1
ds_read_b64_tr_b16 a[202:203], v49 offset:2560
v_accvgpr_write_b32 a181, 0
v_mfma_f32_16x16x32_bf16 a[4:7], a[208:211], a[100:103], a[4:7]
buffer_load_dwordx4 v33, s[24:27], s76 offen offset:1024 sc1 lds
v_mfma_f32_16x16x32_bf16 a[8:11], a[208:211], a[104:107], a[8:11]
s_mul_i32 s17, s17, 6144
ds_read_b64_tr_b16 a[204:205], v49 offset:18432
v_accvgpr_write_b32 a182, 0
v_mfma_f32_16x16x32_bf16 a[8:11], a[212:215], a[120:123], a[8:11]
s_add_u32 s17, s17, s80
v_accvgpr_write_b32 a183, 0
v_accvgpr_write_b32 a184, 0
v_mfma_f32_16x16x32_bf16 a[12:15], a[212:215], a[124:127], a[12:15]
s_cmp_eq_u32 s81, 0
s_cselect_b32 s17, 0x1000000, s17
ds_read_b64_tr_b16 a[206:207], v49 offset:18944
v_accvgpr_write_b32 a185, 0
v_mfma_f32_16x16x32_bf16 a[12:15], a[208:211], a[108:111], a[12:15]
s_mul_i32 s18, s85, 36864
v_accvgpr_write_b32 a186, 0
v_accvgpr_write_b32 a187, 0
v_mfma_f32_16x16x32_bf16 v[204:207], a[220:223], a[124:127], v[204:207]
s_mul_i32 s80, s68, 3072
ds_read_b64_tr_b16 a[208:209], v49 offset:35840
v_accvgpr_write_b32 a188, 0
v_mfma_f32_16x16x32_bf16 v[204:207], a[216:219], a[108:111], v[204:207]
s_add_u32 s18, s18, s80
v_accvgpr_write_b32 a189, 0
v_accvgpr_write_b32 a190, 0
v_mfma_f32_16x16x32_bf16 v[200:203], a[216:219], a[104:107], v[200:203]
s_add_u32 s80, s92, 0x10000
ds_read_b64_tr_b16 a[210:211], v49 offset:36352
v_accvgpr_write_b32 a191, 0
v_mfma_f32_16x16x32_bf16 v[200:203], a[220:223], a[120:123], v[200:203]
s_and_b32 s80, s80, 0x1fff0000
v_mfma_f32_16x16x32_bf16 v[196:199], a[220:223], a[116:119], v[196:199]
s_or_b32 s19, s80, 0x40000000
ds_read_b64_tr_b16 a[212:213], v49 offset:52224
v_mfma_f32_16x16x32_bf16 v[196:199], a[216:219], a[100:103], v[196:199]
v_mov_b32 v62, s19
v_mfma_f32_16x16x32_bf16 v[192:195], a[216:219], a[96:99], v[192:195]
s_and_b32 s80, s68, 1
ds_read_b64_tr_b16 a[214:215], v49 offset:52736
v_mfma_f32_16x16x32_bf16 v[192:195], a[220:223], a[112:115], v[192:195]
s_waitcnt lgkmcnt(4)
v_mfma_f32_16x16x32_bf16 a[16:19], a[192:195], a[64:67], a[16:19]
s_mul_i32 s80, s80, 10240
ds_read_b64_tr_b16 a[216:217], v49 offset:34816
v_mfma_f32_16x16x32_bf16 a[16:19], a[196:199], a[80:83], a[16:19]
v_add_u32 v3, s80, v2
v_mfma_f32_16x16x32_bf16 a[20:23], a[196:199], a[84:87], a[20:23]
s_mul_i32 s80, s68, 5120
ds_read_b64_tr_b16 a[218:219], v49 offset:35328
v_mfma_f32_16x16x32_bf16 a[20:23], a[192:195], a[68:71], a[20:23]
v_add_u32 v4, s80, v2
v_mfma_f32_16x16x32_bf16 a[24:27], a[192:195], a[72:75], a[24:27]
s_lshr_b32 s80, s68, 1
ds_read_b64_tr_b16 a[220:221], v49 offset:51200
v_mfma_f32_16x16x32_bf16 a[24:27], a[196:199], a[88:91], a[24:27]
s_lshl1_add_u32 s80, s83, s80
v_mfma_f32_16x16x32_bf16 a[28:31], a[196:199], a[92:95], a[28:31]
s_mul_i32 s80, s80, 749568
ds_read_b64_tr_b16 a[222:223], v49 offset:51712
v_mfma_f32_16x16x32_bf16 a[28:31], a[192:195], a[76:79], a[28:31]
s_and_b32 s81, s68, 1
v_accvgpr_read_b32 v40, a0
v_accvgpr_read_b32 v41, a1
v_mfma_f32_16x16x32_bf16 v[220:223], a[204:207], a[92:95], v[220:223]
s_lshl_b32 s81, s81, 11
ds_read_b64_tr_b16 a[192:193], v50 offset:3072
v_accvgpr_read_b32 v42, a2
v_mfma_f32_16x16x32_bf16 v[220:223], a[200:203], a[76:79], v[220:223]
s_add_u32 s80, s80, s81
v_accvgpr_read_b32 v43, a3
v_max_f32 v192, 0, v192
v_mfma_f32_16x16x32_bf16 v[216:219], a[200:203], a[72:75], v[216:219]
s_add_u32 s36, s66, s80
s_addc_u32 s37, s67, 0
ds_read_b64_tr_b16 a[194:195], v50 offset:3584
v_max_f32 v193, 0, v193
v_mfma_f32_16x16x32_bf16 v[216:219], a[204:207], a[88:91], v[216:219]
s_mov_b32 s38, 743424
v_max_f32 v194, 0, v194
v_max_f32 v195, 0, v195
v_mfma_f32_16x16x32_bf16 v[212:215], a[204:207], a[84:87], v[212:215]
s_mov_b32 s39, 0x20000
ds_read_b64_tr_b16 a[196:197], v50 offset:19456
v_mul_f32 v192, v192, v40
v_mfma_f32_16x16x32_bf16 v[212:215], a[200:203], a[68:71], v[212:215]
s_mul_i32 s88, s68, 5120
v_mul_f32 v193, v193, v41
v_mul_f32 v194, v194, v42
v_mfma_f32_16x16x32_bf16 v[208:211], a[200:203], a[64:67], v[208:211]
s_mul_i32 s80, s84, 1867776
ds_read_b64_tr_b16 a[198:199], v50 offset:19968
v_mul_f32 v195, v195, v43
v_mfma_f32_16x16x32_bf16 v[208:211], a[204:207], a[80:83], v[208:211]
s_waitcnt lgkmcnt(4)
v_cvt_pk_bf16_f32 v192, v192, v193
v_cvt_pk_bf16_f32 v193, v194, v195
v_mfma_f32_16x16x32_bf16 a[16:19], a[208:211], a[96:99], a[16:19]
s_add_u32 s80, s80, s88
ds_read_b64_tr_b16 a[200:201], v50 offset:2048
v_accvgpr_read_b32 v40, a4
v_mfma_f32_16x16x32_bf16 a[16:19], a[212:215], a[112:115], a[16:19]
s_add_u32 s80, s80, 25165824
v_accvgpr_read_b32 v41, a5
v_accvgpr_read_b32 v42, a6
v_mfma_f32_16x16x32_bf16 a[20:23], a[212:215], a[116:119], a[20:23]
s_add_u32 s40, s66, s80
s_addc_u32 s41, s67, 0
ds_read_b64_tr_b16 a[202:203], v50 offset:2560
v_accvgpr_read_b32 v43, a7
v_mfma_f32_16x16x32_bf16 a[20:23], a[208:211], a[100:103], a[20:23]
s_mov_b32 s42, 1848320
v_max_f32 v196, 0, v196
v_max_f32 v197, 0, v197
v_mfma_f32_16x16x32_bf16 a[24:27], a[208:211], a[104:107], a[24:27]
s_mov_b32 s43, 0x20000
ds_read_b64_tr_b16 a[204:205], v50 offset:18432
v_max_f32 v198, 0, v198
v_mfma_f32_16x16x32_bf16 a[24:27], a[212:215], a[120:123], a[24:27]
v_mov_b32 v60, v2
v_max_f32 v199, 0, v199
v_mfma_f32_16x16x32_bf16 a[28:31], a[212:215], a[124:127], a[28:31]
ds_read_b64_tr_b16 a[206:207], v50 offset:18944
v_add_u32 v61, 4096, v2
v_mfma_f32_16x16x32_bf16 a[28:31], a[208:211], a[108:111], a[28:31]
v_mul_f32 v196, v196, v40
v_mul_f32 v197, v197, v41
v_mfma_f32_16x16x32_bf16 v[220:223], a[220:223], a[124:127], v[220:223]
ds_read_b64_tr_b16 a[208:209], v50 offset:35840
v_mul_f32 v198, v198, v42
v_mfma_f32_16x16x32_bf16 v[220:223], a[216:219], a[108:111], v[220:223]
v_mul_f32 v199, v199, v43
v_cvt_pk_bf16_f32 v196, v196, v197
v_mfma_f32_16x16x32_bf16 v[216:219], a[216:219], a[104:107], v[216:219]
ds_read_b64_tr_b16 a[210:211], v50 offset:36352
v_cvt_pk_bf16_f32 v197, v198, v199
v_mfma_f32_16x16x32_bf16 v[216:219], a[220:223], a[120:123], v[216:219]
v_accvgpr_read_b32 v40, a8
v_accvgpr_read_b32 v41, a9
v_mfma_f32_16x16x32_bf16 v[212:215], a[220:223], a[116:119], v[212:215]
ds_read_b64_tr_b16 a[212:213], v50 offset:52224
v_accvgpr_read_b32 v42, a10
v_mfma_f32_16x16x32_bf16 v[212:215], a[216:219], a[100:103], v[212:215]
v_accvgpr_read_b32 v43, a11
v_max_f32 v200, 0, v200
v_mfma_f32_16x16x32_bf16 v[208:211], a[216:219], a[96:99], v[208:211]
ds_read_b64_tr_b16 a[214:215], v50 offset:52736
v_max_f32 v201, 0, v201
v_mfma_f32_16x16x32_bf16 v[208:211], a[220:223], a[112:115], v[208:211]
s_waitcnt lgkmcnt(4)
v_max_f32 v202, 0, v202
v_max_f32 v203, 0, v203
v_mfma_f32_16x16x32_bf16 a[32:35], a[192:195], a[64:67], a[32:35]
ds_read_b64_tr_b16 a[216:217], v50 offset:34816
v_mul_f32 v200, v200, v40
v_mfma_f32_16x16x32_bf16 a[32:35], a[196:199], a[80:83], a[32:35]
v_mul_f32 v201, v201, v41
v_mul_f32 v202, v202, v42
v_mfma_f32_16x16x32_bf16 a[36:39], a[196:199], a[84:87], a[36:39]
ds_read_b64_tr_b16 a[218:219], v50 offset:35328
v_mul_f32 v203, v203, v43
v_mfma_f32_16x16x32_bf16 a[36:39], a[192:195], a[68:71], a[36:39]
v_cvt_pk_bf16_f32 v200, v200, v201
v_cvt_pk_bf16_f32 v201, v202, v203
v_mfma_f32_16x16x32_bf16 a[40:43], a[192:195], a[72:75], a[40:43]
ds_read_b64_tr_b16 a[220:221], v50 offset:51200
v_accvgpr_read_b32 v40, a12
v_mfma_f32_16x16x32_bf16 a[40:43], a[196:199], a[88:91], a[40:43]
v_accvgpr_read_b32 v41, a13
v_accvgpr_read_b32 v42, a14
v_mfma_f32_16x16x32_bf16 a[44:47], a[196:199], a[92:95], a[44:47]
ds_read_b64_tr_b16 a[222:223], v50 offset:51712
v_accvgpr_read_b32 v43, a15
v_mfma_f32_16x16x32_bf16 a[44:47], a[192:195], a[76:79], a[44:47]
v_max_f32 v204, 0, v204
v_max_f32 v205, 0, v205
v_mfma_f32_16x16x32_bf16 v[236:239], a[204:207], a[92:95], v[236:239]
ds_read_b64_tr_b16 a[192:193], v51 offset:3072
v_max_f32 v206, 0, v206
v_mfma_f32_16x16x32_bf16 v[236:239], a[200:203], a[76:79], v[236:239]
v_max_f32 v207, 0, v207
v_mul_f32 v204, v204, v40
v_mfma_f32_16x16x32_bf16 v[232:235], a[200:203], a[72:75], v[232:235]
ds_read_b64_tr_b16 a[194:195], v51 offset:3584
v_mul_f32 v205, v205, v41
v_mfma_f32_16x16x32_bf16 v[232:235], a[204:207], a[88:91], v[232:235]
v_mul_f32 v206, v206, v42
v_mul_f32 v207, v207, v43
v_mfma_f32_16x16x32_bf16 v[228:231], a[204:207], a[84:87], v[228:231]
ds_read_b64_tr_b16 a[196:197], v51 offset:19456
v_cvt_pk_bf16_f32 v204, v204, v205
v_mfma_f32_16x16x32_bf16 v[228:231], a[200:203], a[68:71], v[228:231]
v_cvt_pk_bf16_f32 v205, v206, v207
v_accvgpr_read_b32 v40, a16
v_mfma_f32_16x16x32_bf16 v[224:227], a[200:203], a[64:67], v[224:227]
ds_read_b64_tr_b16 a[198:199], v51 offset:19968
v_accvgpr_read_b32 v41, a17
v_mfma_f32_16x16x32_bf16 v[224:227], a[204:207], a[80:83], v[224:227]
s_waitcnt lgkmcnt(4)
v_accvgpr_read_b32 v42, a18
v_accvgpr_read_b32 v43, a19
v_mfma_f32_16x16x32_bf16 a[32:35], a[208:211], a[96:99], a[32:35]
ds_read_b64_tr_b16 a[200:201], v51 offset:2048
v_max_f32 v208, 0, v208
v_mfma_f32_16x16x32_bf16 a[32:35], a[212:215], a[112:115], a[32:35]
v_max_f32 v209, 0, v209
v_max_f32 v210, 0, v210
v_mfma_f32_16x16x32_bf16 a[36:39], a[212:215], a[116:119], a[36:39]
ds_read_b64_tr_b16 a[202:203], v51 offset:2560
v_max_f32 v211, 0, v211
v_mfma_f32_16x16x32_bf16 a[36:39], a[208:211], a[100:103], a[36:39]
v_mul_f32 v208, v208, v40
v_mul_f32 v209, v209, v41
v_mfma_f32_16x16x32_bf16 a[40:43], a[208:211], a[104:107], a[40:43]
ds_read_b64_tr_b16 a[204:205], v51 offset:18432
v_mul_f32 v210, v210, v42
v_mfma_f32_16x16x32_bf16 a[40:43], a[212:215], a[120:123], a[40:43]
v_mul_f32 v211, v211, v43
v_cvt_pk_bf16_f32 v194, v208, v209
v_mfma_f32_16x16x32_bf16 a[44:47], a[212:215], a[124:127], a[44:47]
ds_read_b64_tr_b16 a[206:207], v51 offset:18944
v_cvt_pk_bf16_f32 v195, v210, v211
v_mfma_f32_16x16x32_bf16 a[44:47], a[208:211], a[108:111], a[44:47]
s_lshl_b32 s86, s71, 13
s_add_u32 s86, s86, 524288
v_mfma_f32_16x16x32_bf16 v[236:239], a[220:223], a[124:127], v[236:239]
ds_read_b64_tr_b16 a[208:209], v51 offset:35840
v_mfma_f32_16x16x32_bf16 v[236:239], a[216:219], a[108:111], v[236:239]
buffer_store_dwordx4 v[192:195], v2, s[32:35], s86 offen offset:0 sc1
v_mfma_f32_16x16x32_bf16 v[232:235], a[216:219], a[104:107], v[232:235]
ds_read_b64_tr_b16 a[210:211], v51 offset:36352
v_accvgpr_read_b32 v40, a20
v_mfma_f32_16x16x32_bf16 v[232:235], a[220:223], a[120:123], v[232:235]
v_accvgpr_read_b32 v41, a21
v_accvgpr_read_b32 v42, a22
v_mfma_f32_16x16x32_bf16 v[228:231], a[220:223], a[116:119], v[228:231]
ds_read_b64_tr_b16 a[212:213], v51 offset:52224
v_accvgpr_read_b32 v43, a23
v_mfma_f32_16x16x32_bf16 v[228:231], a[216:219], a[100:103], v[228:231]
v_max_f32 v212, 0, v212
v_max_f32 v213, 0, v213
v_mfma_f32_16x16x32_bf16 v[224:227], a[216:219], a[96:99], v[224:227]
ds_read_b64_tr_b16 a[214:215], v51 offset:52736
v_max_f32 v214, 0, v214
v_mfma_f32_16x16x32_bf16 v[224:227], a[220:223], a[112:115], v[224:227]
s_waitcnt lgkmcnt(4)
v_max_f32 v215, 0, v215
v_mul_f32 v212, v212, v40
v_mfma_f32_16x16x32_bf16 a[48:51], a[192:195], a[64:67], a[48:51]
ds_read_b64_tr_b16 a[216:217], v51 offset:34816
v_mul_f32 v213, v213, v41
v_mfma_f32_16x16x32_bf16 a[48:51], a[196:199], a[80:83], a[48:51]
v_mul_f32 v214, v214, v42
v_mul_f32 v215, v215, v43
v_mfma_f32_16x16x32_bf16 a[52:55], a[196:199], a[84:87], a[52:55]
ds_read_b64_tr_b16 a[218:219], v51 offset:35328
v_cvt_pk_bf16_f32 v198, v212, v213
v_mfma_f32_16x16x32_bf16 a[52:55], a[192:195], a[68:71], a[52:55]
v_cvt_pk_bf16_f32 v199, v214, v215
v_mfma_f32_16x16x32_bf16 a[56:59], a[192:195], a[72:75], a[56:59]
ds_read_b64_tr_b16 a[220:221], v51 offset:51200
v_mfma_f32_16x16x32_bf16 a[56:59], a[196:199], a[88:91], a[56:59]
buffer_store_dwordx4 v[196:199], v2, s[32:35], s86 offen offset:1024 sc1
v_mfma_f32_16x16x32_bf16 a[60:63], a[196:199], a[92:95], a[60:63]
ds_read_b64_tr_b16 a[222:223], v51 offset:51712
v_accvgpr_read_b32 v40, a24
v_mfma_f32_16x16x32_bf16 a[60:63], a[192:195], a[76:79], a[60:63]
s_waitcnt vmcnt(63)
s_barrier
v_mfma_f32_16x16x32_bf16 v[252:255], a[204:207], a[92:95], v[252:255]
s_add_u32 m0, s77, 32768
s_mov_b32 s76, 32768
ds_read_b64_tr_b16 a[192:193], v44 offset:0
v_accvgpr_read_b32 v41, a25
v_mfma_f32_16x16x32_bf16 v[252:255], a[200:203], a[76:79], v[252:255]
buffer_load_dwordx4 v32, s[24:27], s76 offen offset:0 sc1 lds
v_mfma_f32_16x16x32_bf16 v[248:251], a[200:203], a[72:75], v[248:251]
ds_read_b64_tr_b16 a[194:195], v44 offset:1024
v_accvgpr_read_b32 v42, a26
v_mfma_f32_16x16x32_bf16 v[248:251], a[204:207], a[88:91], v[248:251]
v_accvgpr_read_b32 v43, a27
v_max_f32 v216, 0, v216
v_mfma_f32_16x16x32_bf16 v[244:247], a[204:207], a[84:87], v[244:247]
ds_read_b64_tr_b16 a[196:197], v44 offset:16384
v_max_f32 v217, 0, v217
v_mfma_f32_16x16x32_bf16 v[244:247], a[200:203], a[68:71], v[244:247]
v_max_f32 v218, 0, v218
v_max_f32 v219, 0, v219
v_mfma_f32_16x16x32_bf16 v[240:243], a[200:203], a[64:67], v[240:243]
s_waitcnt lgkmcnt(4)
ds_read_b64_tr_b16 a[198:199], v44 offset:17408
v_mul_f32 v216, v216, v40
v_mfma_f32_16x16x32_bf16 v[240:243], a[204:207], a[80:83], v[240:243]
buffer_load_dwordx4 v33, s[24:27], s76 offen offset:1024 sc1 lds
v_mfma_f32_16x16x32_bf16 a[48:51], a[208:211], a[96:99], a[48:51]
s_add_u32 m0, s77, 40960
s_mov_b32 s76, 40960
ds_read_b64_tr_b16 a[200:201], v44 offset:8
v_mul_f32 v217, v217, v41
v_mfma_f32_16x16x32_bf16 a[48:51], a[212:215], a[112:115], a[48:51]
v_mul_f32 v218, v218, v42
v_mul_f32 v219, v219, v43
v_mfma_f32_16x16x32_bf16 a[52:55], a[212:215], a[116:119], a[52:55]
ds_read_b64_tr_b16 a[202:203], v44 offset:1032
v_cvt_pk_bf16_f32 v202, v216, v217
v_mfma_f32_16x16x32_bf16 a[52:55], a[208:211], a[100:103], a[52:55]
v_cvt_pk_bf16_f32 v203, v218, v219
v_mfma_f32_16x16x32_bf16 a[56:59], a[208:211], a[104:107], a[56:59]
ds_read_b64_tr_b16 a[204:205], v44 offset:16392
v_mfma_f32_16x16x32_bf16 a[56:59], a[212:215], a[120:123], a[56:59]
buffer_load_dwordx4 v32, s[24:27], s76 offen offset:0 sc1 lds
v_mfma_f32_16x16x32_bf16 a[60:63], a[212:215], a[124:127], a[60:63]
ds_read_b64_tr_b16 a[206:207], v44 offset:17416
v_mfma_f32_16x16x32_bf16 a[60:63], a[208:211], a[108:111], a[60:63]
s_waitcnt lgkmcnt(4)
v_mfma_f32_16x16x32_bf16 v[252:255], a[220:223], a[124:127], v[252:255]
ds_read_b64_tr_b16 a[208:209], v45 offset:0
v_mfma_f32_16x16x32_bf16 v[252:255], a[216:219], a[108:111], v[252:255]
buffer_store_dwordx4 v[200:203], v2, s[32:35], s86 offen offset:2048 sc1
v_mfma_f32_16x16x32_bf16 v[248:251], a[216:219], a[104:107], v[248:251]
ds_read_b64_tr_b16 a[210:211], v45 offset:1024
v_accvgpr_read_b32 v40, a28
v_mfma_f32_16x16x32_bf16 v[248:251], a[220:223], a[120:123], v[248:251]
buffer_load_dwordx4 v33, s[24:27], s76 offen offset:1024 sc1 lds
v_mfma_f32_16x16x32_bf16 v[244:247], a[220:223], a[116:119], v[244:247]
s_add_u32 m0, s77, 49152
s_mov_b32 s76, 49152
ds_read_b64_tr_b16 a[212:213], v45 offset:16384
v_accvgpr_read_b32 v41, a29
v_mfma_f32_16x16x32_bf16 v[244:247], a[216:219], a[100:103], v[244:247]
v_accvgpr_read_b32 v42, a30
v_accvgpr_read_b32 v43, a31
v_mfma_f32_16x16x32_bf16 v[240:243], a[216:219], a[96:99], v[240:243]
ds_read_b64_tr_b16 a[214:215], v45 offset:17408
v_max_f32 v220, 0, v220
v_mfma_f32_16x16x32_bf16 v[240:243], a[220:223], a[112:115], v[240:243]
v_max_f32 v221, 0, v221
v_max_f32 v222, 0, v222
v_mfma_f32_16x16x32_bf16 v[64:67], a[192:195], a[64:67], v[64:67]
ds_read_b64_tr_b16 a[216:217], v45 offset:8
v_max_f32 v223, 0, v223
v_mfma_f32_16x16x32_bf16 v[64:67], a[196:199], a[80:83], v[64:67]
buffer_load_dwordx4 v32, s[24:27], s76 offen offset:0 sc1 lds
v_mfma_f32_16x16x32_bf16 v[68:71], a[196:199], a[84:87], v[68:71]
ds_read_b64_tr_b16 a[218:219], v45 offset:1032
v_mul_f32 v220, v220, v40
v_mfma_f32_16x16x32_bf16 v[68:71], a[192:195], a[68:71], v[68:71]
v_mul_f32 v221, v221, v41
v_mul_f32 v222, v222, v42
v_mfma_f32_16x16x32_bf16 v[72:75], a[192:195], a[72:75], v[72:75]
ds_read_b64_tr_b16 a[220:221], v45 offset:16392
v_mul_f32 v223, v223, v43
v_mfma_f32_16x16x32_bf16 v[72:75], a[196:199], a[88:91], v[72:75]
v_cvt_pk_bf16_f32 v206, v220, v221
v_cvt_pk_bf16_f32 v207, v222, v223
v_mfma_f32_16x16x32_bf16 v[76:79], a[196:199], a[92:95], v[76:79]
s_waitcnt lgkmcnt(4)
ds_read_b64_tr_b16 a[222:223], v45 offset:17416
v_mfma_f32_16x16x32_bf16 v[76:79], a[192:195], a[76:79], v[76:79]
buffer_load_dwordx4 v33, s[24:27], s76 offen offset:1024 sc1 lds
v_mfma_f32_16x16x32_bf16 v[140:143], a[204:207], a[92:95], v[140:143]
s_add_u32 m0, s77, 57344
s_mov_b32 s76, 57344
ds_read_b64_tr_b16 a[192:193], v46 offset:0
v_mfma_f32_16x16x32_bf16 v[140:143], a[200:203], a[76:79], v[140:143]
buffer_store_dwordx4 v[204:207], v2, s[32:35], s86 offen offset:3072 sc1
v_mfma_f32_16x16x32_bf16 v[136:139], a[200:203], a[72:75], v[136:139]
ds_read_b64_tr_b16 a[194:195], v46 offset:1024
v_accvgpr_read_b32 v40, a32
v_mfma_f32_16x16x32_bf16 v[136:139], a[204:207], a[88:91], v[136:139]
v_accvgpr_read_b32 v41, a33
v_accvgpr_read_b32 v42, a34
v_mfma_f32_16x16x32_bf16 v[132:135], a[204:207], a[84:87], v[132:135]
ds_read_b64_tr_b16 a[196:197], v46 offset:16384
v_accvgpr_read_b32 v43, a35
v_mfma_f32_16x16x32_bf16 v[132:135], a[200:203], a[68:71], v[132:135]
buffer_load_dwordx4 v32, s[24:27], s76 offen offset:0 sc1 lds
v_mfma_f32_16x16x32_bf16 v[128:131], a[200:203], a[64:67], v[128:131]
ds_read_b64_tr_b16 a[198:199], v46 offset:17408
v_max_f32 v224, 0, v224
v_mfma_f32_16x16x32_bf16 v[128:131], a[204:207], a[80:83], v[128:131]
v_max_f32 v225, 0, v225
v_max_f32 v226, 0, v226
v_mfma_f32_16x16x32_bf16 v[80:83], a[208:211], a[64:67], v[80:83]
s_waitcnt lgkmcnt(4)
ds_read_b64_tr_b16 a[200:201], v46 offset:8
v_max_f32 v227, 0, v227
v_mfma_f32_16x16x32_bf16 v[80:83], a[212:215], a[80:83], v[80:83]
v_mul_f32 v224, v224, v40
v_mul_f32 v225, v225, v41
v_mfma_f32_16x16x32_bf16 v[84:87], a[212:215], a[84:87], v[84:87]
ds_read_b64_tr_b16 a[202:203], v46 offset:1032
v_mul_f32 v226, v226, v42
v_mfma_f32_16x16x32_bf16 v[84:87], a[208:211], a[68:71], v[84:87]
buffer_load_dwordx4 v33, s[24:27], s76 offen offset:1024 sc1 lds
v_mfma_f32_16x16x32_bf16 v[88:91], a[208:211], a[72:75], v[88:91]
ds_read_b64_tr_b16 a[204:205], v46 offset:16392
v_mul_f32 v227, v227, v43
v_mfma_f32_16x16x32_bf16 v[88:91], a[212:215], a[88:91], v[88:91]
v_cvt_pk_bf16_f32 v224, v224, v225
v_cvt_pk_bf16_f32 v225, v226, v227
v_mfma_f32_16x16x32_bf16 v[92:95], a[212:215], a[92:95], v[92:95]
ds_read_b64_tr_b16 a[206:207], v46 offset:17416
v_accvgpr_read_b32 v40, a36
v_mfma_f32_16x16x32_bf16 v[92:95], a[208:211], a[76:79], v[92:95]
v_accvgpr_read_b32 v41, a37
v_accvgpr_read_b32 v42, a38
v_mfma_f32_16x16x32_bf16 v[156:159], a[220:223], a[92:95], v[156:159]
ds_read_b64_tr_b16 a[208:209], v47 offset:0
v_accvgpr_read_b32 v43, a39
v_mfma_f32_16x16x32_bf16 v[156:159], a[216:219], a[76:79], v[156:159]
v_max_f32 v228, 0, v228
v_max_f32 v229, 0, v229
v_mfma_f32_16x16x32_bf16 v[152:155], a[216:219], a[72:75], v[152:155]
ds_read_b64_tr_b16 a[210:211], v47 offset:1024
v_max_f32 v230, 0, v230
v_mfma_f32_16x16x32_bf16 v[152:155], a[220:223], a[88:91], v[152:155]
v_max_f32 v231, 0, v231
v_mul_f32 v228, v228, v40
v_mfma_f32_16x16x32_bf16 v[148:151], a[220:223], a[84:87], v[148:151]
ds_read_b64_tr_b16 a[212:213], v47 offset:16384
v_mul_f32 v229, v229, v41
v_mfma_f32_16x16x32_bf16 v[148:151], a[216:219], a[68:71], v[148:151]
v_mul_f32 v230, v230, v42
v_mul_f32 v231, v231, v43
v_mfma_f32_16x16x32_bf16 v[144:147], a[216:219], a[64:67], v[144:147]
ds_read_b64_tr_b16 a[214:215], v47 offset:17408
v_cvt_pk_bf16_f32 v228, v228, v229
v_mfma_f32_16x16x32_bf16 v[144:147], a[220:223], a[80:83], v[144:147]
s_waitcnt lgkmcnt(4)
v_cvt_pk_bf16_f32 v229, v230, v231
v_accvgpr_read_b32 v40, a40
v_mfma_f32_16x16x32_bf16 v[96:99], a[192:195], a[64:67], v[96:99]
ds_read_b64_tr_b16 a[216:217], v47 offset:8
v_accvgpr_read_b32 v41, a41
v_mfma_f32_16x16x32_bf16 v[96:99], a[196:199], a[80:83], v[96:99]
v_accvgpr_read_b32 v42, a42
v_accvgpr_read_b32 v43, a43
v_mfma_f32_16x16x32_bf16 v[100:103], a[196:199], a[84:87], v[100:103]
ds_read_b64_tr_b16 a[218:219], v47 offset:1032
v_max_f32 v232, 0, v232
v_mfma_f32_16x16x32_bf16 v[100:103], a[192:195], a[68:71], v[100:103]
v_max_f32 v233, 0, v233
v_max_f32 v234, 0, v234
v_mfma_f32_16x16x32_bf16 v[104:107], a[192:195], a[72:75], v[104:107]
ds_read_b64_tr_b16 a[220:221], v47 offset:16392
v_max_f32 v235, 0, v235
v_mfma_f32_16x16x32_bf16 v[104:107], a[196:199], a[88:91], v[104:107]
v_mul_f32 v232, v232, v40
v_mul_f32 v233, v233, v41
v_mfma_f32_16x16x32_bf16 v[108:111], a[196:199], a[92:95], v[108:111]
ds_read_b64_tr_b16 a[222:223], v47 offset:17416
v_mul_f32 v234, v234, v42
v_mfma_f32_16x16x32_bf16 v[108:111], a[192:195], a[76:79], v[108:111]
s_waitcnt vmcnt(63)
s_barrier
v_mfma_f32_16x16x32_bf16 v[172:175], a[204:207], a[92:95], v[172:175]
ds_read_b64_tr_b16 a[192:193], v44 offset:32768
v_mul_f32 v235, v235, v43
v_mfma_f32_16x16x32_bf16 v[172:175], a[200:203], a[76:79], v[172:175]
v_cvt_pk_bf16_f32 v232, v232, v233
v_cvt_pk_bf16_f32 v233, v234, v235
v_mfma_f32_16x16x32_bf16 v[168:171], a[200:203], a[72:75], v[168:171]
ds_read_b64_tr_b16 a[194:195], v44 offset:33792
v_accvgpr_read_b32 v40, a44
v_mfma_f32_16x16x32_bf16 v[168:171], a[204:207], a[88:91], v[168:171]
v_accvgpr_read_b32 v41, a45
v_accvgpr_read_b32 v42, a46
v_mfma_f32_16x16x32_bf16 v[164:167], a[204:207], a[84:87], v[164:167]
ds_read_b64_tr_b16 a[196:197], v44 offset:49152
v_accvgpr_read_b32 v43, a47
v_mfma_f32_16x16x32_bf16 v[164:167], a[200:203], a[68:71], v[164:167]
v_max_f32 v236, 0, v236
v_max_f32 v237, 0, v237
v_mfma_f32_16x16x32_bf16 v[160:163], a[200:203], a[64:67], v[160:163]
ds_read_b64_tr_b16 a[198:199], v44 offset:50176
v_max_f32 v238, 0, v238
v_mfma_f32_16x16x32_bf16 v[160:163], a[204:207], a[80:83], v[160:163]
s_waitcnt lgkmcnt(4)
v_max_f32 v239, 0, v239
v_mul_f32 v236, v236, v40
v_mfma_f32_16x16x32_bf16 v[112:115], a[208:211], a[64:67], v[112:115]
ds_read_b64_tr_b16 a[200:201], v44 offset:32776
v_mul_f32 v237, v237, v41
v_mfma_f32_16x16x32_bf16 v[112:115], a[212:215], a[80:83], v[112:115]
v_mul_f32 v238, v238, v42
v_mul_f32 v239, v239, v43
v_mfma_f32_16x16x32_bf16 v[116:119], a[212:215], a[84:87], v[116:119]
ds_read_b64_tr_b16 a[202:203], v44 offset:33800
v_cvt_pk_bf16_f32 v236, v236, v237
v_mfma_f32_16x16x32_bf16 v[116:119], a[208:211], a[68:71], v[116:119]
v_cvt_pk_bf16_f32 v237, v238, v239
v_accvgpr_read_b32 v40, a48
v_mfma_f32_16x16x32_bf16 v[120:123], a[208:211], a[72:75], v[120:123]
ds_read_b64_tr_b16 a[204:205], v44 offset:49160
v_accvgpr_read_b32 v41, a49
v_mfma_f32_16x16x32_bf16 v[120:123], a[212:215], a[88:91], v[120:123]
v_accvgpr_read_b32 v42, a50
v_accvgpr_read_b32 v43, a51
v_mfma_f32_16x16x32_bf16 v[124:127], a[212:215], a[92:95], v[124:127]
ds_read_b64_tr_b16 a[206:207], v44 offset:50184
v_max_f32 v240, 0, v240
v_mfma_f32_16x16x32_bf16 v[124:127], a[208:211], a[76:79], v[124:127]
v_max_f32 v241, 0, v241
v_max_f32 v242, 0, v242
v_mfma_f32_16x16x32_bf16 v[188:191], a[220:223], a[92:95], v[188:191]
ds_read_b64_tr_b16 a[208:209], v45 offset:32768
v_max_f32 v243, 0, v243
v_mfma_f32_16x16x32_bf16 v[188:191], a[216:219], a[76:79], v[188:191]
v_mul_f32 v240, v240, v40
v_mul_f32 v241, v241, v41
v_mfma_f32_16x16x32_bf16 v[184:187], a[216:219], a[72:75], v[184:187]
ds_read_b64_tr_b16 a[210:211], v45 offset:33792
v_mul_f32 v242, v242, v42
v_mfma_f32_16x16x32_bf16 v[184:187], a[220:223], a[88:91], v[184:187]
v_mul_f32 v243, v243, v43
v_cvt_pk_bf16_f32 v226, v240, v241
v_mfma_f32_16x16x32_bf16 v[180:183], a[220:223], a[84:87], v[180:183]
ds_read_b64_tr_b16 a[212:213], v45 offset:49152
v_cvt_pk_bf16_f32 v227, v242, v243
v_mfma_f32_16x16x32_bf16 v[180:183], a[216:219], a[68:71], v[180:183]
s_lshl_b32 s86, s71, 13
s_add_u32 s86, s86, 528384
v_mfma_f32_16x16x32_bf16 v[176:179], a[216:219], a[64:67], v[176:179]
ds_read_b64_tr_b16 a[214:215], v45 offset:50176
v_mfma_f32_16x16x32_bf16 v[176:179], a[220:223], a[80:83], v[176:179]
s_waitcnt lgkmcnt(4)
v_mfma_f32_16x16x32_bf16 v[64:67], a[192:195], a[96:99], v[64:67]
ds_read_b64_tr_b16 a[216:217], v45 offset:32776
v_mfma_f32_16x16x32_bf16 v[64:67], a[196:199], a[112:115], v[64:67]
ds_read_b128 a[64:67], v6
v_mfma_f32_16x16x32_bf16 v[68:71], a[196:199], a[116:119], v[68:71]
ds_read_b64_tr_b16 a[218:219], v45 offset:33800
v_mfma_f32_16x16x32_bf16 v[68:71], a[192:195], a[100:103], v[68:71]
s_waitcnt vmcnt(63)
s_barrier
v_mfma_f32_16x16x32_bf16 v[72:75], a[192:195], a[104:107], v[72:75]
s_add_u32 m0, s77, 65536
s_mov_b32 s76, 32768
ds_read_b64_tr_b16 a[220:221], v45 offset:49160
v_mfma_f32_16x16x32_bf16 v[72:75], a[196:199], a[120:123], v[72:75]
buffer_load_dwordx4 v34, s[28:31], s76 offen offset:0 sc1 lds
v_mfma_f32_16x16x32_bf16 v[76:79], a[196:199], a[124:127], v[76:79]
ds_read_b64_tr_b16 a[222:223], v45 offset:50184
v_mfma_f32_16x16x32_bf16 v[76:79], a[192:195], a[108:111], v[76:79]
ds_read_b128 a[68:71], v6
v_mfma_f32_16x16x32_bf16 v[140:143], a[204:207], a[124:127], v[140:143]
ds_read_b64_tr_b16 a[192:193], v46 offset:32768
v_mfma_f32_16x16x32_bf16 v[140:143], a[200:203], a[108:111], v[140:143]
ds_read_b128 a[72:75], v6
v_mfma_f32_16x16x32_bf16 v[136:139], a[200:203], a[104:107], v[136:139]
ds_read_b64_tr_b16 a[194:195], v46 offset:33792
v_mfma_f32_16x16x32_bf16 v[136:139], a[204:207], a[120:123], v[136:139]
buffer_load_dwordx4 v35, s[28:31], s76 offen offset:1024 sc1 lds
v_mfma_f32_16x16x32_bf16 v[132:135], a[204:207], a[116:119], v[132:135]
s_add_u32 m0, s77, 73728
s_mov_b32 s76, 40960
ds_read_b64_tr_b16 a[196:197], v46 offset:49152
v_mfma_f32_16x16x32_bf16 v[132:135], a[200:203], a[100:103], v[132:135]
ds_read_b128 a[76:79], v6
v_mfma_f32_16x16x32_bf16 v[128:131], a[200:203], a[96:99], v[128:131]
ds_read_b64_tr_b16 a[198:199], v46 offset:50176
v_mfma_f32_16x16x32_bf16 v[128:131], a[204:207], a[112:115], v[128:131]
s_waitcnt lgkmcnt(7)
ds_read_b128 a[80:83], v6
v_mfma_f32_16x16x32_bf16 v[80:83], a[208:211], a[96:99], v[80:83]
ds_read_b64_tr_b16 a[200:201], v46 offset:32776
v_mfma_f32_16x16x32_bf16 v[80:83], a[212:215], a[112:115], v[80:83]
buffer_load_dwordx4 v34, s[28:31], s76 offen offset:0 sc1 lds
v_mfma_f32_16x16x32_bf16 v[84:87], a[212:215], a[116:119], v[84:87]
ds_read_b64_tr_b16 a[202:203], v46 offset:33800
v_mfma_f32_16x16x32_bf16 v[84:87], a[208:211], a[100:103], v[84:87]
ds_read_b128 a[84:87], v6
v_mfma_f32_16x16x32_bf16 v[88:91], a[208:211], a[104:107], v[88:91]
ds_read_b64_tr_b16 a[204:205], v46 offset:49160
v_mfma_f32_16x16x32_bf16 v[88:91], a[212:215], a[120:123], v[88:91]
ds_read_b128 a[88:91], v6
v_mfma_f32_16x16x32_bf16 v[92:95], a[212:215], a[124:127], v[92:95]
ds_read_b64_tr_b16 a[206:207], v46 offset:50184
v_mfma_f32_16x16x32_bf16 v[92:95], a[208:211], a[108:111], v[92:95]
buffer_load_dwordx4 v35, s[28:31], s76 offen offset:1024 sc1 lds
v_mfma_f32_16x16x32_bf16 v[156:159], a[220:223], a[124:127], v[156:159]
s_add_u32 m0, s77, 81920
s_mov_b32 s76, 49152
ds_read_b64_tr_b16 a[208:209], v47 offset:32768
v_cvt_pk_bf16_f32 v64, v64, v65
v_mfma_f32_16x16x32_bf16 v[156:159], a[216:219], a[108:111], v[156:159]
ds_read_b128 a[92:95], v6
v_cvt_pk_bf16_f32 v65, v66, v67
v_mfma_f32_16x16x32_bf16 v[152:155], a[216:219], a[104:107], v[152:155]
ds_read_b64_tr_b16 a[210:211], v47 offset:33792
v_cvt_pk_bf16_f32 v66, v128, v129
v_mfma_f32_16x16x32_bf16 v[152:155], a[220:223], a[120:123], v[152:155]
v_cvt_pk_bf16_f32 v67, v130, v131
v_cvt_pk_bf16_f32 v68, v68, v69
v_mfma_f32_16x16x32_bf16 v[148:151], a[220:223], a[116:119], v[148:151]
ds_read_b64_tr_b16 a[212:213], v47 offset:49152
v_cvt_pk_bf16_f32 v69, v70, v71
v_mfma_f32_16x16x32_bf16 v[148:151], a[216:219], a[100:103], v[148:151]
buffer_load_dwordx4 v34, s[28:31], s76 offen offset:0 sc1 lds
v_mfma_f32_16x16x32_bf16 v[144:147], a[216:219], a[96:99], v[144:147]
ds_read_b64_tr_b16 a[214:215], v47 offset:50176
v_cvt_pk_bf16_f32 v70, v132, v133
v_mfma_f32_16x16x32_bf16 v[144:147], a[220:223], a[112:115], v[144:147]
s_waitcnt lgkmcnt(5)
v_cvt_pk_bf16_f32 v71, v134, v135
v_cvt_pk_bf16_f32 v72, v72, v73
v_mfma_f32_16x16x32_bf16 v[96:99], a[192:195], a[96:99], v[96:99]
ds_read_b64_tr_b16 a[216:217], v47 offset:32776
v_cvt_pk_bf16_f32 v73, v74, v75
v_mfma_f32_16x16x32_bf16 v[96:99], a[196:199], a[112:115], v[96:99]
v_cvt_pk_bf16_f32 v74, v136, v137
v_cvt_pk_bf16_f32 v75, v138, v139
v_mfma_f32_16x16x32_bf16 v[100:103], a[196:199], a[116:119], v[100:103]
ds_read_b64_tr_b16 a[218:219], v47 offset:33800
v_cvt_pk_bf16_f32 v76, v76, v77
v_mfma_f32_16x16x32_bf16 v[100:103], a[192:195], a[100:103], v[100:103]
buffer_load_dwordx4 v35, s[28:31], s76 offen offset:1024 sc1 lds
v_mfma_f32_16x16x32_bf16 v[104:107], a[192:195], a[104:107], v[104:107]
s_add_u32 m0, s77, 90112
s_mov_b32 s76, 57344
ds_read_b64_tr_b16 a[220:221], v47 offset:49160
v_cvt_pk_bf16_f32 v77, v78, v79
v_mfma_f32_16x16x32_bf16 v[104:107], a[196:199], a[120:123], v[104:107]
v_cvt_pk_bf16_f32 v78, v140, v141
v_cvt_pk_bf16_f32 v79, v142, v143
v_mfma_f32_16x16x32_bf16 v[108:111], a[196:199], a[124:127], v[108:111]
ds_read_b64_tr_b16 a[222:223], v47 offset:50184
v_mfma_f32_16x16x32_bf16 v[108:111], a[192:195], a[108:111], v[108:111]
v_cvt_pk_bf16_f32 v80, v80, v81
v_cvt_pk_bf16_f32 v81, v82, v83
v_mfma_f32_16x16x32_bf16 v[172:175], a[204:207], a[124:127], v[172:175]
s_waitcnt vmcnt(22)
s_barrier
v_mfma_f32_16x16x32_bf16 v[172:175], a[200:203], a[108:111], v[172:175]
ds_read_b128 a[224:227], v20 offset:0
v_cvt_pk_bf16_f32 v82, v144, v145
v_mfma_f32_16x16x32_bf16 v[168:171], a[200:203], a[104:107], v[168:171]
ds_read_b128 a[240:243], v20 offset:4096
v_cvt_pk_bf16_f32 v83, v146, v147
v_mfma_f32_16x16x32_bf16 v[168:171], a[204:207], a[120:123], v[168:171]
ds_read_b128 a[228:231], v21 offset:0
v_cvt_pk_bf16_f32 v84, v84, v85
v_mfma_f32_16x16x32_bf16 v[164:167], a[204:207], a[116:119], v[164:167]
ds_read_b128 a[244:247], v21 offset:4096
v_cvt_pk_bf16_f32 v85, v86, v87
v_mfma_f32_16x16x32_bf16 v[164:167], a[200:203], a[100:103], v[164:167]
ds_read_b128 a[232:235], v22 offset:0
v_cvt_pk_bf16_f32 v86, v148, v149
v_mfma_f32_16x16x32_bf16 v[160:163], a[200:203], a[96:99], v[160:163]
ds_read_b128 a[248:251], v22 offset:4096
v_cvt_pk_bf16_f32 v87, v150, v151
v_mfma_f32_16x16x32_bf16 v[160:163], a[204:207], a[112:115], v[160:163]
s_waitcnt lgkmcnt(6)
ds_read_b128 a[236:239], v23 offset:0
v_cvt_pk_bf16_f32 v88, v88, v89
v_mfma_f32_16x16x32_bf16 v[112:115], a[208:211], a[96:99], v[112:115]
ds_read_b128 a[252:255], v23 offset:4096
v_cvt_pk_bf16_f32 v89, v90, v91
v_mfma_f32_16x16x32_bf16 v[112:115], a[212:215], a[112:115], v[112:115]
buffer_load_dwordx4 v34, s[28:31], s76 offen offset:0 sc1 lds
v_mfma_f32_16x16x32_bf16 v[116:119], a[212:215], a[116:119], v[116:119]
v_cvt_pk_bf16_f32 v90, v152, v153
v_cvt_pk_bf16_f32 v91, v154, v155
v_mfma_f32_16x16x32_bf16 v[116:119], a[208:211], a[100:103], v[116:119]
v_cvt_pk_bf16_f32 v92, v92, v93
v_cvt_pk_bf16_f32 v93, v94, v95
v_mfma_f32_16x16x32_bf16 v[120:123], a[208:211], a[104:107], v[120:123]
v_cvt_pk_bf16_f32 v94, v156, v157
v_cvt_pk_bf16_f32 v95, v158, v159
v_mfma_f32_16x16x32_bf16 v[120:123], a[212:215], a[120:123], v[120:123]
buffer_store_dwordx4 v[224:227], v2, s[32:35], s86 offen offset:0 sc1
v_mfma_f32_16x16x32_bf16 v[124:127], a[212:215], a[124:127], v[124:127]
buffer_load_dwordx4 v35, s[28:31], s76 offen offset:1024 sc1 lds
v_mfma_f32_16x16x32_bf16 v[124:127], a[208:211], a[108:111], v[124:127]
v_cvt_pk_bf16_f32 v96, v96, v97
v_cvt_pk_bf16_f32 v97, v98, v99
v_mfma_f32_16x16x32_bf16 v[188:191], a[220:223], a[124:127], v[188:191]
v_cvt_pk_bf16_f32 v98, v160, v161
v_cvt_pk_bf16_f32 v99, v162, v163
v_mfma_f32_16x16x32_bf16 v[188:191], a[216:219], a[108:111], v[188:191]
v_cvt_pk_bf16_f32 v100, v100, v101
v_cvt_pk_bf16_f32 v101, v102, v103
v_mfma_f32_16x16x32_bf16 v[184:187], a[216:219], a[104:107], v[184:187]
v_cvt_pk_bf16_f32 v102, v164, v165
v_cvt_pk_bf16_f32 v103, v166, v167
v_mfma_f32_16x16x32_bf16 v[184:187], a[220:223], a[120:123], v[184:187]
v_cvt_pk_bf16_f32 v104, v104, v105
v_cvt_pk_bf16_f32 v105, v106, v107
v_mfma_f32_16x16x32_bf16 v[180:183], a[220:223], a[116:119], v[180:183]
v_cvt_pk_bf16_f32 v106, v168, v169
v_cvt_pk_bf16_f32 v107, v170, v171
v_mfma_f32_16x16x32_bf16 v[180:183], a[216:219], a[100:103], v[180:183]
v_cvt_pk_bf16_f32 v108, v108, v109
v_cvt_pk_bf16_f32 v109, v110, v111
v_mfma_f32_16x16x32_bf16 v[176:179], a[216:219], a[96:99], v[176:179]
v_cvt_pk_bf16_f32 v110, v172, v173
v_cvt_pk_bf16_f32 v111, v174, v175
v_mfma_f32_16x16x32_bf16 v[176:179], a[220:223], a[112:115], v[176:179]
s_waitcnt lgkmcnt(0)
v_accvgpr_read_b32 v40, a52
v_accvgpr_read_b32 v41, a53
v_mfma_f32_16x16x32_bf16 v[128:131], a[224:227], v[64:67], 0
s_waitcnt vmcnt(63)
s_barrier
v_mfma_f32_16x16x32_bf16 v[136:139], a[224:227], v[68:71], 0
s_add_u32 m0, s77, 98304
s_mov_b32 s76, 65536
ds_read_b128 a[96:99], v6
v_accvgpr_read_b32 v42, a54
v_mfma_f32_16x16x32_bf16 v[144:147], a[224:227], v[72:75], 0
buffer_load_dwordx4 v34, s[28:31], s76 offen offset:0 sc1 lds
v_mfma_f32_16x16x32_bf16 v[152:155], a[224:227], v[76:79], 0
ds_read_b128 a[224:227], v20 offset:8192
v_accvgpr_read_b32 v43, a55
v_mfma_f32_16x16x32_bf16 v[132:135], a[240:243], v[64:67], 0
ds_read_b128 a[100:103], v6
v_max_f32 v244, 0, v244
v_mfma_f32_16x16x32_bf16 v[140:143], a[240:243], v[68:71], 0
v_max_f32 v245, 0, v245
v_max_f32 v246, 0, v246
v_mfma_f32_16x16x32_bf16 v[148:151], a[240:243], v[72:75], 0
ds_read_b128 a[104:107], v6
v_max_f32 v247, 0, v247
v_mfma_f32_16x16x32_bf16 v[156:159], a[240:243], v[76:79], 0
ds_read_b128 a[240:243], v20 offset:12288
v_cvt_pk_bf16_f32 v112, v112, v113
v_mfma_f32_16x16x32_bf16 v[128:131], a[228:231], v[80:83], v[128:131]
buffer_load_dwordx4 v35, s[28:31], s76 offen offset:1024 sc1 lds
v_mfma_f32_16x16x32_bf16 v[136:139], a[228:231], v[84:87], v[136:139]
ds_read_b128 a[108:111], v6
v_cvt_pk_bf16_f32 v113, v114, v115
v_mfma_f32_16x16x32_bf16 v[144:147], a[228:231], v[88:91], v[144:147]
v_cvt_pk_bf16_f32 v114, v176, v177
v_cvt_pk_bf16_f32 v115, v178, v179
v_mfma_f32_16x16x32_bf16 v[152:155], a[228:231], v[92:95], v[152:155]
ds_read_b128 a[228:231], v21 offset:8192
v_cvt_pk_bf16_f32 v116, v116, v117
v_mfma_f32_16x16x32_bf16 v[132:135], a[244:247], v[80:83], v[132:135]
ds_read_b128 a[112:115], v6
v_cvt_pk_bf16_f32 v117, v118, v119
v_mfma_f32_16x16x32_bf16 v[140:143], a[244:247], v[84:87], v[140:143]
v_cvt_pk_bf16_f32 v118, v180, v181
v_cvt_pk_bf16_f32 v119, v182, v183
v_mfma_f32_16x16x32_bf16 v[148:151], a[244:247], v[88:91], v[148:151]
ds_read_b128 a[116:119], v6
v_cvt_pk_bf16_f32 v120, v120, v121
v_mfma_f32_16x16x32_bf16 v[156:159], a[244:247], v[92:95], v[156:159]
ds_read_b128 a[244:247], v21 offset:12288
v_cvt_pk_bf16_f32 v121, v122, v123
v_mfma_f32_16x16x32_bf16 v[128:131], a[232:235], v[96:99], v[128:131]
ds_read_b128 a[120:123], v6
v_cvt_pk_bf16_f32 v122, v184, v185
v_mfma_f32_16x16x32_bf16 v[136:139], a[232:235], v[100:103], v[136:139]
v_cvt_pk_bf16_f32 v123, v186, v187
v_cvt_pk_bf16_f32 v124, v124, v125
v_mfma_f32_16x16x32_bf16 v[144:147], a[232:235], v[104:107], v[144:147]
ds_read_b128 a[124:127], v6
v_cvt_pk_bf16_f32 v125, v126, v127
v_mfma_f32_16x16x32_bf16 v[152:155], a[232:235], v[108:111], v[152:155]
ds_read_b128 a[232:235], v22 offset:8192
v_cvt_pk_bf16_f32 v126, v188, v189
v_mfma_f32_16x16x32_bf16 v[132:135], a[248:251], v[96:99], v[132:135]
v_cvt_pk_bf16_f32 v127, v190, v191
v_mul_f32 v244, v244, v40
v_mfma_f32_16x16x32_bf16 v[140:143], a[248:251], v[100:103], v[140:143]
v_mul_f32 v245, v245, v41
v_mul_f32 v246, v246, v42
v_mfma_f32_16x16x32_bf16 v[148:151], a[248:251], v[104:107], v[148:151]
v_mul_f32 v247, v247, v43
v_cvt_pk_bf16_f32 v230, v244, v245
v_mfma_f32_16x16x32_bf16 v[156:159], a[248:251], v[108:111], v[156:159]
ds_read_b128 a[248:251], v22 offset:12288
v_cvt_pk_bf16_f32 v231, v246, v247
v_mfma_f32_16x16x32_bf16 v[128:131], a[236:239], v[112:115], v[128:131]
buffer_store_dwordx4 v[228:231], v2, s[32:35], s86 offen offset:1024 sc1
v_mfma_f32_16x16x32_bf16 v[136:139], a[236:239], v[116:119], v[136:139]
v_accvgpr_read_b32 v40, a56
v_accvgpr_read_b32 v41, a57
v_mfma_f32_16x16x32_bf16 v[144:147], a[236:239], v[120:123], v[144:147]
v_accvgpr_read_b32 v42, a58
v_accvgpr_read_b32 v43, a59
v_mfma_f32_16x16x32_bf16 v[152:155], a[236:239], v[124:127], v[152:155]
ds_read_b128 a[236:239], v23 offset:8192
v_max_f32 v248, 0, v248
v_mfma_f32_16x16x32_bf16 v[132:135], a[252:255], v[112:115], v[132:135]
v_max_f32 v249, 0, v249
v_max_f32 v250, 0, v250
v_mfma_f32_16x16x32_bf16 v[140:143], a[252:255], v[116:119], v[140:143]
v_max_f32 v251, 0, v251
v_mul_f32 v248, v248, v40
v_mfma_f32_16x16x32_bf16 v[148:151], a[252:255], v[120:123], v[148:151]
v_mul_f32 v249, v249, v41
v_mul_f32 v250, v250, v42
v_mfma_f32_16x16x32_bf16 v[156:159], a[252:255], v[124:127], v[156:159]
ds_read_b128 a[252:255], v23 offset:12288
v_mul_f32 v251, v251, v43
v_cvt_pk_bf16_f32 v234, v248, v249
v_cvt_pk_bf16_f32 v235, v250, v251
buffer_store_dwordx4 v[232:235], v2, s[32:35], s86 offen offset:2048 sc1
v_accvgpr_read_b32 v40, a60
v_accvgpr_read_b32 v41, a61
v_accvgpr_read_b32 v42, a62
v_accvgpr_read_b32 v43, a63
v_max_f32 v252, 0, v252
v_max_f32 v253, 0, v253
v_max_f32 v254, 0, v254
v_max_f32 v255, 0, v255
v_mul_f32 v252, v252, v40
v_mul_f32 v253, v253, v41
v_mul_f32 v254, v254, v42
v_mul_f32 v255, v255, v43
v_cvt_pk_bf16_f32 v238, v252, v253
v_cvt_pk_bf16_f32 v239, v254, v255
buffer_store_dwordx4 v[236:239], v2, s[32:35], s86 offen offset:3072 sc1
s_mov_b32 s76, 65536
s_nop 1
v_mov_b32 v240, 0
v_mov_b32 v241, 0
v_mov_b32 v242, 0
v_mov_b32 v243, 0
v_mov_b32 v244, 0
v_mov_b32 v245, 0
v_mov_b32 v246, 0
v_mov_b32 v247, 0
v_mov_b32 v224, 0xff800000
v_mov_b32 v228, 0xff800000
v_mov_b32 v232, 0xff800000
v_mov_b32 v236, 0xff800000
s_waitcnt vmcnt(26)
PROJ_DONE:
ATT_START:
s_barrier
v_max3_f32 v40, v128, v129, v130
v_max3_f32 v42, v136, v137, v138
v_max3_f32 v44, v144, v145, v146
v_max3_f32 v46, v152, v153, v154
v_max3_f32 v40, v40, v131, v224
v_max3_f32 v42, v42, v139, v228
v_max3_f32 v44, v44, v147, v232
v_max3_f32 v46, v46, v155, v236
v_mov_b32 v41, v40
v_mov_b32 v43, v42
v_mov_b32 v45, v44
v_mov_b32 v47, v46
s_nop 0
v_permlane32_swap_b32 v40, v41
v_permlane32_swap_b32 v42, v43
v_permlane32_swap_b32 v44, v45
v_permlane32_swap_b32 v46, v47
v_max_f32 v40, v40, v41
v_max_f32 v42, v42, v43
v_max_f32 v44, v44, v45
v_max_f32 v46, v46, v47
v_mov_b32 v41, v40
v_mov_b32 v43, v42
v_mov_b32 v45, v44
v_mov_b32 v47, v46
s_nop 0
v_permlane16_swap_b32 v40, v41
v_permlane16_swap_b32 v42, v43
v_permlane16_swap_b32 v44, v45
v_permlane16_swap_b32 v46, v47
v_min_f32 v224, -v40, -v41
v_min_f32 v225, -v40, -v41
v_min_f32 v226, -v40, -v41
v_min_f32 v227, -v40, -v41
v_min_f32 v228, -v42, -v43
v_min_f32 v229, -v42, -v43
v_min_f32 v230, -v42, -v43
v_min_f32 v231, -v42, -v43
v_min_f32 v232, -v44, -v45
v_min_f32 v233, -v44, -v45
v_min_f32 v234, -v44, -v45
v_min_f32 v235, -v44, -v45
v_min_f32 v236, -v46, -v47
v_min_f32 v237, -v46, -v47
v_min_f32 v238, -v46, -v47
v_min_f32 v239, -v46, -v47
v_pk_add_f32 v[128:129], v[128:129], v[224:225]
v_pk_add_f32 v[130:131], v[130:131], v[224:225]
v_pk_add_f32 v[132:133], v[132:133], v[224:225]
v_pk_add_f32 v[134:135], v[134:135], v[224:225]
v_pk_add_f32 v[136:137], v[136:137], v[228:229]
v_pk_add_f32 v[138:139], v[138:139], v[228:229]
v_pk_add_f32 v[140:141], v[140:141], v[228:229]
v_pk_add_f32 v[142:143], v[142:143], v[228:229]
v_pk_add_f32 v[144:145], v[144:145], v[232:233]
v_pk_add_f32 v[146:147], v[146:147], v[232:233]
v_pk_add_f32 v[148:149], v[148:149], v[232:233]
v_pk_add_f32 v[150:151], v[150:151], v[232:233]
v_pk_add_f32 v[152:153], v[152:153], v[236:237]
v_pk_add_f32 v[154:155], v[154:155], v[236:237]
v_pk_add_f32 v[156:157], v[156:157], v[236:237]
v_pk_add_f32 v[158:159], v[158:159], v[236:237]
s_waitcnt lgkmcnt(0)
v_mfma_f32_16x16x32_bf16 v[160:163], a[224:227], v[64:67], v[224:227]
v_exp_f32 v128, v128
v_mfma_f32_16x16x32_bf16 v[160:163], a[228:231], v[80:83], v[160:163]
ds_read_b128 a[192:195], v20 offset:24576
v_exp_f32 v129, v129
v_mfma_f32_16x16x32_bf16 v[160:163], a[232:235], v[96:99], v[160:163]
v_exp_f32 v130, v130
v_mfma_f32_16x16x32_bf16 v[160:163], a[236:239], v[112:115], v[160:163]
ds_read_b128 a[196:199], v21 offset:24576
v_exp_f32 v131, v131
v_mfma_f32_16x16x32_bf16 v[168:171], a[236:239], v[116:119], v[228:231]
v_exp_f32 v132, v132
v_mfma_f32_16x16x32_bf16 v[168:171], a[232:235], v[100:103], v[168:171]
ds_read_b128 a[200:203], v22 offset:24576
v_exp_f32 v133, v133
v_mfma_f32_16x16x32_bf16 v[168:171], a[228:231], v[84:87], v[168:171]
v_exp_f32 v134, v134
v_mfma_f32_16x16x32_bf16 v[168:171], a[224:227], v[68:71], v[168:171]
ds_read_b128 a[204:207], v23 offset:24576
v_exp_f32 v135, v135
v_mfma_f32_16x16x32_bf16 v[176:179], a[224:227], v[72:75], v[232:235]
v_exp_f32 v136, v136
v_mfma_f32_16x16x32_bf16 v[176:179], a[228:231], v[88:91], v[176:179]
ds_read_b128 a[208:211], v20 offset:28672
v_exp_f32 v137, v137
v_mfma_f32_16x16x32_bf16 v[176:179], a[232:235], v[104:107], v[176:179]
v_exp_f32 v138, v138
v_mfma_f32_16x16x32_bf16 v[176:179], a[236:239], v[120:123], v[176:179]
ds_read_b128 a[212:215], v21 offset:28672
v_exp_f32 v139, v139
v_mfma_f32_16x16x32_bf16 v[184:187], a[236:239], v[124:127], v[236:239]
v_exp_f32 v140, v140
v_mfma_f32_16x16x32_bf16 v[184:187], a[232:235], v[108:111], v[184:187]
ds_read_b128 a[216:219], v22 offset:28672
v_exp_f32 v141, v141
v_mfma_f32_16x16x32_bf16 v[184:187], a[228:231], v[92:95], v[184:187]
v_exp_f32 v142, v142
v_mfma_f32_16x16x32_bf16 v[184:187], a[224:227], v[76:79], v[184:187]
ds_read_b128 a[220:223], v23 offset:28672
v_exp_f32 v143, v143
v_mfma_f32_16x16x32_bf16 v[164:167], a[240:243], v[64:67], v[224:227]
v_exp_f32 v144, v144
v_mfma_f32_16x16x32_bf16 v[164:167], a[244:247], v[80:83], v[164:167]
ds_read_b128 a[224:227], v20 offset:16384
v_exp_f32 v145, v145
v_mfma_f32_16x16x32_bf16 v[164:167], a[248:251], v[96:99], v[164:167]
v_exp_f32 v146, v146
v_mfma_f32_16x16x32_bf16 v[164:167], a[252:255], v[112:115], v[164:167]
ds_read_b128 a[228:231], v21 offset:16384
v_exp_f32 v147, v147
v_mfma_f32_16x16x32_bf16 v[172:175], a[252:255], v[116:119], v[228:231]
v_exp_f32 v148, v148
v_mfma_f32_16x16x32_bf16 v[172:175], a[248:251], v[100:103], v[172:175]
ds_read_b128 a[232:235], v22 offset:16384
v_exp_f32 v149, v149
v_mfma_f32_16x16x32_bf16 v[172:175], a[244:247], v[84:87], v[172:175]
v_exp_f32 v150, v150
v_mfma_f32_16x16x32_bf16 v[172:175], a[240:243], v[68:71], v[172:175]
ds_read_b128 a[236:239], v23 offset:16384
v_exp_f32 v151, v151
v_mfma_f32_16x16x32_bf16 v[180:183], a[240:243], v[72:75], v[232:235]
v_exp_f32 v152, v152
v_cvt_pk_bf16_f32 v192, v128, v129
v_mfma_f32_16x16x32_bf16 v[180:183], a[244:247], v[88:91], v[180:183]
v_exp_f32 v153, v153
v_mfma_f32_16x16x32_bf16 v[180:183], a[248:251], v[104:107], v[180:183]
v_exp_f32 v154, v154
v_cvt_pk_bf16_f32 v193, v130, v131
v_mfma_f32_16x16x32_bf16 v[180:183], a[252:255], v[120:123], v[180:183]
v_exp_f32 v155, v155
v_mfma_f32_16x16x32_bf16 v[188:191], a[252:255], v[124:127], v[236:239]
v_exp_f32 v156, v156
v_cvt_pk_bf16_f32 v194, v132, v133
v_mfma_f32_16x16x32_bf16 v[188:191], a[248:251], v[108:111], v[188:191]
v_exp_f32 v157, v157
v_mfma_f32_16x16x32_bf16 v[188:191], a[244:247], v[92:95], v[188:191]
v_exp_f32 v158, v158
v_cvt_pk_bf16_f32 v195, v134, v135
v_mfma_f32_16x16x32_bf16 v[188:191], a[240:243], v[76:79], v[188:191]
ds_read_b128 a[240:243], v20 offset:20480
ds_read_b128 a[244:247], v21 offset:20480
ds_read_b128 a[248:251], v22 offset:20480
ds_read_b128 a[252:255], v23 offset:20480
v_exp_f32 v159, v159
v_exp_f32 v160, v160
v_exp_f32 v161, v161
v_exp_f32 v162, v162
v_exp_f32 v163, v163
v_add_u32 v20, 32768, v20
v_add_u32 v21, 32768, v21
v_add_u32 v22, 32768, v22
v_add_u32 v23, 32768, v23
s_mov_b32 s78, 16384
s_mov_b32 s83, 16384
s_mov_b32 s84, 114688
s_waitcnt vmcnt(6) lgkmcnt(0)
s_barrier
s_add_u32 m0, s77, 0
s_nop 0
buffer_load_dwordx4 v32, s[24:27], s76 offen offset:0 sc1 lds
buffer_load_dwordx4 v33, s[24:27], s76 offen offset:1024 sc1 lds
s_add_u32 s76, s76, 8192
s_add_u32 m0, s77, 8192
s_nop 0
buffer_load_dwordx4 v32, s[24:27], s76 offen offset:0 sc1 lds
buffer_load_dwordx4 v33, s[24:27], s76 offen offset:1024 sc1 lds
s_add_u32 m0, s77, 106496
s_nop 0
buffer_load_dwordx4 v34, s[28:31], s76 offen offset:0 sc1 lds
buffer_load_dwordx4 v35, s[28:31], s76 offen offset:1024 sc1 lds
s_add_u32 s76, s76, 8192
s_mov_b32 s85, 524288
s_cmp_eq_u32 s68, 0
s_cselect_b32 s85, 131072, s85
s_cmp_lg_u32 s79, 0
s_cbranch_scc1 NOSIG2
s_cmp_ge_u32 s71, 27
s_cbranch_scc1 LT_INIT
NOSIG2:
.p2align 6
ATT_LOOP:
v_mfma_f32_16x16x32_bf16 v[128:131], a[224:227], v[64:67], v[224:227]
s_waitcnt vmcnt(16) lgkmcnt(0)
v_exp_f32 v164, v164
v_mfma_f32_16x16x32_bf16 v[128:131], a[228:231], v[80:83], v[128:131]
s_barrier
v_mfma_f32_16x16x32_bf16 v[128:131], a[232:235], v[96:99], v[128:131]
v_exp_f32 v165, v165
v_mfma_f32_16x16x32_bf16 v[128:131], a[236:239], v[112:115], v[128:131]
v_cvt_pk_bf16_f32 v196, v136, v137
v_cvt_pk_bf16_f32 v197, v138, v139
v_mfma_f32_16x16x32_bf16 v[132:135], a[252:255], v[112:115], v[224:227]
v_exp_f32 v166, v166
v_mfma_f32_16x16x32_bf16 v[132:135], a[248:251], v[96:99], v[132:135]
ds_read_b64_tr_b16 a[0:1], v24 offset:0
v_cvt_pk_bf16_f32 v198, v140, v141
v_mfma_f32_16x16x32_bf16 v[132:135], a[244:247], v[80:83], v[132:135]
v_exp_f32 v167, v167
v_mfma_f32_16x16x32_bf16 v[132:135], a[240:243], v[64:67], v[132:135]
v_cvt_pk_bf16_f32 v199, v142, v143
v_cvt_pk_bf16_f32 v200, v144, v145
v_mfma_f32_16x16x32_bf16 v[140:143], a[240:243], v[68:71], v[228:231]
v_exp_f32 v168, v168
v_mfma_f32_16x16x32_bf16 v[140:143], a[244:247], v[84:87], v[140:143]
ds_read_b64_tr_b16 a[2:3], v24 offset:4096
v_cvt_pk_bf16_f32 v201, v146, v147
v_mfma_f32_16x16x32_bf16 v[140:143], a[248:251], v[100:103], v[140:143]
v_exp_f32 v169, v169
v_mfma_f32_16x16x32_bf16 v[140:143], a[252:255], v[116:119], v[140:143]
v_cvt_pk_bf16_f32 v202, v148, v149
v_cvt_pk_bf16_f32 v203, v150, v151
v_mfma_f32_16x16x32_bf16 v[136:139], a[236:239], v[116:119], v[228:231]
v_exp_f32 v170, v170
v_mfma_f32_16x16x32_bf16 v[136:139], a[232:235], v[100:103], v[136:139]
ds_read_b64_tr_b16 a[32:33], v24 offset:8192
v_cvt_pk_bf16_f32 v204, v152, v153
v_mfma_f32_16x16x32_bf16 v[136:139], a[228:231], v[84:87], v[136:139]
v_exp_f32 v171, v171
v_mfma_f32_16x16x32_bf16 v[136:139], a[224:227], v[68:71], v[136:139]
v_cvt_pk_bf16_f32 v205, v154, v155
v_cvt_pk_bf16_f32 v206, v156, v157
v_mfma_f32_16x16x32_bf16 v[144:147], a[224:227], v[72:75], v[232:235]
v_exp_f32 v172, v172
v_mfma_f32_16x16x32_bf16 v[144:147], a[228:231], v[88:91], v[144:147]
ds_read_b64_tr_b16 a[34:35], v24 offset:12288
v_cvt_pk_bf16_f32 v207, v158, v159
v_mfma_f32_16x16x32_bf16 v[144:147], a[232:235], v[104:107], v[144:147]
v_exp_f32 v173, v173
v_mfma_f32_16x16x32_bf16 v[144:147], a[236:239], v[120:123], v[144:147]
ds_read_b64_tr_b16 a[4:5], v25 offset:0
v_cvt_pk_bf16_f32 v208, v160, v161
v_mfma_f32_16x16x32_bf16 v[148:151], a[252:255], v[120:123], v[232:235]
v_exp_f32 v174, v174
v_mfma_f32_16x16x32_bf16 v[148:151], a[248:251], v[104:107], v[148:151]
ds_read_b64_tr_b16 a[6:7], v25 offset:4096
v_cvt_pk_bf16_f32 v209, v162, v163
v_mfma_f32_16x16x32_bf16 v[148:151], a[244:247], v[88:91], v[148:151]
v_exp_f32 v175, v175
v_mfma_f32_16x16x32_bf16 v[148:151], a[240:243], v[72:75], v[148:151]
ds_read_b64_tr_b16 a[36:37], v25 offset:8192
v_cvt_pk_bf16_f32 v210, v164, v165
v_mfma_f32_16x16x32_bf16 v[156:159], a[240:243], v[76:79], v[236:239]
v_exp_f32 v176, v176
v_mfma_f32_16x16x32_bf16 v[156:159], a[244:247], v[92:95], v[156:159]
ds_read_b64_tr_b16 a[38:39], v25 offset:12288
v_cvt_pk_bf16_f32 v211, v166, v167
v_mfma_f32_16x16x32_bf16 v[156:159], a[248:251], v[108:111], v[156:159]
v_exp_f32 v177, v177
v_mfma_f32_16x16x32_bf16 v[156:159], a[252:255], v[124:127], v[156:159]
ds_read_b64_tr_b16 a[8:9], v26 offset:0
v_cvt_pk_bf16_f32 v212, v168, v169
v_mfma_f32_16x16x32_bf16 v[152:155], a[236:239], v[124:127], v[236:239]
v_exp_f32 v178, v178
v_mfma_f32_16x16x32_bf16 v[152:155], a[232:235], v[108:111], v[152:155]
ds_read_b64_tr_b16 a[10:11], v26 offset:4096
v_cvt_pk_bf16_f32 v213, v170, v171
v_mfma_f32_16x16x32_bf16 v[152:155], a[228:231], v[92:95], v[152:155]
v_exp_f32 v179, v179
v_mfma_f32_16x16x32_bf16 v[152:155], a[224:227], v[76:79], v[152:155]
ds_read_b64_tr_b16 a[40:41], v26 offset:8192
v_cvt_pk_bf16_f32 v214, v172, v173
v_mfma_f32_16x16x32_bf16 v[160:163], a[192:195], v[64:67], v[224:227]
v_exp_f32 v180, v180
v_mfma_f32_16x16x32_bf16 v[160:163], a[196:199], v[80:83], v[160:163]
ds_read_b64_tr_b16 a[42:43], v26 offset:12288
v_cvt_pk_bf16_f32 v215, v174, v175
v_mfma_f32_16x16x32_bf16 v[160:163], a[200:203], v[96:99], v[160:163]
v_exp_f32 v181, v181
v_mfma_f32_16x16x32_bf16 v[160:163], a[204:207], v[112:115], v[160:163]
ds_read_b64_tr_b16 a[12:13], v27 offset:0
v_cvt_pk_bf16_f32 v216, v176, v177
v_mfma_f32_16x16x32_bf16 v[164:167], a[220:223], v[112:115], v[224:227]
v_exp_f32 v182, v182
v_mfma_f32_16x16x32_bf16 v[164:167], a[216:219], v[96:99], v[164:167]
ds_read_b64_tr_b16 a[14:15], v27 offset:4096
v_cvt_pk_bf16_f32 v217, v178, v179
v_mfma_f32_16x16x32_bf16 v[164:167], a[212:215], v[80:83], v[164:167]
v_exp_f32 v183, v183
v_mfma_f32_16x16x32_bf16 v[164:167], a[208:211], v[64:67], v[164:167]
ds_read_b64_tr_b16 a[44:45], v27 offset:8192
v_cvt_pk_bf16_f32 v218, v180, v181
v_mfma_f32_16x16x32_bf16 v[172:175], a[208:211], v[68:71], v[228:231]
v_exp_f32 v184, v184
v_mfma_f32_16x16x32_bf16 v[172:175], a[212:215], v[84:87], v[172:175]
ds_read_b64_tr_b16 a[46:47], v27 offset:12288
v_cvt_pk_bf16_f32 v219, v182, v183
v_mfma_f32_16x16x32_bf16 v[172:175], a[216:219], v[100:103], v[172:175]
v_exp_f32 v185, v185
v_mfma_f32_16x16x32_bf16 v[172:175], a[220:223], v[116:119], v[172:175]
ds_read_b64_tr_b16 a[16:17], v28 offset:0
v_cvt_pk_bf16_f32 v220, v184, v185
v_mfma_f32_16x16x32_bf16 v[168:171], a[204:207], v[116:119], v[228:231]
v_exp_f32 v186, v186
v_mfma_f32_16x16x32_bf16 v[168:171], a[200:203], v[100:103], v[168:171]
ds_read_b64_tr_b16 a[18:19], v28 offset:4096
v_mfma_f32_16x16x32_bf16 v[168:171], a[196:199], v[84:87], v[168:171]
v_exp_f32 v187, v187
v_mfma_f32_16x16x32_bf16 v[168:171], a[192:195], v[68:71], v[168:171]
ds_read_b64_tr_b16 a[48:49], v28 offset:8192
v_cvt_pk_bf16_f32 v221, v186, v187
v_mfma_f32_16x16x32_bf16 v[176:179], a[192:195], v[72:75], v[232:235]
v_exp_f32 v188, v188
v_mfma_f32_16x16x32_bf16 v[176:179], a[196:199], v[88:91], v[176:179]
ds_read_b64_tr_b16 a[50:51], v28 offset:12288
v_mfma_f32_16x16x32_bf16 v[176:179], a[200:203], v[104:107], v[176:179]
v_exp_f32 v189, v189
v_mfma_f32_16x16x32_bf16 v[176:179], a[204:207], v[120:123], v[176:179]
ds_read_b64_tr_b16 a[20:21], v29 offset:0
v_cvt_pk_bf16_f32 v222, v188, v189
v_mfma_f32_16x16x32_bf16 v[180:183], a[220:223], v[120:123], v[232:235]
v_exp_f32 v190, v190
v_mfma_f32_16x16x32_bf16 v[180:183], a[216:219], v[104:107], v[180:183]
ds_read_b64_tr_b16 a[22:23], v29 offset:4096
v_mfma_f32_16x16x32_bf16 v[180:183], a[212:215], v[88:91], v[180:183]
s_add_u32 m0, s77, s83
v_exp_f32 v191, v191
v_mfma_f32_16x16x32_bf16 v[180:183], a[208:211], v[72:75], v[180:183]
v_cvt_pk_bf16_f32 v223, v190, v191
v_mfma_f32_16x16x32_bf16 v[188:191], a[208:211], v[76:79], v[236:239]
buffer_load_dwordx4 v32, s[24:27], s76 offen offset:0 sc1 lds
v_mfma_f32_16x16x32_bf16 v[188:191], a[212:215], v[92:95], v[188:191]
v_exp_f32 v128, v128
v_mfma_f32_16x16x32_bf16 v[188:191], a[216:219], v[108:111], v[188:191]
buffer_load_dwordx4 v33, s[24:27], s76 offen offset:1024 sc1 lds
v_mfma_f32_16x16x32_bf16 v[188:191], a[220:223], v[124:127], v[188:191]
s_add_u32 m0, s77, s84
v_exp_f32 v129, v129
v_mfma_f32_16x16x32_bf16 v[184:187], a[204:207], v[124:127], v[236:239]
v_exp_f32 v130, v130
v_mfma_f32_16x16x32_bf16 v[184:187], a[200:203], v[108:111], v[184:187]
buffer_load_dwordx4 v34, s[28:31], s76 offen offset:0 sc1 lds
v_mfma_f32_16x16x32_bf16 v[184:187], a[196:199], v[92:95], v[184:187]
s_waitcnt lgkmcnt(0)
v_exp_f32 v131, v131
v_mfma_f32_16x16x32_bf16 v[184:187], a[192:195], v[76:79], v[184:187]
buffer_load_dwordx4 v35, s[28:31], s76 offen offset:1024 sc1 lds
v_smfmac_f32_16x16x64_bf16 v[240:243], v[56:59], v[192:199], v7
s_add_u32 s76, s76, 8192
ds_read_b64_tr_b16 a[52:53], v29 offset:8192
v_smfmac_f32_16x16x64_bf16 v[240:243], v[56:59], v[208:215], v7
s_add_u32 s83, s83, 8192
ds_read_b64_tr_b16 a[54:55], v29 offset:12288
v_smfmac_f32_16x16x64_bf16 v[244:247], v[56:59], v[216:223], v7
s_and_b32 s83, s83, 0xffff
ds_read_b64_tr_b16 a[24:25], v30 offset:0
v_smfmac_f32_16x16x64_bf16 v[244:247], v[56:59], v[200:207], v7
s_add_u32 s84, s84, 8192
ds_read_b64_tr_b16 a[26:27], v30 offset:4096
v_mfma_f32_16x16x32_bf16 a[76:79], a[0:3], v[204:207], a[76:79]
s_and_b32 s84, s84, 0xffff
ds_read_b64_tr_b16 a[56:57], v30 offset:8192
v_xor_b32 v24, s78, v24
v_mfma_f32_16x16x32_bf16 a[76:79], a[32:35], v[220:223], a[76:79]
s_or_b32 s84, s84, 65536
v_exp_f32 v132, v132
v_mfma_f32_16x16x32_bf16 a[72:75], a[32:35], v[216:219], a[72:75]
ds_read_b64_tr_b16 a[58:59], v30 offset:12288
v_xor_b32 v25, s78, v25
v_mfma_f32_16x16x32_bf16 a[72:75], a[0:3], v[200:203], a[72:75]
v_exp_f32 v133, v133
v_mfma_f32_16x16x32_bf16 a[68:71], a[0:3], v[196:199], a[68:71]
ds_read_b64_tr_b16 a[28:29], v31 offset:0
v_xor_b32 v26, s78, v26
v_mfma_f32_16x16x32_bf16 a[68:71], a[32:35], v[212:215], a[68:71]
v_exp_f32 v134, v134
v_mfma_f32_16x16x32_bf16 a[64:67], a[32:35], v[208:211], a[64:67]
ds_read_b64_tr_b16 a[30:31], v31 offset:4096
v_xor_b32 v27, s78, v27
v_mfma_f32_16x16x32_bf16 a[64:67], a[0:3], v[192:195], a[64:67]
v_exp_f32 v135, v135
v_mfma_f32_16x16x32_bf16 a[80:83], a[4:7], v[192:195], a[80:83]
s_add_u32 m0, s77, s83
ds_read_b64_tr_b16 a[60:61], v31 offset:8192
v_xor_b32 v28, s78, v28
v_mfma_f32_16x16x32_bf16 a[80:83], a[36:39], v[208:211], a[80:83]
v_exp_f32 v136, v136
v_mfma_f32_16x16x32_bf16 a[84:87], a[36:39], v[212:215], a[84:87]
ds_read_b64_tr_b16 a[62:63], v31 offset:12288
v_xor_b32 v29, s78, v29
v_mfma_f32_16x16x32_bf16 a[84:87], a[4:7], v[196:199], a[84:87]
buffer_load_dwordx4 v32, s[24:27], s76 offen offset:0 sc1 lds
v_mfma_f32_16x16x32_bf16 a[88:91], a[4:7], v[200:203], a[88:91]
ds_read_b128 a[224:227], v20 offset:0
v_xor_b32 v30, s78, v30
v_mfma_f32_16x16x32_bf16 a[88:91], a[36:39], v[216:219], a[88:91]
buffer_load_dwordx4 v33, s[24:27], s76 offen offset:1024 sc1 lds
v_mfma_f32_16x16x32_bf16 a[92:95], a[36:39], v[220:223], a[92:95]
s_add_u32 m0, s77, s84
ds_read_b128 a[228:231], v21 offset:0
v_xor_b32 v31, s78, v31
v_mfma_f32_16x16x32_bf16 a[92:95], a[4:7], v[204:207], a[92:95]
v_exp_f32 v137, v137
v_mfma_f32_16x16x32_bf16 a[108:111], a[8:11], v[204:207], a[108:111]
ds_read_b128 a[232:235], v22 offset:0
v_mfma_f32_16x16x32_bf16 a[108:111], a[40:43], v[220:223], a[108:111]
buffer_load_dwordx4 v34, s[28:31], s76 offen offset:0 sc1 lds
v_mfma_f32_16x16x32_bf16 a[104:107], a[40:43], v[216:219], a[104:107]
ds_read_b128 a[236:239], v23 offset:0
v_mfma_f32_16x16x32_bf16 a[104:107], a[8:11], v[200:203], a[104:107]
buffer_load_dwordx4 v35, s[28:31], s76 offen offset:1024 sc1 lds
v_mfma_f32_16x16x32_bf16 a[100:103], a[8:11], v[196:199], a[100:103]
s_add_u32 s76, s76, 8192
ds_read_b128 a[240:243], v20 offset:4096
v_mfma_f32_16x16x32_bf16 a[100:103], a[40:43], v[212:215], a[100:103]
s_add_u32 s83, s83, 8192
v_exp_f32 v138, v138
v_mfma_f32_16x16x32_bf16 a[96:99], a[40:43], v[208:211], a[96:99]
s_and_b32 s83, s83, 0xffff
ds_read_b128 a[244:247], v21 offset:4096
v_mfma_f32_16x16x32_bf16 a[96:99], a[8:11], v[192:195], a[96:99]
s_add_u32 s84, s84, 8192
v_exp_f32 v139, v139
v_mfma_f32_16x16x32_bf16 a[112:115], a[12:15], v[192:195], a[112:115]
s_and_b32 s84, s84, 0xffff
ds_read_b128 a[248:251], v22 offset:4096
v_mfma_f32_16x16x32_bf16 a[112:115], a[44:47], v[208:211], a[112:115]
s_or_b32 s84, s84, 65536
v_exp_f32 v140, v140
v_mfma_f32_16x16x32_bf16 a[116:119], a[44:47], v[212:215], a[116:119]
ds_read_b128 a[252:255], v23 offset:4096
v_mfma_f32_16x16x32_bf16 a[116:119], a[12:15], v[196:199], a[116:119]
v_exp_f32 v141, v141
v_mfma_f32_16x16x32_bf16 a[120:123], a[12:15], v[200:203], a[120:123]
ds_read_b128 a[192:195], v20 offset:8192
v_mfma_f32_16x16x32_bf16 a[120:123], a[44:47], v[216:219], a[120:123]
v_exp_f32 v142, v142
v_mfma_f32_16x16x32_bf16 a[124:127], a[44:47], v[220:223], a[124:127]
ds_read_b128 a[196:199], v21 offset:8192
v_mfma_f32_16x16x32_bf16 a[124:127], a[12:15], v[204:207], a[124:127]
v_exp_f32 v143, v143
v_mfma_f32_16x16x32_bf16 a[140:143], a[16:19], v[204:207], a[140:143]
ds_read_b128 a[200:203], v22 offset:8192
v_mfma_f32_16x16x32_bf16 a[140:143], a[48:51], v[220:223], a[140:143]
v_exp_f32 v144, v144
v_mfma_f32_16x16x32_bf16 a[136:139], a[48:51], v[216:219], a[136:139]
ds_read_b128 a[204:207], v23 offset:8192
v_mfma_f32_16x16x32_bf16 a[136:139], a[16:19], v[200:203], a[136:139]
v_exp_f32 v145, v145
v_mfma_f32_16x16x32_bf16 a[132:135], a[16:19], v[196:199], a[132:135]
ds_read_b128 a[208:211], v20 offset:12288
v_xor_b32 v20, s78, v20
v_mfma_f32_16x16x32_bf16 a[132:135], a[48:51], v[212:215], a[132:135]
v_exp_f32 v146, v146
v_mfma_f32_16x16x32_bf16 a[128:131], a[48:51], v[208:211], a[128:131]
ds_read_b128 a[212:215], v21 offset:12288
v_xor_b32 v21, s78, v21
v_mfma_f32_16x16x32_bf16 a[128:131], a[16:19], v[192:195], a[128:131]
v_exp_f32 v147, v147
v_mfma_f32_16x16x32_bf16 a[144:147], a[20:23], v[192:195], a[144:147]
s_waitcnt lgkmcnt(4)
ds_read_b128 a[216:219], v22 offset:12288
v_xor_b32 v22, s78, v22
v_mfma_f32_16x16x32_bf16 a[144:147], a[52:55], v[208:211], a[144:147]
v_exp_f32 v148, v148
v_mfma_f32_16x16x32_bf16 a[148:151], a[52:55], v[212:215], a[148:151]
ds_read_b128 a[220:223], v23 offset:12288
v_xor_b32 v23, s78, v23
v_mfma_f32_16x16x32_bf16 a[148:151], a[20:23], v[196:199], a[148:151]
s_xor_b32 s78, s78, 32768
v_exp_f32 v149, v149
v_mfma_f32_16x16x32_bf16 a[152:155], a[20:23], v[200:203], a[152:155]
s_cmp_lt_u32 s76, s85
v_exp_f32 v150, v150
v_mfma_f32_16x16x32_bf16 a[152:155], a[52:55], v[216:219], a[152:155]
v_exp_f32 v151, v151
v_mfma_f32_16x16x32_bf16 a[156:159], a[52:55], v[220:223], a[156:159]
v_exp_f32 v152, v152
v_mfma_f32_16x16x32_bf16 a[156:159], a[20:23], v[204:207], a[156:159]
v_exp_f32 v153, v153
v_mfma_f32_16x16x32_bf16 a[172:175], a[24:27], v[204:207], a[172:175]
v_exp_f32 v154, v154
v_mfma_f32_16x16x32_bf16 a[172:175], a[56:59], v[220:223], a[172:175]
v_exp_f32 v155, v155
v_mfma_f32_16x16x32_bf16 a[168:171], a[56:59], v[216:219], a[168:171]
v_exp_f32 v156, v156
v_mfma_f32_16x16x32_bf16 a[168:171], a[24:27], v[200:203], a[168:171]
v_exp_f32 v157, v157
v_mfma_f32_16x16x32_bf16 a[164:167], a[24:27], v[196:199], a[164:167]
v_exp_f32 v158, v158
v_mfma_f32_16x16x32_bf16 a[164:167], a[56:59], v[212:215], a[164:167]
v_exp_f32 v159, v159
v_mfma_f32_16x16x32_bf16 a[160:163], a[56:59], v[208:211], a[160:163]
v_exp_f32 v160, v160
v_mfma_f32_16x16x32_bf16 a[160:163], a[24:27], v[192:195], a[160:163]
v_exp_f32 v161, v161
v_mfma_f32_16x16x32_bf16 a[176:179], a[28:31], v[192:195], a[176:179]
v_exp_f32 v162, v162
v_mfma_f32_16x16x32_bf16 a[176:179], a[60:63], v[208:211], a[176:179]
v_exp_f32 v163, v163
v_mfma_f32_16x16x32_bf16 a[180:183], a[60:63], v[212:215], a[180:183]
v_mfma_f32_16x16x32_bf16 a[180:183], a[28:31], v[196:199], a[180:183]
v_mfma_f32_16x16x32_bf16 a[184:187], a[28:31], v[200:203], a[184:187]
v_cvt_pk_bf16_f32 v192, v128, v129
v_cvt_pk_bf16_f32 v193, v130, v131
v_mfma_f32_16x16x32_bf16 a[184:187], a[60:63], v[216:219], a[184:187]
v_cvt_pk_bf16_f32 v194, v132, v133
v_cvt_pk_bf16_f32 v195, v134, v135
v_mfma_f32_16x16x32_bf16 a[188:191], a[60:63], v[220:223], a[188:191]
v_mfma_f32_16x16x32_bf16 a[188:191], a[28:31], v[204:207], a[188:191]
s_waitcnt lgkmcnt(15)
s_cbranch_scc1 ATT_LOOP
s_cmp_lt_u32 s76, 589824
s_cbranch_scc1 ATT_EVT
TAILC0:
s_waitcnt vmcnt(16) lgkmcnt(0)
s_barrier
s_cmp_lg_u32 s68, 0
s_cbranch_scc1 NOPOLLW
s_mov_b32 s81, 66560
buffer_load_dwordx4 v[36:39], v2, s[4:7], s81 offen sc1
NOPOLLW:
ds_read_b64_tr_b16 a[0:1], v24 offset:0
ds_read_b64_tr_b16 a[2:3], v24 offset:4096
ds_read_b64_tr_b16 a[4:5], v25 offset:0
ds_read_b64_tr_b16 a[6:7], v25 offset:4096
ds_read_b64_tr_b16 a[8:9], v26 offset:0
ds_read_b64_tr_b16 a[10:11], v26 offset:4096
ds_read_b64_tr_b16 a[12:13], v27 offset:0
ds_read_b64_tr_b16 a[14:15], v27 offset:4096
ds_read_b64_tr_b16 a[16:17], v28 offset:0
ds_read_b64_tr_b16 a[18:19], v28 offset:4096
ds_read_b64_tr_b16 a[20:21], v29 offset:0
ds_read_b64_tr_b16 a[22:23], v29 offset:4096
ds_read_b64_tr_b16 a[24:25], v30 offset:0
ds_read_b64_tr_b16 a[26:27], v30 offset:4096
ds_read_b64_tr_b16 a[28:29], v31 offset:0
ds_read_b64_tr_b16 a[30:31], v31 offset:4096
v_cvt_pk_bf16_f32 v196, v136, v137
v_cvt_pk_bf16_f32 v197, v138, v139
v_cvt_pk_bf16_f32 v198, v140, v141
v_cvt_pk_bf16_f32 v199, v142, v143
v_cvt_pk_bf16_f32 v200, v144, v145
v_cvt_pk_bf16_f32 v201, v146, v147
v_cvt_pk_bf16_f32 v202, v148, v149
v_cvt_pk_bf16_f32 v203, v150, v151
v_cvt_pk_bf16_f32 v204, v152, v153
v_cvt_pk_bf16_f32 v205, v154, v155
v_cvt_pk_bf16_f32 v206, v156, v157
v_cvt_pk_bf16_f32 v207, v158, v159
s_nop 0
v_smfmac_f32_16x16x64_bf16 v[240:243], v[56:59], v[192:199], v7
s_waitcnt lgkmcnt(14)
ds_read_b64_tr_b16 a[32:33], v24 offset:8192
v_mfma_f32_16x16x32_bf16 a[64:67], a[0:3], v[192:195], a[64:67]
s_add_u32 s89, s72, 0
ds_read_b64_tr_b16 a[34:35], v24 offset:12288
v_exp_f32 v164, v164
v_cvt_pk_bf16_f32 v208, v160, v161
v_mfma_f32_16x16x32_bf16 a[68:71], a[0:3], v[196:199], a[68:71]
s_waitcnt lgkmcnt(14)
ds_read_b64_tr_b16 a[36:37], v25 offset:8192
v_exp_f32 v165, v165
v_cvt_pk_bf16_f32 v209, v162, v163
buffer_load_dwordx4 a[192:195], v2, s[36:39], s89 offen offset:0 sc1
v_mfma_f32_16x16x32_bf16 a[84:87], a[4:7], v[196:199], a[84:87]
ds_read_b64_tr_b16 a[38:39], v25 offset:12288
v_exp_f32 v166, v166
v_mfma_f32_16x16x32_bf16 a[80:83], a[4:7], v[192:195], a[80:83]
s_waitcnt lgkmcnt(14)
ds_read_b64_tr_b16 a[40:41], v26 offset:8192
v_exp_f32 v167, v167
v_cvt_pk_bf16_f32 v210, v164, v165
buffer_load_dwordx4 a[196:199], v2, s[36:39], s89 offen offset:1024 sc1
v_mfma_f32_16x16x32_bf16 a[96:99], a[8:11], v[192:195], a[96:99]
ds_read_b64_tr_b16 a[42:43], v26 offset:12288
v_exp_f32 v168, v168
buffer_load_dwordx4 a[200:203], v61, s[36:39], s89 offen offset:0 sc1
v_mfma_f32_16x16x32_bf16 a[100:103], a[8:11], v[196:199], a[100:103]
s_waitcnt lgkmcnt(14)
ds_read_b64_tr_b16 a[44:45], v27 offset:8192
v_exp_f32 v169, v169
v_cvt_pk_bf16_f32 v211, v166, v167
v_mfma_f32_16x16x32_bf16 a[116:119], a[12:15], v[196:199], a[116:119]
ds_read_b64_tr_b16 a[46:47], v27 offset:12288
v_exp_f32 v170, v170
buffer_load_dwordx4 a[204:207], v61, s[36:39], s89 offen offset:1024 sc1
v_mfma_f32_16x16x32_bf16 a[112:115], a[12:15], v[192:195], a[112:115]
s_waitcnt lgkmcnt(14)
ds_read_b64_tr_b16 a[48:49], v28 offset:8192
v_exp_f32 v171, v171
v_cvt_pk_bf16_f32 v212, v168, v169
v_mfma_f32_16x16x32_bf16 a[128:131], a[16:19], v[192:195], a[128:131]
s_add_u32 s89, s72, 8192
ds_read_b64_tr_b16 a[50:51], v28 offset:12288
v_exp_f32 v172, v172
v_mfma_f32_16x16x32_bf16 a[132:135], a[16:19], v[196:199], a[132:135]
s_waitcnt lgkmcnt(14)
ds_read_b64_tr_b16 a[52:53], v29 offset:8192
v_exp_f32 v173, v173
v_cvt_pk_bf16_f32 v213, v170, v171
buffer_load_dwordx4 a[208:211], v2, s[36:39], s89 offen offset:0 sc1
v_mfma_f32_16x16x32_bf16 a[148:151], a[20:23], v[196:199], a[148:151]
ds_read_b64_tr_b16 a[54:55], v29 offset:12288
v_exp_f32 v174, v174
v_mfma_f32_16x16x32_bf16 a[144:147], a[20:23], v[192:195], a[144:147]
s_waitcnt lgkmcnt(14)
ds_read_b64_tr_b16 a[56:57], v30 offset:8192
v_exp_f32 v175, v175
v_cvt_pk_bf16_f32 v214, v172, v173
buffer_load_dwordx4 a[212:215], v2, s[36:39], s89 offen offset:1024 sc1
v_mfma_f32_16x16x32_bf16 a[160:163], a[24:27], v[192:195], a[160:163]
ds_read_b64_tr_b16 a[58:59], v30 offset:12288
v_mfma_f32_16x16x32_bf16 a[164:167], a[24:27], v[196:199], a[164:167]
s_waitcnt lgkmcnt(14)
ds_read_b64_tr_b16 a[60:61], v31 offset:8192
v_cvt_pk_bf16_f32 v215, v174, v175
buffer_load_dwordx4 a[216:219], v61, s[36:39], s89 offen offset:0 sc1
v_mfma_f32_16x16x32_bf16 a[180:183], a[28:31], v[196:199], a[180:183]
ds_read_b64_tr_b16 a[62:63], v31 offset:12288
buffer_load_dwordx4 a[220:223], v61, s[36:39], s89 offen offset:1024 sc1
v_mfma_f32_16x16x32_bf16 a[176:179], a[28:31], v[192:195], a[176:179]
v_exp_f32 v176, v176
v_smfmac_f32_16x16x64_bf16 v[244:247], v[56:59], v[200:207], v7
s_add_u32 s89, s72, 16384
v_exp_f32 v177, v177
v_smfmac_f32_16x16x64_bf16 v[240:243], v[56:59], v[208:215], v7
s_waitcnt lgkmcnt(14)
v_exp_f32 v178, v178
v_cvt_pk_bf16_f32 v216, v176, v177
buffer_load_dwordx4 a[224:227], v2, s[36:39], s89 offen offset:0 sc1
v_mfma_f32_16x16x32_bf16 a[64:67], a[32:35], v[208:211], a[64:67]
v_exp_f32 v179, v179
buffer_load_dwordx4 a[228:231], v2, s[36:39], s89 offen offset:1024 sc1
v_mfma_f32_16x16x32_bf16 a[68:71], a[32:35], v[212:215], a[68:71]
s_waitcnt lgkmcnt(12)
v_exp_f32 v180, v180
v_cvt_pk_bf16_f32 v217, v178, v179
v_mfma_f32_16x16x32_bf16 a[84:87], a[36:39], v[212:215], a[84:87]
v_exp_f32 v181, v181
buffer_load_dwordx4 a[232:235], v61, s[36:39], s89 offen offset:0 sc1
v_mfma_f32_16x16x32_bf16 a[80:83], a[36:39], v[208:211], a[80:83]
s_waitcnt lgkmcnt(10)
v_exp_f32 v182, v182
v_cvt_pk_bf16_f32 v218, v180, v181
v_mfma_f32_16x16x32_bf16 a[96:99], a[40:43], v[208:211], a[96:99]
v_exp_f32 v183, v183
buffer_load_dwordx4 a[236:239], v61, s[36:39], s89 offen offset:1024 sc1
v_mfma_f32_16x16x32_bf16 a[100:103], a[40:43], v[212:215], a[100:103]
s_waitcnt lgkmcnt(8)
v_exp_f32 v184, v184
v_cvt_pk_bf16_f32 v219, v182, v183
v_mfma_f32_16x16x32_bf16 a[116:119], a[44:47], v[212:215], a[116:119]
v_exp_f32 v185, v185
v_mfma_f32_16x16x32_bf16 a[112:115], a[44:47], v[208:211], a[112:115]
s_waitcnt lgkmcnt(6)
v_exp_f32 v186, v186
v_cvt_pk_bf16_f32 v220, v184, v185
v_mfma_f32_16x16x32_bf16 a[128:131], a[48:51], v[208:211], a[128:131]
s_waitcnt lgkmcnt(0)
s_barrier
v_exp_f32 v187, v187
v_mfma_f32_16x16x32_bf16 a[132:135], a[48:51], v[212:215], a[132:135]
v_exp_f32 v188, v188
v_cvt_pk_bf16_f32 v221, v186, v187
v_mfma_f32_16x16x32_bf16 a[148:151], a[52:55], v[212:215], a[148:151]
v_exp_f32 v189, v189
v_mfma_f32_16x16x32_bf16 a[144:147], a[52:55], v[208:211], a[144:147]
v_exp_f32 v190, v190
v_cvt_pk_bf16_f32 v222, v188, v189
v_mfma_f32_16x16x32_bf16 a[160:163], a[56:59], v[208:211], a[160:163]
v_exp_f32 v191, v191
v_mfma_f32_16x16x32_bf16 a[164:167], a[56:59], v[212:215], a[164:167]
v_cvt_pk_bf16_f32 v223, v190, v191
v_mfma_f32_16x16x32_bf16 a[180:183], a[60:63], v[212:215], a[180:183]
v_mfma_f32_16x16x32_bf16 a[176:179], a[60:63], v[208:211], a[176:179]
v_smfmac_f32_16x16x64_bf16 v[244:247], v[56:59], v[216:223], v7
v_mfma_f32_16x16x32_bf16 a[72:75], a[0:3], v[200:203], a[72:75]
v_add_f32 v240, v240, v241
v_add_f32 v242, v242, v243
v_rcp_f32 v40, v240
v_rcp_f32 v42, v242
v_mfma_f32_16x16x32_bf16 a[72:75], a[32:35], v[216:219], a[72:75]
v_mov_b32 v248, 0
v_mov_b32 v249, 0
v_mov_b32 v250, 0
v_mov_b32 v251, 0
v_mfma_f32_16x16x32_bf16 a[76:79], a[32:35], v[220:223], a[76:79]
s_lshl_b32 s44, s69, 14
s_add_u32 s45, s44, 4096
s_add_u32 s46, s44, 8192
s_add_u32 s47, s44, 12288
v_mfma_f32_16x16x32_bf16 a[76:79], a[0:3], v[204:207], a[76:79]
v_mov_b32 v41, v40
v_mov_b32 v43, v42
v_accvgpr_read_b32 v224, a64
v_accvgpr_read_b32 v225, a65
v_mfma_f32_16x16x32_bf16 a[92:95], a[4:7], v[204:207], a[92:95]
v_accvgpr_read_b32 v226, a66
v_accvgpr_read_b32 v227, a67
v_accvgpr_read_b32 v228, a80
v_accvgpr_read_b32 v229, a81
v_mfma_f32_16x16x32_bf16 a[92:95], a[36:39], v[220:223], a[92:95]
v_accvgpr_read_b32 v230, a82
v_accvgpr_read_b32 v231, a83
v_mul_f32 v224, v224, v40
v_mul_f32 v225, v225, v40
v_mfma_f32_16x16x32_bf16 a[88:91], a[36:39], v[216:219], a[88:91]
v_mul_f32 v226, v226, v40
v_mul_f32 v227, v227, v40
v_mul_f32 v228, v228, v40
v_mul_f32 v229, v229, v40
v_mfma_f32_16x16x32_bf16 a[88:91], a[4:7], v[200:203], a[88:91]
v_mul_f32 v230, v230, v40
v_mul_f32 v231, v231, v40
v_cvt_pk_bf16_f32 v232, v224, v225
v_mfma_f32_16x16x32_bf16 a[104:107], a[8:11], v[200:203], a[104:107]
v_cvt_pk_bf16_f32 v233, v226, v227
v_cvt_pk_bf16_f32 v234, v228, v229
v_cvt_pk_bf16_f32 v235, v230, v231
buffer_store_dwordx4 v[232:235], v2, s[32:35], s44 offen offset:0 sc1
v_mfma_f32_16x16x32_bf16 a[104:107], a[40:43], v[216:219], a[104:107]
s_nop 0
v_mfma_f32_16x16x32_bf16 v[252:255], v[248:251], v[232:235], 0
v_accvgpr_read_b32 v224, a68
v_accvgpr_read_b32 v225, a69
v_accvgpr_read_b32 v226, a70
v_mfma_f32_16x16x32_bf16 a[108:111], a[40:43], v[220:223], a[108:111]
v_accvgpr_read_b32 v227, a71
v_accvgpr_read_b32 v228, a84
v_accvgpr_read_b32 v229, a85
v_accvgpr_read_b32 v230, a86
v_mfma_f32_16x16x32_bf16 a[108:111], a[8:11], v[204:207], a[108:111]
v_accvgpr_read_b32 v231, a87
v_mul_f32 v224, v224, v42
v_mul_f32 v225, v225, v42
v_mul_f32 v226, v226, v42
v_mfma_f32_16x16x32_bf16 a[124:127], a[12:15], v[204:207], a[124:127]
v_mul_f32 v227, v227, v42
v_mul_f32 v228, v228, v42
v_mul_f32 v229, v229, v42
v_mul_f32 v230, v230, v42
v_mfma_f32_16x16x32_bf16 a[124:127], a[44:47], v[220:223], a[124:127]
v_mul_f32 v231, v231, v42
v_cvt_pk_bf16_f32 v236, v224, v225
v_cvt_pk_bf16_f32 v237, v226, v227
v_cvt_pk_bf16_f32 v238, v228, v229
v_mfma_f32_16x16x32_bf16 a[120:123], a[44:47], v[216:219], a[120:123]
v_cvt_pk_bf16_f32 v239, v230, v231
buffer_store_dwordx4 v[236:239], v2, s[32:35], s44 offen offset:1024 sc1
s_nop 0
v_mfma_f32_16x16x32_bf16 v[252:255], v[248:251], v[236:239], v[252:255]
v_accvgpr_read_b32 v224, a96
v_mfma_f32_16x16x32_bf16 a[120:123], a[12:15], v[200:203], a[120:123]
v_accvgpr_read_b32 v225, a97
v_accvgpr_read_b32 v226, a98
v_accvgpr_read_b32 v227, a99
v_mfma_f32_16x16x32_bf16 a[136:139], a[16:19], v[200:203], a[136:139]
v_accvgpr_read_b32 v228, a112
v_accvgpr_read_b32 v229, a113
v_accvgpr_read_b32 v230, a114
v_accvgpr_read_b32 v231, a115
v_mfma_f32_16x16x32_bf16 a[136:139], a[48:51], v[216:219], a[136:139]
v_mul_f32 v224, v224, v40
v_mul_f32 v225, v225, v40
v_mul_f32 v226, v226, v40
v_mul_f32 v227, v227, v40
v_mfma_f32_16x16x32_bf16 a[140:143], a[48:51], v[220:223], a[140:143]
v_mul_f32 v228, v228, v40
v_mul_f32 v229, v229, v40
v_mul_f32 v230, v230, v40
v_mul_f32 v231, v231, v40
v_mfma_f32_16x16x32_bf16 a[140:143], a[16:19], v[204:207], a[140:143]
v_cvt_pk_bf16_f32 v232, v224, v225
v_cvt_pk_bf16_f32 v233, v226, v227
v_cvt_pk_bf16_f32 v234, v228, v229
v_cvt_pk_bf16_f32 v235, v230, v231
v_mfma_f32_16x16x32_bf16 a[156:159], a[20:23], v[204:207], a[156:159]
buffer_store_dwordx4 v[232:235], v2, s[32:35], s45 offen offset:0 sc1
s_nop 0
v_mfma_f32_16x16x32_bf16 v[252:255], v[248:251], v[232:235], v[252:255]
v_accvgpr_read_b32 v224, a100
v_accvgpr_read_b32 v225, a101
v_mfma_f32_16x16x32_bf16 a[156:159], a[52:55], v[220:223], a[156:159]
v_accvgpr_read_b32 v226, a102
v_accvgpr_read_b32 v227, a103
v_accvgpr_read_b32 v228, a116
v_accvgpr_read_b32 v229, a117
v_mfma_f32_16x16x32_bf16 a[152:155], a[52:55], v[216:219], a[152:155]
v_accvgpr_read_b32 v230, a118
v_accvgpr_read_b32 v231, a119
v_mul_f32 v224, v224, v42
v_mul_f32 v225, v225, v42
v_mfma_f32_16x16x32_bf16 a[152:155], a[20:23], v[200:203], a[152:155]
v_mul_f32 v226, v226, v42
v_mul_f32 v227, v227, v42
v_mul_f32 v228, v228, v42
v_mfma_f32_16x16x32_bf16 a[168:171], a[24:27], v[200:203], a[168:171]
v_mul_f32 v229, v229, v42
v_mul_f32 v230, v230, v42
v_mul_f32 v231, v231, v42
v_cvt_pk_bf16_f32 v236, v224, v225
v_mfma_f32_16x16x32_bf16 a[168:171], a[56:59], v[216:219], a[168:171]
v_cvt_pk_bf16_f32 v237, v226, v227
v_cvt_pk_bf16_f32 v238, v228, v229
v_cvt_pk_bf16_f32 v239, v230, v231
buffer_store_dwordx4 v[236:239], v2, s[32:35], s45 offen offset:1024 sc1
v_mfma_f32_16x16x32_bf16 a[172:175], a[56:59], v[220:223], a[172:175]
s_nop 0
v_mfma_f32_16x16x32_bf16 v[252:255], v[248:251], v[236:239], v[252:255]
v_accvgpr_read_b32 v224, a128
v_accvgpr_read_b32 v225, a129
v_accvgpr_read_b32 v226, a130
v_mfma_f32_16x16x32_bf16 a[172:175], a[24:27], v[204:207], a[172:175]
v_accvgpr_read_b32 v227, a131
v_accvgpr_read_b32 v228, a144
v_accvgpr_read_b32 v229, a145
v_accvgpr_read_b32 v230, a146
v_mfma_f32_16x16x32_bf16 a[188:191], a[28:31], v[204:207], a[188:191]
v_accvgpr_read_b32 v231, a147
v_mul_f32 v224, v224, v40
v_mul_f32 v225, v225, v40
v_mul_f32 v226, v226, v40
v_mfma_f32_16x16x32_bf16 a[188:191], a[60:63], v[220:223], a[188:191]
v_mul_f32 v227, v227, v40
v_mul_f32 v228, v228, v40
v_mul_f32 v229, v229, v40
v_mul_f32 v230, v230, v40
v_mfma_f32_16x16x32_bf16 a[184:187], a[60:63], v[216:219], a[184:187]
v_mul_f32 v231, v231, v40
v_cvt_pk_bf16_f32 v232, v224, v225
v_cvt_pk_bf16_f32 v233, v226, v227
v_cvt_pk_bf16_f32 v234, v228, v229
v_mfma_f32_16x16x32_bf16 a[184:187], a[28:31], v[200:203], a[184:187]
v_cvt_pk_bf16_f32 v235, v230, v231
buffer_store_dwordx4 v[232:235], v2, s[32:35], s46 offen offset:0 sc1
s_nop 0
v_mfma_f32_16x16x32_bf16 v[252:255], v[248:251], v[232:235], v[252:255]
v_accvgpr_read_b32 v224, a132
v_accvgpr_read_b32 v225, a133
v_accvgpr_read_b32 v226, a134
v_accvgpr_read_b32 v227, a135
v_accvgpr_read_b32 v228, a148
v_accvgpr_read_b32 v229, a149
v_accvgpr_read_b32 v230, a150
v_accvgpr_read_b32 v231, a151
v_pk_mul_f32 v[224:225], v[224:225], v[42:43]
v_pk_mul_f32 v[226:227], v[226:227], v[42:43]
v_pk_mul_f32 v[228:229], v[228:229], v[42:43]
v_pk_mul_f32 v[230:231], v[230:231], v[42:43]
v_cvt_pk_bf16_f32 v236, v224, v225
v_cvt_pk_bf16_f32 v237, v226, v227
v_cvt_pk_bf16_f32 v238, v228, v229
v_cvt_pk_bf16_f32 v239, v230, v231
buffer_store_dwordx4 v[236:239], v2, s[32:35], s46 offen offset:1024 sc1
s_nop 0
v_mfma_f32_16x16x32_bf16 v[252:255], v[248:251], v[236:239], v[252:255]
v_accvgpr_read_b32 v224, a160
v_accvgpr_read_b32 v225, a161
v_accvgpr_read_b32 v226, a162
v_accvgpr_read_b32 v227, a163
v_accvgpr_read_b32 v228, a176
v_accvgpr_read_b32 v229, a177
v_accvgpr_read_b32 v230, a178
v_accvgpr_read_b32 v231, a179
v_pk_mul_f32 v[224:225], v[224:225], v[40:41]
v_pk_mul_f32 v[226:227], v[226:227], v[40:41]
v_pk_mul_f32 v[228:229], v[228:229], v[40:41]
v_pk_mul_f32 v[230:231], v[230:231], v[40:41]
v_cvt_pk_bf16_f32 v232, v224, v225
v_cvt_pk_bf16_f32 v233, v226, v227
v_cvt_pk_bf16_f32 v234, v228, v229
v_cvt_pk_bf16_f32 v235, v230, v231
buffer_store_dwordx4 v[232:235], v2, s[32:35], s47 offen offset:0 sc1
s_nop 0
v_mfma_f32_16x16x32_bf16 v[252:255], v[248:251], v[232:235], v[252:255]
v_accvgpr_read_b32 v224, a164
v_accvgpr_read_b32 v225, a165
v_accvgpr_read_b32 v226, a166
v_accvgpr_read_b32 v227, a167
v_accvgpr_read_b32 v228, a180
v_accvgpr_read_b32 v229, a181
v_accvgpr_read_b32 v230, a182
v_accvgpr_read_b32 v231, a183
v_pk_mul_f32 v[224:225], v[224:225], v[42:43]
v_pk_mul_f32 v[226:227], v[226:227], v[42:43]
v_pk_mul_f32 v[228:229], v[228:229], v[42:43]
v_pk_mul_f32 v[230:231], v[230:231], v[42:43]
v_cvt_pk_bf16_f32 v236, v224, v225
v_cvt_pk_bf16_f32 v237, v226, v227
v_cvt_pk_bf16_f32 v238, v228, v229
v_cvt_pk_bf16_f32 v239, v230, v231
buffer_store_dwordx4 v[236:239], v2, s[32:35], s47 offen offset:1024 sc1
s_nop 0
v_mfma_f32_16x16x32_bf16 v[252:255], v[248:251], v[236:239], v[252:255]
v_add_f32 v244, v244, v245
v_add_f32 v246, v246, v247
v_rcp_f32 v44, v244
v_rcp_f32 v46, v246
v_max3_f32 v48, v240, v242, v244
v_max_f32 v48, v48, v246
v_mul_f32 v48, 0x5f800000, v48
v_mul_f32 v48, 0, v48
v_fma_f32 v48, v240, 0, v48
v_fma_f32 v48, v242, 0, v48
v_fma_f32 v48, v244, 0, v48
v_fma_f32 v48, v246, 0, v48
v_mov_b32 v45, v44
v_mov_b32 v47, v46
v_accvgpr_read_b32 v224, a72
v_accvgpr_read_b32 v225, a73
v_accvgpr_read_b32 v226, a74
v_accvgpr_read_b32 v227, a75
v_accvgpr_read_b32 v228, a88
v_accvgpr_read_b32 v229, a89
v_accvgpr_read_b32 v230, a90
v_accvgpr_read_b32 v231, a91
v_pk_mul_f32 v[224:225], v[224:225], v[44:45]
v_pk_mul_f32 v[226:227], v[226:227], v[44:45]
v_pk_mul_f32 v[228:229], v[228:229], v[44:45]
v_pk_mul_f32 v[230:231], v[230:231], v[44:45]
v_cvt_pk_bf16_f32 v232, v224, v225
v_cvt_pk_bf16_f32 v233, v226, v227
v_cvt_pk_bf16_f32 v234, v228, v229
v_cvt_pk_bf16_f32 v235, v230, v231
buffer_store_dwordx4 v[232:235], v2, s[32:35], s44 offen offset:2048 sc1
s_nop 0
v_mfma_f32_16x16x32_bf16 v[252:255], v[248:251], v[232:235], v[252:255]
v_accvgpr_read_b32 v224, a76
v_accvgpr_read_b32 v225, a77
v_accvgpr_read_b32 v226, a78
v_accvgpr_read_b32 v227, a79
v_accvgpr_read_b32 v228, a92
v_accvgpr_read_b32 v229, a93
v_accvgpr_read_b32 v230, a94
v_accvgpr_read_b32 v231, a95
v_pk_mul_f32 v[224:225], v[224:225], v[46:47]
v_pk_mul_f32 v[226:227], v[226:227], v[46:47]
v_pk_mul_f32 v[228:229], v[228:229], v[46:47]
v_pk_mul_f32 v[230:231], v[230:231], v[46:47]
v_cvt_pk_bf16_f32 v236, v224, v225
v_cvt_pk_bf16_f32 v237, v226, v227
v_cvt_pk_bf16_f32 v238, v228, v229
v_cvt_pk_bf16_f32 v239, v230, v231
buffer_store_dwordx4 v[236:239], v2, s[32:35], s44 offen offset:3072 sc1
s_nop 0
v_mfma_f32_16x16x32_bf16 v[252:255], v[248:251], v[236:239], v[252:255]
s_waitcnt vmcnt(18) lgkmcnt(0)
s_cmp_lg_u32 s68, 0
s_cbranch_scc1 SPUN_EARLY3
s_mov_b32 s87, 0
s_add_u32 s86, s93, 3
SPIN_EARLY3:
v_subrev_u32 v36, s86, v36
v_subrev_u32 v37, s86, v37
v_subrev_u32 v38, s86, v38
v_subrev_u32 v39, s86, v39
v_max3_u32 v36, v36, v37, v38
v_max_u32 v36, v36, v39
v_cmp_lt_u32 vcc, 1, v36
s_add_u32 s87, s87, 1
s_cmp_eq_u64 vcc, 0
s_cbranch_scc1 SPUN_EARLY3
s_cmp_ge_u32 s87, 0x40000
s_cbranch_scc1 SPUN_EARLY3
s_sleep 2
s_mov_b32 s81, 66560
buffer_load_dwordx4 v[36:39], v2, s[4:7], s81 offen sc1
s_waitcnt vmcnt(0)
s_branch SPIN_EARLY3
SPUN_EARLY3:
v_min_u32 v39, 7, v1
v_lshlrev_b32 v39, 7, v39
s_barrier
ds_read_b128 a[0:3], v60 offset:0
ds_read_b128 a[4:7], v60 offset:10240
ds_read_b128 a[8:11], v60 offset:1024
ds_read_b128 a[12:15], v60 offset:11264
ds_read_b128 a[16:19], v60 offset:2048
ds_read_b128 a[20:23], v60 offset:12288
ds_read_b128 a[24:27], v60 offset:3072
ds_read_b128 a[28:31], v60 offset:13312
s_waitcnt lgkmcnt(0)
v_mfma_f32_16x16x32_bf16 v[128:131], a[0:3], a[192:195], 0
ds_read_b128 a[240:243], v60 offset:4096
v_accvgpr_read_b32 v224, a104
v_accvgpr_read_b32 v225, a105
v_accvgpr_read_b32 v226, a106
v_mfma_f32_16x16x32_bf16 v[128:131], a[4:7], a[200:203], v[128:131]
v_accvgpr_read_b32 v227, a107
v_accvgpr_read_b32 v228, a120
v_accvgpr_read_b32 v229, a121
v_mfma_f32_16x16x32_bf16 v[132:135], a[4:7], a[204:207], 0
ds_read_b128 a[244:247], v60 offset:14336
v_accvgpr_read_b32 v230, a122
v_accvgpr_read_b32 v231, a123
v_mul_f32 v224, v224, v44
v_mfma_f32_16x16x32_bf16 v[132:135], a[0:3], a[196:199], v[132:135]
v_mul_f32 v225, v225, v44
v_mul_f32 v226, v226, v44
v_mfma_f32_16x16x32_bf16 v[136:139], a[8:11], a[192:195], 0
ds_read_b128 a[0:3], v60 offset:5120
v_mul_f32 v227, v227, v44
v_mul_f32 v228, v228, v44
v_mul_f32 v229, v229, v44
v_mfma_f32_16x16x32_bf16 v[136:139], a[12:15], a[200:203], v[136:139]
v_mul_f32 v230, v230, v44
v_mul_f32 v231, v231, v44
v_cvt_pk_bf16_f32 v232, v224, v225
v_mfma_f32_16x16x32_bf16 v[140:143], a[12:15], a[204:207], 0
ds_read_b128 a[4:7], v60 offset:15360
v_cvt_pk_bf16_f32 v233, v226, v227
v_cvt_pk_bf16_f32 v234, v228, v229
v_mfma_f32_16x16x32_bf16 v[140:143], a[8:11], a[196:199], v[140:143]
v_cvt_pk_bf16_f32 v235, v230, v231
buffer_store_dwordx4 v[232:235], v2, s[32:35], s45 offen offset:2048 sc1
s_nop 0
v_mfma_f32_16x16x32_bf16 v[252:255], v[248:251], v[232:235], v[252:255]
v_mfma_f32_16x16x32_bf16 v[144:147], a[16:19], a[192:195], 0
ds_read_b128 a[8:11], v60 offset:6144
v_accvgpr_read_b32 v224, a108
v_accvgpr_read_b32 v225, a109
v_accvgpr_read_b32 v226, a110
v_mfma_f32_16x16x32_bf16 v[144:147], a[20:23], a[200:203], v[144:147]
v_accvgpr_read_b32 v227, a111
v_accvgpr_read_b32 v228, a124
v_mfma_f32_16x16x32_bf16 v[148:151], a[20:23], a[204:207], 0
ds_read_b128 a[12:15], v60 offset:16384
v_accvgpr_read_b32 v229, a125
v_accvgpr_read_b32 v230, a126
v_accvgpr_read_b32 v231, a127
v_mfma_f32_16x16x32_bf16 v[148:151], a[16:19], a[196:199], v[148:151]
v_mul_f32 v224, v224, v46
v_mul_f32 v225, v225, v46
v_mul_f32 v226, v226, v46
v_mfma_f32_16x16x32_bf16 v[152:155], a[24:27], a[192:195], 0
ds_read_b128 a[16:19], v60 offset:7168
v_mul_f32 v227, v227, v46
v_mul_f32 v228, v228, v46
v_mul_f32 v229, v229, v46
v_mfma_f32_16x16x32_bf16 v[152:155], a[28:31], a[200:203], v[152:155]
v_mul_f32 v230, v230, v46
v_mul_f32 v231, v231, v46
v_mfma_f32_16x16x32_bf16 v[156:159], a[28:31], a[204:207], 0
ds_read_b128 a[20:23], v60 offset:17408
v_cvt_pk_bf16_f32 v236, v224, v225
v_cvt_pk_bf16_f32 v237, v226, v227
v_cvt_pk_bf16_f32 v238, v228, v229
v_mfma_f32_16x16x32_bf16 v[156:159], a[24:27], a[196:199], v[156:159]
s_waitcnt lgkmcnt(4)
v_cvt_pk_bf16_f32 v239, v230, v231
buffer_store_dwordx4 v[236:239], v2, s[32:35], s45 offen offset:3072 sc1
s_nop 0
v_mfma_f32_16x16x32_bf16 v[252:255], v[248:251], v[236:239], v[252:255]
v_mfma_f32_16x16x32_bf16 v[160:163], a[240:243], a[192:195], 0
ds_read_b128 a[24:27], v60 offset:8192
v_accvgpr_read_b32 v224, a136
v_accvgpr_read_b32 v225, a137
v_mfma_f32_16x16x32_bf16 v[160:163], a[244:247], a[200:203], v[160:163]
v_accvgpr_read_b32 v226, a138
v_accvgpr_read_b32 v227, a139
v_accvgpr_read_b32 v228, a152
v_mfma_f32_16x16x32_bf16 v[164:167], a[244:247], a[204:207], 0
ds_read_b128 a[28:31], v60 offset:18432
v_accvgpr_read_b32 v229, a153
v_accvgpr_read_b32 v230, a154
v_accvgpr_read_b32 v231, a155
v_mfma_f32_16x16x32_bf16 v[164:167], a[240:243], a[196:199], v[164:167]
v_mul_f32 v224, v224, v44
v_mul_f32 v225, v225, v44
v_mfma_f32_16x16x32_bf16 v[168:171], a[0:3], a[192:195], 0
ds_read_b128 a[240:243], v60 offset:9216
v_mul_f32 v226, v226, v44
v_mul_f32 v227, v227, v44
v_mul_f32 v228, v228, v44
v_mfma_f32_16x16x32_bf16 v[168:171], a[4:7], a[200:203], v[168:171]
v_mul_f32 v229, v229, v44
v_mul_f32 v230, v230, v44
v_mul_f32 v231, v231, v44
v_mfma_f32_16x16x32_bf16 v[172:175], a[4:7], a[204:207], 0
s_waitcnt lgkmcnt(4)
ds_read_b128 a[244:247], v60 offset:19456
v_cvt_pk_bf16_f32 v232, v224, v225
v_cvt_pk_bf16_f32 v233, v226, v227
v_mfma_f32_16x16x32_bf16 v[172:175], a[0:3], a[196:199], v[172:175]
s_waitcnt vmcnt(16)
s_barrier
v_mfma_f32_16x16x32_bf16 v[176:179], a[8:11], a[192:195], 0
ds_read_b128 a[0:3], v60 offset:20480
v_cvt_pk_bf16_f32 v234, v228, v229
v_cvt_pk_bf16_f32 v235, v230, v231
buffer_store_dwordx4 v[232:235], v2, s[32:35], s46 offen offset:2048 sc1
v_mfma_f32_16x16x32_bf16 v[176:179], a[12:15], a[200:203], v[176:179]
s_nop 0
v_mfma_f32_16x16x32_bf16 v[252:255], v[248:251], v[232:235], v[252:255]
v_accvgpr_read_b32 v224, a140
v_accvgpr_read_b32 v225, a141
v_mfma_f32_16x16x32_bf16 v[180:183], a[12:15], a[204:207], 0
ds_read_b128 a[4:7], v60 offset:30720
v_accvgpr_read_b32 v226, a142
v_accvgpr_read_b32 v227, a143
v_accvgpr_read_b32 v228, a156
v_mfma_f32_16x16x32_bf16 v[180:183], a[8:11], a[196:199], v[180:183]
v_accvgpr_read_b32 v229, a157
v_accvgpr_read_b32 v230, a158
v_mfma_f32_16x16x32_bf16 v[184:187], a[16:19], a[192:195], 0
s_waitcnt lgkmcnt(4)
ds_read_b128 a[8:11], v60 offset:21504
v_accvgpr_read_b32 v231, a159
v_mul_f32 v224, v224, v46
v_mul_f32 v225, v225, v46
v_mfma_f32_16x16x32_bf16 v[184:187], a[20:23], a[200:203], v[184:187]
v_mul_f32 v226, v226, v46
v_mul_f32 v227, v227, v46
v_mul_f32 v228, v228, v46
v_mfma_f32_16x16x32_bf16 v[188:191], a[20:23], a[204:207], 0
ds_read_b128 a[12:15], v60 offset:31744
v_mul_f32 v229, v229, v46
v_mul_f32 v230, v230, v46
v_mfma_f32_16x16x32_bf16 v[188:191], a[16:19], a[196:199], v[188:191]
v_mul_f32 v231, v231, v46
v_cvt_pk_bf16_f32 v236, v224, v225
v_cvt_pk_bf16_f32 v237, v226, v227
v_mfma_f32_16x16x32_bf16 v[192:195], a[24:27], a[192:195], 0
ds_read_b128 a[16:19], v60 offset:22528
v_cvt_pk_bf16_f32 v238, v228, v229
v_cvt_pk_bf16_f32 v239, v230, v231
buffer_store_dwordx4 v[236:239], v2, s[32:35], s46 offen offset:3072 sc1
v_mfma_f32_16x16x32_bf16 v[192:195], a[28:31], a[200:203], v[192:195]
s_nop 0
v_mfma_f32_16x16x32_bf16 v[252:255], v[248:251], v[236:239], v[252:255]
v_accvgpr_read_b32 v224, a168
v_mfma_f32_16x16x32_bf16 v[196:199], a[28:31], a[204:207], 0
ds_read_b128 a[20:23], v60 offset:32768
v_accvgpr_read_b32 v225, a169
v_accvgpr_read_b32 v226, a170
v_accvgpr_read_b32 v227, a171
v_mfma_f32_16x16x32_bf16 v[196:199], a[24:27], a[196:199], v[196:199]
s_waitcnt lgkmcnt(4)
v_accvgpr_read_b32 v228, a184
v_accvgpr_read_b32 v229, a185
v_accvgpr_read_b32 v230, a186
v_mfma_f32_16x16x32_bf16 v[200:203], a[240:243], a[192:195], 0
ds_read_b128 a[24:27], v60 offset:23552
v_accvgpr_read_b32 v231, a187
v_mul_f32 v224, v224, v44
v_mfma_f32_16x16x32_bf16 v[200:203], a[244:247], a[200:203], v[200:203]
v_mul_f32 v225, v225, v44
v_mul_f32 v226, v226, v44
v_mul_f32 v227, v227, v44
v_mfma_f32_16x16x32_bf16 v[204:207], a[244:247], a[204:207], 0
ds_read_b128 a[28:31], v60 offset:33792
v_mul_f32 v228, v228, v44
v_mul_f32 v229, v229, v44
v_mul_f32 v230, v230, v44
v_mfma_f32_16x16x32_bf16 v[204:207], a[240:243], a[196:199], v[204:207]
v_mul_f32 v231, v231, v44
v_cvt_pk_bf16_f32 v232, v224, v225
v_cvt_pk_bf16_f32 v233, v226, v227
v_mfma_f32_16x16x32_bf16 v[128:131], a[0:3], a[208:211], v[128:131]
ds_read_b128 a[240:243], v60 offset:24576
v_cvt_pk_bf16_f32 v234, v228, v229
v_cvt_pk_bf16_f32 v235, v230, v231
v_mfma_f32_16x16x32_bf16 v[128:131], a[4:7], a[216:219], v[128:131]
buffer_store_dwordx4 v[232:235], v2, s[32:35], s47 offen offset:2048 sc1
s_nop 0
v_mfma_f32_16x16x32_bf16 v[252:255], v[248:251], v[232:235], v[252:255]
v_accvgpr_read_b32 v224, a172
v_mfma_f32_16x16x32_bf16 v[132:135], a[4:7], a[220:223], v[132:135]
ds_read_b128 a[244:247], v60 offset:34816
v_accvgpr_read_b32 v225, a173
v_accvgpr_read_b32 v226, a174
v_accvgpr_read_b32 v227, a175
v_mfma_f32_16x16x32_bf16 v[132:135], a[0:3], a[212:215], v[132:135]
s_waitcnt lgkmcnt(4)
v_accvgpr_read_b32 v228, a188
v_accvgpr_read_b32 v229, a189
v_mfma_f32_16x16x32_bf16 v[136:139], a[8:11], a[208:211], v[136:139]
ds_read_b128 a[0:3], v60 offset:25600
v_accvgpr_read_b32 v230, a190
v_accvgpr_read_b32 v231, a191
v_mul_f32 v224, v224, v46
v_mfma_f32_16x16x32_bf16 v[136:139], a[12:15], a[216:219], v[136:139]
v_mul_f32 v225, v225, v46
v_mul_f32 v226, v226, v46
v_mul_f32 v227, v227, v46
v_mfma_f32_16x16x32_bf16 v[140:143], a[12:15], a[220:223], v[140:143]
ds_read_b128 a[4:7], v60 offset:35840
v_mul_f32 v228, v228, v46
v_mul_f32 v229, v229, v46
v_mfma_f32_16x16x32_bf16 v[140:143], a[8:11], a[212:215], v[140:143]
v_mul_f32 v230, v230, v46
v_mul_f32 v231, v231, v46
v_cvt_pk_bf16_f32 v236, v224, v225
v_mfma_f32_16x16x32_bf16 v[144:147], a[16:19], a[208:211], v[144:147]
ds_read_b128 a[8:11], v60 offset:26624
v_cvt_pk_bf16_f32 v237, v226, v227
v_cvt_pk_bf16_f32 v238, v228, v229
v_cvt_pk_bf16_f32 v239, v230, v231
v_mfma_f32_16x16x32_bf16 v[144:147], a[20:23], a[216:219], v[144:147]
buffer_store_dwordx4 v[236:239], v2, s[32:35], s47 offen offset:3072 sc1
s_nop 0
v_mfma_f32_16x16x32_bf16 v[252:255], v[248:251], v[236:239], v[252:255]
v_mfma_f32_16x16x32_bf16 v[148:151], a[20:23], a[220:223], v[148:151]
s_waitcnt lgkmcnt(4)
ds_read_b128 a[12:15], v60 offset:36864
v_mfma_f32_16x16x32_bf16 v[148:151], a[16:19], a[212:215], v[148:151]
s_add_u32 s89, s72, 24576
v_mfma_f32_16x16x32_bf16 v[152:155], a[24:27], a[208:211], v[152:155]
ds_read_b128 a[16:19], v60 offset:27648
v_mfma_f32_16x16x32_bf16 v[152:155], a[28:31], a[216:219], v[152:155]
buffer_load_dwordx4 a[32:35], v2, s[36:39], s89 offen offset:0 sc1
v_mfma_f32_16x16x32_bf16 v[156:159], a[28:31], a[220:223], v[156:159]
ds_read_b128 a[20:23], v60 offset:37888
v_mfma_f32_16x16x32_bf16 v[156:159], a[24:27], a[212:215], v[156:159]
v_mfma_f32_16x16x32_bf16 v[160:163], a[240:243], a[208:211], v[160:163]
s_waitcnt lgkmcnt(4)
ds_read_b128 a[24:27], v60 offset:28672
v_mfma_f32_16x16x32_bf16 v[160:163], a[244:247], a[216:219], v[160:163]
buffer_load_dwordx4 a[36:39], v2, s[36:39], s89 offen offset:1024 sc1
v_mfma_f32_16x16x32_bf16 v[164:167], a[244:247], a[220:223], v[164:167]
ds_read_b128 a[28:31], v60 offset:38912
v_cmp_u_f32 vcc, v48, v252
s_cmp_lg_u64 vcc, 0
s_cselect_b32 s80, 1, 0
v_mov_b32 v52, s80
s_lshl_b32 s81, s68, 2
s_add_u32 s81, s81, 155648
v_mov_b32 v53, s81
v_mov_b32 v54, 155648
ds_write_b32 v53, v52
v_mfma_f32_16x16x32_bf16 v[164:167], a[240:243], a[212:215], v[164:167]
v_mfma_f32_16x16x32_bf16 v[168:171], a[0:3], a[208:211], v[168:171]
ds_read_b128 a[240:243], v60 offset:29696
v_mfma_f32_16x16x32_bf16 v[168:171], a[4:7], a[216:219], v[168:171]
buffer_load_dwordx4 a[40:43], v61, s[36:39], s89 offen offset:0 sc1
v_mfma_f32_16x16x32_bf16 v[172:175], a[4:7], a[220:223], v[172:175]
s_waitcnt lgkmcnt(4)
ds_read_b128 a[244:247], v60 offset:39936
v_mfma_f32_16x16x32_bf16 v[172:175], a[0:3], a[212:215], v[172:175]
s_waitcnt vmcnt(19)
s_barrier
v_mfma_f32_16x16x32_bf16 v[176:179], a[8:11], a[208:211], v[176:179]
ds_read_b128 a[0:3], v60 offset:40960
v_mfma_f32_16x16x32_bf16 v[176:179], a[12:15], a[216:219], v[176:179]
buffer_load_dwordx4 a[44:47], v61, s[36:39], s89 offen offset:1024 sc1
v_mfma_f32_16x16x32_bf16 v[180:183], a[12:15], a[220:223], v[180:183]
s_add_u32 s90, s74, 81920
s_add_u32 m0, s88, 81920
ds_read_b128 a[4:7], v60 offset:51200
v_mfma_f32_16x16x32_bf16 v[180:183], a[8:11], a[212:215], v[180:183]
v_mfma_f32_16x16x32_bf16 v[184:187], a[16:19], a[208:211], v[184:187]
s_waitcnt lgkmcnt(4)
ds_read_b128 a[8:11], v60 offset:41984
v_mfma_f32_16x16x32_bf16 v[184:187], a[20:23], a[216:219], v[184:187]
buffer_load_dwordx4 v2, s[40:43], s90 offen offset:0 sc1 lds
v_mfma_f32_16x16x32_bf16 v[188:191], a[20:23], a[220:223], v[188:191]
ds_read_b128 a[12:15], v60 offset:52224
v_mfma_f32_16x16x32_bf16 v[188:191], a[16:19], a[212:215], v[188:191]
v_mfma_f32_16x16x32_bf16 v[192:195], a[24:27], a[208:211], v[192:195]
ds_read_b128 a[16:19], v60 offset:43008
v_mfma_f32_16x16x32_bf16 v[192:195], a[28:31], a[216:219], v[192:195]
buffer_load_dwordx4 v2, s[40:43], s90 offen offset:1024 sc1 lds
v_mfma_f32_16x16x32_bf16 v[196:199], a[28:31], a[220:223], v[196:199]
ds_read_b128 a[20:23], v60 offset:53248
v_mfma_f32_16x16x32_bf16 v[196:199], a[24:27], a[212:215], v[196:199]
s_waitcnt lgkmcnt(4)
v_mfma_f32_16x16x32_bf16 v[200:203], a[240:243], a[208:211], v[200:203]
ds_read_b128 a[24:27], v60 offset:44032
v_mfma_f32_16x16x32_bf16 v[200:203], a[244:247], a[216:219], v[200:203]
buffer_load_dwordx4 v2, s[40:43], s90 offen offset:2048 sc1 lds
v_mfma_f32_16x16x32_bf16 v[204:207], a[244:247], a[220:223], v[204:207]
ds_read_b128 a[28:31], v60 offset:54272
v_mfma_f32_16x16x32_bf16 v[204:207], a[240:243], a[212:215], v[204:207]
v_mfma_f32_16x16x32_bf16 v[128:131], a[0:3], a[224:227], v[128:131]
ds_read_b128 a[240:243], v60 offset:45056
v_mfma_f32_16x16x32_bf16 v[128:131], a[4:7], a[232:235], v[128:131]
buffer_load_dwordx4 v2, s[40:43], s90 offen offset:3072 sc1 lds
v_mfma_f32_16x16x32_bf16 v[132:135], a[4:7], a[236:239], v[132:135]
s_add_u32 m0, s88, 86016
ds_read_b128 a[244:247], v60 offset:55296
v_mfma_f32_16x16x32_bf16 v[132:135], a[0:3], a[228:231], v[132:135]
s_waitcnt lgkmcnt(4)
v_mfma_f32_16x16x32_bf16 v[136:139], a[8:11], a[224:227], v[136:139]
ds_read_b128 a[0:3], v60 offset:46080
v_mfma_f32_16x16x32_bf16 v[136:139], a[12:15], a[232:235], v[136:139]
buffer_load_dwordx4 v61, s[40:43], s90 offen offset:0 sc1 lds
v_mfma_f32_16x16x32_bf16 v[140:143], a[12:15], a[236:239], v[140:143]
s_add_u32 s89, s72, 32768
ds_read_b128 a[4:7], v60 offset:56320
v_mfma_f32_16x16x32_bf16 v[140:143], a[8:11], a[228:231], v[140:143]
v_mfma_f32_16x16x32_bf16 v[144:147], a[16:19], a[224:227], v[144:147]
ds_read_b128 a[8:11], v60 offset:47104
v_mfma_f32_16x16x32_bf16 v[144:147], a[20:23], a[232:235], v[144:147]
buffer_load_dwordx4 a[48:51], v2, s[36:39], s89 offen offset:0 sc1
v_mfma_f32_16x16x32_bf16 v[148:151], a[20:23], a[236:239], v[148:151]
ds_read_b128 a[12:15], v60 offset:57344
v_mfma_f32_16x16x32_bf16 v[148:151], a[16:19], a[228:231], v[148:151]
s_waitcnt lgkmcnt(4)
v_mfma_f32_16x16x32_bf16 v[152:155], a[24:27], a[224:227], v[152:155]
ds_read_b128 a[16:19], v60 offset:48128
v_mfma_f32_16x16x32_bf16 v[152:155], a[28:31], a[232:235], v[152:155]
buffer_load_dwordx4 a[52:55], v2, s[36:39], s89 offen offset:1024 sc1
v_mfma_f32_16x16x32_bf16 v[156:159], a[28:31], a[236:239], v[156:159]
ds_read_b128 a[20:23], v60 offset:58368
v_mfma_f32_16x16x32_bf16 v[156:159], a[24:27], a[228:231], v[156:159]
v_mfma_f32_16x16x32_bf16 v[160:163], a[240:243], a[224:227], v[160:163]
ds_read_b128 a[24:27], v60 offset:49152
v_mfma_f32_16x16x32_bf16 v[160:163], a[244:247], a[232:235], v[160:163]
buffer_load_dwordx4 a[56:59], v61, s[36:39], s89 offen offset:0 sc1
v_mfma_f32_16x16x32_bf16 v[164:167], a[244:247], a[236:239], v[164:167]
ds_read_b128 a[28:31], v60 offset:59392
v_mfma_f32_16x16x32_bf16 v[164:167], a[240:243], a[228:231], v[164:167]
s_waitcnt lgkmcnt(4)
v_mfma_f32_16x16x32_bf16 v[168:171], a[0:3], a[224:227], v[168:171]
ds_read_b128 a[240:243], v60 offset:50176
v_mfma_f32_16x16x32_bf16 v[168:171], a[4:7], a[232:235], v[168:171]
buffer_load_dwordx4 a[60:63], v61, s[36:39], s89 offen offset:1024 sc1
v_mfma_f32_16x16x32_bf16 v[172:175], a[4:7], a[236:239], v[172:175]
s_add_u32 s90, s74, 102400
s_add_u32 m0, s88, 102400
ds_read_b128 a[244:247], v60 offset:60416
v_add_u32 v60, 61440, v60
v_mfma_f32_16x16x32_bf16 v[172:175], a[0:3], a[228:231], v[172:175]
s_waitcnt vmcnt(13)
s_barrier
ds_read_b128 v[56:59], v54
s_waitcnt lgkmcnt(0)
v_or3_b32 v56, v56, v57, v58
v_or_b32 v56, v56, v59
s_nop 0
v_readfirstlane_b32 s80, v56
s_nop 3
s_andn2_b32 s80, s80, s79
s_cbranch_scc1 ATT_RETRY
s_cmp_lg_u32 s68, 0
s_cbranch_scc1 NOSIG3
s_add_u32 s87, s93, 4
s_mov_b64 exec, 1
v_mov_b32 v36, s87
buffer_store_dword v36, off, s[4:7], s94 sc1
s_mov_b64 exec, -1
s_cmp_lg_u32 s2, 0
s_cbranch_scc1 NOSIG3
s_add_u32 s87, s92, 0x10001
s_mov_b64 exec, 1
v_mov_b32 v37, s87
s_mov_b32 s86, 65536
buffer_store_dword v37, off, s[4:7], s86 sc1
s_mov_b64 exec, -1
NOSIG3:
v_mfma_f32_16x16x32_bf16 v[176:179], a[8:11], a[224:227], v[176:179]
ds_read_b128 a[0:3], v60 offset:0
v_mfma_f32_16x16x32_bf16 v[176:179], a[12:15], a[232:235], v[176:179]
buffer_load_dwordx4 v2, s[40:43], s90 offen offset:0 sc1 lds
v_mfma_f32_16x16x32_bf16 v[180:183], a[12:15], a[236:239], v[180:183]
ds_read_b128 a[4:7], v60 offset:10240
v_mfma_f32_16x16x32_bf16 v[180:183], a[8:11], a[228:231], v[180:183]
s_waitcnt lgkmcnt(4)
v_mfma_f32_16x16x32_bf16 v[184:187], a[16:19], a[224:227], v[184:187]
ds_read_b128 a[8:11], v60 offset:1024
v_mfma_f32_16x16x32_bf16 v[184:187], a[20:23], a[232:235], v[184:187]
buffer_load_dwordx4 v2, s[40:43], s90 offen offset:1024 sc1 lds
v_mfma_f32_16x16x32_bf16 v[188:191], a[20:23], a[236:239], v[188:191]
ds_read_b128 a[12:15], v60 offset:11264
v_mfma_f32_16x16x32_bf16 v[188:191], a[16:19], a[228:231], v[188:191]
v_mfma_f32_16x16x32_bf16 v[192:195], a[24:27], a[224:227], v[192:195]
ds_read_b128 a[16:19], v60 offset:2048
v_mfma_f32_16x16x32_bf16 v[192:195], a[28:31], a[232:235], v[192:195]
buffer_load_dwordx4 v2, s[40:43], s90 offen offset:2048 sc1 lds
v_mfma_f32_16x16x32_bf16 v[196:199], a[28:31], a[236:239], v[196:199]
ds_read_b128 a[20:23], v60 offset:12288
v_mfma_f32_16x16x32_bf16 v[196:199], a[24:27], a[228:231], v[196:199]
s_waitcnt lgkmcnt(4)
v_mfma_f32_16x16x32_bf16 v[200:203], a[240:243], a[224:227], v[200:203]
ds_read_b128 a[24:27], v60 offset:3072
v_mfma_f32_16x16x32_bf16 v[200:203], a[244:247], a[232:235], v[200:203]
buffer_load_dwordx4 v2, s[40:43], s90 offen offset:3072 sc1 lds
v_mfma_f32_16x16x32_bf16 v[204:207], a[244:247], a[236:239], v[204:207]
s_add_u32 m0, s88, 106496
ds_read_b128 a[28:31], v60 offset:13312
v_mfma_f32_16x16x32_bf16 v[204:207], a[240:243], a[228:231], v[204:207]
s_waitcnt vmcnt(13)
v_mfma_f32_16x16x32_bf16 v[128:131], a[0:3], a[32:35], v[128:131]
ds_read_b128 a[240:243], v60 offset:4096
v_mfma_f32_16x16x32_bf16 v[128:131], a[4:7], a[40:43], v[128:131]
buffer_load_dwordx4 v61, s[40:43], s90 offen offset:0 sc1 lds
v_mfma_f32_16x16x32_bf16 v[132:135], a[4:7], a[44:47], v[132:135]
s_add_u32 s89, s72, 40960
ds_read_b128 a[244:247], v60 offset:14336
v_mfma_f32_16x16x32_bf16 v[132:135], a[0:3], a[36:39], v[132:135]
s_waitcnt lgkmcnt(4)
v_mfma_f32_16x16x32_bf16 v[136:139], a[8:11], a[32:35], v[136:139]
ds_read_b128 a[0:3], v60 offset:5120
v_mfma_f32_16x16x32_bf16 v[136:139], a[12:15], a[40:43], v[136:139]
buffer_load_dwordx4 a[192:195], v2, s[36:39], s89 offen offset:0 sc1
v_mfma_f32_16x16x32_bf16 v[140:143], a[12:15], a[44:47], v[140:143]
ds_read_b128 a[4:7], v60 offset:15360
v_mfma_f32_16x16x32_bf16 v[140:143], a[8:11], a[36:39], v[140:143]
v_mfma_f32_16x16x32_bf16 v[144:147], a[16:19], a[32:35], v[144:147]
ds_read_b128 a[8:11], v60 offset:6144
v_mfma_f32_16x16x32_bf16 v[144:147], a[20:23], a[40:43], v[144:147]
buffer_load_dwordx4 a[196:199], v2, s[36:39], s89 offen offset:1024 sc1
v_mfma_f32_16x16x32_bf16 v[148:151], a[20:23], a[44:47], v[148:151]
ds_read_b128 a[12:15], v60 offset:16384
v_mfma_f32_16x16x32_bf16 v[148:151], a[16:19], a[36:39], v[148:151]
s_waitcnt lgkmcnt(4)
v_mfma_f32_16x16x32_bf16 v[152:155], a[24:27], a[32:35], v[152:155]
ds_read_b128 a[16:19], v60 offset:7168
v_mfma_f32_16x16x32_bf16 v[152:155], a[28:31], a[40:43], v[152:155]
buffer_load_dwordx4 a[200:203], v61, s[36:39], s89 offen offset:0 sc1
v_mfma_f32_16x16x32_bf16 v[156:159], a[28:31], a[44:47], v[156:159]
ds_read_b128 a[20:23], v60 offset:17408
v_mfma_f32_16x16x32_bf16 v[156:159], a[24:27], a[36:39], v[156:159]
v_mfma_f32_16x16x32_bf16 v[160:163], a[240:243], a[32:35], v[160:163]
ds_read_b128 a[24:27], v60 offset:8192
v_mfma_f32_16x16x32_bf16 v[160:163], a[244:247], a[40:43], v[160:163]
buffer_load_dwordx4 a[204:207], v61, s[36:39], s89 offen offset:1024 sc1
v_mfma_f32_16x16x32_bf16 v[164:167], a[244:247], a[44:47], v[164:167]
s_add_u32 s90, s74, 122880
s_add_u32 m0, s88, 0
ds_read_b128 a[28:31], v60 offset:18432
v_mfma_f32_16x16x32_bf16 v[164:167], a[240:243], a[36:39], v[164:167]
s_waitcnt lgkmcnt(4)
v_mfma_f32_16x16x32_bf16 v[168:171], a[0:3], a[32:35], v[168:171]
ds_read_b128 a[240:243], v60 offset:9216
v_mfma_f32_16x16x32_bf16 v[168:171], a[4:7], a[40:43], v[168:171]
buffer_load_dwordx4 v2, s[40:43], s90 offen offset:0 sc1 lds
v_mfma_f32_16x16x32_bf16 v[172:175], a[4:7], a[44:47], v[172:175]
ds_read_b128 a[244:247], v60 offset:19456
v_mfma_f32_16x16x32_bf16 v[172:175], a[0:3], a[36:39], v[172:175]
s_waitcnt vmcnt(10)
s_barrier
v_mfma_f32_16x16x32_bf16 v[176:179], a[8:11], a[32:35], v[176:179]
ds_read_b128 a[0:3], v60 offset:20480
v_mfma_f32_16x16x32_bf16 v[176:179], a[12:15], a[40:43], v[176:179]
buffer_load_dwordx4 v2, s[40:43], s90 offen offset:1024 sc1 lds
v_mfma_f32_16x16x32_bf16 v[180:183], a[12:15], a[44:47], v[180:183]
ds_read_b128 a[4:7], v60 offset:30720
v_mfma_f32_16x16x32_bf16 v[180:183], a[8:11], a[36:39], v[180:183]
s_waitcnt lgkmcnt(4)
v_mfma_f32_16x16x32_bf16 v[184:187], a[16:19], a[32:35], v[184:187]
ds_read_b128 a[8:11], v60 offset:21504
v_mfma_f32_16x16x32_bf16 v[184:187], a[20:23], a[40:43], v[184:187]
buffer_load_dwordx4 v2, s[40:43], s90 offen offset:2048 sc1 lds
v_mfma_f32_16x16x32_bf16 v[188:191], a[20:23], a[44:47], v[188:191]
ds_read_b128 a[12:15], v60 offset:31744
v_mfma_f32_16x16x32_bf16 v[188:191], a[16:19], a[36:39], v[188:191]
v_mfma_f32_16x16x32_bf16 v[192:195], a[24:27], a[32:35], v[192:195]
ds_read_b128 a[16:19], v60 offset:22528
v_mfma_f32_16x16x32_bf16 v[192:195], a[28:31], a[40:43], v[192:195]
buffer_load_dwordx4 v2, s[40:43], s90 offen offset:3072 sc1 lds
v_mfma_f32_16x16x32_bf16 v[196:199], a[28:31], a[44:47], v[196:199]
s_add_u32 m0, s88, 4096
ds_read_b128 a[20:23], v60 offset:32768
v_mfma_f32_16x16x32_bf16 v[196:199], a[24:27], a[36:39], v[196:199]
s_waitcnt lgkmcnt(4)
v_mfma_f32_16x16x32_bf16 v[200:203], a[240:243], a[32:35], v[200:203]
ds_read_b128 a[24:27], v60 offset:23552
v_mfma_f32_16x16x32_bf16 v[200:203], a[244:247], a[40:43], v[200:203]
buffer_load_dwordx4 v61, s[40:43], s90 offen offset:0 sc1 lds
v_mfma_f32_16x16x32_bf16 v[204:207], a[244:247], a[44:47], v[204:207]
s_add_u32 s89, s72, 49152
ds_read_b128 a[28:31], v60 offset:33792
v_mfma_f32_16x16x32_bf16 v[204:207], a[240:243], a[36:39], v[204:207]
v_mfma_f32_16x16x32_bf16 v[128:131], a[0:3], a[48:51], v[128:131]
ds_read_b128 a[240:243], v60 offset:24576
v_mfma_f32_16x16x32_bf16 v[128:131], a[4:7], a[56:59], v[128:131]
buffer_load_dwordx4 a[208:211], v2, s[36:39], s89 offen offset:0 sc1
v_mfma_f32_16x16x32_bf16 v[132:135], a[4:7], a[60:63], v[132:135]
ds_read_b128 a[244:247], v60 offset:34816
v_mfma_f32_16x16x32_bf16 v[132:135], a[0:3], a[52:55], v[132:135]
s_waitcnt lgkmcnt(4)
v_mfma_f32_16x16x32_bf16 v[136:139], a[8:11], a[48:51], v[136:139]
ds_read_b128 a[0:3], v60 offset:25600
v_mfma_f32_16x16x32_bf16 v[136:139], a[12:15], a[56:59], v[136:139]
buffer_load_dwordx4 a[212:215], v2, s[36:39], s89 offen offset:1024 sc1
v_mfma_f32_16x16x32_bf16 v[140:143], a[12:15], a[60:63], v[140:143]
ds_read_b128 a[4:7], v60 offset:35840
v_mfma_f32_16x16x32_bf16 v[140:143], a[8:11], a[52:55], v[140:143]
v_mfma_f32_16x16x32_bf16 v[144:147], a[16:19], a[48:51], v[144:147]
ds_read_b128 a[8:11], v60 offset:26624
v_mfma_f32_16x16x32_bf16 v[144:147], a[20:23], a[56:59], v[144:147]
buffer_load_dwordx4 a[216:219], v61, s[36:39], s89 offen offset:0 sc1
v_mfma_f32_16x16x32_bf16 v[148:151], a[20:23], a[60:63], v[148:151]
ds_read_b128 a[12:15], v60 offset:36864
v_mfma_f32_16x16x32_bf16 v[148:151], a[16:19], a[52:55], v[148:151]
s_waitcnt lgkmcnt(4)
v_mfma_f32_16x16x32_bf16 v[152:155], a[24:27], a[48:51], v[152:155]
ds_read_b128 a[16:19], v60 offset:27648
v_mfma_f32_16x16x32_bf16 v[152:155], a[28:31], a[56:59], v[152:155]
buffer_load_dwordx4 a[220:223], v61, s[36:39], s89 offen offset:1024 sc1
v_mfma_f32_16x16x32_bf16 v[156:159], a[28:31], a[60:63], v[156:159]
s_add_u32 s90, s75, 0
s_add_u32 m0, s88, 20480
ds_read_b128 a[20:23], v60 offset:37888
v_mfma_f32_16x16x32_bf16 v[156:159], a[24:27], a[52:55], v[156:159]
v_mfma_f32_16x16x32_bf16 v[160:163], a[240:243], a[48:51], v[160:163]
ds_read_b128 a[24:27], v60 offset:28672
v_mfma_f32_16x16x32_bf16 v[160:163], a[244:247], a[56:59], v[160:163]
buffer_load_dwordx4 v2, s[40:43], s90 offen offset:0 sc1 lds
v_mfma_f32_16x16x32_bf16 v[164:167], a[244:247], a[60:63], v[164:167]
ds_read_b128 a[28:31], v60 offset:38912
v_mfma_f32_16x16x32_bf16 v[164:167], a[240:243], a[52:55], v[164:167]
s_waitcnt lgkmcnt(4)
v_mfma_f32_16x16x32_bf16 v[168:171], a[0:3], a[48:51], v[168:171]
ds_read_b128 a[240:243], v60 offset:29696
v_mfma_f32_16x16x32_bf16 v[168:171], a[4:7], a[56:59], v[168:171]
buffer_load_dwordx4 v2, s[40:43], s90 offen offset:1024 sc1 lds
v_mfma_f32_16x16x32_bf16 v[172:175], a[4:7], a[60:63], v[172:175]
ds_read_b128 a[244:247], v60 offset:39936
v_mfma_f32_16x16x32_bf16 v[172:175], a[0:3], a[52:55], v[172:175]
s_waitcnt vmcnt(11)
s_barrier
s_cmp_lg_u32 s68, 0
s_cbranch_scc1 NOPOLL3
buffer_load_dword v36, v39, s[4:7], s95 offen sc1
NOPOLL3:
v_mfma_f32_16x16x32_bf16 v[176:179], a[8:11], a[48:51], v[176:179]
ds_read_b128 a[0:3], v60 offset:40960
v_mfma_f32_16x16x32_bf16 v[176:179], a[12:15], a[56:59], v[176:179]
buffer_load_dwordx4 v2, s[40:43], s90 offen offset:2048 sc1 lds
v_mfma_f32_16x16x32_bf16 v[180:183], a[12:15], a[60:63], v[180:183]
ds_read_b128 a[4:7], v60 offset:51200
v_mfma_f32_16x16x32_bf16 v[180:183], a[8:11], a[52:55], v[180:183]
s_waitcnt lgkmcnt(4)
v_mfma_f32_16x16x32_bf16 v[184:187], a[16:19], a[48:51], v[184:187]
ds_read_b128 a[8:11], v60 offset:41984
v_mfma_f32_16x16x32_bf16 v[184:187], a[20:23], a[56:59], v[184:187]
buffer_load_dwordx4 v2, s[40:43], s90 offen offset:3072 sc1 lds
v_mfma_f32_16x16x32_bf16 v[188:191], a[20:23], a[60:63], v[188:191]
s_add_u32 m0, s88, 24576
ds_read_b128 a[12:15], v60 offset:52224
v_mfma_f32_16x16x32_bf16 v[188:191], a[16:19], a[52:55], v[188:191]
v_mfma_f32_16x16x32_bf16 v[192:195], a[24:27], a[48:51], v[192:195]
ds_read_b128 a[16:19], v60 offset:43008
v_mfma_f32_16x16x32_bf16 v[192:195], a[28:31], a[56:59], v[192:195]
buffer_load_dwordx4 v61, s[40:43], s90 offen offset:0 sc1 lds
v_mfma_f32_16x16x32_bf16 v[196:199], a[28:31], a[60:63], v[196:199]
s_add_u32 s90, s75, 20480
s_add_u32 m0, s88, 40960
ds_read_b128 a[20:23], v60 offset:53248
v_mfma_f32_16x16x32_bf16 v[196:199], a[24:27], a[52:55], v[196:199]
s_waitcnt lgkmcnt(4)
v_mfma_f32_16x16x32_bf16 v[200:203], a[240:243], a[48:51], v[200:203]
ds_read_b128 a[24:27], v60 offset:44032
v_mfma_f32_16x16x32_bf16 v[200:203], a[244:247], a[56:59], v[200:203]
buffer_load_dwordx4 v2, s[40:43], s90 offen offset:0 sc1 lds
v_mfma_f32_16x16x32_bf16 v[204:207], a[244:247], a[60:63], v[204:207]
ds_read_b128 a[28:31], v60 offset:54272
v_mfma_f32_16x16x32_bf16 v[204:207], a[240:243], a[52:55], v[204:207]
v_mfma_f32_16x16x32_bf16 v[128:131], a[0:3], a[192:195], v[128:131]
ds_read_b128 a[240:243], v60 offset:45056
v_mfma_f32_16x16x32_bf16 v[128:131], a[4:7], a[200:203], v[128:131]
buffer_load_dwordx4 v2, s[40:43], s90 offen offset:1024 sc1 lds
v_mfma_f32_16x16x32_bf16 v[132:135], a[4:7], a[204:207], v[132:135]
ds_read_b128 a[244:247], v60 offset:55296
v_mfma_f32_16x16x32_bf16 v[132:135], a[0:3], a[196:199], v[132:135]
s_waitcnt lgkmcnt(4)
v_mfma_f32_16x16x32_bf16 v[136:139], a[8:11], a[192:195], v[136:139]
ds_read_b128 a[0:3], v60 offset:46080
v_mfma_f32_16x16x32_bf16 v[136:139], a[12:15], a[200:203], v[136:139]
buffer_load_dwordx4 v2, s[40:43], s90 offen offset:2048 sc1 lds
v_mfma_f32_16x16x32_bf16 v[140:143], a[12:15], a[204:207], v[140:143]
ds_read_b128 a[4:7], v60 offset:56320
v_mfma_f32_16x16x32_bf16 v[140:143], a[8:11], a[196:199], v[140:143]
v_mfma_f32_16x16x32_bf16 v[144:147], a[16:19], a[192:195], v[144:147]
ds_read_b128 a[8:11], v60 offset:47104
v_mfma_f32_16x16x32_bf16 v[144:147], a[20:23], a[200:203], v[144:147]
buffer_load_dwordx4 v2, s[40:43], s90 offen offset:3072 sc1 lds
v_mfma_f32_16x16x32_bf16 v[148:151], a[20:23], a[204:207], v[148:151]
s_add_u32 m0, s88, 45056
ds_read_b128 a[12:15], v60 offset:57344
v_mfma_f32_16x16x32_bf16 v[148:151], a[16:19], a[196:199], v[148:151]
s_waitcnt lgkmcnt(4)
v_mfma_f32_16x16x32_bf16 v[152:155], a[24:27], a[192:195], v[152:155]
ds_read_b128 a[16:19], v60 offset:48128
v_mfma_f32_16x16x32_bf16 v[152:155], a[28:31], a[200:203], v[152:155]
buffer_load_dwordx4 v61, s[40:43], s90 offen offset:0 sc1 lds
v_mfma_f32_16x16x32_bf16 v[156:159], a[28:31], a[204:207], v[156:159]
s_add_u32 s90, s75, 40960
s_add_u32 m0, s88, 61440
ds_read_b128 a[20:23], v60 offset:58368
v_mfma_f32_16x16x32_bf16 v[156:159], a[24:27], a[196:199], v[156:159]
v_mfma_f32_16x16x32_bf16 v[160:163], a[240:243], a[192:195], v[160:163]
ds_read_b128 a[24:27], v60 offset:49152
v_mfma_f32_16x16x32_bf16 v[160:163], a[244:247], a[200:203], v[160:163]
buffer_load_dwordx4 v2, s[40:43], s90 offen offset:0 sc1 lds
v_mfma_f32_16x16x32_bf16 v[164:167], a[244:247], a[204:207], v[164:167]
ds_read_b128 a[28:31], v60 offset:59392
v_mfma_f32_16x16x32_bf16 v[164:167], a[240:243], a[196:199], v[164:167]
s_waitcnt lgkmcnt(4)
v_mfma_f32_16x16x32_bf16 v[168:171], a[0:3], a[192:195], v[168:171]
ds_read_b128 a[240:243], v60 offset:50176
v_mfma_f32_16x16x32_bf16 v[168:171], a[4:7], a[200:203], v[168:171]
buffer_load_dwordx4 v2, s[40:43], s90 offen offset:1024 sc1 lds
v_mfma_f32_16x16x32_bf16 v[172:175], a[4:7], a[204:207], v[172:175]
ds_read_b128 a[244:247], v60 offset:60416
v_subrev_u32 v60, 61440, v60
v_mfma_f32_16x16x32_bf16 v[172:175], a[0:3], a[196:199], v[172:175]
s_waitcnt vmcnt(12)
s_cmp_lg_u32 s68, 0
s_cbranch_scc1 SPUN_O
s_waitcnt vmcnt(10)
s_mov_b32 s87, 0
s_add_u32 s86, s93, 4
SPIN_O:
v_subrev_u32 v36, s86, v36
v_cmp_lt_u32 vcc, 0, v36
s_add_u32 s87, s87, 1
s_cmp_eq_u64 vcc, 0
s_cbranch_scc1 SPUN_O
s_cmp_ge_u32 s87, 0x40000
s_cbranch_scc1 SPUN_O
s_sleep 2
buffer_load_dword v36, v39, s[4:7], s95 offen sc1
s_waitcnt vmcnt(0)
s_branch SPIN_O
SPUN_O:
s_barrier
v_mfma_f32_16x16x32_bf16 v[176:179], a[8:11], a[192:195], v[176:179]
ds_read_b128 a[0:3], v60 offset:0
v_mfma_f32_16x16x32_bf16 v[176:179], a[12:15], a[200:203], v[176:179]
buffer_load_dwordx4 v2, s[40:43], s90 offen offset:2048 sc1 lds
v_mfma_f32_16x16x32_bf16 v[180:183], a[12:15], a[204:207], v[180:183]
ds_read_b128 a[4:7], v60 offset:10240
v_mfma_f32_16x16x32_bf16 v[180:183], a[8:11], a[196:199], v[180:183]
s_waitcnt lgkmcnt(4)
v_mfma_f32_16x16x32_bf16 v[184:187], a[16:19], a[192:195], v[184:187]
ds_read_b128 a[8:11], v60 offset:1024
v_mfma_f32_16x16x32_bf16 v[184:187], a[20:23], a[200:203], v[184:187]
buffer_load_dwordx4 v2, s[40:43], s90 offen offset:3072 sc1 lds
v_mfma_f32_16x16x32_bf16 v[188:191], a[20:23], a[204:207], v[188:191]
s_add_u32 m0, s88, 65536
ds_read_b128 a[12:15], v60 offset:11264
v_mfma_f32_16x16x32_bf16 v[188:191], a[16:19], a[196:199], v[188:191]
v_mfma_f32_16x16x32_bf16 v[192:195], a[24:27], a[192:195], v[192:195]
ds_read_b128 a[16:19], v60 offset:2048
v_mfma_f32_16x16x32_bf16 v[192:195], a[28:31], a[200:203], v[192:195]
buffer_load_dwordx4 v61, s[40:43], s90 offen offset:0 sc1 lds
v_mfma_f32_16x16x32_bf16 v[196:199], a[28:31], a[204:207], v[196:199]
s_add_u32 s89, s73, 0
ds_read_b128 a[20:23], v60 offset:12288
v_mfma_f32_16x16x32_bf16 v[196:199], a[24:27], a[196:199], v[196:199]
s_waitcnt lgkmcnt(4)
v_mfma_f32_16x16x32_bf16 v[200:203], a[240:243], a[192:195], v[200:203]
ds_read_b128 a[24:27], v60 offset:3072
v_mfma_f32_16x16x32_bf16 v[200:203], a[244:247], a[200:203], v[200:203]
buffer_load_dwordx4 a[224:227], v2, s[36:39], s89 offen offset:0 sc1
v_mfma_f32_16x16x32_bf16 v[204:207], a[244:247], a[204:207], v[204:207]
ds_read_b128 a[28:31], v60 offset:13312
v_mfma_f32_16x16x32_bf16 v[204:207], a[240:243], a[196:199], v[204:207]
v_mfma_f32_16x16x32_bf16 v[128:131], a[0:3], a[208:211], v[128:131]
ds_read_b128 a[240:243], v60 offset:4096
v_mfma_f32_16x16x32_bf16 v[128:131], a[4:7], a[216:219], v[128:131]
buffer_load_dwordx4 a[228:231], v2, s[36:39], s89 offen offset:1024 sc1
v_mfma_f32_16x16x32_bf16 v[132:135], a[4:7], a[220:223], v[132:135]
ds_read_b128 a[244:247], v60 offset:14336
v_mfma_f32_16x16x32_bf16 v[132:135], a[0:3], a[212:215], v[132:135]
s_waitcnt lgkmcnt(4)
v_mfma_f32_16x16x32_bf16 v[136:139], a[8:11], a[208:211], v[136:139]
ds_read_b128 a[0:3], v60 offset:5120
v_mfma_f32_16x16x32_bf16 v[136:139], a[12:15], a[216:219], v[136:139]
buffer_load_dwordx4 a[232:235], v61, s[36:39], s89 offen offset:0 sc1
v_mfma_f32_16x16x32_bf16 v[140:143], a[12:15], a[220:223], v[140:143]
ds_read_b128 a[4:7], v60 offset:15360
v_mfma_f32_16x16x32_bf16 v[140:143], a[8:11], a[212:215], v[140:143]
v_mfma_f32_16x16x32_bf16 v[144:147], a[16:19], a[208:211], v[144:147]
ds_read_b128 a[8:11], v60 offset:6144
v_mfma_f32_16x16x32_bf16 v[144:147], a[20:23], a[216:219], v[144:147]
buffer_load_dwordx4 a[236:239], v61, s[36:39], s89 offen offset:1024 sc1
v_mfma_f32_16x16x32_bf16 v[148:151], a[20:23], a[220:223], v[148:151]
s_add_u32 s89, s73, 8192
ds_read_b128 a[12:15], v60 offset:16384
v_mfma_f32_16x16x32_bf16 v[148:151], a[16:19], a[212:215], v[148:151]
s_waitcnt lgkmcnt(4)
v_mfma_f32_16x16x32_bf16 v[152:155], a[24:27], a[208:211], v[152:155]
ds_read_b128 a[16:19], v60 offset:7168
v_mfma_f32_16x16x32_bf16 v[152:155], a[28:31], a[216:219], v[152:155]
buffer_load_dwordx4 a[32:35], v2, s[36:39], s89 offen offset:0 sc1
v_mfma_f32_16x16x32_bf16 v[156:159], a[28:31], a[220:223], v[156:159]
ds_read_b128 a[20:23], v60 offset:17408
v_mfma_f32_16x16x32_bf16 v[156:159], a[24:27], a[212:215], v[156:159]
v_mfma_f32_16x16x32_bf16 v[160:163], a[240:243], a[208:211], v[160:163]
ds_read_b128 a[24:27], v60 offset:8192
v_mfma_f32_16x16x32_bf16 v[160:163], a[244:247], a[216:219], v[160:163]
buffer_load_dwordx4 a[36:39], v2, s[36:39], s89 offen offset:1024 sc1
v_mfma_f32_16x16x32_bf16 v[164:167], a[244:247], a[220:223], v[164:167]
ds_read_b128 a[28:31], v60 offset:18432
v_mfma_f32_16x16x32_bf16 v[164:167], a[240:243], a[212:215], v[164:167]
s_waitcnt lgkmcnt(4)
v_mfma_f32_16x16x32_bf16 v[168:171], a[0:3], a[208:211], v[168:171]
ds_read_b128 a[240:243], v60 offset:9216
v_mfma_f32_16x16x32_bf16 v[168:171], a[4:7], a[216:219], v[168:171]
buffer_load_dwordx4 a[40:43], v61, s[36:39], s89 offen offset:0 sc1
v_mfma_f32_16x16x32_bf16 v[172:175], a[4:7], a[220:223], v[172:175]
ds_read_b128 a[244:247], v60 offset:19456
v_mfma_f32_16x16x32_bf16 v[172:175], a[0:3], a[212:215], v[172:175]
s_waitcnt vmcnt(17)
s_barrier
v_mfma_f32_16x16x32_bf16 v[176:179], a[8:11], a[208:211], v[176:179]
ds_read_b128 a[0:3], v60 offset:20480
v_mfma_f32_16x16x32_bf16 v[176:179], a[12:15], a[216:219], v[176:179]
buffer_load_dwordx4 a[44:47], v61, s[36:39], s89 offen offset:1024 sc1
v_mfma_f32_16x16x32_bf16 v[180:183], a[12:15], a[220:223], v[180:183]
s_add_u32 s89, s73, 16384
ds_read_b128 a[4:7], v60 offset:30720
v_mfma_f32_16x16x32_bf16 v[180:183], a[8:11], a[212:215], v[180:183]
s_waitcnt lgkmcnt(4)
v_mfma_f32_16x16x32_bf16 v[184:187], a[16:19], a[208:211], v[184:187]
ds_read_b128 a[8:11], v60 offset:21504
v_mfma_f32_16x16x32_bf16 v[184:187], a[20:23], a[216:219], v[184:187]
buffer_load_dwordx4 a[48:51], v2, s[36:39], s89 offen offset:0 sc1
v_mfma_f32_16x16x32_bf16 v[188:191], a[20:23], a[220:223], v[188:191]
ds_read_b128 a[12:15], v60 offset:31744
v_mfma_f32_16x16x32_bf16 v[188:191], a[16:19], a[212:215], v[188:191]
v_mfma_f32_16x16x32_bf16 v[192:195], a[24:27], a[208:211], v[192:195]
ds_read_b128 a[16:19], v60 offset:22528
v_mfma_f32_16x16x32_bf16 v[192:195], a[28:31], a[216:219], v[192:195]
buffer_load_dwordx4 a[52:55], v2, s[36:39], s89 offen offset:1024 sc1
v_mfma_f32_16x16x32_bf16 v[196:199], a[28:31], a[220:223], v[196:199]
ds_read_b128 a[20:23], v60 offset:32768
v_mfma_f32_16x16x32_bf16 v[196:199], a[24:27], a[212:215], v[196:199]
s_waitcnt lgkmcnt(4)
v_mfma_f32_16x16x32_bf16 v[200:203], a[240:243], a[208:211], v[200:203]
ds_read_b128 a[24:27], v60 offset:23552
v_mfma_f32_16x16x32_bf16 v[200:203], a[244:247], a[216:219], v[200:203]
buffer_load_dwordx4 a[56:59], v61, s[36:39], s89 offen offset:0 sc1
v_mfma_f32_16x16x32_bf16 v[204:207], a[244:247], a[220:223], v[204:207]
ds_read_b128 a[28:31], v60 offset:33792
v_mfma_f32_16x16x32_bf16 v[204:207], a[240:243], a[212:215], v[204:207]
s_waitcnt vmcnt(7)
v_mfma_f32_16x16x32_bf16 v[64:67], a[0:3], a[224:227], 0
ds_read_b128 a[240:243], v60 offset:24576
v_mfma_f32_16x16x32_bf16 v[64:67], a[4:7], a[232:235], v[64:67]
buffer_load_dwordx4 a[60:63], v61, s[36:39], s89 offen offset:1024 sc1
v_mfma_f32_16x16x32_bf16 v[68:71], a[4:7], a[236:239], 0
s_add_u32 s90, s75, 61440
s_add_u32 m0, s88, 81920
ds_read_b128 a[244:247], v60 offset:34816
v_mfma_f32_16x16x32_bf16 v[68:71], a[0:3], a[228:231], v[68:71]
s_waitcnt lgkmcnt(4)
v_mfma_f32_16x16x32_bf16 v[72:75], a[8:11], a[224:227], 0
ds_read_b128 a[0:3], v60 offset:25600
v_mfma_f32_16x16x32_bf16 v[72:75], a[12:15], a[232:235], v[72:75]
buffer_load_dwordx4 v2, s[40:43], s90 offen offset:0 sc1 lds
v_mfma_f32_16x16x32_bf16 v[76:79], a[12:15], a[236:239], 0
ds_read_b128 a[4:7], v60 offset:35840
v_mfma_f32_16x16x32_bf16 v[76:79], a[8:11], a[228:231], v[76:79]
v_mfma_f32_16x16x32_bf16 v[80:83], a[16:19], a[224:227], 0
ds_read_b128 a[8:11], v60 offset:26624
v_mfma_f32_16x16x32_bf16 v[80:83], a[20:23], a[232:235], v[80:83]
buffer_load_dwordx4 v2, s[40:43], s90 offen offset:1024 sc1 lds
v_mfma_f32_16x16x32_bf16 v[84:87], a[20:23], a[236:239], 0
ds_read_b128 a[12:15], v60 offset:36864
v_mfma_f32_16x16x32_bf16 v[84:87], a[16:19], a[228:231], v[84:87]
s_waitcnt lgkmcnt(4)
v_mfma_f32_16x16x32_bf16 v[88:91], a[24:27], a[224:227], 0
ds_read_b128 a[16:19], v60 offset:27648
v_mfma_f32_16x16x32_bf16 v[88:91], a[28:31], a[232:235], v[88:91]
buffer_load_dwordx4 v2, s[40:43], s90 offen offset:2048 sc1 lds
v_mfma_f32_16x16x32_bf16 v[92:95], a[28:31], a[236:239], 0
ds_read_b128 a[20:23], v60 offset:37888
v_mfma_f32_16x16x32_bf16 v[92:95], a[24:27], a[228:231], v[92:95]
v_mfma_f32_16x16x32_bf16 v[96:99], a[240:243], a[224:227], 0
s_waitcnt lgkmcnt(4)
ds_read_b128 a[24:27], v60 offset:28672
v_mfma_f32_16x16x32_bf16 v[96:99], a[244:247], a[232:235], v[96:99]
buffer_load_dwordx4 v2, s[40:43], s90 offen offset:3072 sc1 lds
v_mfma_f32_16x16x32_bf16 v[100:103], a[244:247], a[236:239], 0
s_add_u32 m0, s88, 86016
ds_read_b128 a[28:31], v60 offset:38912
v_mfma_f32_16x16x32_bf16 v[100:103], a[240:243], a[228:231], v[100:103]
s_add_u32 s82, s16, 0
v_cvt_pk_bf16_f32 v40, v128, v129
v_cvt_pk_bf16_f32 v41, v130, v131
v_mfma_f32_16x16x32_bf16 v[104:107], a[0:3], a[224:227], 0
s_waitcnt lgkmcnt(4)
ds_read_b128 a[240:243], v60 offset:29696
v_cvt_pk_bf16_f32 v42, v136, v137
v_mfma_f32_16x16x32_bf16 v[104:107], a[4:7], a[232:235], v[104:107]
buffer_load_dwordx4 v61, s[40:43], s90 offen offset:0 sc1 lds
v_mfma_f32_16x16x32_bf16 v[108:111], a[4:7], a[236:239], 0
s_add_u32 s89, s73, 24576
ds_read_b128 a[244:247], v60 offset:39936
v_cvt_pk_bf16_f32 v43, v138, v62
v_mfma_f32_16x16x32_bf16 v[108:111], a[0:3], a[228:231], v[108:111]
s_waitcnt vmcnt(22)
s_barrier
v_mfma_f32_16x16x32_bf16 v[112:115], a[8:11], a[224:227], 0
ds_read_b128 a[0:3], v60 offset:40960
v_mfma_f32_16x16x32_bf16 v[112:115], a[12:15], a[232:235], v[112:115]
buffer_load_dwordx4 a[192:195], v2, s[36:39], s89 offen offset:0 sc1
v_mfma_f32_16x16x32_bf16 v[116:119], a[12:15], a[236:239], 0
s_waitcnt lgkmcnt(4)
ds_read_b128 a[4:7], v60 offset:51200
v_mfma_f32_16x16x32_bf16 v[116:119], a[8:11], a[228:231], v[116:119]
buffer_store_dwordx4 v[40:43], v2, s[12:15], s82 offen offset:0 sc1
v_mfma_f32_16x16x32_bf16 v[120:123], a[16:19], a[224:227], 0
ds_read_b128 a[8:11], v60 offset:41984
v_cvt_pk_bf16_f32 v44, v139, v144
v_mfma_f32_16x16x32_bf16 v[120:123], a[20:23], a[232:235], v[120:123]
buffer_load_dwordx4 a[196:199], v2, s[36:39], s89 offen offset:1024 sc1
v_mfma_f32_16x16x32_bf16 v[124:127], a[20:23], a[236:239], 0
ds_read_b128 a[12:15], v60 offset:52224
v_cvt_pk_bf16_f32 v45, v145, v146
v_mfma_f32_16x16x32_bf16 v[124:127], a[16:19], a[228:231], v[124:127]
v_cvt_pk_bf16_f32 v46, v147, v152
v_cvt_pk_bf16_f32 v47, v153, v62
v_mfma_f32_16x16x32_bf16 v[208:211], a[24:27], a[224:227], 0
s_waitcnt lgkmcnt(4)
ds_read_b128 a[16:19], v60 offset:43008
v_mfma_f32_16x16x32_bf16 v[208:211], a[28:31], a[232:235], v[208:211]
buffer_load_dwordx4 a[200:203], v61, s[36:39], s89 offen offset:0 sc1
v_mfma_f32_16x16x32_bf16 v[212:215], a[28:31], a[236:239], 0
ds_read_b128 a[20:23], v60 offset:53248
v_mfma_f32_16x16x32_bf16 v[212:215], a[24:27], a[228:231], v[212:215]
v_mfma_f32_16x16x32_bf16 v[216:219], a[240:243], a[224:227], 0
s_waitcnt lgkmcnt(4)
ds_read_b128 a[24:27], v60 offset:44032
v_mfma_f32_16x16x32_bf16 v[216:219], a[244:247], a[232:235], v[216:219]
buffer_load_dwordx4 a[204:207], v61, s[36:39], s89 offen offset:1024 sc1
v_mfma_f32_16x16x32_bf16 v[220:223], a[244:247], a[236:239], 0
s_add_u32 s90, s75, 81920
s_add_u32 m0, s88, 102400
ds_read_b128 a[28:31], v60 offset:54272
v_mfma_f32_16x16x32_bf16 v[220:223], a[240:243], a[228:231], v[220:223]
s_waitcnt vmcnt(14)
v_mfma_f32_16x16x32_bf16 v[64:67], a[0:3], a[32:35], v[64:67]
ds_read_b128 a[240:243], v60 offset:45056
v_mfma_f32_16x16x32_bf16 v[64:67], a[4:7], a[40:43], v[64:67]
buffer_load_dwordx4 v2, s[40:43], s90 offen offset:0 sc1 lds
v_mfma_f32_16x16x32_bf16 v[68:71], a[4:7], a[44:47], v[68:71]
s_waitcnt lgkmcnt(4)
ds_read_b128 a[244:247], v60 offset:55296
v_mfma_f32_16x16x32_bf16 v[68:71], a[0:3], a[36:39], v[68:71]
buffer_store_dwordx4 v[44:47], v2, s[12:15], s82 offen offset:1024 sc1
v_mfma_f32_16x16x32_bf16 v[72:75], a[8:11], a[32:35], v[72:75]
ds_read_b128 a[0:3], v60 offset:46080
v_cvt_pk_bf16_f32 v48, v154, v155
v_mfma_f32_16x16x32_bf16 v[72:75], a[12:15], a[40:43], v[72:75]
buffer_load_dwordx4 v2, s[40:43], s90 offen offset:1024 sc1 lds
v_mfma_f32_16x16x32_bf16 v[76:79], a[12:15], a[44:47], v[76:79]
ds_read_b128 a[4:7], v60 offset:56320
v_cvt_pk_bf16_f32 v49, v160, v161
v_mfma_f32_16x16x32_bf16 v[76:79], a[8:11], a[36:39], v[76:79]
v_cvt_pk_bf16_f32 v50, v162, v163
v_cvt_pk_bf16_f32 v51, v62, v62
v_mfma_f32_16x16x32_bf16 v[80:83], a[16:19], a[32:35], v[80:83]
s_waitcnt lgkmcnt(4)
ds_read_b128 a[8:11], v60 offset:47104
v_mfma_f32_16x16x32_bf16 v[80:83], a[20:23], a[40:43], v[80:83]
buffer_load_dwordx4 v2, s[40:43], s90 offen offset:2048 sc1 lds
v_mfma_f32_16x16x32_bf16 v[84:87], a[20:23], a[44:47], v[84:87]
ds_read_b128 a[12:15], v60 offset:57344
v_mfma_f32_16x16x32_bf16 v[84:87], a[16:19], a[36:39], v[84:87]
v_mfma_f32_16x16x32_bf16 v[88:91], a[24:27], a[32:35], v[88:91]
ds_read_b128 a[16:19], v60 offset:48128
v_mfma_f32_16x16x32_bf16 v[88:91], a[28:31], a[40:43], v[88:91]
buffer_load_dwordx4 v2, s[40:43], s90 offen offset:3072 sc1 lds
v_mfma_f32_16x16x32_bf16 v[92:95], a[28:31], a[44:47], v[92:95]
s_add_u32 m0, s88, 106496
ds_read_b128 a[20:23], v60 offset:58368
v_mfma_f32_16x16x32_bf16 v[92:95], a[24:27], a[36:39], v[92:95]
s_waitcnt lgkmcnt(4)
v_mfma_f32_16x16x32_bf16 v[96:99], a[240:243], a[32:35], v[96:99]
ds_read_b128 a[24:27], v60 offset:49152
v_mfma_f32_16x16x32_bf16 v[96:99], a[244:247], a[40:43], v[96:99]
buffer_load_dwordx4 v61, s[40:43], s90 offen offset:0 sc1 lds
v_mfma_f32_16x16x32_bf16 v[100:103], a[244:247], a[44:47], v[100:103]
s_add_u32 s89, s73, 32768
ds_read_b128 a[28:31], v60 offset:59392
v_mfma_f32_16x16x32_bf16 v[100:103], a[240:243], a[36:39], v[100:103]
buffer_store_dwordx4 v[48:51], v2, s[12:15], s82 offen offset:2048 sc1
v_mfma_f32_16x16x32_bf16 v[104:107], a[0:3], a[32:35], v[104:107]
ds_read_b128 a[240:243], v60 offset:50176
v_cvt_pk_bf16_f32 v240, v132, v133
v_mfma_f32_16x16x32_bf16 v[104:107], a[4:7], a[40:43], v[104:107]
buffer_load_dwordx4 a[208:211], v2, s[36:39], s89 offen offset:0 sc1
v_mfma_f32_16x16x32_bf16 v[108:111], a[4:7], a[44:47], v[108:111]
s_waitcnt lgkmcnt(4)
ds_read_b128 a[244:247], v60 offset:60416
v_add_u32 v60, 61440, v60
v_mfma_f32_16x16x32_bf16 v[108:111], a[0:3], a[36:39], v[108:111]
s_waitcnt vmcnt(18)
s_barrier
v_mfma_f32_16x16x32_bf16 v[112:115], a[8:11], a[32:35], v[112:115]
ds_read_b128 a[0:3], v60 offset:0
v_cvt_pk_bf16_f32 v241, v134, v135
v_mfma_f32_16x16x32_bf16 v[112:115], a[12:15], a[40:43], v[112:115]
buffer_load_dwordx4 a[212:215], v2, s[36:39], s89 offen offset:1024 sc1
v_mfma_f32_16x16x32_bf16 v[116:119], a[12:15], a[44:47], v[116:119]
ds_read_b128 a[4:7], v60 offset:10240
v_cvt_pk_bf16_f32 v242, v140, v141
v_mfma_f32_16x16x32_bf16 v[116:119], a[8:11], a[36:39], v[116:119]
v_cvt_pk_bf16_f32 v243, v142, v62
v_mfma_f32_16x16x32_bf16 v[120:123], a[16:19], a[32:35], v[120:123]
s_waitcnt lgkmcnt(4)
ds_read_b128 a[8:11], v60 offset:1024
v_mfma_f32_16x16x32_bf16 v[120:123], a[20:23], a[40:43], v[120:123]
buffer_load_dwordx4 a[216:219], v61, s[36:39], s89 offen offset:0 sc1
v_mfma_f32_16x16x32_bf16 v[124:127], a[20:23], a[44:47], v[124:127]
ds_read_b128 a[12:15], v60 offset:11264
v_mfma_f32_16x16x32_bf16 v[124:127], a[16:19], a[36:39], v[124:127]
v_mfma_f32_16x16x32_bf16 v[208:211], a[24:27], a[32:35], v[208:211]
s_waitcnt lgkmcnt(4)
ds_read_b128 a[16:19], v60 offset:2048
v_mfma_f32_16x16x32_bf16 v[208:211], a[28:31], a[40:43], v[208:211]
buffer_load_dwordx4 a[220:223], v61, s[36:39], s89 offen offset:1024 sc1
v_mfma_f32_16x16x32_bf16 v[212:215], a[28:31], a[44:47], v[212:215]
s_add_u32 s90, s75, 102400
s_add_u32 m0, s88, 0
ds_read_b128 a[20:23], v60 offset:12288
v_mfma_f32_16x16x32_bf16 v[212:215], a[24:27], a[36:39], v[212:215]
buffer_store_dwordx4 v[240:243], v2, s[12:15], s82 offen offset:3072 sc1
v_mfma_f32_16x16x32_bf16 v[216:219], a[240:243], a[32:35], v[216:219]
ds_read_b128 a[24:27], v60 offset:3072
v_cvt_pk_bf16_f32 v244, v143, v148
v_mfma_f32_16x16x32_bf16 v[216:219], a[244:247], a[40:43], v[216:219]
buffer_load_dwordx4 v2, s[40:43], s90 offen offset:0 sc1 lds
v_mfma_f32_16x16x32_bf16 v[220:223], a[244:247], a[44:47], v[220:223]
ds_read_b128 a[28:31], v60 offset:13312
v_cvt_pk_bf16_f32 v245, v149, v150
v_mfma_f32_16x16x32_bf16 v[220:223], a[240:243], a[36:39], v[220:223]
s_waitcnt lgkmcnt(4)
v_cvt_pk_bf16_f32 v246, v151, v156
v_cvt_pk_bf16_f32 v247, v157, v62
v_mfma_f32_16x16x32_bf16 v[64:67], a[0:3], a[48:51], v[64:67]
ds_read_b128 a[240:243], v60 offset:4096
v_mfma_f32_16x16x32_bf16 v[64:67], a[4:7], a[56:59], v[64:67]
buffer_load_dwordx4 v2, s[40:43], s90 offen offset:1024 sc1 lds
v_mfma_f32_16x16x32_bf16 v[68:71], a[4:7], a[60:63], v[68:71]
ds_read_b128 a[244:247], v60 offset:14336
v_mfma_f32_16x16x32_bf16 v[68:71], a[0:3], a[52:55], v[68:71]
v_mfma_f32_16x16x32_bf16 v[72:75], a[8:11], a[48:51], v[72:75]
ds_read_b128 a[0:3], v60 offset:5120
v_mfma_f32_16x16x32_bf16 v[72:75], a[12:15], a[56:59], v[72:75]
buffer_load_dwordx4 v2, s[40:43], s90 offen offset:2048 sc1 lds
v_mfma_f32_16x16x32_bf16 v[76:79], a[12:15], a[60:63], v[76:79]
ds_read_b128 a[4:7], v60 offset:15360
v_mfma_f32_16x16x32_bf16 v[76:79], a[8:11], a[52:55], v[76:79]
s_waitcnt lgkmcnt(4)
v_mfma_f32_16x16x32_bf16 v[80:83], a[16:19], a[48:51], v[80:83]
ds_read_b128 a[8:11], v60 offset:6144
v_mfma_f32_16x16x32_bf16 v[80:83], a[20:23], a[56:59], v[80:83]
buffer_load_dwordx4 v2, s[40:43], s90 offen offset:3072 sc1 lds
v_mfma_f32_16x16x32_bf16 v[84:87], a[20:23], a[60:63], v[84:87]
s_add_u32 m0, s88, 4096
ds_read_b128 a[12:15], v60 offset:16384
v_mfma_f32_16x16x32_bf16 v[84:87], a[16:19], a[52:55], v[84:87]
buffer_store_dwordx4 v[244:247], v61, s[12:15], s82 offen offset:0 sc1
v_mfma_f32_16x16x32_bf16 v[88:91], a[24:27], a[48:51], v[88:91]
ds_read_b128 a[16:19], v60 offset:7168
v_cvt_pk_bf16_f32 v248, v158, v159
v_mfma_f32_16x16x32_bf16 v[88:91], a[28:31], a[56:59], v[88:91]
buffer_load_dwordx4 v61, s[40:43], s90 offen offset:0 sc1 lds
v_mfma_f32_16x16x32_bf16 v[92:95], a[28:31], a[60:63], v[92:95]
s_add_u32 s89, s73, 40960
ds_read_b128 a[20:23], v60 offset:17408
v_cvt_pk_bf16_f32 v249, v164, v165
v_mfma_f32_16x16x32_bf16 v[92:95], a[24:27], a[52:55], v[92:95]
s_waitcnt lgkmcnt(4)
v_cvt_pk_bf16_f32 v250, v166, v167
v_cvt_pk_bf16_f32 v251, v62, v62
v_mfma_f32_16x16x32_bf16 v[96:99], a[240:243], a[48:51], v[96:99]
ds_read_b128 a[24:27], v60 offset:8192
v_mfma_f32_16x16x32_bf16 v[96:99], a[244:247], a[56:59], v[96:99]
buffer_load_dwordx4 a[224:227], v2, s[36:39], s89 offen offset:0 sc1
v_mfma_f32_16x16x32_bf16 v[100:103], a[244:247], a[60:63], v[100:103]
ds_read_b128 a[28:31], v60 offset:18432
v_mfma_f32_16x16x32_bf16 v[100:103], a[240:243], a[52:55], v[100:103]
v_mfma_f32_16x16x32_bf16 v[104:107], a[0:3], a[48:51], v[104:107]
ds_read_b128 a[240:243], v60 offset:9216
v_mfma_f32_16x16x32_bf16 v[104:107], a[4:7], a[56:59], v[104:107]
buffer_load_dwordx4 a[228:231], v2, s[36:39], s89 offen offset:1024 sc1
v_mfma_f32_16x16x32_bf16 v[108:111], a[4:7], a[60:63], v[108:111]
s_waitcnt lgkmcnt(4)
ds_read_b128 a[244:247], v60 offset:19456
v_mfma_f32_16x16x32_bf16 v[108:111], a[0:3], a[52:55], v[108:111]
s_waitcnt vmcnt(20)
s_barrier
v_mfma_f32_16x16x32_bf16 v[112:115], a[8:11], a[48:51], v[112:115]
ds_read_b128 a[0:3], v60 offset:20480
v_mfma_f32_16x16x32_bf16 v[112:115], a[12:15], a[56:59], v[112:115]
buffer_load_dwordx4 a[232:235], v61, s[36:39], s89 offen offset:0 sc1
v_mfma_f32_16x16x32_bf16 v[116:119], a[12:15], a[60:63], v[116:119]
s_waitcnt lgkmcnt(4)
ds_read_b128 a[4:7], v60 offset:30720
v_mfma_f32_16x16x32_bf16 v[116:119], a[8:11], a[52:55], v[116:119]
buffer_store_dwordx4 v[248:251], v61, s[12:15], s82 offen offset:1024 sc1
v_mfma_f32_16x16x32_bf16 v[120:123], a[16:19], a[48:51], v[120:123]
s_add_u32 s82, s17, 0
ds_read_b128 a[8:11], v60 offset:21504
v_cvt_pk_bf16_f32 v40, v168, v169
v_mfma_f32_16x16x32_bf16 v[120:123], a[20:23], a[56:59], v[120:123]
buffer_load_dwordx4 a[236:239], v61, s[36:39], s89 offen offset:1024 sc1
v_mfma_f32_16x16x32_bf16 v[124:127], a[20:23], a[60:63], v[124:127]
s_add_u32 s90, s75, 122880
s_add_u32 m0, s88, 20480
ds_read_b128 a[12:15], v60 offset:31744
v_cvt_pk_bf16_f32 v41, v170, v171
v_mfma_f32_16x16x32_bf16 v[124:127], a[16:19], a[52:55], v[124:127]
v_cvt_pk_bf16_f32 v42, v176, v177
v_cvt_pk_bf16_f32 v43, v178, v62
v_mfma_f32_16x16x32_bf16 v[208:211], a[24:27], a[48:51], v[208:211]
s_waitcnt lgkmcnt(4)
ds_read_b128 a[16:19], v60 offset:22528
v_mfma_f32_16x16x32_bf16 v[208:211], a[28:31], a[56:59], v[208:211]
buffer_load_dwordx4 v2, s[40:43], s90 offen offset:0 sc1 lds
v_mfma_f32_16x16x32_bf16 v[212:215], a[28:31], a[60:63], v[212:215]
ds_read_b128 a[20:23], v60 offset:32768
v_mfma_f32_16x16x32_bf16 v[212:215], a[24:27], a[52:55], v[212:215]
v_mfma_f32_16x16x32_bf16 v[216:219], a[240:243], a[48:51], v[216:219]
ds_read_b128 a[24:27], v60 offset:23552
v_mfma_f32_16x16x32_bf16 v[216:219], a[244:247], a[56:59], v[216:219]
buffer_load_dwordx4 v2, s[40:43], s90 offen offset:1024 sc1 lds
v_mfma_f32_16x16x32_bf16 v[220:223], a[244:247], a[60:63], v[220:223]
ds_read_b128 a[28:31], v60 offset:33792
v_mfma_f32_16x16x32_bf16 v[220:223], a[240:243], a[52:55], v[220:223]
s_waitcnt lgkmcnt(4)
v_mfma_f32_16x16x32_bf16 v[64:67], a[0:3], a[192:195], v[64:67]
ds_read_b128 a[240:243], v60 offset:24576
v_mfma_f32_16x16x32_bf16 v[64:67], a[4:7], a[200:203], v[64:67]
buffer_load_dwordx4 v2, s[40:43], s90 offen offset:2048 sc1 lds
v_mfma_f32_16x16x32_bf16 v[68:71], a[4:7], a[204:207], v[68:71]
ds_read_b128 a[244:247], v60 offset:34816
v_mfma_f32_16x16x32_bf16 v[68:71], a[0:3], a[196:199], v[68:71]
buffer_store_dwordx4 v[40:43], v2, s[12:15], s82 offen offset:0 sc1
v_mfma_f32_16x16x32_bf16 v[72:75], a[8:11], a[192:195], v[72:75]
ds_read_b128 a[0:3], v60 offset:25600
v_cvt_pk_bf16_f32 v44, v179, v184
v_mfma_f32_16x16x32_bf16 v[72:75], a[12:15], a[200:203], v[72:75]
buffer_load_dwordx4 v2, s[40:43], s90 offen offset:3072 sc1 lds
v_mfma_f32_16x16x32_bf16 v[76:79], a[12:15], a[204:207], v[76:79]
s_add_u32 m0, s88, 24576
ds_read_b128 a[4:7], v60 offset:35840
v_cvt_pk_bf16_f32 v45, v185, v186
v_mfma_f32_16x16x32_bf16 v[76:79], a[8:11], a[196:199], v[76:79]
s_waitcnt lgkmcnt(4)
v_cvt_pk_bf16_f32 v46, v187, v192
v_cvt_pk_bf16_f32 v47, v193, v62
v_mfma_f32_16x16x32_bf16 v[80:83], a[16:19], a[192:195], v[80:83]
ds_read_b128 a[8:11], v60 offset:26624
v_mfma_f32_16x16x32_bf16 v[80:83], a[20:23], a[200:203], v[80:83]
buffer_load_dwordx4 v61, s[40:43], s90 offen offset:0 sc1 lds
v_mfma_f32_16x16x32_bf16 v[84:87], a[20:23], a[204:207], v[84:87]
s_add_u32 s89, s73, 49152
ds_read_b128 a[12:15], v60 offset:36864
v_mfma_f32_16x16x32_bf16 v[84:87], a[16:19], a[196:199], v[84:87]
v_mfma_f32_16x16x32_bf16 v[88:91], a[24:27], a[192:195], v[88:91]
ds_read_b128 a[16:19], v60 offset:27648
v_mfma_f32_16x16x32_bf16 v[88:91], a[28:31], a[200:203], v[88:91]
buffer_load_dwordx4 a[32:35], v2, s[36:39], s89 offen offset:0 sc1
v_mfma_f32_16x16x32_bf16 v[92:95], a[28:31], a[204:207], v[92:95]
ds_read_b128 a[20:23], v60 offset:37888
v_mfma_f32_16x16x32_bf16 v[92:95], a[24:27], a[196:199], v[92:95]
s_waitcnt lgkmcnt(4)
v_mfma_f32_16x16x32_bf16 v[96:99], a[240:243], a[192:195], v[96:99]
ds_read_b128 a[24:27], v60 offset:28672
v_mfma_f32_16x16x32_bf16 v[96:99], a[244:247], a[200:203], v[96:99]
buffer_load_dwordx4 a[36:39], v2, s[36:39], s89 offen offset:1024 sc1
v_mfma_f32_16x16x32_bf16 v[100:103], a[244:247], a[204:207], v[100:103]
ds_read_b128 a[28:31], v60 offset:38912
v_mfma_f32_16x16x32_bf16 v[100:103], a[240:243], a[196:199], v[100:103]
buffer_store_dwordx4 v[44:47], v2, s[12:15], s82 offen offset:1024 sc1
v_mfma_f32_16x16x32_bf16 v[104:107], a[0:3], a[192:195], v[104:107]
ds_read_b128 a[240:243], v60 offset:29696
v_cvt_pk_bf16_f32 v48, v194, v195
v_mfma_f32_16x16x32_bf16 v[104:107], a[4:7], a[200:203], v[104:107]
buffer_load_dwordx4 a[40:43], v61, s[36:39], s89 offen offset:0 sc1
v_mfma_f32_16x16x32_bf16 v[108:111], a[4:7], a[204:207], v[108:111]
s_waitcnt lgkmcnt(4)
ds_read_b128 a[244:247], v60 offset:39936
v_cvt_pk_bf16_f32 v49, v200, v201
v_mfma_f32_16x16x32_bf16 v[108:111], a[0:3], a[196:199], v[108:111]
s_waitcnt vmcnt(22)
s_barrier
v_mfma_f32_16x16x32_bf16 v[112:115], a[8:11], a[192:195], v[112:115]
ds_read_b128 a[0:3], v60 offset:40960
v_cvt_pk_bf16_f32 v50, v202, v203
v_mfma_f32_16x16x32_bf16 v[112:115], a[12:15], a[200:203], v[112:115]
buffer_load_dwordx4 a[44:47], v61, s[36:39], s89 offen offset:1024 sc1
v_mfma_f32_16x16x32_bf16 v[116:119], a[12:15], a[204:207], v[116:119]
s_add_u32 s90, s75, 143360
s_add_u32 m0, s88, 40960
ds_read_b128 a[4:7], v60 offset:51200
v_cvt_pk_bf16_f32 v51, v62, v62
v_mfma_f32_16x16x32_bf16 v[116:119], a[8:11], a[196:199], v[116:119]
v_mfma_f32_16x16x32_bf16 v[120:123], a[16:19], a[192:195], v[120:123]
s_waitcnt lgkmcnt(4)
ds_read_b128 a[8:11], v60 offset:41984
v_mfma_f32_16x16x32_bf16 v[120:123], a[20:23], a[200:203], v[120:123]
buffer_load_dwordx4 v2, s[40:43], s90 offen offset:0 sc1 lds
v_mfma_f32_16x16x32_bf16 v[124:127], a[20:23], a[204:207], v[124:127]
ds_read_b128 a[12:15], v60 offset:52224
v_mfma_f32_16x16x32_bf16 v[124:127], a[16:19], a[196:199], v[124:127]
v_mfma_f32_16x16x32_bf16 v[208:211], a[24:27], a[192:195], v[208:211]
ds_read_b128 a[16:19], v60 offset:43008
v_mfma_f32_16x16x32_bf16 v[208:211], a[28:31], a[200:203], v[208:211]
buffer_load_dwordx4 v2, s[40:43], s90 offen offset:1024 sc1 lds
v_mfma_f32_16x16x32_bf16 v[212:215], a[28:31], a[204:207], v[212:215]
s_waitcnt lgkmcnt(4)
ds_read_b128 a[20:23], v60 offset:53248
v_mfma_f32_16x16x32_bf16 v[212:215], a[24:27], a[196:199], v[212:215]
buffer_store_dwordx4 v[48:51], v2, s[12:15], s82 offen offset:2048 sc1
v_mfma_f32_16x16x32_bf16 v[216:219], a[240:243], a[192:195], v[216:219]
ds_read_b128 a[24:27], v60 offset:44032
v_cvt_pk_bf16_f32 v240, v172, v173
v_mfma_f32_16x16x32_bf16 v[216:219], a[244:247], a[200:203], v[216:219]
buffer_load_dwordx4 v2, s[40:43], s90 offen offset:2048 sc1 lds
v_mfma_f32_16x16x32_bf16 v[220:223], a[244:247], a[204:207], v[220:223]
ds_read_b128 a[28:31], v60 offset:54272
v_cvt_pk_bf16_f32 v241, v174, v175
v_mfma_f32_16x16x32_bf16 v[220:223], a[240:243], a[196:199], v[220:223]
v_cvt_pk_bf16_f32 v242, v180, v181
v_cvt_pk_bf16_f32 v243, v182, v62
v_mfma_f32_16x16x32_bf16 v[64:67], a[0:3], a[208:211], v[64:67]
s_waitcnt lgkmcnt(4)
ds_read_b128 a[240:243], v60 offset:45056
v_mfma_f32_16x16x32_bf16 v[64:67], a[4:7], a[216:219], v[64:67]
buffer_load_dwordx4 v2, s[40:43], s90 offen offset:3072 sc1 lds
v_mfma_f32_16x16x32_bf16 v[68:71], a[4:7], a[220:223], v[68:71]
s_add_u32 m0, s88, 45056
ds_read_b128 a[244:247], v60 offset:55296
v_mfma_f32_16x16x32_bf16 v[68:71], a[0:3], a[212:215], v[68:71]
v_mfma_f32_16x16x32_bf16 v[72:75], a[8:11], a[208:211], v[72:75]
ds_read_b128 a[0:3], v60 offset:46080
v_mfma_f32_16x16x32_bf16 v[72:75], a[12:15], a[216:219], v[72:75]
buffer_load_dwordx4 v61, s[40:43], s90 offen offset:0 sc1 lds
v_mfma_f32_16x16x32_bf16 v[76:79], a[12:15], a[220:223], v[76:79]
s_add_u32 s89, s73, 57344
ds_read_b128 a[4:7], v60 offset:56320
v_mfma_f32_16x16x32_bf16 v[76:79], a[8:11], a[212:215], v[76:79]
s_waitcnt lgkmcnt(4)
v_mfma_f32_16x16x32_bf16 v[80:83], a[16:19], a[208:211], v[80:83]
ds_read_b128 a[8:11], v60 offset:47104
v_mfma_f32_16x16x32_bf16 v[80:83], a[20:23], a[216:219], v[80:83]
buffer_load_dwordx4 a[48:51], v2, s[36:39], s89 offen offset:0 sc1
v_mfma_f32_16x16x32_bf16 v[84:87], a[20:23], a[220:223], v[84:87]
ds_read_b128 a[12:15], v60 offset:57344
v_mfma_f32_16x16x32_bf16 v[84:87], a[16:19], a[212:215], v[84:87]
buffer_store_dwordx4 v[240:243], v2, s[12:15], s82 offen offset:3072 sc1
v_mfma_f32_16x16x32_bf16 v[88:91], a[24:27], a[208:211], v[88:91]
ds_read_b128 a[16:19], v60 offset:48128
v_cvt_pk_bf16_f32 v244, v183, v188
v_mfma_f32_16x16x32_bf16 v[88:91], a[28:31], a[216:219], v[88:91]
buffer_load_dwordx4 a[52:55], v2, s[36:39], s89 offen offset:1024 sc1
v_mfma_f32_16x16x32_bf16 v[92:95], a[28:31], a[220:223], v[92:95]
ds_read_b128 a[20:23], v60 offset:58368
v_cvt_pk_bf16_f32 v245, v189, v190
v_mfma_f32_16x16x32_bf16 v[92:95], a[24:27], a[212:215], v[92:95]
s_waitcnt lgkmcnt(4)
v_cvt_pk_bf16_f32 v246, v191, v196
v_cvt_pk_bf16_f32 v247, v197, v62
v_mfma_f32_16x16x32_bf16 v[96:99], a[240:243], a[208:211], v[96:99]
ds_read_b128 a[24:27], v60 offset:49152
v_mfma_f32_16x16x32_bf16 v[96:99], a[244:247], a[216:219], v[96:99]
buffer_load_dwordx4 a[56:59], v61, s[36:39], s89 offen offset:0 sc1
v_mfma_f32_16x16x32_bf16 v[100:103], a[244:247], a[220:223], v[100:103]
ds_read_b128 a[28:31], v60 offset:59392
v_mfma_f32_16x16x32_bf16 v[100:103], a[240:243], a[212:215], v[100:103]
v_mfma_f32_16x16x32_bf16 v[104:107], a[0:3], a[208:211], v[104:107]
s_waitcnt lgkmcnt(4)
ds_read_b128 a[240:243], v60 offset:50176
v_mfma_f32_16x16x32_bf16 v[104:107], a[4:7], a[216:219], v[104:107]
buffer_load_dwordx4 a[60:63], v61, s[36:39], s89 offen offset:1024 sc1
v_mfma_f32_16x16x32_bf16 v[108:111], a[4:7], a[220:223], v[108:111]
s_add_u32 s90, s75, 163840
s_add_u32 m0, s88, 61440
ds_read_b128 a[244:247], v60 offset:60416
v_subrev_u32 v60, 61440, v60
v_mfma_f32_16x16x32_bf16 v[108:111], a[0:3], a[212:215], v[108:111]
s_waitcnt vmcnt(22)
s_barrier
v_mfma_f32_16x16x32_bf16 v[112:115], a[8:11], a[208:211], v[112:115]
ds_read_b128 a[0:3], v60 offset:0
v_mfma_f32_16x16x32_bf16 v[112:115], a[12:15], a[216:219], v[112:115]
buffer_load_dwordx4 v2, s[40:43], s90 offen offset:0 sc1 lds
v_mfma_f32_16x16x32_bf16 v[116:119], a[12:15], a[220:223], v[116:119]
s_waitcnt lgkmcnt(4)
ds_read_b128 a[4:7], v60 offset:10240
v_mfma_f32_16x16x32_bf16 v[116:119], a[8:11], a[212:215], v[116:119]
buffer_store_dwordx4 v[244:247], v61, s[12:15], s82 offen offset:0 sc1
v_mfma_f32_16x16x32_bf16 v[120:123], a[16:19], a[208:211], v[120:123]
ds_read_b128 a[8:11], v60 offset:1024
v_cvt_pk_bf16_f32 v248, v198, v199
v_mfma_f32_16x16x32_bf16 v[120:123], a[20:23], a[216:219], v[120:123]
buffer_load_dwordx4 v2, s[40:43], s90 offen offset:1024 sc1 lds
v_mfma_f32_16x16x32_bf16 v[124:127], a[20:23], a[220:223], v[124:127]
ds_read_b128 a[12:15], v60 offset:11264
v_cvt_pk_bf16_f32 v249, v204, v205
v_mfma_f32_16x16x32_bf16 v[124:127], a[16:19], a[212:215], v[124:127]
v_cvt_pk_bf16_f32 v250, v206, v207
v_cvt_pk_bf16_f32 v251, v62, v62
v_mfma_f32_16x16x32_bf16 v[208:211], a[24:27], a[208:211], v[208:211]
s_waitcnt lgkmcnt(4)
ds_read_b128 a[16:19], v60 offset:2048
v_mfma_f32_16x16x32_bf16 v[208:211], a[28:31], a[216:219], v[208:211]
buffer_load_dwordx4 v2, s[40:43], s90 offen offset:2048 sc1 lds
v_mfma_f32_16x16x32_bf16 v[212:215], a[28:31], a[220:223], v[212:215]
ds_read_b128 a[20:23], v60 offset:12288
v_mfma_f32_16x16x32_bf16 v[212:215], a[24:27], a[212:215], v[212:215]
v_mfma_f32_16x16x32_bf16 v[216:219], a[240:243], a[208:211], v[216:219]
ds_read_b128 a[24:27], v60 offset:3072
v_mfma_f32_16x16x32_bf16 v[216:219], a[244:247], a[216:219], v[216:219]
buffer_load_dwordx4 v2, s[40:43], s90 offen offset:3072 sc1 lds
v_mfma_f32_16x16x32_bf16 v[220:223], a[244:247], a[220:223], v[220:223]
s_add_u32 m0, s88, 65536
ds_read_b128 a[28:31], v60 offset:13312
v_mfma_f32_16x16x32_bf16 v[220:223], a[240:243], a[212:215], v[220:223]
s_waitcnt lgkmcnt(4)
v_mfma_f32_16x16x32_bf16 v[64:67], a[0:3], a[224:227], v[64:67]
s_waitcnt lgkmcnt(3)
ds_read_b128 a[240:243], v60 offset:4096
v_mfma_f32_16x16x32_bf16 v[64:67], a[4:7], a[232:235], v[64:67]
buffer_load_dwordx4 v61, s[40:43], s90 offen offset:0 sc1 lds
v_mfma_f32_16x16x32_bf16 v[68:71], a[4:7], a[236:239], v[68:71]
s_add_u32 s89, s73, 65536
ds_read_b128 a[244:247], v60 offset:14336
v_mfma_f32_16x16x32_bf16 v[68:71], a[0:3], a[228:231], v[68:71]
buffer_store_dwordx4 v[248:251], v61, s[12:15], s82 offen offset:1024 sc1
v_mfma_f32_16x16x32_bf16 v[72:75], a[8:11], a[224:227], v[72:75]
s_getpc_b64 s[84:85]
CODE4:
s_add_u32 s84, s84, K_END-CODE4-8192
s_addc_u32 s85, s85, 0
ds_read_b128 a[0:3], v60 offset:5120
v_add_u32 v52, 122880, v3
s_cmp_lg_u32 s16, 0x1000000
s_cbranch_scc1 NOOWN00
ds_write_b128 v52, v[128:131] offset:0
ds_write_b128 v52, v[136:139] offset:1024
ds_write_b128 v52, v[144:147] offset:2048
ds_write_b128 v52, v[152:155] offset:3072
ds_write_b128 v52, v[160:163] offset:4096
ds_write_b128 v52, v[132:135] offset:5120
ds_write_b128 v52, v[140:143] offset:6144
ds_write_b128 v52, v[148:151] offset:7168
ds_write_b128 v52, v[156:159] offset:8192
ds_write_b128 v52, v[164:167] offset:9216
NOOWN00:
s_cmp_lg_u32 s17, 0x1000000
s_cbranch_scc1 NOOWN01
ds_write_b128 v52, v[168:171] offset:0
ds_write_b128 v52, v[176:179] offset:1024
ds_write_b128 v52, v[184:187] offset:2048
ds_write_b128 v52, v[192:195] offset:3072
ds_write_b128 v52, v[200:203] offset:4096
ds_write_b128 v52, v[172:175] offset:5120
ds_write_b128 v52, v[180:183] offset:6144
ds_write_b128 v52, v[188:191] offset:7168
ds_write_b128 v52, v[196:199] offset:8192
ds_write_b128 v52, v[204:207] offset:9216
NOOWN01:
v_mfma_f32_16x16x32_bf16 v[72:75], a[12:15], a[232:235], v[72:75]
buffer_load_dwordx4 a[192:195], v2, s[36:39], s89 offen offset:0 sc1
v_mfma_f32_16x16x32_bf16 v[76:79], a[12:15], a[236:239], v[76:79]
s_lshr_b32 s80, s2, 3
s_lshl2_add_u32 s80, s80, s68
ds_read_b128 a[4:7], v60 offset:15360
v_mfma_f32_16x16x32_bf16 v[76:79], a[8:11], a[228:231], v[76:79]
s_min_u32 s80, s80, 63
s_lshl_b32 s80, s80, 7
v_mov_b32 v37, s80
v_mfma_f32_16x16x32_bf16 v[80:83], a[16:19], a[224:227], v[80:83]
s_waitcnt lgkmcnt(4)
ds_read_b128 a[8:11], v60 offset:6144
v_mfma_f32_16x16x32_bf16 v[80:83], a[20:23], a[232:235], v[80:83]
buffer_load_dwordx4 a[196:199], v2, s[36:39], s89 offen offset:1024 sc1
v_mfma_f32_16x16x32_bf16 v[84:87], a[20:23], a[236:239], v[84:87]
ds_read_b128 a[12:15], v60 offset:16384
v_mfma_f32_16x16x32_bf16 v[84:87], a[16:19], a[228:231], v[84:87]
global_load_dword v18, v37, s[84:85]
v_mfma_f32_16x16x32_bf16 v[88:91], a[24:27], a[224:227], v[88:91]
ds_read_b128 a[16:19], v60 offset:7168
v_mfma_f32_16x16x32_bf16 v[88:91], a[28:31], a[232:235], v[88:91]
buffer_load_dwordx4 a[200:203], v61, s[36:39], s89 offen offset:0 sc1
v_mfma_f32_16x16x32_bf16 v[92:95], a[28:31], a[236:239], v[92:95]
ds_read_b128 a[20:23], v60 offset:17408
v_mfma_f32_16x16x32_bf16 v[92:95], a[24:27], a[228:231], v[92:95]
s_waitcnt lgkmcnt(4)
v_mfma_f32_16x16x32_bf16 v[96:99], a[240:243], a[224:227], v[96:99]
ds_read_b128 a[24:27], v60 offset:8192
v_mfma_f32_16x16x32_bf16 v[96:99], a[244:247], a[232:235], v[96:99]
buffer_load_dwordx4 a[204:207], v61, s[36:39], s89 offen offset:1024 sc1
v_mfma_f32_16x16x32_bf16 v[100:103], a[244:247], a[236:239], v[100:103]
s_add_u32 s90, s75, 184320
s_add_u32 m0, s88, 81920
ds_read_b128 a[28:31], v60 offset:18432
v_mfma_f32_16x16x32_bf16 v[100:103], a[240:243], a[228:231], v[100:103]
v_mfma_f32_16x16x32_bf16 v[104:107], a[0:3], a[224:227], v[104:107]
ds_read_b128 a[240:243], v60 offset:9216
v_mfma_f32_16x16x32_bf16 v[104:107], a[4:7], a[232:235], v[104:107]
buffer_load_dwordx4 v2, s[40:43], s90 offen offset:0 sc1 lds
v_mfma_f32_16x16x32_bf16 v[108:111], a[4:7], a[236:239], v[108:111]
s_waitcnt lgkmcnt(4)
ds_read_b128 a[244:247], v60 offset:19456
v_mfma_f32_16x16x32_bf16 v[108:111], a[0:3], a[228:231], v[108:111]
s_waitcnt vmcnt(24)
s_barrier
v_mfma_f32_16x16x32_bf16 v[112:115], a[8:11], a[224:227], v[112:115]
ds_read_b128 a[0:3], v60 offset:20480
v_mfma_f32_16x16x32_bf16 v[112:115], a[12:15], a[232:235], v[112:115]
buffer_load_dwordx4 v2, s[40:43], s90 offen offset:1024 sc1 lds
v_mfma_f32_16x16x32_bf16 v[116:119], a[12:15], a[236:239], v[116:119]
ds_read_b128 a[4:7], v60 offset:30720
v_mfma_f32_16x16x32_bf16 v[116:119], a[8:11], a[228:231], v[116:119]
v_mfma_f32_16x16x32_bf16 v[120:123], a[16:19], a[224:227], v[120:123]
s_waitcnt lgkmcnt(4)
ds_read_b128 a[8:11], v60 offset:21504
v_mfma_f32_16x16x32_bf16 v[120:123], a[20:23], a[232:235], v[120:123]
buffer_load_dwordx4 v2, s[40:43], s90 offen offset:2048 sc1 lds
v_mfma_f32_16x16x32_bf16 v[124:127], a[20:23], a[236:239], v[124:127]
ds_read_b128 a[12:15], v60 offset:31744
v_mfma_f32_16x16x32_bf16 v[124:127], a[16:19], a[228:231], v[124:127]
v_mfma_f32_16x16x32_bf16 v[208:211], a[24:27], a[224:227], v[208:211]
ds_read_b128 a[16:19], v60 offset:22528
v_mfma_f32_16x16x32_bf16 v[208:211], a[28:31], a[232:235], v[208:211]
buffer_load_dwordx4 v2, s[40:43], s90 offen offset:3072 sc1 lds
v_mfma_f32_16x16x32_bf16 v[212:215], a[28:31], a[236:239], v[212:215]
s_add_u32 m0, s88, 86016
ds_read_b128 a[20:23], v60 offset:32768
v_mfma_f32_16x16x32_bf16 v[212:215], a[24:27], a[228:231], v[212:215]
s_waitcnt lgkmcnt(4)
v_mfma_f32_16x16x32_bf16 v[216:219], a[240:243], a[224:227], v[216:219]
ds_read_b128 a[24:27], v60 offset:23552
v_mfma_f32_16x16x32_bf16 v[216:219], a[244:247], a[232:235], v[216:219]
buffer_load_dwordx4 v61, s[40:43], s90 offen offset:0 sc1 lds
v_mfma_f32_16x16x32_bf16 v[220:223], a[244:247], a[236:239], v[220:223]
s_add_u32 s89, s73, 73728
ds_read_b128 a[28:31], v60 offset:33792
v_mfma_f32_16x16x32_bf16 v[220:223], a[240:243], a[228:231], v[220:223]
v_mfma_f32_16x16x32_bf16 v[64:67], a[0:3], a[32:35], v[64:67]
ds_read_b128 a[240:243], v60 offset:24576
v_mfma_f32_16x16x32_bf16 v[64:67], a[4:7], a[40:43], v[64:67]
buffer_load_dwordx4 a[208:211], v2, s[36:39], s89 offen offset:0 sc1
v_mfma_f32_16x16x32_bf16 v[68:71], a[4:7], a[44:47], v[68:71]
ds_read_b128 a[244:247], v60 offset:34816
v_mfma_f32_16x16x32_bf16 v[68:71], a[0:3], a[36:39], v[68:71]
s_waitcnt lgkmcnt(4)
v_mfma_f32_16x16x32_bf16 v[72:75], a[8:11], a[32:35], v[72:75]
ds_read_b128 a[0:3], v60 offset:25600
v_mfma_f32_16x16x32_bf16 v[72:75], a[12:15], a[40:43], v[72:75]
buffer_load_dwordx4 a[212:215], v2, s[36:39], s89 offen offset:1024 sc1
v_mfma_f32_16x16x32_bf16 v[76:79], a[12:15], a[44:47], v[76:79]
ds_read_b128 a[4:7], v60 offset:35840
v_mfma_f32_16x16x32_bf16 v[76:79], a[8:11], a[36:39], v[76:79]
v_mfma_f32_16x16x32_bf16 v[80:83], a[16:19], a[32:35], v[80:83]
ds_read_b128 a[8:11], v60 offset:26624
v_mfma_f32_16x16x32_bf16 v[80:83], a[20:23], a[40:43], v[80:83]
buffer_load_dwordx4 a[216:219], v61, s[36:39], s89 offen offset:0 sc1
v_mfma_f32_16x16x32_bf16 v[84:87], a[20:23], a[44:47], v[84:87]
ds_read_b128 a[12:15], v60 offset:36864
v_mfma_f32_16x16x32_bf16 v[84:87], a[16:19], a[36:39], v[84:87]
s_waitcnt lgkmcnt(4)
v_mfma_f32_16x16x32_bf16 v[88:91], a[24:27], a[32:35], v[88:91]
ds_read_b128 a[16:19], v60 offset:27648
v_mfma_f32_16x16x32_bf16 v[88:91], a[28:31], a[40:43], v[88:91]
buffer_load_dwordx4 a[220:223], v61, s[36:39], s89 offen offset:1024 sc1
v_mfma_f32_16x16x32_bf16 v[92:95], a[28:31], a[44:47], v[92:95]
s_add_u32 s90, s75, 204800
s_add_u32 m0, s88, 102400
ds_read_b128 a[20:23], v60 offset:37888
v_mfma_f32_16x16x32_bf16 v[92:95], a[24:27], a[36:39], v[92:95]
v_mfma_f32_16x16x32_bf16 v[96:99], a[240:243], a[32:35], v[96:99]
ds_read_b128 a[24:27], v60 offset:28672
v_mfma_f32_16x16x32_bf16 v[96:99], a[244:247], a[40:43], v[96:99]
buffer_load_dwordx4 v2, s[40:43], s90 offen offset:0 sc1 lds
v_mfma_f32_16x16x32_bf16 v[100:103], a[244:247], a[44:47], v[100:103]
ds_read_b128 a[28:31], v60 offset:38912
v_mfma_f32_16x16x32_bf16 v[100:103], a[240:243], a[36:39], v[100:103]
s_waitcnt lgkmcnt(4)
v_mfma_f32_16x16x32_bf16 v[104:107], a[0:3], a[32:35], v[104:107]
ds_read_b128 a[240:243], v60 offset:29696
v_mfma_f32_16x16x32_bf16 v[104:107], a[4:7], a[40:43], v[104:107]
buffer_load_dwordx4 v2, s[40:43], s90 offen offset:1024 sc1 lds
v_mfma_f32_16x16x32_bf16 v[108:111], a[4:7], a[44:47], v[108:111]
ds_read_b128 a[244:247], v60 offset:39936
v_mfma_f32_16x16x32_bf16 v[108:111], a[0:3], a[36:39], v[108:111]
s_waitcnt vmcnt(23)
s_barrier
v_mfma_f32_16x16x32_bf16 v[112:115], a[8:11], a[32:35], v[112:115]
ds_read_b128 a[0:3], v60 offset:40960
v_mfma_f32_16x16x32_bf16 v[112:115], a[12:15], a[40:43], v[112:115]
buffer_load_dwordx4 v2, s[40:43], s90 offen offset:2048 sc1 lds
v_mfma_f32_16x16x32_bf16 v[116:119], a[12:15], a[44:47], v[116:119]
ds_read_b128 a[4:7], v60 offset:51200
v_mfma_f32_16x16x32_bf16 v[116:119], a[8:11], a[36:39], v[116:119]
s_waitcnt lgkmcnt(4)
v_mfma_f32_16x16x32_bf16 v[120:123], a[16:19], a[32:35], v[120:123]
ds_read_b128 a[8:11], v60 offset:41984
v_mfma_f32_16x16x32_bf16 v[120:123], a[20:23], a[40:43], v[120:123]
buffer_load_dwordx4 v2, s[40:43], s90 offen offset:3072 sc1 lds
v_mfma_f32_16x16x32_bf16 v[124:127], a[20:23], a[44:47], v[124:127]
s_add_u32 m0, s88, 106496
ds_read_b128 a[12:15], v60 offset:52224
v_mfma_f32_16x16x32_bf16 v[124:127], a[16:19], a[36:39], v[124:127]
v_mfma_f32_16x16x32_bf16 v[208:211], a[24:27], a[32:35], v[208:211]
ds_read_b128 a[16:19], v60 offset:43008
v_mfma_f32_16x16x32_bf16 v[208:211], a[28:31], a[40:43], v[208:211]
buffer_load_dwordx4 v61, s[40:43], s90 offen offset:0 sc1 lds
v_mfma_f32_16x16x32_bf16 v[212:215], a[28:31], a[44:47], v[212:215]
s_add_u32 s89, s73, 81920
ds_read_b128 a[20:23], v60 offset:53248
v_mfma_f32_16x16x32_bf16 v[212:215], a[24:27], a[36:39], v[212:215]
s_waitcnt lgkmcnt(4)
v_mfma_f32_16x16x32_bf16 v[216:219], a[240:243], a[32:35], v[216:219]
ds_read_b128 a[24:27], v60 offset:44032
v_mfma_f32_16x16x32_bf16 v[216:219], a[244:247], a[40:43], v[216:219]
buffer_load_dwordx4 a[224:227], v2, s[36:39], s89 offen offset:0 sc1
v_mfma_f32_16x16x32_bf16 v[220:223], a[244:247], a[44:47], v[220:223]
ds_read_b128 a[28:31], v60 offset:54272
v_mfma_f32_16x16x32_bf16 v[220:223], a[240:243], a[36:39], v[220:223]
v_mfma_f32_16x16x32_bf16 v[64:67], a[0:3], a[48:51], v[64:67]
ds_read_b128 a[240:243], v60 offset:45056
v_mfma_f32_16x16x32_bf16 v[64:67], a[4:7], a[56:59], v[64:67]
buffer_load_dwordx4 a[228:231], v2, s[36:39], s89 offen offset:1024 sc1
v_mfma_f32_16x16x32_bf16 v[68:71], a[4:7], a[60:63], v[68:71]
ds_read_b128 a[244:247], v60 offset:55296
v_mfma_f32_16x16x32_bf16 v[68:71], a[0:3], a[52:55], v[68:71]
s_waitcnt lgkmcnt(4)
v_mfma_f32_16x16x32_bf16 v[72:75], a[8:11], a[48:51], v[72:75]
ds_read_b128 a[0:3], v60 offset:46080
v_mfma_f32_16x16x32_bf16 v[72:75], a[12:15], a[56:59], v[72:75]
buffer_load_dwordx4 a[232:235], v61, s[36:39], s89 offen offset:0 sc1
v_mfma_f32_16x16x32_bf16 v[76:79], a[12:15], a[60:63], v[76:79]
ds_read_b128 a[4:7], v60 offset:56320
v_mfma_f32_16x16x32_bf16 v[76:79], a[8:11], a[52:55], v[76:79]
v_mfma_f32_16x16x32_bf16 v[80:83], a[16:19], a[48:51], v[80:83]
ds_read_b128 a[8:11], v60 offset:47104
v_mfma_f32_16x16x32_bf16 v[80:83], a[20:23], a[56:59], v[80:83]
buffer_load_dwordx4 a[236:239], v61, s[36:39], s89 offen offset:1024 sc1
v_mfma_f32_16x16x32_bf16 v[84:87], a[20:23], a[60:63], v[84:87]
s_add_u32 s90, s75, 225280
s_add_u32 m0, s88, 0
ds_read_b128 a[12:15], v60 offset:57344
v_mfma_f32_16x16x32_bf16 v[84:87], a[16:19], a[52:55], v[84:87]
s_waitcnt lgkmcnt(4)
v_mfma_f32_16x16x32_bf16 v[88:91], a[24:27], a[48:51], v[88:91]
ds_read_b128 a[16:19], v60 offset:48128
v_mfma_f32_16x16x32_bf16 v[88:91], a[28:31], a[56:59], v[88:91]
buffer_load_dwordx4 v2, s[40:43], s90 offen offset:0 sc1 lds
v_mfma_f32_16x16x32_bf16 v[92:95], a[28:31], a[60:63], v[92:95]
ds_read_b128 a[20:23], v60 offset:58368
v_mfma_f32_16x16x32_bf16 v[92:95], a[24:27], a[52:55], v[92:95]
v_mfma_f32_16x16x32_bf16 v[96:99], a[240:243], a[48:51], v[96:99]
ds_read_b128 a[24:27], v60 offset:49152
v_mfma_f32_16x16x32_bf16 v[96:99], a[244:247], a[56:59], v[96:99]
buffer_load_dwordx4 v2, s[40:43], s90 offen offset:1024 sc1 lds
v_mfma_f32_16x16x32_bf16 v[100:103], a[244:247], a[60:63], v[100:103]
ds_read_b128 a[28:31], v60 offset:59392
v_mfma_f32_16x16x32_bf16 v[100:103], a[240:243], a[52:55], v[100:103]
s_waitcnt lgkmcnt(4)
v_mfma_f32_16x16x32_bf16 v[104:107], a[0:3], a[48:51], v[104:107]
ds_read_b128 a[240:243], v60 offset:50176
v_mfma_f32_16x16x32_bf16 v[104:107], a[4:7], a[56:59], v[104:107]
buffer_load_dwordx4 v2, s[40:43], s90 offen offset:2048 sc1 lds
v_mfma_f32_16x16x32_bf16 v[108:111], a[4:7], a[60:63], v[108:111]
ds_read_b128 a[244:247], v60 offset:60416
v_add_u32 v60, 61440, v60
v_mfma_f32_16x16x32_bf16 v[108:111], a[0:3], a[52:55], v[108:111]
s_waitcnt vmcnt(21)
s_barrier
v_mfma_f32_16x16x32_bf16 v[112:115], a[8:11], a[48:51], v[112:115]
ds_read_b128 a[0:3], v60 offset:0
v_mfma_f32_16x16x32_bf16 v[112:115], a[12:15], a[56:59], v[112:115]
buffer_load_dwordx4 v2, s[40:43], s90 offen offset:3072 sc1 lds
v_mfma_f32_16x16x32_bf16 v[116:119], a[12:15], a[60:63], v[116:119]
s_add_u32 m0, s88, 4096
ds_read_b128 a[4:7], v60 offset:10240
v_mfma_f32_16x16x32_bf16 v[116:119], a[8:11], a[52:55], v[116:119]
s_waitcnt lgkmcnt(4)
v_mfma_f32_16x16x32_bf16 v[120:123], a[16:19], a[48:51], v[120:123]
ds_read_b128 a[8:11], v60 offset:1024
v_mfma_f32_16x16x32_bf16 v[120:123], a[20:23], a[56:59], v[120:123]
buffer_load_dwordx4 v61, s[40:43], s90 offen offset:0 sc1 lds
v_mfma_f32_16x16x32_bf16 v[124:127], a[20:23], a[60:63], v[124:127]
s_add_u32 s89, s73, 90112
ds_read_b128 a[12:15], v60 offset:11264
v_mfma_f32_16x16x32_bf16 v[124:127], a[16:19], a[52:55], v[124:127]
v_mfma_f32_16x16x32_bf16 v[208:211], a[24:27], a[48:51], v[208:211]
ds_read_b128 a[16:19], v60 offset:2048
v_mfma_f32_16x16x32_bf16 v[208:211], a[28:31], a[56:59], v[208:211]
buffer_load_dwordx4 a[32:35], v2, s[36:39], s89 offen offset:0 sc1
v_mfma_f32_16x16x32_bf16 v[212:215], a[28:31], a[60:63], v[212:215]
ds_read_b128 a[20:23], v60 offset:12288
v_mfma_f32_16x16x32_bf16 v[212:215], a[24:27], a[52:55], v[212:215]
s_waitcnt lgkmcnt(4)
v_mfma_f32_16x16x32_bf16 v[216:219], a[240:243], a[48:51], v[216:219]
ds_read_b128 a[24:27], v60 offset:3072
v_mfma_f32_16x16x32_bf16 v[216:219], a[244:247], a[56:59], v[216:219]
buffer_load_dwordx4 a[36:39], v2, s[36:39], s89 offen offset:1024 sc1
v_mfma_f32_16x16x32_bf16 v[220:223], a[244:247], a[60:63], v[220:223]
ds_read_b128 a[28:31], v60 offset:13312
v_mfma_f32_16x16x32_bf16 v[220:223], a[240:243], a[52:55], v[220:223]
v_mfma_f32_16x16x32_bf16 v[64:67], a[0:3], a[192:195], v[64:67]
ds_read_b128 a[240:243], v60 offset:4096
v_mfma_f32_16x16x32_bf16 v[64:67], a[4:7], a[200:203], v[64:67]
buffer_load_dwordx4 a[40:43], v61, s[36:39], s89 offen offset:0 sc1
v_mfma_f32_16x16x32_bf16 v[68:71], a[4:7], a[204:207], v[68:71]
ds_read_b128 a[244:247], v60 offset:14336
v_mfma_f32_16x16x32_bf16 v[68:71], a[0:3], a[196:199], v[68:71]
s_waitcnt lgkmcnt(4)
v_mfma_f32_16x16x32_bf16 v[72:75], a[8:11], a[192:195], v[72:75]
ds_read_b128 a[0:3], v60 offset:5120
v_mfma_f32_16x16x32_bf16 v[72:75], a[12:15], a[200:203], v[72:75]
buffer_load_dwordx4 a[44:47], v61, s[36:39], s89 offen offset:1024 sc1
v_mfma_f32_16x16x32_bf16 v[76:79], a[12:15], a[204:207], v[76:79]
s_add_u32 s90, s75, 245760
s_add_u32 m0, s88, 20480
ds_read_b128 a[4:7], v60 offset:15360
v_mfma_f32_16x16x32_bf16 v[76:79], a[8:11], a[196:199], v[76:79]
v_mfma_f32_16x16x32_bf16 v[80:83], a[16:19], a[192:195], v[80:83]
ds_read_b128 a[8:11], v60 offset:6144
v_mfma_f32_16x16x32_bf16 v[80:83], a[20:23], a[200:203], v[80:83]
buffer_load_dwordx4 v2, s[40:43], s90 offen offset:0 sc1 lds
v_mfma_f32_16x16x32_bf16 v[84:87], a[20:23], a[204:207], v[84:87]
ds_read_b128 a[12:15], v60 offset:16384
v_mfma_f32_16x16x32_bf16 v[84:87], a[16:19], a[196:199], v[84:87]
s_waitcnt lgkmcnt(4)
v_mfma_f32_16x16x32_bf16 v[88:91], a[24:27], a[192:195], v[88:91]
ds_read_b128 a[16:19], v60 offset:7168
v_mfma_f32_16x16x32_bf16 v[88:91], a[28:31], a[200:203], v[88:91]
buffer_load_dwordx4 v2, s[40:43], s90 offen offset:1024 sc1 lds
v_mfma_f32_16x16x32_bf16 v[92:95], a[28:31], a[204:207], v[92:95]
ds_read_b128 a[20:23], v60 offset:17408
v_mfma_f32_16x16x32_bf16 v[92:95], a[24:27], a[196:199], v[92:95]
v_mfma_f32_16x16x32_bf16 v[96:99], a[240:243], a[192:195], v[96:99]
ds_read_b128 a[24:27], v60 offset:8192
v_mfma_f32_16x16x32_bf16 v[96:99], a[244:247], a[200:203], v[96:99]
buffer_load_dwordx4 v2, s[40:43], s90 offen offset:2048 sc1 lds
v_mfma_f32_16x16x32_bf16 v[100:103], a[244:247], a[204:207], v[100:103]
ds_read_b128 a[28:31], v60 offset:18432
v_mfma_f32_16x16x32_bf16 v[100:103], a[240:243], a[196:199], v[100:103]
s_waitcnt lgkmcnt(4)
v_mfma_f32_16x16x32_bf16 v[104:107], a[0:3], a[192:195], v[104:107]
ds_read_b128 a[240:243], v60 offset:9216
v_mfma_f32_16x16x32_bf16 v[104:107], a[4:7], a[200:203], v[104:107]
buffer_load_dwordx4 v2, s[40:43], s90 offen offset:3072 sc1 lds
v_mfma_f32_16x16x32_bf16 v[108:111], a[4:7], a[204:207], v[108:111]
s_add_u32 m0, s88, 24576
ds_read_b128 a[244:247], v60 offset:19456
v_mfma_f32_16x16x32_bf16 v[108:111], a[0:3], a[196:199], v[108:111]
s_waitcnt vmcnt(22)
s_barrier
v_mfma_f32_16x16x32_bf16 v[112:115], a[8:11], a[192:195], v[112:115]
ds_read_b128 a[0:3], v60 offset:20480
v_mfma_f32_16x16x32_bf16 v[112:115], a[12:15], a[200:203], v[112:115]
buffer_load_dwordx4 v61, s[40:43], s90 offen offset:0 sc1 lds
v_mfma_f32_16x16x32_bf16 v[116:119], a[12:15], a[204:207], v[116:119]
s_add_u32 s89, s73, 98304
ds_read_b128 a[4:7], v60 offset:30720
v_mfma_f32_16x16x32_bf16 v[116:119], a[8:11], a[196:199], v[116:119]
s_waitcnt lgkmcnt(4)
v_mfma_f32_16x16x32_bf16 v[120:123], a[16:19], a[192:195], v[120:123]
ds_read_b128 a[8:11], v60 offset:21504
v_mfma_f32_16x16x32_bf16 v[120:123], a[20:23], a[200:203], v[120:123]
buffer_load_dwordx4 a[48:51], v2, s[36:39], s89 offen offset:0 sc1
v_mfma_f32_16x16x32_bf16 v[124:127], a[20:23], a[204:207], v[124:127]
ds_read_b128 a[12:15], v60 offset:31744
v_mfma_f32_16x16x32_bf16 v[124:127], a[16:19], a[196:199], v[124:127]
v_mfma_f32_16x16x32_bf16 v[208:211], a[24:27], a[192:195], v[208:211]
ds_read_b128 a[16:19], v60 offset:22528
v_mfma_f32_16x16x32_bf16 v[208:211], a[28:31], a[200:203], v[208:211]
buffer_load_dwordx4 a[52:55], v2, s[36:39], s89 offen offset:1024 sc1
v_mfma_f32_16x16x32_bf16 v[212:215], a[28:31], a[204:207], v[212:215]
ds_read_b128 a[20:23], v60 offset:32768
v_mfma_f32_16x16x32_bf16 v[212:215], a[24:27], a[196:199], v[212:215]
s_waitcnt lgkmcnt(4)
v_mfma_f32_16x16x32_bf16 v[216:219], a[240:243], a[192:195], v[216:219]
ds_read_b128 a[24:27], v60 offset:23552
v_mfma_f32_16x16x32_bf16 v[216:219], a[244:247], a[200:203], v[216:219]
buffer_load_dwordx4 a[56:59], v61, s[36:39], s89 offen offset:0 sc1
v_mfma_f32_16x16x32_bf16 v[220:223], a[244:247], a[204:207], v[220:223]
ds_read_b128 a[28:31], v60 offset:33792
v_mfma_f32_16x16x32_bf16 v[220:223], a[240:243], a[196:199], v[220:223]
v_mfma_f32_16x16x32_bf16 v[64:67], a[0:3], a[208:211], v[64:67]
ds_read_b128 a[240:243], v60 offset:24576
v_mfma_f32_16x16x32_bf16 v[64:67], a[4:7], a[216:219], v[64:67]
buffer_load_dwordx4 a[60:63], v61, s[36:39], s89 offen offset:1024 sc1
v_mfma_f32_16x16x32_bf16 v[68:71], a[4:7], a[220:223], v[68:71]
s_add_u32 s90, s75, 266240
s_add_u32 m0, s88, 40960
ds_read_b128 a[244:247], v60 offset:34816
v_mfma_f32_16x16x32_bf16 v[68:71], a[0:3], a[212:215], v[68:71]
s_waitcnt lgkmcnt(4)
v_mfma_f32_16x16x32_bf16 v[72:75], a[8:11], a[208:211], v[72:75]
ds_read_b128 a[0:3], v60 offset:25600
v_mfma_f32_16x16x32_bf16 v[72:75], a[12:15], a[216:219], v[72:75]
buffer_load_dwordx4 v2, s[40:43], s90 offen offset:0 sc1 lds
v_mfma_f32_16x16x32_bf16 v[76:79], a[12:15], a[220:223], v[76:79]
ds_read_b128 a[4:7], v60 offset:35840
v_mfma_f32_16x16x32_bf16 v[76:79], a[8:11], a[212:215], v[76:79]
v_mfma_f32_16x16x32_bf16 v[80:83], a[16:19], a[208:211], v[80:83]
ds_read_b128 a[8:11], v60 offset:26624
v_mfma_f32_16x16x32_bf16 v[80:83], a[20:23], a[216:219], v[80:83]
buffer_load_dwordx4 v2, s[40:43], s90 offen offset:1024 sc1 lds
v_mfma_f32_16x16x32_bf16 v[84:87], a[20:23], a[220:223], v[84:87]
ds_read_b128 a[12:15], v60 offset:36864
v_mfma_f32_16x16x32_bf16 v[84:87], a[16:19], a[212:215], v[84:87]
s_waitcnt lgkmcnt(4)
v_mfma_f32_16x16x32_bf16 v[88:91], a[24:27], a[208:211], v[88:91]
ds_read_b128 a[16:19], v60 offset:27648
v_mfma_f32_16x16x32_bf16 v[88:91], a[28:31], a[216:219], v[88:91]
buffer_load_dwordx4 v2, s[40:43], s90 offen offset:2048 sc1 lds
v_mfma_f32_16x16x32_bf16 v[92:95], a[28:31], a[220:223], v[92:95]
ds_read_b128 a[20:23], v60 offset:37888
v_mfma_f32_16x16x32_bf16 v[92:95], a[24:27], a[212:215], v[92:95]
v_mfma_f32_16x16x32_bf16 v[96:99], a[240:243], a[208:211], v[96:99]
ds_read_b128 a[24:27], v60 offset:28672
v_mfma_f32_16x16x32_bf16 v[96:99], a[244:247], a[216:219], v[96:99]
buffer_load_dwordx4 v2, s[40:43], s90 offen offset:3072 sc1 lds
v_mfma_f32_16x16x32_bf16 v[100:103], a[244:247], a[220:223], v[100:103]
s_add_u32 m0, s88, 45056
ds_read_b128 a[28:31], v60 offset:38912
v_mfma_f32_16x16x32_bf16 v[100:103], a[240:243], a[212:215], v[100:103]
s_waitcnt lgkmcnt(4)
v_mfma_f32_16x16x32_bf16 v[104:107], a[0:3], a[208:211], v[104:107]
ds_read_b128 a[240:243], v60 offset:29696
v_mfma_f32_16x16x32_bf16 v[104:107], a[4:7], a[216:219], v[104:107]
buffer_load_dwordx4 v61, s[40:43], s90 offen offset:0 sc1 lds
v_mfma_f32_16x16x32_bf16 v[108:111], a[4:7], a[220:223], v[108:111]
s_add_u32 s89, s73, 106496
ds_read_b128 a[244:247], v60 offset:39936
v_mfma_f32_16x16x32_bf16 v[108:111], a[0:3], a[212:215], v[108:111]
s_waitcnt vmcnt(23)
s_barrier
v_mfma_f32_16x16x32_bf16 v[112:115], a[8:11], a[208:211], v[112:115]
ds_read_b128 a[0:3], v60 offset:40960
v_mfma_f32_16x16x32_bf16 v[112:115], a[12:15], a[216:219], v[112:115]
buffer_load_dwordx4 a[192:195], v2, s[36:39], s89 offen offset:0 sc1
v_mfma_f32_16x16x32_bf16 v[116:119], a[12:15], a[220:223], v[116:119]
ds_read_b128 a[4:7], v60 offset:51200
v_mfma_f32_16x16x32_bf16 v[116:119], a[8:11], a[212:215], v[116:119]
s_waitcnt lgkmcnt(4)
v_mfma_f32_16x16x32_bf16 v[120:123], a[16:19], a[208:211], v[120:123]
ds_read_b128 a[8:11], v60 offset:41984
v_mfma_f32_16x16x32_bf16 v[120:123], a[20:23], a[216:219], v[120:123]
buffer_load_dwordx4 a[196:199], v2, s[36:39], s89 offen offset:1024 sc1
v_mfma_f32_16x16x32_bf16 v[124:127], a[20:23], a[220:223], v[124:127]
ds_read_b128 a[12:15], v60 offset:52224
v_mfma_f32_16x16x32_bf16 v[124:127], a[16:19], a[212:215], v[124:127]
v_mfma_f32_16x16x32_bf16 v[208:211], a[24:27], a[208:211], v[208:211]
ds_read_b128 a[16:19], v60 offset:43008
v_mfma_f32_16x16x32_bf16 v[208:211], a[28:31], a[216:219], v[208:211]
buffer_load_dwordx4 a[200:203], v61, s[36:39], s89 offen offset:0 sc1
v_mfma_f32_16x16x32_bf16 v[212:215], a[28:31], a[220:223], v[212:215]
ds_read_b128 a[20:23], v60 offset:53248
v_mfma_f32_16x16x32_bf16 v[212:215], a[24:27], a[212:215], v[212:215]
s_waitcnt lgkmcnt(4)
v_mfma_f32_16x16x32_bf16 v[216:219], a[240:243], a[208:211], v[216:219]
ds_read_b128 a[24:27], v60 offset:44032
v_mfma_f32_16x16x32_bf16 v[216:219], a[244:247], a[216:219], v[216:219]
buffer_load_dwordx4 a[204:207], v61, s[36:39], s89 offen offset:1024 sc1
v_mfma_f32_16x16x32_bf16 v[220:223], a[244:247], a[220:223], v[220:223]
s_add_u32 s90, s75, 286720
s_add_u32 m0, s88, 61440
ds_read_b128 a[28:31], v60 offset:54272
v_mfma_f32_16x16x32_bf16 v[220:223], a[240:243], a[212:215], v[220:223]
v_mfma_f32_16x16x32_bf16 v[64:67], a[0:3], a[224:227], v[64:67]
ds_read_b128 a[240:243], v60 offset:45056
v_mfma_f32_16x16x32_bf16 v[64:67], a[4:7], a[232:235], v[64:67]
buffer_load_dwordx4 v2, s[40:43], s90 offen offset:0 sc1 lds
v_mfma_f32_16x16x32_bf16 v[68:71], a[4:7], a[236:239], v[68:71]
ds_read_b128 a[244:247], v60 offset:55296
v_mfma_f32_16x16x32_bf16 v[68:71], a[0:3], a[228:231], v[68:71]
s_waitcnt lgkmcnt(4)
v_mfma_f32_16x16x32_bf16 v[72:75], a[8:11], a[224:227], v[72:75]
ds_read_b128 a[0:3], v60 offset:46080
v_mfma_f32_16x16x32_bf16 v[72:75], a[12:15], a[232:235], v[72:75]
buffer_load_dwordx4 v2, s[40:43], s90 offen offset:1024 sc1 lds
v_mfma_f32_16x16x32_bf16 v[76:79], a[12:15], a[236:239], v[76:79]
ds_read_b128 a[4:7], v60 offset:56320
v_mfma_f32_16x16x32_bf16 v[76:79], a[8:11], a[228:231], v[76:79]
v_mfma_f32_16x16x32_bf16 v[80:83], a[16:19], a[224:227], v[80:83]
ds_read_b128 a[8:11], v60 offset:47104
v_mfma_f32_16x16x32_bf16 v[80:83], a[20:23], a[232:235], v[80:83]
buffer_load_dwordx4 v2, s[40:43], s90 offen offset:2048 sc1 lds
v_mfma_f32_16x16x32_bf16 v[84:87], a[20:23], a[236:239], v[84:87]
ds_read_b128 a[12:15], v60 offset:57344
v_mfma_f32_16x16x32_bf16 v[84:87], a[16:19], a[228:231], v[84:87]
s_waitcnt lgkmcnt(4)
v_mfma_f32_16x16x32_bf16 v[88:91], a[24:27], a[224:227], v[88:91]
ds_read_b128 a[16:19], v60 offset:48128
v_mfma_f32_16x16x32_bf16 v[88:91], a[28:31], a[232:235], v[88:91]
buffer_load_dwordx4 v2, s[40:43], s90 offen offset:3072 sc1 lds
v_mfma_f32_16x16x32_bf16 v[92:95], a[28:31], a[236:239], v[92:95]
s_add_u32 m0, s88, 65536
ds_read_b128 a[20:23], v60 offset:58368
v_mfma_f32_16x16x32_bf16 v[92:95], a[24:27], a[228:231], v[92:95]
v_mfma_f32_16x16x32_bf16 v[96:99], a[240:243], a[224:227], v[96:99]
ds_read_b128 a[24:27], v60 offset:49152
v_mfma_f32_16x16x32_bf16 v[96:99], a[244:247], a[232:235], v[96:99]
buffer_load_dwordx4 v61, s[40:43], s90 offen offset:0 sc1 lds
v_mfma_f32_16x16x32_bf16 v[100:103], a[244:247], a[236:239], v[100:103]
s_add_u32 s89, s73, 114688
ds_read_b128 a[28:31], v60 offset:59392
v_mfma_f32_16x16x32_bf16 v[100:103], a[240:243], a[228:231], v[100:103]
s_waitcnt lgkmcnt(4)
v_mfma_f32_16x16x32_bf16 v[104:107], a[0:3], a[224:227], v[104:107]
ds_read_b128 a[240:243], v60 offset:50176
v_mfma_f32_16x16x32_bf16 v[104:107], a[4:7], a[232:235], v[104:107]
buffer_load_dwordx4 a[208:211], v2, s[36:39], s89 offen offset:0 sc1
v_mfma_f32_16x16x32_bf16 v[108:111], a[4:7], a[236:239], v[108:111]
ds_read_b128 a[244:247], v60 offset:60416
v_subrev_u32 v60, 61440, v60
v_mfma_f32_16x16x32_bf16 v[108:111], a[0:3], a[228:231], v[108:111]
s_waitcnt vmcnt(24)
s_barrier
v_mfma_f32_16x16x32_bf16 v[112:115], a[8:11], a[224:227], v[112:115]
ds_read_b128 a[0:3], v60 offset:0
v_mfma_f32_16x16x32_bf16 v[112:115], a[12:15], a[232:235], v[112:115]
buffer_load_dwordx4 a[212:215], v2, s[36:39], s89 offen offset:1024 sc1
v_mfma_f32_16x16x32_bf16 v[116:119], a[12:15], a[236:239], v[116:119]
ds_read_b128 a[4:7], v60 offset:10240
v_mfma_f32_16x16x32_bf16 v[116:119], a[8:11], a[228:231], v[116:119]
s_waitcnt lgkmcnt(4)
v_mfma_f32_16x16x32_bf16 v[120:123], a[16:19], a[224:227], v[120:123]
ds_read_b128 a[8:11], v60 offset:1024
v_mfma_f32_16x16x32_bf16 v[120:123], a[20:23], a[232:235], v[120:123]
buffer_load_dwordx4 a[216:219], v61, s[36:39], s89 offen offset:0 sc1
v_mfma_f32_16x16x32_bf16 v[124:127], a[20:23], a[236:239], v[124:127]
ds_read_b128 a[12:15], v60 offset:11264
v_mfma_f32_16x16x32_bf16 v[124:127], a[16:19], a[228:231], v[124:127]
v_mfma_f32_16x16x32_bf16 v[208:211], a[24:27], a[224:227], v[208:211]
ds_read_b128 a[16:19], v60 offset:2048
v_mfma_f32_16x16x32_bf16 v[208:211], a[28:31], a[232:235], v[208:211]
buffer_load_dwordx4 a[220:223], v61, s[36:39], s89 offen offset:1024 sc1
v_mfma_f32_16x16x32_bf16 v[212:215], a[28:31], a[236:239], v[212:215]
s_add_u32 s90, s75, 307200
s_add_u32 m0, s88, 81920
ds_read_b128 a[20:23], v60 offset:12288
v_mfma_f32_16x16x32_bf16 v[212:215], a[24:27], a[228:231], v[212:215]
s_waitcnt lgkmcnt(4)
v_mfma_f32_16x16x32_bf16 v[216:219], a[240:243], a[224:227], v[216:219]
ds_read_b128 a[24:27], v60 offset:3072
v_mfma_f32_16x16x32_bf16 v[216:219], a[244:247], a[232:235], v[216:219]
buffer_load_dwordx4 v2, s[40:43], s90 offen offset:0 sc1 lds
v_mfma_f32_16x16x32_bf16 v[220:223], a[244:247], a[236:239], v[220:223]
ds_read_b128 a[28:31], v60 offset:13312
v_mfma_f32_16x16x32_bf16 v[220:223], a[240:243], a[228:231], v[220:223]
v_mfma_f32_16x16x32_bf16 v[64:67], a[0:3], a[32:35], v[64:67]
ds_read_b128 a[240:243], v60 offset:4096
v_mfma_f32_16x16x32_bf16 v[64:67], a[4:7], a[40:43], v[64:67]
buffer_load_dwordx4 v2, s[40:43], s90 offen offset:1024 sc1 lds
v_mfma_f32_16x16x32_bf16 v[68:71], a[4:7], a[44:47], v[68:71]
ds_read_b128 a[244:247], v60 offset:14336
v_mfma_f32_16x16x32_bf16 v[68:71], a[0:3], a[36:39], v[68:71]
s_waitcnt lgkmcnt(4)
v_mfma_f32_16x16x32_bf16 v[72:75], a[8:11], a[32:35], v[72:75]
ds_read_b128 a[0:3], v60 offset:5120
v_mfma_f32_16x16x32_bf16 v[72:75], a[12:15], a[40:43], v[72:75]
buffer_load_dwordx4 v2, s[40:43], s90 offen offset:2048 sc1 lds
v_mfma_f32_16x16x32_bf16 v[76:79], a[12:15], a[44:47], v[76:79]
ds_read_b128 a[4:7], v60 offset:15360
v_mfma_f32_16x16x32_bf16 v[76:79], a[8:11], a[36:39], v[76:79]
v_mfma_f32_16x16x32_bf16 v[80:83], a[16:19], a[32:35], v[80:83]
ds_read_b128 a[8:11], v60 offset:6144
v_mfma_f32_16x16x32_bf16 v[80:83], a[20:23], a[40:43], v[80:83]
buffer_load_dwordx4 v2, s[40:43], s90 offen offset:3072 sc1 lds
v_mfma_f32_16x16x32_bf16 v[84:87], a[20:23], a[44:47], v[84:87]
s_add_u32 m0, s88, 86016
ds_read_b128 a[12:15], v60 offset:16384
v_mfma_f32_16x16x32_bf16 v[84:87], a[16:19], a[36:39], v[84:87]
s_waitcnt lgkmcnt(4)
v_mfma_f32_16x16x32_bf16 v[88:91], a[24:27], a[32:35], v[88:91]
ds_read_b128 a[16:19], v60 offset:7168
v_mfma_f32_16x16x32_bf16 v[88:91], a[28:31], a[40:43], v[88:91]
buffer_load_dwordx4 v61, s[40:43], s90 offen offset:0 sc1 lds
v_mfma_f32_16x16x32_bf16 v[92:95], a[28:31], a[44:47], v[92:95]
s_add_u32 s89, s73, 122880
ds_read_b128 a[20:23], v60 offset:17408
v_mfma_f32_16x16x32_bf16 v[92:95], a[24:27], a[36:39], v[92:95]
v_mfma_f32_16x16x32_bf16 v[96:99], a[240:243], a[32:35], v[96:99]
ds_read_b128 a[24:27], v60 offset:8192
v_mfma_f32_16x16x32_bf16 v[96:99], a[244:247], a[40:43], v[96:99]
buffer_load_dwordx4 a[224:227], v2, s[36:39], s89 offen offset:0 sc1
v_mfma_f32_16x16x32_bf16 v[100:103], a[244:247], a[44:47], v[100:103]
ds_read_b128 a[28:31], v60 offset:18432
v_mfma_f32_16x16x32_bf16 v[100:103], a[240:243], a[36:39], v[100:103]
s_waitcnt lgkmcnt(4)
v_mfma_f32_16x16x32_bf16 v[104:107], a[0:3], a[32:35], v[104:107]
ds_read_b128 a[240:243], v60 offset:9216
v_mfma_f32_16x16x32_bf16 v[104:107], a[4:7], a[40:43], v[104:107]
buffer_load_dwordx4 a[228:231], v2, s[36:39], s89 offen offset:1024 sc1
v_mfma_f32_16x16x32_bf16 v[108:111], a[4:7], a[44:47], v[108:111]
ds_read_b128 a[244:247], v60 offset:19456
v_mfma_f32_16x16x32_bf16 v[108:111], a[0:3], a[36:39], v[108:111]
s_waitcnt vmcnt(25)
s_barrier
v_mfma_f32_16x16x32_bf16 v[112:115], a[8:11], a[32:35], v[112:115]
ds_read_b128 a[0:3], v60 offset:20480
v_mfma_f32_16x16x32_bf16 v[112:115], a[12:15], a[40:43], v[112:115]
buffer_load_dwordx4 a[232:235], v61, s[36:39], s89 offen offset:0 sc1
v_mfma_f32_16x16x32_bf16 v[116:119], a[12:15], a[44:47], v[116:119]
ds_read_b128 a[4:7], v60 offset:30720
v_mfma_f32_16x16x32_bf16 v[116:119], a[8:11], a[36:39], v[116:119]
s_waitcnt lgkmcnt(4)
v_mfma_f32_16x16x32_bf16 v[120:123], a[16:19], a[32:35], v[120:123]
ds_read_b128 a[8:11], v60 offset:21504
v_mfma_f32_16x16x32_bf16 v[120:123], a[20:23], a[40:43], v[120:123]
buffer_load_dwordx4 a[236:239], v61, s[36:39], s89 offen offset:1024 sc1
v_mfma_f32_16x16x32_bf16 v[124:127], a[20:23], a[44:47], v[124:127]
ds_read_b128 a[12:15], v60 offset:31744
v_mfma_f32_16x16x32_bf16 v[124:127], a[16:19], a[36:39], v[124:127]
v_mfma_f32_16x16x32_bf16 v[208:211], a[24:27], a[32:35], v[208:211]
ds_read_b128 a[16:19], v60 offset:22528
v_mfma_f32_16x16x32_bf16 v[208:211], a[28:31], a[40:43], v[208:211]
v_mfma_f32_16x16x32_bf16 v[212:215], a[28:31], a[44:47], v[212:215]
ds_read_b128 a[20:23], v60 offset:32768
v_mfma_f32_16x16x32_bf16 v[212:215], a[24:27], a[36:39], v[212:215]
s_waitcnt lgkmcnt(4)
v_mfma_f32_16x16x32_bf16 v[216:219], a[240:243], a[32:35], v[216:219]
ds_read_b128 a[24:27], v60 offset:23552
v_mfma_f32_16x16x32_bf16 v[216:219], a[244:247], a[40:43], v[216:219]
v_mfma_f32_16x16x32_bf16 v[220:223], a[244:247], a[44:47], v[220:223]
ds_read_b128 a[28:31], v60 offset:33792
v_mfma_f32_16x16x32_bf16 v[220:223], a[240:243], a[36:39], v[220:223]
v_mfma_f32_16x16x32_bf16 v[64:67], a[0:3], a[48:51], v[64:67]
ds_read_b128 a[240:243], v60 offset:24576
v_add_u32 v8, 0, v1
v_mfma_f32_16x16x32_bf16 v[64:67], a[4:7], a[56:59], v[64:67]
v_mul_u32_u24 v36, 6554, v8
v_lshrrev_b32 v36, 16, v36
v_mfma_f32_16x16x32_bf16 v[68:71], a[4:7], a[60:63], v[68:71]
ds_read_b128 a[244:247], v60 offset:34816
v_lshlrev_b32 v11, 5, v8
v_mfma_f32_16x16x32_bf16 v[68:71], a[0:3], a[52:55], v[68:71]
s_waitcnt lgkmcnt(4)
v_mad_u32_u24 v11, v36, 16, v11
v_mul_u32_u24 v36, 1120, v36
v_mfma_f32_16x16x32_bf16 v[72:75], a[8:11], a[48:51], v[72:75]
ds_read_b128 a[0:3], v60 offset:25600
v_lshl_add_u32 v8, v8, 4, v36
v_mfma_f32_16x16x32_bf16 v[72:75], a[12:15], a[56:59], v[72:75]
buffer_load_dwordx4 v[224:227], v8, s[20:23], 0 offen
v_mfma_f32_16x16x32_bf16 v[76:79], a[12:15], a[60:63], v[76:79]
ds_read_b128 a[4:7], v60 offset:35840
v_add_u32 v9, 64, v1
v_mfma_f32_16x16x32_bf16 v[76:79], a[8:11], a[52:55], v[76:79]
v_mul_u32_u24 v36, 6554, v9
v_lshrrev_b32 v36, 16, v36
v_mfma_f32_16x16x32_bf16 v[80:83], a[16:19], a[48:51], v[80:83]
ds_read_b128 a[8:11], v60 offset:26624
v_lshlrev_b32 v12, 5, v9
v_mfma_f32_16x16x32_bf16 v[80:83], a[20:23], a[56:59], v[80:83]
v_mad_u32_u24 v12, v36, 16, v12
v_mul_u32_u24 v36, 1120, v36
v_mfma_f32_16x16x32_bf16 v[84:87], a[20:23], a[60:63], v[84:87]
s_waitcnt lgkmcnt(4)
ds_read_b128 a[12:15], v60 offset:36864
v_lshl_add_u32 v9, v9, 4, v36
v_mfma_f32_16x16x32_bf16 v[84:87], a[16:19], a[52:55], v[84:87]
buffer_load_dwordx4 v[228:231], v9, s[20:23], 0 offen
v_mfma_f32_16x16x32_bf16 v[88:91], a[24:27], a[48:51], v[88:91]
ds_read_b128 a[16:19], v60 offset:27648
v_add_u32 v10, 128, v1
v_mfma_f32_16x16x32_bf16 v[88:91], a[28:31], a[56:59], v[88:91]
v_mul_u32_u24 v36, 6554, v10
v_lshrrev_b32 v36, 16, v36
v_mfma_f32_16x16x32_bf16 v[92:95], a[28:31], a[60:63], v[92:95]
ds_read_b128 a[20:23], v60 offset:37888
v_lshlrev_b32 v13, 5, v10
v_mfma_f32_16x16x32_bf16 v[92:95], a[24:27], a[52:55], v[92:95]
v_mad_u32_u24 v13, v36, 16, v13
v_mul_u32_u24 v36, 1120, v36
v_mfma_f32_16x16x32_bf16 v[96:99], a[240:243], a[48:51], v[96:99]
s_waitcnt lgkmcnt(4)
ds_read_b128 a[24:27], v60 offset:28672
v_lshl_add_u32 v10, v10, 4, v36
v_mfma_f32_16x16x32_bf16 v[96:99], a[244:247], a[56:59], v[96:99]
buffer_load_dwordx4 v[232:235], v10, s[20:23], 0 offen
v_mfma_f32_16x16x32_bf16 v[100:103], a[244:247], a[60:63], v[100:103]
ds_read_b128 a[28:31], v60 offset:38912
v_mfma_f32_16x16x32_bf16 v[100:103], a[240:243], a[52:55], v[100:103]
v_mfma_f32_16x16x32_bf16 v[104:107], a[0:3], a[48:51], v[104:107]
ds_read_b128 a[240:243], v60 offset:29696
v_mfma_f32_16x16x32_bf16 v[104:107], a[4:7], a[56:59], v[104:107]
v_mfma_f32_16x16x32_bf16 v[108:111], a[4:7], a[60:63], v[108:111]
s_waitcnt lgkmcnt(4)
ds_read_b128 a[244:247], v60 offset:39936
v_mfma_f32_16x16x32_bf16 v[108:111], a[0:3], a[52:55], v[108:111]
s_waitcnt vmcnt(21)
s_barrier
v_mfma_f32_16x16x32_bf16 v[112:115], a[8:11], a[48:51], v[112:115]
ds_read_b128 a[0:3], v60 offset:40960
v_mfma_f32_16x16x32_bf16 v[112:115], a[12:15], a[56:59], v[112:115]
v_mfma_f32_16x16x32_bf16 v[116:119], a[12:15], a[60:63], v[116:119]
ds_read_b128 a[4:7], v60 offset:51200
v_mfma_f32_16x16x32_bf16 v[116:119], a[8:11], a[52:55], v[116:119]
v_mfma_f32_16x16x32_bf16 v[120:123], a[16:19], a[48:51], v[120:123]
s_waitcnt lgkmcnt(4)
ds_read_b128 a[8:11], v60 offset:41984
v_mfma_f32_16x16x32_bf16 v[120:123], a[20:23], a[56:59], v[120:123]
v_mfma_f32_16x16x32_bf16 v[124:127], a[20:23], a[60:63], v[124:127]
ds_read_b128 a[12:15], v60 offset:52224
v_mfma_f32_16x16x32_bf16 v[124:127], a[16:19], a[52:55], v[124:127]
v_mfma_f32_16x16x32_bf16 v[208:211], a[24:27], a[48:51], v[208:211]
ds_read_b128 a[16:19], v60 offset:43008
v_mfma_f32_16x16x32_bf16 v[208:211], a[28:31], a[56:59], v[208:211]
v_mfma_f32_16x16x32_bf16 v[212:215], a[28:31], a[60:63], v[212:215]
ds_read_b128 a[20:23], v60 offset:53248
v_mfma_f32_16x16x32_bf16 v[212:215], a[24:27], a[52:55], v[212:215]
s_waitcnt lgkmcnt(4)
v_mfma_f32_16x16x32_bf16 v[216:219], a[240:243], a[48:51], v[216:219]
ds_read_b128 a[24:27], v60 offset:44032
v_mfma_f32_16x16x32_bf16 v[216:219], a[244:247], a[56:59], v[216:219]
v_mfma_f32_16x16x32_bf16 v[220:223], a[244:247], a[60:63], v[220:223]
ds_read_b128 a[28:31], v60 offset:54272
v_mfma_f32_16x16x32_bf16 v[220:223], a[240:243], a[52:55], v[220:223]
v_mfma_f32_16x16x32_bf16 v[64:67], a[0:3], a[192:195], v[64:67]
ds_read_b128 a[240:243], v60 offset:45056
v_mfma_f32_16x16x32_bf16 v[64:67], a[4:7], a[200:203], v[64:67]
s_add_u32 s83, s18, 0
v_mfma_f32_16x16x32_bf16 v[68:71], a[4:7], a[204:207], v[68:71]
s_waitcnt lgkmcnt(4)
ds_read_b128 a[244:247], v60 offset:55296
v_mfma_f32_16x16x32_bf16 v[68:71], a[0:3], a[196:199], v[68:71]
buffer_load_dwordx4 v[128:131], v2, s[12:15], s83 offen offset:0 sc1
v_mfma_f32_16x16x32_bf16 v[72:75], a[8:11], a[192:195], v[72:75]
ds_read_b128 a[0:3], v60 offset:46080
v_mfma_f32_16x16x32_bf16 v[72:75], a[12:15], a[200:203], v[72:75]
v_mfma_f32_16x16x32_bf16 v[76:79], a[12:15], a[204:207], v[76:79]
ds_read_b128 a[4:7], v60 offset:56320
v_mfma_f32_16x16x32_bf16 v[76:79], a[8:11], a[196:199], v[76:79]
v_mfma_f32_16x16x32_bf16 v[80:83], a[16:19], a[192:195], v[80:83]
s_waitcnt lgkmcnt(4)
ds_read_b128 a[8:11], v60 offset:47104
v_mfma_f32_16x16x32_bf16 v[80:83], a[20:23], a[200:203], v[80:83]
buffer_load_dwordx4 v[132:135], v2, s[12:15], s83 offen offset:1024 sc1
v_mfma_f32_16x16x32_bf16 v[84:87], a[20:23], a[204:207], v[84:87]
ds_read_b128 a[12:15], v60 offset:57344
v_mfma_f32_16x16x32_bf16 v[84:87], a[16:19], a[196:199], v[84:87]
v_mfma_f32_16x16x32_bf16 v[88:91], a[24:27], a[192:195], v[88:91]
ds_read_b128 a[16:19], v60 offset:48128
v_mfma_f32_16x16x32_bf16 v[88:91], a[28:31], a[200:203], v[88:91]
v_mfma_f32_16x16x32_bf16 v[92:95], a[28:31], a[204:207], v[92:95]
s_waitcnt lgkmcnt(4)
ds_read_b128 a[20:23], v60 offset:58368
v_mfma_f32_16x16x32_bf16 v[92:95], a[24:27], a[196:199], v[92:95]
buffer_load_dwordx4 v[136:139], v2, s[12:15], s83 offen offset:2048 sc1
v_mfma_f32_16x16x32_bf16 v[96:99], a[240:243], a[192:195], v[96:99]
s_add_u32 s83, s18, 12288
ds_read_b128 a[24:27], v60 offset:49152
v_mfma_f32_16x16x32_bf16 v[96:99], a[244:247], a[200:203], v[96:99]
v_mfma_f32_16x16x32_bf16 v[100:103], a[244:247], a[204:207], v[100:103]
ds_read_b128 a[28:31], v60 offset:59392
v_mfma_f32_16x16x32_bf16 v[100:103], a[240:243], a[196:199], v[100:103]
v_mfma_f32_16x16x32_bf16 v[104:107], a[0:3], a[192:195], v[104:107]
s_waitcnt lgkmcnt(4)
ds_read_b128 a[240:243], v60 offset:50176
v_mfma_f32_16x16x32_bf16 v[104:107], a[4:7], a[200:203], v[104:107]
buffer_load_dwordx4 v[140:143], v2, s[12:15], s83 offen offset:0 sc1
v_mfma_f32_16x16x32_bf16 v[108:111], a[4:7], a[204:207], v[108:111]
ds_read_b128 a[244:247], v60 offset:60416
v_add_u32 v60, 61440, v60
v_mfma_f32_16x16x32_bf16 v[108:111], a[0:3], a[196:199], v[108:111]
s_waitcnt vmcnt(16)
s_barrier
v_mfma_f32_16x16x32_bf16 v[112:115], a[8:11], a[192:195], v[112:115]
ds_read_b128 a[0:3], v60 offset:0
v_mfma_f32_16x16x32_bf16 v[112:115], a[12:15], a[200:203], v[112:115]
v_mfma_f32_16x16x32_bf16 v[116:119], a[12:15], a[204:207], v[116:119]
s_waitcnt lgkmcnt(4)
ds_read_b128 a[4:7], v60 offset:10240
v_mfma_f32_16x16x32_bf16 v[116:119], a[8:11], a[196:199], v[116:119]
buffer_load_dwordx4 v[144:147], v2, s[12:15], s83 offen offset:1024 sc1
v_mfma_f32_16x16x32_bf16 v[120:123], a[16:19], a[192:195], v[120:123]
ds_read_b128 a[8:11], v60 offset:1024
v_mfma_f32_16x16x32_bf16 v[120:123], a[20:23], a[200:203], v[120:123]
v_mfma_f32_16x16x32_bf16 v[124:127], a[20:23], a[204:207], v[124:127]
ds_read_b128 a[12:15], v60 offset:11264
v_mfma_f32_16x16x32_bf16 v[124:127], a[16:19], a[196:199], v[124:127]
v_mfma_f32_16x16x32_bf16 v[208:211], a[24:27], a[192:195], v[208:211]
s_waitcnt lgkmcnt(4)
ds_read_b128 a[16:19], v60 offset:2048
v_mfma_f32_16x16x32_bf16 v[208:211], a[28:31], a[200:203], v[208:211]
buffer_load_dwordx4 v[148:151], v2, s[12:15], s83 offen offset:2048 sc1
v_mfma_f32_16x16x32_bf16 v[212:215], a[28:31], a[204:207], v[212:215]
s_add_u32 s83, s18, 24576
ds_read_b128 a[20:23], v60 offset:12288
v_mfma_f32_16x16x32_bf16 v[212:215], a[24:27], a[196:199], v[212:215]
v_mfma_f32_16x16x32_bf16 v[216:219], a[240:243], a[192:195], v[216:219]
ds_read_b128 a[24:27], v60 offset:3072
v_mfma_f32_16x16x32_bf16 v[216:219], a[244:247], a[200:203], v[216:219]
v_mfma_f32_16x16x32_bf16 v[220:223], a[244:247], a[204:207], v[220:223]
s_waitcnt lgkmcnt(4)
ds_read_b128 a[28:31], v60 offset:13312
v_mfma_f32_16x16x32_bf16 v[220:223], a[240:243], a[196:199], v[220:223]
buffer_load_dwordx4 v[152:155], v2, s[12:15], s83 offen offset:0 sc1
v_mfma_f32_16x16x32_bf16 v[64:67], a[0:3], a[208:211], v[64:67]
ds_read_b128 a[240:243], v60 offset:4096
v_mfma_f32_16x16x32_bf16 v[64:67], a[4:7], a[216:219], v[64:67]
v_mfma_f32_16x16x32_bf16 v[68:71], a[4:7], a[220:223], v[68:71]
ds_read_b128 a[244:247], v60 offset:14336
v_mfma_f32_16x16x32_bf16 v[68:71], a[0:3], a[212:215], v[68:71]
v_mfma_f32_16x16x32_bf16 v[72:75], a[8:11], a[208:211], v[72:75]
s_waitcnt lgkmcnt(4)
ds_read_b128 a[0:3], v60 offset:5120
v_mfma_f32_16x16x32_bf16 v[72:75], a[12:15], a[216:219], v[72:75]
buffer_load_dwordx4 v[156:159], v2, s[12:15], s83 offen offset:1024 sc1
v_mfma_f32_16x16x32_bf16 v[76:79], a[12:15], a[220:223], v[76:79]
ds_read_b128 a[4:7], v60 offset:15360
v_mfma_f32_16x16x32_bf16 v[76:79], a[8:11], a[212:215], v[76:79]
v_mfma_f32_16x16x32_bf16 v[80:83], a[16:19], a[208:211], v[80:83]
ds_read_b128 a[8:11], v60 offset:6144
v_mfma_f32_16x16x32_bf16 v[80:83], a[20:23], a[216:219], v[80:83]
v_mfma_f32_16x16x32_bf16 v[84:87], a[20:23], a[220:223], v[84:87]
s_waitcnt lgkmcnt(4)
ds_read_b128 a[12:15], v60 offset:16384
v_mfma_f32_16x16x32_bf16 v[84:87], a[16:19], a[212:215], v[84:87]
buffer_load_dwordx4 v[160:163], v2, s[12:15], s83 offen offset:2048 sc1
v_mfma_f32_16x16x32_bf16 v[88:91], a[24:27], a[208:211], v[88:91]
ds_read_b128 a[16:19], v60 offset:7168
v_mfma_f32_16x16x32_bf16 v[88:91], a[28:31], a[216:219], v[88:91]
v_mfma_f32_16x16x32_bf16 v[92:95], a[28:31], a[220:223], v[92:95]
ds_read_b128 a[20:23], v60 offset:17408
v_mfma_f32_16x16x32_bf16 v[92:95], a[24:27], a[212:215], v[92:95]
v_mfma_f32_16x16x32_bf16 v[96:99], a[240:243], a[208:211], v[96:99]
s_waitcnt lgkmcnt(4)
ds_read_b128 a[24:27], v60 offset:8192
v_mfma_f32_16x16x32_bf16 v[96:99], a[244:247], a[216:219], v[96:99]
v_mfma_f32_16x16x32_bf16 v[100:103], a[244:247], a[220:223], v[100:103]
ds_read_b128 a[28:31], v60 offset:18432
v_mfma_f32_16x16x32_bf16 v[100:103], a[240:243], a[212:215], v[100:103]
v_mfma_f32_16x16x32_bf16 v[104:107], a[0:3], a[208:211], v[104:107]
ds_read_b128 a[240:243], v60 offset:9216
v_mfma_f32_16x16x32_bf16 v[104:107], a[4:7], a[216:219], v[104:107]
v_mfma_f32_16x16x32_bf16 v[108:111], a[4:7], a[220:223], v[108:111]
s_waitcnt lgkmcnt(4)
ds_read_b128 a[244:247], v60 offset:19456
v_mfma_f32_16x16x32_bf16 v[108:111], a[0:3], a[212:215], v[108:111]
s_waitcnt vmcnt(12)
s_barrier
v_mfma_f32_16x16x32_bf16 v[112:115], a[8:11], a[208:211], v[112:115]
ds_read_b128 a[0:3], v60 offset:20480
v_mfma_f32_16x16x32_bf16 v[112:115], a[12:15], a[216:219], v[112:115]
v_mfma_f32_16x16x32_bf16 v[116:119], a[12:15], a[220:223], v[116:119]
ds_read_b128 a[4:7], v60 offset:30720
v_mfma_f32_16x16x32_bf16 v[116:119], a[8:11], a[212:215], v[116:119]
v_mfma_f32_16x16x32_bf16 v[120:123], a[16:19], a[208:211], v[120:123]
s_waitcnt lgkmcnt(4)
ds_read_b128 a[8:11], v60 offset:21504
v_mfma_f32_16x16x32_bf16 v[120:123], a[20:23], a[216:219], v[120:123]
v_mfma_f32_16x16x32_bf16 v[124:127], a[20:23], a[220:223], v[124:127]
ds_read_b128 a[12:15], v60 offset:31744
v_mfma_f32_16x16x32_bf16 v[124:127], a[16:19], a[212:215], v[124:127]
v_mfma_f32_16x16x32_bf16 v[208:211], a[24:27], a[208:211], v[208:211]
ds_read_b128 a[16:19], v60 offset:22528
v_mfma_f32_16x16x32_bf16 v[208:211], a[28:31], a[216:219], v[208:211]
v_mfma_f32_16x16x32_bf16 v[212:215], a[28:31], a[220:223], v[212:215]
ds_read_b128 a[20:23], v60 offset:32768
v_mfma_f32_16x16x32_bf16 v[212:215], a[24:27], a[212:215], v[212:215]
s_waitcnt lgkmcnt(4)
v_mfma_f32_16x16x32_bf16 v[216:219], a[240:243], a[208:211], v[216:219]
ds_read_b128 a[24:27], v60 offset:23552
v_mfma_f32_16x16x32_bf16 v[216:219], a[244:247], a[216:219], v[216:219]
v_mfma_f32_16x16x32_bf16 v[220:223], a[244:247], a[220:223], v[220:223]
ds_read_b128 a[28:31], v60 offset:33792
v_mfma_f32_16x16x32_bf16 v[220:223], a[240:243], a[212:215], v[220:223]
v_mfma_f32_16x16x32_bf16 v[64:67], a[0:3], a[224:227], v[64:67]
ds_read_b128 a[240:243], v60 offset:24576
v_mfma_f32_16x16x32_bf16 v[64:67], a[4:7], a[232:235], v[64:67]
v_mfma_f32_16x16x32_bf16 v[68:71], a[4:7], a[236:239], v[68:71]
ds_read_b128 a[244:247], v60 offset:34816
v_mfma_f32_16x16x32_bf16 v[68:71], a[0:3], a[228:231], v[68:71]
s_waitcnt lgkmcnt(4)
v_mfma_f32_16x16x32_bf16 v[72:75], a[8:11], a[224:227], v[72:75]
ds_read_b128 a[0:3], v60 offset:25600
v_mfma_f32_16x16x32_bf16 v[72:75], a[12:15], a[232:235], v[72:75]
v_mfma_f32_16x16x32_bf16 v[76:79], a[12:15], a[236:239], v[76:79]
ds_read_b128 a[4:7], v60 offset:35840
v_mfma_f32_16x16x32_bf16 v[76:79], a[8:11], a[228:231], v[76:79]
v_mfma_f32_16x16x32_bf16 v[80:83], a[16:19], a[224:227], v[80:83]
ds_read_b128 a[8:11], v60 offset:26624
v_mfma_f32_16x16x32_bf16 v[80:83], a[20:23], a[232:235], v[80:83]
v_mfma_f32_16x16x32_bf16 v[84:87], a[20:23], a[236:239], v[84:87]
ds_read_b128 a[12:15], v60 offset:36864
v_mfma_f32_16x16x32_bf16 v[84:87], a[16:19], a[228:231], v[84:87]
s_waitcnt lgkmcnt(4)
v_mfma_f32_16x16x32_bf16 v[88:91], a[24:27], a[224:227], v[88:91]
ds_read_b128 a[16:19], v60 offset:27648
v_mfma_f32_16x16x32_bf16 v[88:91], a[28:31], a[232:235], v[88:91]
v_mfma_f32_16x16x32_bf16 v[92:95], a[28:31], a[236:239], v[92:95]
ds_read_b128 a[20:23], v60 offset:37888
v_mfma_f32_16x16x32_bf16 v[92:95], a[24:27], a[228:231], v[92:95]
v_mfma_f32_16x16x32_bf16 v[96:99], a[240:243], a[224:227], v[96:99]
ds_read_b128 a[24:27], v60 offset:28672
v_mfma_f32_16x16x32_bf16 v[96:99], a[244:247], a[232:235], v[96:99]
v_mfma_f32_16x16x32_bf16 v[100:103], a[244:247], a[236:239], v[100:103]
ds_read_b128 a[28:31], v60 offset:38912
v_mfma_f32_16x16x32_bf16 v[100:103], a[240:243], a[228:231], v[100:103]
s_waitcnt lgkmcnt(4)
v_mfma_f32_16x16x32_bf16 v[104:107], a[0:3], a[224:227], v[104:107]
ds_read_b128 a[240:243], v60 offset:29696
v_mfma_f32_16x16x32_bf16 v[104:107], a[4:7], a[232:235], v[104:107]
v_mfma_f32_16x16x32_bf16 v[108:111], a[4:7], a[236:239], v[108:111]
ds_read_b128 a[244:247], v60 offset:39936
v_mfma_f32_16x16x32_bf16 v[108:111], a[0:3], a[228:231], v[108:111]
v_mfma_f32_16x16x32_bf16 v[112:115], a[8:11], a[224:227], v[112:115]
v_mfma_f32_16x16x32_bf16 v[112:115], a[12:15], a[232:235], v[112:115]
v_mfma_f32_16x16x32_bf16 v[116:119], a[12:15], a[236:239], v[116:119]
v_mfma_f32_16x16x32_bf16 v[116:119], a[8:11], a[228:231], v[116:119]
s_waitcnt lgkmcnt(2)
v_mfma_f32_16x16x32_bf16 v[120:123], a[16:19], a[224:227], v[120:123]
v_mfma_f32_16x16x32_bf16 v[120:123], a[20:23], a[232:235], v[120:123]
v_mfma_f32_16x16x32_bf16 v[124:127], a[20:23], a[236:239], v[124:127]
v_mfma_f32_16x16x32_bf16 v[124:127], a[16:19], a[228:231], v[124:127]
v_mfma_f32_16x16x32_bf16 v[208:211], a[24:27], a[224:227], v[208:211]
v_mfma_f32_16x16x32_bf16 v[208:211], a[28:31], a[232:235], v[208:211]
v_mfma_f32_16x16x32_bf16 v[212:215], a[28:31], a[236:239], v[212:215]
v_mfma_f32_16x16x32_bf16 v[212:215], a[24:27], a[228:231], v[212:215]
s_waitcnt lgkmcnt(0)
v_mfma_f32_16x16x32_bf16 v[216:219], a[240:243], a[224:227], v[216:219]
v_mfma_f32_16x16x32_bf16 v[216:219], a[244:247], a[232:235], v[216:219]
v_mfma_f32_16x16x32_bf16 v[220:223], a[244:247], a[236:239], v[220:223]
v_mfma_f32_16x16x32_bf16 v[220:223], a[240:243], a[228:231], v[220:223]
s_mov_b32 s87, 0
s_waitcnt vmcnt(0)
XCHK0:
v_xor_b32 v20, s19, v131
v_xor_b32 v21, s19, v135
v_xor_b32 v22, s19, v139
v_xor_b32 v23, s19, v143
v_xor_b32 v24, s19, v147
v_xor_b32 v25, s19, v151
v_xor_b32 v26, s19, v155
v_xor_b32 v27, s19, v159
v_xor_b32 v28, s19, v163
v_or3_b32 v20, v20, v21, v22
v_or3_b32 v20, v20, v23, v24
v_or3_b32 v20, v20, v25, v26
v_or3_b32 v20, v20, v27, v28
v_cmp_lt_u32 vcc, 0xffff, v20
s_add_u32 s87, s87, 1
s_cmp_eq_u64 vcc, 0
s_cbranch_scc1 XOK0
s_cmp_ge_u32 s87, 0x40000
s_cbranch_scc1 XOK0
v_min_u32 v31, 2, v1
v_mul_u32_u24 v31, 12288, v31
s_add_u32 s83, s18, 3068
DPROBE:
s_sleep 24
buffer_load_dword v30, v31, s[12:15], s83 offen sc1
s_waitcnt vmcnt(0)
v_xor_b32 v30, s19, v30
v_cmp_lt_u32 vcc, 0xffff, v30
s_add_u32 s87, s87, 1
s_cmp_ge_u32 s87, 0x40000
s_cbranch_scc1 DPROBED
s_cmp_lg_u64 vcc, 0
s_cbranch_scc1 DPROBE
DPROBED:
s_add_u32 s83, s18, 0
buffer_load_dwordx4 v[128:131], v2, s[12:15], s83 offen offset:0 sc1
buffer_load_dwordx4 v[132:135], v2, s[12:15], s83 offen offset:1024 sc1
buffer_load_dwordx4 v[136:139], v2, s[12:15], s83 offen offset:2048 sc1
s_add_u32 s83, s18, 12288
buffer_load_dwordx4 v[140:143], v2, s[12:15], s83 offen offset:0 sc1
buffer_load_dwordx4 v[144:147], v2, s[12:15], s83 offen offset:1024 sc1
buffer_load_dwordx4 v[148:151], v2, s[12:15], s83 offen offset:2048 sc1
s_add_u32 s83, s18, 24576
buffer_load_dwordx4 v[152:155], v2, s[12:15], s83 offen offset:0 sc1
buffer_load_dwordx4 v[156:159], v2, s[12:15], s83 offen offset:1024 sc1
buffer_load_dwordx4 v[160:163], v2, s[12:15], s83 offen offset:2048 sc1
s_waitcnt vmcnt(0)
s_branch XCHK0
XOK0:
s_barrier
s_xor_b32 s19, s19, 0x80000000
v_mov_b32 v62, s19
s_cmp_eq_u32 s16, 0x1000000
s_cbranch_scc1 NOPUB0
s_and_b32 s80, s2, 3
s_and_b32 s81, s68, 2
s_sub_u32 s80, s80, s81
s_sub_u32 s80, s80, 0
s_mul_i32 s80, s80, 36864
s_add_u32 s82, s16, s80
v_cvt_pk_bf16_f32 v40, v64, v65
v_cvt_pk_bf16_f32 v41, v66, v67
v_cvt_pk_bf16_f32 v42, v72, v73
v_cvt_pk_bf16_f32 v43, v74, v62
buffer_store_dwordx4 v[40:43], v2, s[12:15], s82 offen offset:0 sc1
v_cvt_pk_bf16_f32 v44, v75, v80
v_cvt_pk_bf16_f32 v45, v81, v82
v_cvt_pk_bf16_f32 v46, v83, v88
v_cvt_pk_bf16_f32 v47, v89, v62
buffer_store_dwordx4 v[44:47], v2, s[12:15], s82 offen offset:1024 sc1
v_cvt_pk_bf16_f32 v48, v90, v91
v_cvt_pk_bf16_f32 v49, v96, v97
v_cvt_pk_bf16_f32 v50, v98, v99
v_cvt_pk_bf16_f32 v51, v62, v62
buffer_store_dwordx4 v[48:51], v2, s[12:15], s82 offen offset:2048 sc1
v_cvt_pk_bf16_f32 v240, v68, v69
v_cvt_pk_bf16_f32 v241, v70, v71
v_cvt_pk_bf16_f32 v242, v76, v77
v_cvt_pk_bf16_f32 v243, v78, v62
buffer_store_dwordx4 v[240:243], v2, s[12:15], s82 offen offset:3072 sc1
v_cvt_pk_bf16_f32 v244, v79, v84
v_cvt_pk_bf16_f32 v245, v85, v86
v_cvt_pk_bf16_f32 v246, v87, v92
v_cvt_pk_bf16_f32 v247, v93, v62
buffer_store_dwordx4 v[244:247], v61, s[12:15], s82 offen offset:0 sc1
v_cvt_pk_bf16_f32 v248, v94, v95
v_cvt_pk_bf16_f32 v249, v100, v101
v_cvt_pk_bf16_f32 v250, v102, v103
v_cvt_pk_bf16_f32 v251, v62, v62
buffer_store_dwordx4 v[248:251], v61, s[12:15], s82 offen offset:1024 sc1
NOPUB0:
s_cmp_eq_u32 s17, 0x1000000
s_cbranch_scc1 NOPUB1
s_and_b32 s80, s2, 3
s_and_b32 s81, s68, 2
s_sub_u32 s80, s80, s81
s_sub_u32 s80, s80, 1
s_mul_i32 s80, s80, 36864
s_add_u32 s82, s17, s80
v_cvt_pk_bf16_f32 v40, v104, v105
v_cvt_pk_bf16_f32 v41, v106, v107
v_cvt_pk_bf16_f32 v42, v112, v113
v_cvt_pk_bf16_f32 v43, v114, v62
buffer_store_dwordx4 v[40:43], v2, s[12:15], s82 offen offset:0 sc1
v_cvt_pk_bf16_f32 v44, v115, v120
v_cvt_pk_bf16_f32 v45, v121, v122
v_cvt_pk_bf16_f32 v46, v123, v208
v_cvt_pk_bf16_f32 v47, v209, v62
buffer_store_dwordx4 v[44:47], v2, s[12:15], s82 offen offset:1024 sc1
v_cvt_pk_bf16_f32 v48, v210, v211
v_cvt_pk_bf16_f32 v49, v216, v217
v_cvt_pk_bf16_f32 v50, v218, v219
v_cvt_pk_bf16_f32 v51, v62, v62
buffer_store_dwordx4 v[48:51], v2, s[12:15], s82 offen offset:2048 sc1
v_cvt_pk_bf16_f32 v240, v108, v109
v_cvt_pk_bf16_f32 v241, v110, v111
v_cvt_pk_bf16_f32 v242, v116, v117
v_cvt_pk_bf16_f32 v243, v118, v62
buffer_store_dwordx4 v[240:243], v2, s[12:15], s82 offen offset:3072 sc1
v_cvt_pk_bf16_f32 v244, v119, v124
v_cvt_pk_bf16_f32 v245, v125, v126
v_cvt_pk_bf16_f32 v246, v127, v212
v_cvt_pk_bf16_f32 v247, v213, v62
buffer_store_dwordx4 v[244:247], v61, s[12:15], s82 offen offset:0 sc1
v_cvt_pk_bf16_f32 v248, v214, v215
v_cvt_pk_bf16_f32 v249, v220, v221
v_cvt_pk_bf16_f32 v250, v222, v223
v_cvt_pk_bf16_f32 v251, v62, v62
buffer_store_dwordx4 v[248:251], v61, s[12:15], s82 offen offset:1024 sc1
NOPUB1:
s_cmp_lg_u32 s16, 0x1000000
s_cbranch_scc1 NOOWN10
ds_write_b128 v3, v[64:67] offset:0
ds_write_b128 v3, v[72:75] offset:1024
ds_write_b128 v3, v[80:83] offset:2048
ds_write_b128 v3, v[88:91] offset:3072
ds_write_b128 v3, v[96:99] offset:4096
ds_write_b128 v3, v[68:71] offset:5120
ds_write_b128 v3, v[76:79] offset:6144
ds_write_b128 v3, v[84:87] offset:7168
ds_write_b128 v3, v[92:95] offset:8192
ds_write_b128 v3, v[100:103] offset:9216
NOOWN10:
s_cmp_lg_u32 s17, 0x1000000
s_cbranch_scc1 NOOWN11
ds_write_b128 v3, v[104:107] offset:0
ds_write_b128 v3, v[112:115] offset:1024
ds_write_b128 v3, v[120:123] offset:2048
ds_write_b128 v3, v[208:211] offset:3072
ds_write_b128 v3, v[216:219] offset:4096
ds_write_b128 v3, v[108:111] offset:5120
ds_write_b128 v3, v[116:119] offset:6144
ds_write_b128 v3, v[124:127] offset:7168
ds_write_b128 v3, v[212:215] offset:8192
ds_write_b128 v3, v[220:223] offset:9216
NOOWN11:
v_add_u32 v52, 122880, v4
s_and_b32 s80, s2, 3
s_xor_b32 s81, s80, 1
s_sub_u32 s80, s81, s80
s_mul_i32 s80, s80, 36864
s_add_u32 s80, s80, s18
s_add_u32 s72, s80, 0
s_and_b32 s80, s2, 3
s_xor_b32 s81, s80, 2
s_sub_u32 s80, s81, s80
s_mul_i32 s80, s80, 36864
s_add_u32 s80, s80, s18
s_add_u32 s73, s80, 12288
s_and_b32 s80, s2, 3
s_xor_b32 s81, s80, 3
s_sub_u32 s80, s81, s80
s_mul_i32 s80, s80, 36864
s_add_u32 s80, s80, s18
s_add_u32 s74, s80, 24576
s_waitcnt lgkmcnt(0)
s_barrier
ds_read_b128 v[164:167], v52 offset:0
ds_read_b128 v[168:171], v52 offset:1024
ds_read_b128 v[172:175], v52 offset:2048
ds_read_b128 v[176:179], v52 offset:3072
ds_read_b128 v[180:183], v52 offset:4096
ds_read_b128 v[184:187], v4 offset:0
ds_read_b128 v[188:191], v4 offset:1024
ds_read_b128 v[192:195], v4 offset:2048
ds_read_b128 v[196:199], v4 offset:3072
ds_read_b128 v[200:203], v4 offset:4096
s_waitcnt lgkmcnt(0)
v_mov_b32 v36, 0x3c853526
v_mov_b32 v38, s74
v_writelane_b32 v38, s72, 0
v_writelane_b32 v38, s73, 1
s_movk_i32 s84, 3068
s_mov_b32 s85, 0
v_lshlrev_b32 v20, 16, v128
v_and_b32 v21, 0xffff0000, v128
v_lshlrev_b32 v22, 16, v129
v_and_b32 v23, 0xffff0000, v129
v_lshlrev_b32 v24, 16, v140
v_and_b32 v25, 0xffff0000, v140
v_lshlrev_b32 v26, 16, v141
v_and_b32 v27, 0xffff0000, v141
v_lshlrev_b32 v28, 16, v152
v_and_b32 v29, 0xffff0000, v152
v_lshlrev_b32 v30, 16, v153
v_and_b32 v31, 0xffff0000, v153
v_pk_add_f32 v[164:165], v[164:165], v[20:21]
v_pk_add_f32 v[24:25], v[24:25], v[28:29]
v_pk_add_f32 v[166:167], v[166:167], v[22:23]
v_pk_add_f32 v[26:27], v[26:27], v[30:31]
v_pk_add_f32 v[164:165], v[164:165], v[24:25]
v_pk_add_f32 v[166:167], v[166:167], v[26:27]
v_mul_f32 v100, 0xc2b17218, v164
v_mul_f32 v101, 0xc2b17218, v165
v_mul_f32 v102, 0xc2b17218, v166
v_mul_f32 v103, 0xc2b17218, v167
v_exp_f32 v100, v100
v_exp_f32 v101, v101
v_exp_f32 v102, v102
v_exp_f32 v103, v103
s_nop 0
v_fma_f32 v100, v100, v36, v36
v_fma_f32 v101, v101, v36, v36
v_fma_f32 v102, v102, v36, v36
v_fma_f32 v103, v103, v36, v36
v_rcp_f32 v100, v100
v_rcp_f32 v101, v101
v_rcp_f32 v102, v102
v_rcp_f32 v103, v103
s_nop 0
v_mul_f32 v100, v100, v164
v_mul_f32 v101, v101, v165
v_mul_f32 v102, v102, v166
v_mul_f32 v103, v103, v167
v_lshlrev_b32 v20, 16, v130
v_and_b32 v21, 0xffff0000, v130
v_lshlrev_b32 v22, 16, v131
v_lshlrev_b32 v23, 16, v132
v_lshlrev_b32 v24, 16, v142
v_and_b32 v25, 0xffff0000, v142
v_lshlrev_b32 v26, 16, v143
v_lshlrev_b32 v27, 16, v144
v_lshlrev_b32 v28, 16, v154
v_and_b32 v29, 0xffff0000, v154
v_lshlrev_b32 v30, 16, v155
v_lshlrev_b32 v31, 16, v156
v_pk_add_f32 v[168:169], v[168:169], v[20:21]
v_pk_add_f32 v[24:25], v[24:25], v[28:29]
v_pk_add_f32 v[170:171], v[170:171], v[22:23]
v_pk_add_f32 v[26:27], v[26:27], v[30:31]
v_pk_add_f32 v[168:169], v[168:169], v[24:25]
v_pk_add_f32 v[170:171], v[170:171], v[26:27]
v_mul_f32 v104, 0xc2b17218, v168
v_mul_f32 v105, 0xc2b17218, v169
v_mul_f32 v106, 0xc2b17218, v170
v_mul_f32 v107, 0xc2b17218, v171
v_exp_f32 v104, v104
v_exp_f32 v105, v105
v_exp_f32 v106, v106
v_exp_f32 v107, v107
s_nop 0
v_fma_f32 v104, v104, v36, v36
v_fma_f32 v105, v105, v36, v36
v_fma_f32 v106, v106, v36, v36
v_fma_f32 v107, v107, v36, v36
v_rcp_f32 v104, v104
v_rcp_f32 v105, v105
v_rcp_f32 v106, v106
v_rcp_f32 v107, v107
s_nop 0
v_mul_f32 v104, v104, v168
v_mul_f32 v105, v105, v169
v_mul_f32 v106, v106, v170
v_mul_f32 v107, v107, v171
v_and_b32 v20, 0xffff0000, v132
v_lshlrev_b32 v21, 16, v133
v_and_b32 v22, 0xffff0000, v133
v_lshlrev_b32 v23, 16, v134
v_and_b32 v24, 0xffff0000, v144
v_lshlrev_b32 v25, 16, v145
v_and_b32 v26, 0xffff0000, v145
v_lshlrev_b32 v27, 16, v146
v_and_b32 v28, 0xffff0000, v156
v_lshlrev_b32 v29, 16, v157
v_and_b32 v30, 0xffff0000, v157
v_lshlrev_b32 v31, 16, v158
v_pk_add_f32 v[172:173], v[172:173], v[20:21]
v_pk_add_f32 v[24:25], v[24:25], v[28:29]
v_pk_add_f32 v[174:175], v[174:175], v[22:23]
v_pk_add_f32 v[26:27], v[26:27], v[30:31]
v_pk_add_f32 v[172:173], v[172:173], v[24:25]
v_pk_add_f32 v[174:175], v[174:175], v[26:27]
v_mul_f32 v108, 0xc2b17218, v172
v_mul_f32 v109, 0xc2b17218, v173
v_mul_f32 v110, 0xc2b17218, v174
v_mul_f32 v111, 0xc2b17218, v175
v_exp_f32 v108, v108
v_exp_f32 v109, v109
v_exp_f32 v110, v110
v_exp_f32 v111, v111
s_nop 0
v_fma_f32 v108, v108, v36, v36
v_fma_f32 v109, v109, v36, v36
v_fma_f32 v110, v110, v36, v36
v_fma_f32 v111, v111, v36, v36
v_rcp_f32 v108, v108
v_rcp_f32 v109, v109
v_rcp_f32 v110, v110
v_rcp_f32 v111, v111
s_nop 0
v_mul_f32 v108, v108, v172
v_mul_f32 v109, v109, v173
v_mul_f32 v110, v110, v174
v_mul_f32 v111, v111, v175
v_and_b32 v20, 0xffff0000, v134
v_lshlrev_b32 v21, 16, v135
v_lshlrev_b32 v22, 16, v136
v_and_b32 v23, 0xffff0000, v136
v_and_b32 v24, 0xffff0000, v146
v_lshlrev_b32 v25, 16, v147
v_lshlrev_b32 v26, 16, v148
v_and_b32 v27, 0xffff0000, v148
v_and_b32 v28, 0xffff0000, v158
v_lshlrev_b32 v29, 16, v159
v_lshlrev_b32 v30, 16, v160
v_and_b32 v31, 0xffff0000, v160
v_pk_add_f32 v[176:177], v[176:177], v[20:21]
v_pk_add_f32 v[24:25], v[24:25], v[28:29]
v_pk_add_f32 v[178:179], v[178:179], v[22:23]
v_pk_add_f32 v[26:27], v[26:27], v[30:31]
v_pk_add_f32 v[176:177], v[176:177], v[24:25]
v_pk_add_f32 v[178:179], v[178:179], v[26:27]
v_mul_f32 v112, 0xc2b17218, v176
v_mul_f32 v113, 0xc2b17218, v177
v_mul_f32 v114, 0xc2b17218, v178
v_mul_f32 v115, 0xc2b17218, v179
v_exp_f32 v112, v112
v_exp_f32 v113, v113
v_exp_f32 v114, v114
v_exp_f32 v115, v115
s_nop 0
v_fma_f32 v112, v112, v36, v36
v_fma_f32 v113, v113, v36, v36
v_fma_f32 v114, v114, v36, v36
v_fma_f32 v115, v115, v36, v36
v_rcp_f32 v112, v112
v_rcp_f32 v113, v113
v_rcp_f32 v114, v114
v_rcp_f32 v115, v115
s_nop 0
v_mul_f32 v112, v112, v176
v_mul_f32 v113, v113, v177
v_mul_f32 v114, v114, v178
v_mul_f32 v115, v115, v179
v_lshlrev_b32 v20, 16, v137
v_and_b32 v21, 0xffff0000, v137
v_lshlrev_b32 v22, 16, v138
v_and_b32 v23, 0xffff0000, v138
v_lshlrev_b32 v24, 16, v149
v_and_b32 v25, 0xffff0000, v149
v_lshlrev_b32 v26, 16, v150
v_and_b32 v27, 0xffff0000, v150
v_lshlrev_b32 v28, 16, v161
v_and_b32 v29, 0xffff0000, v161
v_lshlrev_b32 v30, 16, v162
v_and_b32 v31, 0xffff0000, v162
v_pk_add_f32 v[180:181], v[180:181], v[20:21]
v_pk_add_f32 v[24:25], v[24:25], v[28:29]
v_pk_add_f32 v[182:183], v[182:183], v[22:23]
v_pk_add_f32 v[26:27], v[26:27], v[30:31]
v_pk_add_f32 v[180:181], v[180:181], v[24:25]
v_pk_add_f32 v[182:183], v[182:183], v[26:27]
v_mul_f32 v116, 0xc2b17218, v180
v_mul_f32 v117, 0xc2b17218, v181
v_mul_f32 v118, 0xc2b17218, v182
v_mul_f32 v119, 0xc2b17218, v183
v_exp_f32 v116, v116
v_exp_f32 v117, v117
v_exp_f32 v118, v118
v_exp_f32 v119, v119
s_nop 0
v_fma_f32 v116, v116, v36, v36
v_fma_f32 v117, v117, v36, v36
v_fma_f32 v118, v118, v36, v36
v_fma_f32 v119, v119, v36, v36
v_rcp_f32 v116, v116
v_rcp_f32 v117, v117
v_rcp_f32 v118, v118
v_rcp_f32 v119, v119
s_nop 0
v_mul_f32 v116, v116, v180
v_mul_f32 v117, v117, v181
v_mul_f32 v118, v118, v182
v_mul_f32 v119, v119, v183
v_lshlrev_b32 v128, 16, v224
v_and_b32 v129, 0xffff0000, v224
v_lshlrev_b32 v130, 16, v225
v_and_b32 v131, 0xffff0000, v225
v_lshlrev_b32 v132, 16, v226
v_and_b32 v133, 0xffff0000, v226
v_lshlrev_b32 v134, 16, v227
v_and_b32 v135, 0xffff0000, v227
v_lshlrev_b32 v136, 16, v228
v_and_b32 v137, 0xffff0000, v228
v_lshlrev_b32 v138, 16, v229
v_and_b32 v139, 0xffff0000, v229
v_lshlrev_b32 v140, 16, v230
v_and_b32 v141, 0xffff0000, v230
v_lshlrev_b32 v142, 16, v231
v_and_b32 v143, 0xffff0000, v231
v_lshlrev_b32 v144, 16, v232
v_and_b32 v145, 0xffff0000, v232
v_lshlrev_b32 v146, 16, v233
v_and_b32 v147, 0xffff0000, v233
v_lshlrev_b32 v148, 16, v234
v_and_b32 v149, 0xffff0000, v234
v_lshlrev_b32 v150, 16, v235
v_and_b32 v151, 0xffff0000, v235
s_mul_i32 s80, s68, 6720
s_add_u32 s80, s80, 20480
v_and_b32 v14, 15, v1
v_mul_u32_u24 v14, 336, v14
v_lshrrev_b32 v15, 4, v1
v_lshl_add_u32 v14, v15, 4, v14
v_add_u32 v14, s80, v14
v_add_u32 v11, s80, v11
v_add_u32 v12, s80, v12
v_add_u32 v13, s80, v13
s_mov_b32 s87, 0
s_cmp_lg_u32 s85, 0
s_cbranch_scc1 LOADED
PROBE:
buffer_load_dword v37, v38, s[12:15], s84 offen sc1
s_waitcnt vmcnt(0)
v_xor_b32 v37, s19, v37
v_cmp_lt_u32 vcc, 0xffff, v37
s_add_u32 s87, s87, 1
s_cmp_eq_u64 vcc, 0
s_cbranch_scc1 PROBED
s_cmp_ge_u32 s87, 0x40000
s_cbranch_scc1 PROBED
s_sleep 12
s_branch PROBE
PROBED:
s_mov_b32 s83, s72
buffer_load_dwordx4 v[64:67], v2, s[12:15], s83 offen offset:0 sc1
buffer_load_dwordx4 v[68:71], v2, s[12:15], s83 offen offset:1024 sc1
buffer_load_dwordx4 v[72:75], v2, s[12:15], s83 offen offset:2048 sc1
s_mov_b32 s83, s73
buffer_load_dwordx4 v[76:79], v2, s[12:15], s83 offen offset:0 sc1
buffer_load_dwordx4 v[80:83], v2, s[12:15], s83 offen offset:1024 sc1
buffer_load_dwordx4 v[84:87], v2, s[12:15], s83 offen offset:2048 sc1
s_mov_b32 s83, s74
buffer_load_dwordx4 v[88:91], v2, s[12:15], s83 offen offset:0 sc1
buffer_load_dwordx4 v[92:95], v2, s[12:15], s83 offen offset:1024 sc1
buffer_load_dwordx4 v[96:99], v2, s[12:15], s83 offen offset:2048 sc1
LOADED:
s_mov_b32 s87, 0
s_waitcnt vmcnt(0)
XCHK1:
v_xor_b32 v20, s19, v67
v_xor_b32 v21, s19, v71
v_xor_b32 v22, s19, v75
v_xor_b32 v23, s19, v79
v_xor_b32 v24, s19, v83
v_xor_b32 v25, s19, v87
v_xor_b32 v26, s19, v91
v_xor_b32 v27, s19, v95
v_xor_b32 v28, s19, v99
v_or3_b32 v20, v20, v21, v22
v_or3_b32 v20, v20, v23, v24
v_or3_b32 v20, v20, v25, v26
v_or3_b32 v20, v20, v27, v28
v_cmp_lt_u32 vcc, 0xffff, v20
s_add_u32 s87, s87, 1
s_cmp_eq_u64 vcc, 0
s_cbranch_scc1 XOK1
s_cmp_ge_u32 s87, 0x40000
s_cbranch_scc1 XOK1
s_sleep 4
s_mov_b32 s83, s72
buffer_load_dwordx4 v[64:67], v2, s[12:15], s83 offen offset:0 sc1
buffer_load_dwordx4 v[68:71], v2, s[12:15], s83 offen offset:1024 sc1
buffer_load_dwordx4 v[72:75], v2, s[12:15], s83 offen offset:2048 sc1
s_mov_b32 s83, s73
buffer_load_dwordx4 v[76:79], v2, s[12:15], s83 offen offset:0 sc1
buffer_load_dwordx4 v[80:83], v2, s[12:15], s83 offen offset:1024 sc1
buffer_load_dwordx4 v[84:87], v2, s[12:15], s83 offen offset:2048 sc1
s_mov_b32 s83, s74
buffer_load_dwordx4 v[88:91], v2, s[12:15], s83 offen offset:0 sc1
buffer_load_dwordx4 v[92:95], v2, s[12:15], s83 offen offset:1024 sc1
buffer_load_dwordx4 v[96:99], v2, s[12:15], s83 offen offset:2048 sc1
s_waitcnt vmcnt(0)
s_branch XCHK1
XOK1:
v_lshlrev_b32 v20, 16, v64
v_and_b32 v21, 0xffff0000, v64
v_lshlrev_b32 v22, 16, v65
v_and_b32 v23, 0xffff0000, v65
v_lshlrev_b32 v24, 16, v76
v_and_b32 v25, 0xffff0000, v76
v_lshlrev_b32 v26, 16, v77
v_and_b32 v27, 0xffff0000, v77
v_lshlrev_b32 v28, 16, v88
v_and_b32 v29, 0xffff0000, v88
v_lshlrev_b32 v30, 16, v89
v_and_b32 v31, 0xffff0000, v89
v_pk_add_f32 v[184:185], v[184:185], v[20:21]
v_pk_add_f32 v[24:25], v[24:25], v[28:29]
v_pk_add_f32 v[186:187], v[186:187], v[22:23]
v_pk_add_f32 v[26:27], v[26:27], v[30:31]
v_pk_add_f32 v[184:185], v[184:185], v[24:25]
v_pk_add_f32 v[186:187], v[186:187], v[26:27]
v_pk_mul_f32 v[184:185], v[184:185], v[100:101]
v_pk_mul_f32 v[186:187], v[186:187], v[102:103]
ds_write_b128 v14, v[184:187] offset:0
v_lshlrev_b32 v20, 16, v66
v_and_b32 v21, 0xffff0000, v66
v_lshlrev_b32 v22, 16, v67
v_lshlrev_b32 v23, 16, v68
v_lshlrev_b32 v24, 16, v78
v_and_b32 v25, 0xffff0000, v78
v_lshlrev_b32 v26, 16, v79
v_lshlrev_b32 v27, 16, v80
v_lshlrev_b32 v28, 16, v90
v_and_b32 v29, 0xffff0000, v90
v_lshlrev_b32 v30, 16, v91
v_lshlrev_b32 v31, 16, v92
v_pk_add_f32 v[188:189], v[188:189], v[20:21]
v_pk_add_f32 v[24:25], v[24:25], v[28:29]
v_pk_add_f32 v[190:191], v[190:191], v[22:23]
v_pk_add_f32 v[26:27], v[26:27], v[30:31]
v_pk_add_f32 v[188:189], v[188:189], v[24:25]
v_pk_add_f32 v[190:191], v[190:191], v[26:27]
v_pk_mul_f32 v[188:189], v[188:189], v[104:105]
v_pk_mul_f32 v[190:191], v[190:191], v[106:107]
ds_write_b128 v14, v[188:191] offset:64
v_and_b32 v20, 0xffff0000, v68
v_lshlrev_b32 v21, 16, v69
v_and_b32 v22, 0xffff0000, v69
v_lshlrev_b32 v23, 16, v70
v_and_b32 v24, 0xffff0000, v80
v_lshlrev_b32 v25, 16, v81
v_and_b32 v26, 0xffff0000, v81
v_lshlrev_b32 v27, 16, v82
v_and_b32 v28, 0xffff0000, v92
v_lshlrev_b32 v29, 16, v93
v_and_b32 v30, 0xffff0000, v93
v_lshlrev_b32 v31, 16, v94
v_pk_add_f32 v[192:193], v[192:193], v[20:21]
v_pk_add_f32 v[24:25], v[24:25], v[28:29]
v_pk_add_f32 v[194:195], v[194:195], v[22:23]
v_pk_add_f32 v[26:27], v[26:27], v[30:31]
v_pk_add_f32 v[192:193], v[192:193], v[24:25]
v_pk_add_f32 v[194:195], v[194:195], v[26:27]
v_pk_mul_f32 v[192:193], v[192:193], v[108:109]
v_pk_mul_f32 v[194:195], v[194:195], v[110:111]
ds_write_b128 v14, v[192:195] offset:128
v_and_b32 v20, 0xffff0000, v70
v_lshlrev_b32 v21, 16, v71
v_lshlrev_b32 v22, 16, v72
v_and_b32 v23, 0xffff0000, v72
v_and_b32 v24, 0xffff0000, v82
v_lshlrev_b32 v25, 16, v83
v_lshlrev_b32 v26, 16, v84
v_and_b32 v27, 0xffff0000, v84
v_and_b32 v28, 0xffff0000, v94
v_lshlrev_b32 v29, 16, v95
v_lshlrev_b32 v30, 16, v96
v_and_b32 v31, 0xffff0000, v96
v_pk_add_f32 v[196:197], v[196:197], v[20:21]
v_pk_add_f32 v[24:25], v[24:25], v[28:29]
v_pk_add_f32 v[198:199], v[198:199], v[22:23]
v_pk_add_f32 v[26:27], v[26:27], v[30:31]
v_pk_add_f32 v[196:197], v[196:197], v[24:25]
v_pk_add_f32 v[198:199], v[198:199], v[26:27]
v_pk_mul_f32 v[196:197], v[196:197], v[112:113]
v_pk_mul_f32 v[198:199], v[198:199], v[114:115]
ds_write_b128 v14, v[196:199] offset:192
v_lshlrev_b32 v20, 16, v73
v_and_b32 v21, 0xffff0000, v73
v_lshlrev_b32 v22, 16, v74
v_and_b32 v23, 0xffff0000, v74
v_lshlrev_b32 v24, 16, v85
v_and_b32 v25, 0xffff0000, v85
v_lshlrev_b32 v26, 16, v86
v_and_b32 v27, 0xffff0000, v86
v_lshlrev_b32 v28, 16, v97
v_and_b32 v29, 0xffff0000, v97
v_lshlrev_b32 v30, 16, v98
v_and_b32 v31, 0xffff0000, v98
v_pk_add_f32 v[200:201], v[200:201], v[20:21]
v_pk_add_f32 v[24:25], v[24:25], v[28:29]
v_pk_add_f32 v[202:203], v[202:203], v[22:23]
v_pk_add_f32 v[26:27], v[26:27], v[30:31]
v_pk_add_f32 v[200:201], v[200:201], v[24:25]
v_pk_add_f32 v[202:203], v[202:203], v[26:27]
v_pk_mul_f32 v[200:201], v[200:201], v[116:117]
v_pk_mul_f32 v[202:203], v[202:203], v[118:119]
ds_write_b128 v14, v[200:203] offset:256
ds_read_b128 v[64:67], v11 offset:0
ds_read_b128 v[68:71], v11 offset:16
ds_read_b128 v[72:75], v12 offset:0
ds_read_b128 v[76:79], v12 offset:16
ds_read_b128 v[80:83], v13 offset:0
ds_read_b128 v[84:87], v13 offset:16
s_waitcnt lgkmcnt(4)
v_pk_add_f32 v[64:65], v[64:65], v[128:129]
v_pk_add_f32 v[66:67], v[66:67], v[130:131]
v_pk_add_f32 v[68:69], v[68:69], v[132:133]
v_pk_add_f32 v[70:71], v[70:71], v[134:135]
v_cvt_pk_bf16_f32 v100, v64, v65
v_cvt_pk_bf16_f32 v101, v66, v67
v_cvt_pk_bf16_f32 v102, v68, v69
v_cvt_pk_bf16_f32 v103, v70, v71
buffer_store_dwordx4 v[100:103], v8, s[8:11], 0 offen sc1
s_waitcnt lgkmcnt(2)
v_pk_add_f32 v[72:73], v[72:73], v[136:137]
v_pk_add_f32 v[74:75], v[74:75], v[138:139]
v_pk_add_f32 v[76:77], v[76:77], v[140:141]
v_pk_add_f32 v[78:79], v[78:79], v[142:143]
v_cvt_pk_bf16_f32 v104, v72, v73
v_cvt_pk_bf16_f32 v105, v74, v75
v_cvt_pk_bf16_f32 v106, v76, v77
v_cvt_pk_bf16_f32 v107, v78, v79
buffer_store_dwordx4 v[104:107], v9, s[8:11], 0 offen sc1
s_waitcnt lgkmcnt(0)
v_pk_add_f32 v[80:81], v[80:81], v[144:145]
v_pk_add_f32 v[82:83], v[82:83], v[146:147]
v_pk_add_f32 v[84:85], v[84:85], v[148:149]
v_pk_add_f32 v[86:87], v[86:87], v[150:151]
v_cvt_pk_bf16_f32 v108, v80, v81
v_cvt_pk_bf16_f32 v109, v82, v83
v_cvt_pk_bf16_f32 v110, v84, v85
v_cvt_pk_bf16_f32 v111, v86, v87
buffer_store_dwordx4 v[108:111], v10, s[8:11], 0 offen sc1
K_END:
s_endpgm
LT_INIT:
s_sub_u32 s80, s71, 27
s_lshl_b32 s80, s80, 3
s_add_u32 s80, s80, s70
s_lshl2_add_u32 s80, s80, s68
s_mul_i32 s81, s80, 3277
s_lshr_b32 s81, s81, 16
s_mul_i32 s86, s81, 20
s_sub_u32 s80, s80, s86
s_mul_i32 s91, s81, 40960
s_lshl_b32 s86, s80, 6
s_add_u32 s91, s91, s86
s_add_u32 s96, s81, 104
s_mul_i32 s96, s96, 10240
s_add_u32 s44, s60, 0
s_addc_u32 s45, s61, 0
s_mov_b32 s46, 2211840
s_mov_b32 s47, 0x20000
s_mul_i32 s86, s80, 13108
s_lshr_b32 s86, s86, 16
s_mul_i32 s86, s86, 1857536
s_lshl_b32 s81, s80, 11
s_add_u32 s86, s86, s81
s_add_u32 s86, s86, 25165824
s_add_u32 s48, s66, s86
s_addc_u32 s49, s67, 0
s_mov_b32 s50, 1855488
s_mov_b32 s51, 0x20000
s_mul_i32 s80, s68, 6144
s_add_u32 s80, s80, 131072
s_mov_b32 s97, 0
s_mov_b32 s85, 196608
v_lshrrev_b32 v46, 2, v1
v_bfe_u32 v47, v1, 4, 1
v_and_b32 v48, 3, v1
v_lshlrev_b32 v49, 1, v47
v_xor_b32 v49, v49, v48
v_mul_u32_u24 v40, 1280, v46
v_lshl_add_u32 v40, v49, 4, v40
v_add_u32 v41, 19456, v40
v_lshlrev_b32 v42, 6, v46
v_lshl_add_u32 v42, v48, 3, v42
v_lshl_add_u32 v42, v47, 5, v42
v_add_u32 v42, s80, v42
v_xor_b32 v43, 32, v42
v_mov_b32 v44, v42
v_mov_b32 v45, v43
.p2align 6
LT_LOOP:
v_mfma_f32_16x16x32_bf16 v[128:131], a[224:227], v[64:67], v[224:227]
s_waitcnt vmcnt(24) lgkmcnt(0)
v_exp_f32 v164, v164
v_mfma_f32_16x16x32_bf16 v[128:131], a[228:231], v[80:83], v[128:131]
s_barrier
v_mfma_f32_16x16x32_bf16 v[128:131], a[232:235], v[96:99], v[128:131]
ds_read_b64_tr_b16 v[48:49], v44 offset:0
v_exp_f32 v165, v165
v_mfma_f32_16x16x32_bf16 v[128:131], a[236:239], v[112:115], v[128:131]
v_cvt_pk_bf16_f32 v196, v136, v137
v_cvt_pk_bf16_f32 v197, v138, v139
v_mfma_f32_16x16x32_bf16 v[132:135], a[252:255], v[112:115], v[224:227]
ds_read_b64_tr_b16 v[50:51], v44 offset:1024
v_exp_f32 v166, v166
v_mfma_f32_16x16x32_bf16 v[132:135], a[248:251], v[96:99], v[132:135]
ds_read_b64_tr_b16 a[0:1], v24 offset:0
v_cvt_pk_bf16_f32 v198, v140, v141
v_mfma_f32_16x16x32_bf16 v[132:135], a[244:247], v[80:83], v[132:135]
ds_read_b64_tr_b16 v[52:53], v45 offset:0
v_exp_f32 v167, v167
v_mfma_f32_16x16x32_bf16 v[132:135], a[240:243], v[64:67], v[132:135]
v_cvt_pk_bf16_f32 v199, v142, v143
v_cvt_pk_bf16_f32 v200, v144, v145
v_mfma_f32_16x16x32_bf16 v[140:143], a[240:243], v[68:71], v[228:231]
ds_read_b64_tr_b16 v[54:55], v45 offset:1024
v_exp_f32 v168, v168
v_mfma_f32_16x16x32_bf16 v[140:143], a[244:247], v[84:87], v[140:143]
ds_read_b64_tr_b16 a[2:3], v24 offset:4096
v_cvt_pk_bf16_f32 v201, v146, v147
v_mfma_f32_16x16x32_bf16 v[140:143], a[248:251], v[100:103], v[140:143]
v_exp_f32 v169, v169
v_mfma_f32_16x16x32_bf16 v[140:143], a[252:255], v[116:119], v[140:143]
v_cvt_pk_bf16_f32 v202, v148, v149
v_cvt_pk_bf16_f32 v203, v150, v151
v_mfma_f32_16x16x32_bf16 v[136:139], a[236:239], v[116:119], v[228:231]
v_exp_f32 v170, v170
v_mfma_f32_16x16x32_bf16 v[136:139], a[232:235], v[100:103], v[136:139]
ds_read_b64_tr_b16 a[32:33], v24 offset:8192
v_cvt_pk_bf16_f32 v204, v152, v153
v_mfma_f32_16x16x32_bf16 v[136:139], a[228:231], v[84:87], v[136:139]
v_exp_f32 v171, v171
v_mfma_f32_16x16x32_bf16 v[136:139], a[224:227], v[68:71], v[136:139]
v_cvt_pk_bf16_f32 v205, v154, v155
v_cvt_pk_bf16_f32 v206, v156, v157
v_mfma_f32_16x16x32_bf16 v[144:147], a[224:227], v[72:75], v[232:235]
v_exp_f32 v172, v172
v_mfma_f32_16x16x32_bf16 v[144:147], a[228:231], v[88:91], v[144:147]
ds_read_b64_tr_b16 a[34:35], v24 offset:12288
v_cvt_pk_bf16_f32 v207, v158, v159
v_mfma_f32_16x16x32_bf16 v[144:147], a[232:235], v[104:107], v[144:147]
v_exp_f32 v173, v173
v_mfma_f32_16x16x32_bf16 v[144:147], a[236:239], v[120:123], v[144:147]
ds_read_b64_tr_b16 a[4:5], v25 offset:0
v_cvt_pk_bf16_f32 v208, v160, v161
v_mfma_f32_16x16x32_bf16 v[148:151], a[252:255], v[120:123], v[232:235]
v_exp_f32 v174, v174
v_mfma_f32_16x16x32_bf16 v[148:151], a[248:251], v[104:107], v[148:151]
ds_read_b64_tr_b16 a[6:7], v25 offset:4096
v_cvt_pk_bf16_f32 v209, v162, v163
v_mfma_f32_16x16x32_bf16 v[148:151], a[244:247], v[88:91], v[148:151]
v_exp_f32 v175, v175
v_mfma_f32_16x16x32_bf16 v[148:151], a[240:243], v[72:75], v[148:151]
ds_read_b64_tr_b16 a[36:37], v25 offset:8192
v_cvt_pk_bf16_f32 v210, v164, v165
v_mfma_f32_16x16x32_bf16 v[156:159], a[240:243], v[76:79], v[236:239]
v_exp_f32 v176, v176
v_mfma_f32_16x16x32_bf16 v[156:159], a[244:247], v[92:95], v[156:159]
ds_read_b64_tr_b16 a[38:39], v25 offset:12288
v_cvt_pk_bf16_f32 v211, v166, v167
v_mfma_f32_16x16x32_bf16 v[156:159], a[248:251], v[108:111], v[156:159]
v_exp_f32 v177, v177
v_mfma_f32_16x16x32_bf16 v[156:159], a[252:255], v[124:127], v[156:159]
ds_read_b64_tr_b16 a[8:9], v26 offset:0
v_cvt_pk_bf16_f32 v212, v168, v169
v_mfma_f32_16x16x32_bf16 v[152:155], a[236:239], v[124:127], v[236:239]
v_exp_f32 v178, v178
v_mfma_f32_16x16x32_bf16 v[152:155], a[232:235], v[108:111], v[152:155]
ds_read_b64_tr_b16 a[10:11], v26 offset:4096
v_cvt_pk_bf16_f32 v213, v170, v171
v_mfma_f32_16x16x32_bf16 v[152:155], a[228:231], v[92:95], v[152:155]
v_exp_f32 v179, v179
v_mfma_f32_16x16x32_bf16 v[152:155], a[224:227], v[76:79], v[152:155]
ds_read_b64_tr_b16 a[40:41], v26 offset:8192
v_cvt_pk_bf16_f32 v214, v172, v173
v_mfma_f32_16x16x32_bf16 v[160:163], a[192:195], v[64:67], v[224:227]
v_exp_f32 v180, v180
v_mfma_f32_16x16x32_bf16 v[160:163], a[196:199], v[80:83], v[160:163]
ds_read_b64_tr_b16 a[42:43], v26 offset:12288
v_cvt_pk_bf16_f32 v215, v174, v175
v_mfma_f32_16x16x32_bf16 v[160:163], a[200:203], v[96:99], v[160:163]
v_exp_f32 v181, v181
v_mfma_f32_16x16x32_bf16 v[160:163], a[204:207], v[112:115], v[160:163]
ds_read_b64_tr_b16 a[12:13], v27 offset:0
v_cvt_pk_bf16_f32 v216, v176, v177
v_mfma_f32_16x16x32_bf16 v[164:167], a[220:223], v[112:115], v[224:227]
v_exp_f32 v182, v182
v_mfma_f32_16x16x32_bf16 v[164:167], a[216:219], v[96:99], v[164:167]
ds_read_b64_tr_b16 a[14:15], v27 offset:4096
v_cvt_pk_bf16_f32 v217, v178, v179
v_mfma_f32_16x16x32_bf16 v[164:167], a[212:215], v[80:83], v[164:167]
v_exp_f32 v183, v183
v_mfma_f32_16x16x32_bf16 v[164:167], a[208:211], v[64:67], v[164:167]
ds_read_b64_tr_b16 a[44:45], v27 offset:8192
v_cvt_pk_bf16_f32 v218, v180, v181
v_mfma_f32_16x16x32_bf16 v[172:175], a[208:211], v[68:71], v[228:231]
v_exp_f32 v184, v184
v_mfma_f32_16x16x32_bf16 v[172:175], a[212:215], v[84:87], v[172:175]
ds_read_b64_tr_b16 a[46:47], v27 offset:12288
v_cvt_pk_bf16_f32 v219, v182, v183
v_mfma_f32_16x16x32_bf16 v[172:175], a[216:219], v[100:103], v[172:175]
v_exp_f32 v185, v185
v_mfma_f32_16x16x32_bf16 v[172:175], a[220:223], v[116:119], v[172:175]
ds_read_b64_tr_b16 a[16:17], v28 offset:0
v_cvt_pk_bf16_f32 v220, v184, v185
v_mfma_f32_16x16x32_bf16 v[168:171], a[204:207], v[116:119], v[228:231]
s_waitcnt lgkmcnt(2)
v_exp_f32 v186, v186
v_mfma_f32_16x16x32_bf16 v[168:171], a[200:203], v[100:103], v[168:171]
ds_read_b64_tr_b16 a[18:19], v28 offset:4096
buffer_store_dwordx4 v[48:51], v2, s[48:51], s96 offen sc1
v_mfma_f32_16x16x32_bf16 v[168:171], a[196:199], v[84:87], v[168:171]
v_exp_f32 v187, v187
v_mfma_f32_16x16x32_bf16 v[168:171], a[192:195], v[68:71], v[168:171]
ds_read_b64_tr_b16 a[48:49], v28 offset:8192
v_cvt_pk_bf16_f32 v221, v186, v187
v_mfma_f32_16x16x32_bf16 v[176:179], a[192:195], v[72:75], v[232:235]
v_exp_f32 v188, v188
v_mfma_f32_16x16x32_bf16 v[176:179], a[196:199], v[88:91], v[176:179]
ds_read_b64_tr_b16 a[50:51], v28 offset:12288
v_mfma_f32_16x16x32_bf16 v[176:179], a[200:203], v[104:107], v[176:179]
v_exp_f32 v189, v189
v_mfma_f32_16x16x32_bf16 v[176:179], a[204:207], v[120:123], v[176:179]
ds_read_b64_tr_b16 a[20:21], v29 offset:0
v_cvt_pk_bf16_f32 v222, v188, v189
v_mfma_f32_16x16x32_bf16 v[180:183], a[220:223], v[120:123], v[232:235]
v_exp_f32 v190, v190
v_mfma_f32_16x16x32_bf16 v[180:183], a[216:219], v[104:107], v[180:183]
ds_read_b64_tr_b16 a[22:23], v29 offset:4096
buffer_store_dwordx4 v[52:55], v2, s[48:51], s96 offen offset:1024 sc1
v_mfma_f32_16x16x32_bf16 v[180:183], a[212:215], v[88:91], v[180:183]
s_add_u32 m0, s77, s83
v_exp_f32 v191, v191
v_mfma_f32_16x16x32_bf16 v[180:183], a[208:211], v[72:75], v[180:183]
s_add_u32 s96, s96, 81920
v_cvt_pk_bf16_f32 v223, v190, v191
v_mfma_f32_16x16x32_bf16 v[188:191], a[208:211], v[76:79], v[236:239]
buffer_load_dwordx4 v32, s[24:27], s76 offen offset:0 sc1 lds
v_mfma_f32_16x16x32_bf16 v[188:191], a[212:215], v[92:95], v[188:191]
s_sub_u32 s81, s96, 1884160
s_cselect_b32 s96, s96, s81
v_exp_f32 v128, v128
v_mfma_f32_16x16x32_bf16 v[188:191], a[216:219], v[108:111], v[188:191]
buffer_load_dwordx4 v33, s[24:27], s76 offen offset:1024 sc1 lds
v_mfma_f32_16x16x32_bf16 v[188:191], a[220:223], v[124:127], v[188:191]
s_add_u32 m0, s77, s84
v_exp_f32 v129, v129
v_mfma_f32_16x16x32_bf16 v[184:187], a[204:207], v[124:127], v[236:239]
v_exp_f32 v130, v130
v_mfma_f32_16x16x32_bf16 v[184:187], a[200:203], v[108:111], v[184:187]
buffer_load_dwordx4 v34, s[28:31], s76 offen offset:0 sc1 lds
v_mfma_f32_16x16x32_bf16 v[184:187], a[196:199], v[92:95], v[184:187]
s_waitcnt lgkmcnt(0)
v_exp_f32 v131, v131
v_mfma_f32_16x16x32_bf16 v[184:187], a[192:195], v[76:79], v[184:187]
buffer_load_dwordx4 v35, s[28:31], s76 offen offset:1024 sc1 lds
v_smfmac_f32_16x16x64_bf16 v[240:243], v[56:59], v[192:199], v7
s_add_u32 s76, s76, 8192
ds_read_b64_tr_b16 a[52:53], v29 offset:8192
v_smfmac_f32_16x16x64_bf16 v[240:243], v[56:59], v[208:215], v7
s_add_u32 s83, s83, 8192
ds_read_b64_tr_b16 a[54:55], v29 offset:12288
v_smfmac_f32_16x16x64_bf16 v[244:247], v[56:59], v[216:223], v7
s_and_b32 s83, s83, 0xffff
ds_read_b64_tr_b16 a[24:25], v30 offset:0
v_smfmac_f32_16x16x64_bf16 v[244:247], v[56:59], v[200:207], v7
s_add_u32 s84, s84, 8192
ds_read_b64_tr_b16 a[26:27], v30 offset:4096
v_mfma_f32_16x16x32_bf16 a[76:79], a[0:3], v[204:207], a[76:79]
s_and_b32 s84, s84, 0xffff
ds_read_b64_tr_b16 a[56:57], v30 offset:8192
v_xor_b32 v24, s78, v24
v_mfma_f32_16x16x32_bf16 a[76:79], a[32:35], v[220:223], a[76:79]
s_or_b32 s84, s84, 65536
v_exp_f32 v132, v132
v_mfma_f32_16x16x32_bf16 a[72:75], a[32:35], v[216:219], a[72:75]
ds_read_b64_tr_b16 a[58:59], v30 offset:12288
v_xor_b32 v25, s78, v25
v_mfma_f32_16x16x32_bf16 a[72:75], a[0:3], v[200:203], a[72:75]
v_exp_f32 v133, v133
v_mfma_f32_16x16x32_bf16 a[68:71], a[0:3], v[196:199], a[68:71]
ds_read_b64_tr_b16 a[28:29], v31 offset:0
v_xor_b32 v26, s78, v26
v_mfma_f32_16x16x32_bf16 a[68:71], a[32:35], v[212:215], a[68:71]
v_exp_f32 v134, v134
v_mfma_f32_16x16x32_bf16 a[64:67], a[32:35], v[208:211], a[64:67]
ds_read_b64_tr_b16 a[30:31], v31 offset:4096
v_xor_b32 v27, s78, v27
v_mfma_f32_16x16x32_bf16 a[64:67], a[0:3], v[192:195], a[64:67]
v_exp_f32 v135, v135
v_mfma_f32_16x16x32_bf16 a[80:83], a[4:7], v[192:195], a[80:83]
s_add_u32 m0, s77, s83
ds_read_b64_tr_b16 a[60:61], v31 offset:8192
v_xor_b32 v28, s78, v28
v_mfma_f32_16x16x32_bf16 a[80:83], a[36:39], v[208:211], a[80:83]
v_exp_f32 v136, v136
v_mfma_f32_16x16x32_bf16 a[84:87], a[36:39], v[212:215], a[84:87]
ds_read_b64_tr_b16 a[62:63], v31 offset:12288
v_xor_b32 v29, s78, v29
v_mfma_f32_16x16x32_bf16 a[84:87], a[4:7], v[196:199], a[84:87]
buffer_load_dwordx4 v32, s[24:27], s76 offen offset:0 sc1 lds
v_mfma_f32_16x16x32_bf16 a[88:91], a[4:7], v[200:203], a[88:91]
ds_read_b128 a[224:227], v20 offset:0
v_xor_b32 v30, s78, v30
v_mfma_f32_16x16x32_bf16 a[88:91], a[36:39], v[216:219], a[88:91]
buffer_load_dwordx4 v33, s[24:27], s76 offen offset:1024 sc1 lds
v_mfma_f32_16x16x32_bf16 a[92:95], a[36:39], v[220:223], a[92:95]
s_add_u32 m0, s77, s84
ds_read_b128 a[228:231], v21 offset:0
v_xor_b32 v31, s78, v31
v_mfma_f32_16x16x32_bf16 a[92:95], a[4:7], v[204:207], a[92:95]
v_exp_f32 v137, v137
v_mfma_f32_16x16x32_bf16 a[108:111], a[8:11], v[204:207], a[108:111]
ds_read_b128 a[232:235], v22 offset:0
v_mfma_f32_16x16x32_bf16 a[108:111], a[40:43], v[220:223], a[108:111]
buffer_load_dwordx4 v34, s[28:31], s76 offen offset:0 sc1 lds
v_mfma_f32_16x16x32_bf16 a[104:107], a[40:43], v[216:219], a[104:107]
ds_read_b128 a[236:239], v23 offset:0
v_mfma_f32_16x16x32_bf16 a[104:107], a[8:11], v[200:203], a[104:107]
buffer_load_dwordx4 v35, s[28:31], s76 offen offset:1024 sc1 lds
v_mfma_f32_16x16x32_bf16 a[100:103], a[8:11], v[196:199], a[100:103]
s_add_u32 s76, s76, 8192
ds_read_b128 a[240:243], v20 offset:4096
v_mfma_f32_16x16x32_bf16 a[100:103], a[40:43], v[212:215], a[100:103]
s_add_u32 s83, s83, 8192
v_exp_f32 v138, v138
v_mfma_f32_16x16x32_bf16 a[96:99], a[40:43], v[208:211], a[96:99]
s_and_b32 s83, s83, 0xffff
ds_read_b128 a[244:247], v21 offset:4096
v_mfma_f32_16x16x32_bf16 a[96:99], a[8:11], v[192:195], a[96:99]
s_add_u32 s84, s84, 8192
v_exp_f32 v139, v139
v_mfma_f32_16x16x32_bf16 a[112:115], a[12:15], v[192:195], a[112:115]
s_and_b32 s84, s84, 0xffff
ds_read_b128 a[248:251], v22 offset:4096
v_mfma_f32_16x16x32_bf16 a[112:115], a[44:47], v[208:211], a[112:115]
s_or_b32 s84, s84, 65536
v_exp_f32 v140, v140
v_mfma_f32_16x16x32_bf16 a[116:119], a[44:47], v[212:215], a[116:119]
s_add_u32 m0, s97, s80
ds_read_b128 a[252:255], v23 offset:4096
v_mfma_f32_16x16x32_bf16 a[116:119], a[12:15], v[196:199], a[116:119]
v_exp_f32 v141, v141
v_mfma_f32_16x16x32_bf16 a[120:123], a[12:15], v[200:203], a[120:123]
ds_read_b128 a[192:195], v20 offset:8192
buffer_load_dwordx4 v40, s[44:47], s91 offen offset:0 lds
v_mfma_f32_16x16x32_bf16 a[120:123], a[44:47], v[216:219], a[120:123]
v_exp_f32 v142, v142
v_mfma_f32_16x16x32_bf16 a[124:127], a[44:47], v[220:223], a[124:127]
ds_read_b128 a[196:199], v21 offset:8192
buffer_load_dwordx4 v41, s[44:47], s91 offen offset:1024 lds
v_mfma_f32_16x16x32_bf16 a[124:127], a[12:15], v[204:207], a[124:127]
s_add_u32 s91, s91, 327680
s_add_u32 s97, s97, 2048
v_exp_f32 v143, v143
v_mfma_f32_16x16x32_bf16 a[140:143], a[16:19], v[204:207], a[140:143]
s_cmp_eq_u32 s97, 6144
s_cselect_b32 s97, 0, s97
ds_read_b128 a[200:203], v22 offset:8192
v_mfma_f32_16x16x32_bf16 a[140:143], a[48:51], v[220:223], a[140:143]
v_exp_f32 v144, v144
v_mfma_f32_16x16x32_bf16 a[136:139], a[48:51], v[216:219], a[136:139]
ds_read_b128 a[204:207], v23 offset:8192
v_add_u32 v44, s97, v42
v_mfma_f32_16x16x32_bf16 a[136:139], a[16:19], v[200:203], a[136:139]
v_exp_f32 v145, v145
v_add_u32 v45, s97, v43
v_mfma_f32_16x16x32_bf16 a[132:135], a[16:19], v[196:199], a[132:135]
ds_read_b128 a[208:211], v20 offset:12288
v_xor_b32 v20, s78, v20
v_mfma_f32_16x16x32_bf16 a[132:135], a[48:51], v[212:215], a[132:135]
v_exp_f32 v146, v146
v_mfma_f32_16x16x32_bf16 a[128:131], a[48:51], v[208:211], a[128:131]
ds_read_b128 a[212:215], v21 offset:12288
v_xor_b32 v21, s78, v21
v_mfma_f32_16x16x32_bf16 a[128:131], a[16:19], v[192:195], a[128:131]
v_exp_f32 v147, v147
v_mfma_f32_16x16x32_bf16 a[144:147], a[20:23], v[192:195], a[144:147]
s_waitcnt lgkmcnt(4)
ds_read_b128 a[216:219], v22 offset:12288
v_xor_b32 v22, s78, v22
v_mfma_f32_16x16x32_bf16 a[144:147], a[52:55], v[208:211], a[144:147]
v_exp_f32 v148, v148
v_mfma_f32_16x16x32_bf16 a[148:151], a[52:55], v[212:215], a[148:151]
ds_read_b128 a[220:223], v23 offset:12288
v_xor_b32 v23, s78, v23
v_mfma_f32_16x16x32_bf16 a[148:151], a[20:23], v[196:199], a[148:151]
s_xor_b32 s78, s78, 32768
v_exp_f32 v149, v149
v_mfma_f32_16x16x32_bf16 a[152:155], a[20:23], v[200:203], a[152:155]
s_cmp_lt_u32 s76, s85
v_exp_f32 v150, v150
v_mfma_f32_16x16x32_bf16 a[152:155], a[52:55], v[216:219], a[152:155]
v_exp_f32 v151, v151
v_mfma_f32_16x16x32_bf16 a[156:159], a[52:55], v[220:223], a[156:159]
v_exp_f32 v152, v152
v_mfma_f32_16x16x32_bf16 a[156:159], a[20:23], v[204:207], a[156:159]
v_exp_f32 v153, v153
v_mfma_f32_16x16x32_bf16 a[172:175], a[24:27], v[204:207], a[172:175]
v_exp_f32 v154, v154
v_mfma_f32_16x16x32_bf16 a[172:175], a[56:59], v[220:223], a[172:175]
v_exp_f32 v155, v155
v_mfma_f32_16x16x32_bf16 a[168:171], a[56:59], v[216:219], a[168:171]
v_exp_f32 v156, v156
v_mfma_f32_16x16x32_bf16 a[168:171], a[24:27], v[200:203], a[168:171]
v_exp_f32 v157, v157
v_mfma_f32_16x16x32_bf16 a[164:167], a[24:27], v[196:199], a[164:167]
v_exp_f32 v158, v158
v_mfma_f32_16x16x32_bf16 a[164:167], a[56:59], v[212:215], a[164:167]
v_exp_f32 v159, v159
v_mfma_f32_16x16x32_bf16 a[160:163], a[56:59], v[208:211], a[160:163]
v_exp_f32 v160, v160
v_mfma_f32_16x16x32_bf16 a[160:163], a[24:27], v[192:195], a[160:163]
v_exp_f32 v161, v161
v_mfma_f32_16x16x32_bf16 a[176:179], a[28:31], v[192:195], a[176:179]
v_exp_f32 v162, v162
v_mfma_f32_16x16x32_bf16 a[176:179], a[60:63], v[208:211], a[176:179]
v_exp_f32 v163, v163
v_mfma_f32_16x16x32_bf16 a[180:183], a[60:63], v[212:215], a[180:183]
v_mfma_f32_16x16x32_bf16 a[180:183], a[28:31], v[196:199], a[180:183]
v_mfma_f32_16x16x32_bf16 a[184:187], a[28:31], v[200:203], a[184:187]
v_cvt_pk_bf16_f32 v192, v128, v129
v_cvt_pk_bf16_f32 v193, v130, v131
v_mfma_f32_16x16x32_bf16 a[184:187], a[60:63], v[216:219], a[184:187]
v_cvt_pk_bf16_f32 v194, v132, v133
v_cvt_pk_bf16_f32 v195, v134, v135
v_mfma_f32_16x16x32_bf16 a[188:191], a[60:63], v[220:223], a[188:191]
v_mfma_f32_16x16x32_bf16 a[188:191], a[28:31], v[204:207], a[188:191]
s_waitcnt lgkmcnt(15)
s_cbranch_scc1 LT_LOOP
s_cmp_lg_u32 s76, 196608
s_cbranch_scc1 LT_E2
s_add_u32 s44, s52, 0
s_addc_u32 s45, s53, 0
s_mov_b32 s46, 5242880
s_mov_b32 s47, 0x20000
s_sub_u32 s91, s91, 2293760
s_mov_b32 s85, 294912
s_branch LT_LOOP
LT_E2:
s_cmp_lg_u32 s76, 294912
s_cbranch_scc1 LT_E3
s_mov_b32 s85, 507904
s_cmp_lg_u32 s68, 0
s_cbranch_scc1 LT_LOOP
s_add_u32 s87, s93, 2
s_mov_b64 exec, 1
v_mov_b32 v36, s87
s_lshr_b32 s87, s94, 5
s_add_u32 s87, s87, 66560
buffer_store_dword v36, off, s[4:7], s87 sc1
s_mov_b64 exec, -1
s_mov_b32 s85, 458752
s_branch LT_LOOP
LT_E3:
s_cmp_lg_u32 s76, 458752
s_cbranch_scc1 LT_END
s_mov_b32 s81, 66560
buffer_load_dwordx4 v[36:39], v2, s[4:7], s81 offen sc1
s_mov_b32 s85, 507904
s_branch LT_LOOP
LT_END:
s_mov_b32 s85, 524288
s_branch ATT_LOOP
ATT_EVT:
s_cmp_lg_u32 s76, 524288
s_cbranch_scc1 ATT_EVT1
s_sub_u32 s86, s74, s88
s_add_u32 s24, s40, s86
s_addc_u32 s25, s41, 0
s_sub_u32 s24, s24, 524288
s_subb_u32 s25, s25, 0
s_mov_b32 s26, 589824
v_add_u32 v32, s77, v2
v_add_u32 v33, s77, v2
s_mov_b32 s85, 557056
s_cmp_lg_u32 s68, 0
s_cbranch_scc1 ATT_LOOP
s_waitcnt vmcnt(16)
s_mov_b32 s87, 0
s_add_u32 s86, s93, 2
SPIN_EARLY:
v_subrev_u32 v36, s86, v36
v_subrev_u32 v37, s86, v37
v_subrev_u32 v38, s86, v38
v_subrev_u32 v39, s86, v39
v_max3_u32 v36, v36, v37, v38
v_max_u32 v36, v36, v39
v_cmp_lt_u32 vcc, 2, v36
s_add_u32 s87, s87, 1
s_cmp_eq_u64 vcc, 0
s_cbranch_scc1 SPUN_EARLY
s_cmp_ge_u32 s87, 0x40000
s_cbranch_scc1 SPUN_EARLY
s_sleep 2
s_mov_b32 s81, 66560
buffer_load_dwordx4 v[36:39], v2, s[4:7], s81 offen sc1
s_waitcnt vmcnt(0)
s_branch SPIN_EARLY
SPUN_EARLY:
s_branch ATT_LOOP
ATT_EVT1:
s_cmp_lg_u32 s76, 557056
s_cbranch_scc1 ATT_EVT2
s_sub_u32 s86, s74, s88
s_add_u32 s28, s40, s86
s_addc_u32 s29, s41, 0
s_sub_u32 s28, s28, 491520
s_subb_u32 s29, s29, 0
s_mov_b32 s30, 573440
v_add_u32 v34, s77, v2
v_add_u32 v35, s77, v2
s_mov_b32 s85, 589824
s_cmp_lg_u32 s68, 0
s_cbranch_scc1 ATT_LOOP
s_cmp_lt_u32 s71, 27
s_cbranch_scc1 ATT_LOOP
s_add_u32 s87, s93, 3
s_mov_b64 exec, 1
v_mov_b32 v36, s87
s_lshr_b32 s87, s94, 5
s_add_u32 s87, s87, 66560
buffer_store_dword v36, off, s[4:7], s87 sc1
s_mov_b64 exec, -1
s_branch ATT_LOOP
ATT_EVT2:
s_cmp_lg_u32 s76, 131072
s_cbranch_scc1 ATT_EVT3
s_add_u32 s87, s93, 3
s_mov_b64 exec, 1
v_mov_b32 v36, s87
s_lshr_b32 s87, s94, 5
s_add_u32 s87, s87, 66560
buffer_store_dword v36, off, s[4:7], s87 sc1
s_mov_b64 exec, -1
s_mov_b32 s85, 491520
s_branch ATT_LOOP
ATT_EVT3:
s_mov_b32 s81, 66560
buffer_load_dwordx4 v[36:39], v2, s[4:7], s81 offen sc1
s_mov_b32 s85, 524288
s_branch ATT_LOOP
ATT_RETRY:
s_waitcnt vmcnt(0) lgkmcnt(0)
s_mov_b32 s79, 1
v_mov_b32 v60, v2
s_lshl_b32 s80, s69, 19
s_add_u32 s24, s54, s80
s_addc_u32 s25, s55, 0
s_mov_b32 s26, 524288
s_mov_b32 s27, 0x20000
s_add_u32 s28, s56, s80
s_addc_u32 s29, s57, 0
s_mov_b32 s30, 557056
s_mov_b32 s31, 0x20000
s_sub_u32 s28, s28, 32768
s_subb_u32 s29, s29, 0
v_lshrrev_b32 v52, 4, v1
s_lshl_b32 s80, s68, 3
v_add_u32 v52, s80, v52
v_and_b32 v53, 15, v1
v_lshlrev_b32 v54, 8, v52
v_add_u32 v55, 0, v52
v_and_b32 v56, 15, v55
v_xor_b32 v56, v56, v53
v_lshl_add_u32 v32, v56, 4, v54
v_and_b32 v56, 7, v55
v_lshlrev_b32 v56, 1, v56
v_xor_b32 v56, v56, v53
v_lshl_add_u32 v34, v56, 4, v54
v_add_u32 v55, 4, v52
v_and_b32 v56, 15, v55
v_xor_b32 v56, v56, v53
v_lshl_add_u32 v33, v56, 4, v54
v_and_b32 v56, 7, v55
v_lshlrev_b32 v56, 1, v56
v_xor_b32 v56, v56, v53
v_lshl_add_u32 v35, v56, 4, v54
v_and_b32 v52, 15, v1
v_lshrrev_b32 v53, 4, v1
v_xor_b32 v53, v53, v52
v_lshlrev_b32 v52, 8, v52
v_lshl_add_u32 v52, v53, 4, v52
v_xor_b32 v20, 0, v52
v_xor_b32 v21, 64, v52
v_xor_b32 v22, 128, v52
v_xor_b32 v23, 192, v52
v_lshrrev_b32 v52, 2, v1
v_and_b32 v53, 7, v52
v_lshlrev_b32 v52, 8, v52
v_lshl_add_u32 v52, v53, 5, v52
v_and_b32 v53, 3, v1
v_lshl_add_u32 v52, v53, 3, v52
v_add_u32 v52, 65536, v52
v_xor_b32 v24, 0, v52
v_xor_b32 v25, 32, v52
v_xor_b32 v26, 64, v52
v_xor_b32 v27, 96, v52
v_xor_b32 v28, 128, v52
v_xor_b32 v29, 160, v52
v_xor_b32 v30, 192, v52
v_xor_b32 v31, 224, v52
v_mov_b32 v224, 0xff800000
v_mov_b32 v228, 0xff800000
v_mov_b32 v232, 0xff800000
v_mov_b32 v236, 0xff800000
s_mov_b32 s76, 0
RETRY_LOOP:
s_barrier
s_add_u32 m0, s77, 0
s_nop 0
buffer_load_dwordx4 v32, s[24:27], s76 offen offset:0 sc1 lds
buffer_load_dwordx4 v33, s[24:27], s76 offen offset:1024 sc1 lds
s_waitcnt vmcnt(0)
s_barrier
ds_read_b128 a[224:227], v20 offset:0
ds_read_b128 a[228:231], v21 offset:0
ds_read_b128 a[232:235], v22 offset:0
ds_read_b128 a[236:239], v23 offset:0
ds_read_b128 a[240:243], v20 offset:4096
ds_read_b128 a[244:247], v21 offset:4096
ds_read_b128 a[248:251], v22 offset:4096
ds_read_b128 a[252:255], v23 offset:4096
s_waitcnt lgkmcnt(0)
v_mfma_f32_16x16x32_bf16 v[128:131], a[224:227], v[64:67], 0
v_mfma_f32_16x16x32_bf16 v[128:131], a[228:231], v[80:83], v[128:131]
v_mfma_f32_16x16x32_bf16 v[128:131], a[232:235], v[96:99], v[128:131]
v_mfma_f32_16x16x32_bf16 v[128:131], a[236:239], v[112:115], v[128:131]
v_mfma_f32_16x16x32_bf16 v[136:139], a[236:239], v[116:119], 0
v_mfma_f32_16x16x32_bf16 v[136:139], a[232:235], v[100:103], v[136:139]
v_mfma_f32_16x16x32_bf16 v[136:139], a[228:231], v[84:87], v[136:139]
v_mfma_f32_16x16x32_bf16 v[136:139], a[224:227], v[68:71], v[136:139]
v_mfma_f32_16x16x32_bf16 v[144:147], a[224:227], v[72:75], 0
v_mfma_f32_16x16x32_bf16 v[144:147], a[228:231], v[88:91], v[144:147]
v_mfma_f32_16x16x32_bf16 v[144:147], a[232:235], v[104:107], v[144:147]
v_mfma_f32_16x16x32_bf16 v[144:147], a[236:239], v[120:123], v[144:147]
v_mfma_f32_16x16x32_bf16 v[152:155], a[236:239], v[124:127], 0
v_mfma_f32_16x16x32_bf16 v[152:155], a[232:235], v[108:111], v[152:155]
v_mfma_f32_16x16x32_bf16 v[152:155], a[228:231], v[92:95], v[152:155]
v_mfma_f32_16x16x32_bf16 v[152:155], a[224:227], v[76:79], v[152:155]
v_mfma_f32_16x16x32_bf16 v[132:135], a[240:243], v[64:67], 0
v_mfma_f32_16x16x32_bf16 v[132:135], a[244:247], v[80:83], v[132:135]
v_mfma_f32_16x16x32_bf16 v[132:135], a[248:251], v[96:99], v[132:135]
v_mfma_f32_16x16x32_bf16 v[132:135], a[252:255], v[112:115], v[132:135]
v_mfma_f32_16x16x32_bf16 v[140:143], a[252:255], v[116:119], 0
v_mfma_f32_16x16x32_bf16 v[140:143], a[248:251], v[100:103], v[140:143]
v_mfma_f32_16x16x32_bf16 v[140:143], a[244:247], v[84:87], v[140:143]
v_mfma_f32_16x16x32_bf16 v[140:143], a[240:243], v[68:71], v[140:143]
v_mfma_f32_16x16x32_bf16 v[148:151], a[240:243], v[72:75], 0
v_mfma_f32_16x16x32_bf16 v[148:151], a[244:247], v[88:91], v[148:151]
v_mfma_f32_16x16x32_bf16 v[148:151], a[248:251], v[104:107], v[148:151]
v_mfma_f32_16x16x32_bf16 v[148:151], a[252:255], v[120:123], v[148:151]
v_mfma_f32_16x16x32_bf16 v[156:159], a[252:255], v[124:127], 0
v_mfma_f32_16x16x32_bf16 v[156:159], a[248:251], v[108:111], v[156:159]
v_mfma_f32_16x16x32_bf16 v[156:159], a[244:247], v[92:95], v[156:159]
v_mfma_f32_16x16x32_bf16 v[156:159], a[240:243], v[76:79], v[156:159]
s_nop 7
v_max3_f32 v224, v224, v128, v129
v_max3_f32 v224, v224, v130, v131
v_max3_f32 v224, v224, v132, v133
v_max3_f32 v224, v224, v134, v135
v_max3_f32 v228, v228, v136, v137
v_max3_f32 v228, v228, v138, v139
v_max3_f32 v228, v228, v140, v141
v_max3_f32 v228, v228, v142, v143
v_max3_f32 v232, v232, v144, v145
v_max3_f32 v232, v232, v146, v147
v_max3_f32 v232, v232, v148, v149
v_max3_f32 v232, v232, v150, v151
v_max3_f32 v236, v236, v152, v153
v_max3_f32 v236, v236, v154, v155
v_max3_f32 v236, v236, v156, v157
v_max3_f32 v236, v236, v158, v159
s_add_u32 s76, s76, 8192
s_cmp_lt_u32 s76, 524288
s_cbranch_scc1 RETRY_LOOP
s_barrier
s_mov_b32 s76, 0
s_add_u32 m0, s77, 0
s_nop 0
buffer_load_dwordx4 v32, s[24:27], s76 offen offset:0 sc1 lds
buffer_load_dwordx4 v33, s[24:27], s76 offen offset:1024 sc1 lds
s_add_u32 s76, s76, 8192
s_add_u32 m0, s77, 8192
s_nop 0
buffer_load_dwordx4 v32, s[24:27], s76 offen offset:0 sc1 lds
buffer_load_dwordx4 v33, s[24:27], s76 offen offset:1024 sc1 lds
s_add_u32 s76, s76, 8192
s_add_u32 m0, s77, 16384
s_nop 0
buffer_load_dwordx4 v32, s[24:27], s76 offen offset:0 sc1 lds
buffer_load_dwordx4 v33, s[24:27], s76 offen offset:1024 sc1 lds
s_add_u32 s76, s76, 8192
s_add_u32 m0, s77, 24576
s_nop 0
buffer_load_dwordx4 v32, s[24:27], s76 offen offset:0 sc1 lds
buffer_load_dwordx4 v33, s[24:27], s76 offen offset:1024 sc1 lds
s_add_u32 s76, s76, 8192
s_add_u32 m0, s77, 32768
s_nop 0
buffer_load_dwordx4 v32, s[24:27], s76 offen offset:0 sc1 lds
buffer_load_dwordx4 v33, s[24:27], s76 offen offset:1024 sc1 lds
s_add_u32 m0, s77, 65536
s_nop 0
buffer_load_dwordx4 v34, s[28:31], s76 offen offset:0 sc1 lds
buffer_load_dwordx4 v35, s[28:31], s76 offen offset:1024 sc1 lds
s_add_u32 s76, s76, 8192
s_add_u32 m0, s77, 40960
s_nop 0
buffer_load_dwordx4 v32, s[24:27], s76 offen offset:0 sc1 lds
buffer_load_dwordx4 v33, s[24:27], s76 offen offset:1024 sc1 lds
s_add_u32 m0, s77, 73728
s_nop 0
buffer_load_dwordx4 v34, s[28:31], s76 offen offset:0 sc1 lds
buffer_load_dwordx4 v35, s[28:31], s76 offen offset:1024 sc1 lds
s_add_u32 s76, s76, 8192
s_add_u32 m0, s77, 49152
s_nop 0
buffer_load_dwordx4 v32, s[24:27], s76 offen offset:0 sc1 lds
buffer_load_dwordx4 v33, s[24:27], s76 offen offset:1024 sc1 lds
s_add_u32 m0, s77, 81920
s_nop 0
buffer_load_dwordx4 v34, s[28:31], s76 offen offset:0 sc1 lds
buffer_load_dwordx4 v35, s[28:31], s76 offen offset:1024 sc1 lds
s_add_u32 s76, s76, 8192
s_add_u32 m0, s77, 57344
s_nop 0
buffer_load_dwordx4 v32, s[24:27], s76 offen offset:0 sc1 lds
buffer_load_dwordx4 v33, s[24:27], s76 offen offset:1024 sc1 lds
s_add_u32 m0, s77, 90112
s_nop 0
buffer_load_dwordx4 v34, s[28:31], s76 offen offset:0 sc1 lds
buffer_load_dwordx4 v35, s[28:31], s76 offen offset:1024 sc1 lds
s_add_u32 s76, s76, 8192
s_add_u32 m0, s77, 98304
s_nop 0
buffer_load_dwordx4 v34, s[28:31], s76 offen offset:0 sc1 lds
buffer_load_dwordx4 v35, s[28:31], s76 offen offset:1024 sc1 lds
s_waitcnt vmcnt(0)
s_barrier
ds_read_b128 a[224:227], v20 offset:0
ds_read_b128 a[228:231], v21 offset:0
ds_read_b128 a[232:235], v22 offset:0
ds_read_b128 a[236:239], v23 offset:0
ds_read_b128 a[240:243], v20 offset:4096
ds_read_b128 a[244:247], v21 offset:4096
ds_read_b128 a[248:251], v22 offset:4096
ds_read_b128 a[252:255], v23 offset:4096
v_lshrrev_b32 v40, 4, v1
v_xor_b32 v40, v40, v1
v_bfe_u32 v40, v40, 1, 1
v_subrev_u32 v40, 1, v40
v_and_b32 v40, 0x3f803f80, v40
v_mov_b32 v56, v40
v_mov_b32 v57, v40
v_mov_b32 v58, v40
v_mov_b32 v59, v40
v_and_b32 v7, 1, v1
v_mul_u32_u24 v7, 0xaaaa, v7
v_or_b32 v7, 0x4444, v7
v_accvgpr_write_b32 a64, 0
v_accvgpr_write_b32 a65, 0
v_accvgpr_write_b32 a66, 0
v_accvgpr_write_b32 a67, 0
v_accvgpr_write_b32 a68, 0
v_accvgpr_write_b32 a69, 0
v_accvgpr_write_b32 a70, 0
v_accvgpr_write_b32 a71, 0
v_accvgpr_write_b32 a72, 0
v_accvgpr_write_b32 a73, 0
v_accvgpr_write_b32 a74, 0
v_accvgpr_write_b32 a75, 0
v_accvgpr_write_b32 a76, 0
v_accvgpr_write_b32 a77, 0
v_accvgpr_write_b32 a78, 0
v_accvgpr_write_b32 a79, 0
v_accvgpr_write_b32 a80, 0
v_accvgpr_write_b32 a81, 0
v_accvgpr_write_b32 a82, 0
v_accvgpr_write_b32 a83, 0
v_accvgpr_write_b32 a84, 0
v_accvgpr_write_b32 a85, 0
v_accvgpr_write_b32 a86, 0
v_accvgpr_write_b32 a87, 0
v_accvgpr_write_b32 a88, 0
v_accvgpr_write_b32 a89, 0
v_accvgpr_write_b32 a90, 0
v_accvgpr_write_b32 a91, 0
v_accvgpr_write_b32 a92, 0
v_accvgpr_write_b32 a93, 0
v_accvgpr_write_b32 a94, 0
v_accvgpr_write_b32 a95, 0
v_accvgpr_write_b32 a96, 0
v_accvgpr_write_b32 a97, 0
v_accvgpr_write_b32 a98, 0
v_accvgpr_write_b32 a99, 0
v_accvgpr_write_b32 a100, 0
v_accvgpr_write_b32 a101, 0
v_accvgpr_write_b32 a102, 0
v_accvgpr_write_b32 a103, 0
v_accvgpr_write_b32 a104, 0
v_accvgpr_write_b32 a105, 0
v_accvgpr_write_b32 a106, 0
v_accvgpr_write_b32 a107, 0
v_accvgpr_write_b32 a108, 0
v_accvgpr_write_b32 a109, 0
v_accvgpr_write_b32 a110, 0
v_accvgpr_write_b32 a111, 0
v_accvgpr_write_b32 a112, 0
v_accvgpr_write_b32 a113, 0
v_accvgpr_write_b32 a114, 0
v_accvgpr_write_b32 a115, 0
v_accvgpr_write_b32 a116, 0
v_accvgpr_write_b32 a117, 0
v_accvgpr_write_b32 a118, 0
v_accvgpr_write_b32 a119, 0
v_accvgpr_write_b32 a120, 0
v_accvgpr_write_b32 a121, 0
v_accvgpr_write_b32 a122, 0
v_accvgpr_write_b32 a123, 0
v_accvgpr_write_b32 a124, 0
v_accvgpr_write_b32 a125, 0
v_accvgpr_write_b32 a126, 0
v_accvgpr_write_b32 a127, 0
v_accvgpr_write_b32 a128, 0
v_accvgpr_write_b32 a129, 0
v_accvgpr_write_b32 a130, 0
v_accvgpr_write_b32 a131, 0
v_accvgpr_write_b32 a132, 0
v_accvgpr_write_b32 a133, 0
v_accvgpr_write_b32 a134, 0
v_accvgpr_write_b32 a135, 0
v_accvgpr_write_b32 a136, 0
v_accvgpr_write_b32 a137, 0
v_accvgpr_write_b32 a138, 0
v_accvgpr_write_b32 a139, 0
v_accvgpr_write_b32 a140, 0
v_accvgpr_write_b32 a141, 0
v_accvgpr_write_b32 a142, 0
v_accvgpr_write_b32 a143, 0
v_accvgpr_write_b32 a144, 0
v_accvgpr_write_b32 a145, 0
v_accvgpr_write_b32 a146, 0
v_accvgpr_write_b32 a147, 0
v_accvgpr_write_b32 a148, 0
v_accvgpr_write_b32 a149, 0
v_accvgpr_write_b32 a150, 0
v_accvgpr_write_b32 a151, 0
v_accvgpr_write_b32 a152, 0
v_accvgpr_write_b32 a153, 0
v_accvgpr_write_b32 a154, 0
v_accvgpr_write_b32 a155, 0
v_accvgpr_write_b32 a156, 0
v_accvgpr_write_b32 a157, 0
v_accvgpr_write_b32 a158, 0
v_accvgpr_write_b32 a159, 0
v_accvgpr_write_b32 a160, 0
v_accvgpr_write_b32 a161, 0
v_accvgpr_write_b32 a162, 0
v_accvgpr_write_b32 a163, 0
v_accvgpr_write_b32 a164, 0
v_accvgpr_write_b32 a165, 0
v_accvgpr_write_b32 a166, 0
v_accvgpr_write_b32 a167, 0
v_accvgpr_write_b32 a168, 0
v_accvgpr_write_b32 a169, 0
v_accvgpr_write_b32 a170, 0
v_accvgpr_write_b32 a171, 0
v_accvgpr_write_b32 a172, 0
v_accvgpr_write_b32 a173, 0
v_accvgpr_write_b32 a174, 0
v_accvgpr_write_b32 a175, 0
v_accvgpr_write_b32 a176, 0
v_accvgpr_write_b32 a177, 0
v_accvgpr_write_b32 a178, 0
v_accvgpr_write_b32 a179, 0
v_accvgpr_write_b32 a180, 0
v_accvgpr_write_b32 a181, 0
v_accvgpr_write_b32 a182, 0
v_accvgpr_write_b32 a183, 0
v_accvgpr_write_b32 a184, 0
v_accvgpr_write_b32 a185, 0
v_accvgpr_write_b32 a186, 0
v_accvgpr_write_b32 a187, 0
v_accvgpr_write_b32 a188, 0
v_accvgpr_write_b32 a189, 0
v_accvgpr_write_b32 a190, 0
v_accvgpr_write_b32 a191, 0
v_mov_b32 v240, 0
v_mov_b32 v241, 0
v_mov_b32 v242, 0
v_mov_b32 v243, 0
v_mov_b32 v244, 0
v_mov_b32 v245, 0
v_mov_b32 v246, 0
v_mov_b32 v247, 0
s_waitcnt lgkmcnt(0)
v_mfma_f32_16x16x32_bf16 v[128:131], a[224:227], v[64:67], 0
v_mfma_f32_16x16x32_bf16 v[128:131], a[228:231], v[80:83], v[128:131]
v_mfma_f32_16x16x32_bf16 v[128:131], a[232:235], v[96:99], v[128:131]
v_mfma_f32_16x16x32_bf16 v[128:131], a[236:239], v[112:115], v[128:131]
v_mfma_f32_16x16x32_bf16 v[136:139], a[236:239], v[116:119], 0
v_mfma_f32_16x16x32_bf16 v[136:139], a[232:235], v[100:103], v[136:139]
v_mfma_f32_16x16x32_bf16 v[136:139], a[228:231], v[84:87], v[136:139]
v_mfma_f32_16x16x32_bf16 v[136:139], a[224:227], v[68:71], v[136:139]
v_mfma_f32_16x16x32_bf16 v[144:147], a[224:227], v[72:75], 0
v_mfma_f32_16x16x32_bf16 v[144:147], a[228:231], v[88:91], v[144:147]
v_mfma_f32_16x16x32_bf16 v[144:147], a[232:235], v[104:107], v[144:147]
v_mfma_f32_16x16x32_bf16 v[144:147], a[236:239], v[120:123], v[144:147]
v_mfma_f32_16x16x32_bf16 v[152:155], a[236:239], v[124:127], 0
v_mfma_f32_16x16x32_bf16 v[152:155], a[232:235], v[108:111], v[152:155]
v_mfma_f32_16x16x32_bf16 v[152:155], a[228:231], v[92:95], v[152:155]
v_mfma_f32_16x16x32_bf16 v[152:155], a[224:227], v[76:79], v[152:155]
v_mfma_f32_16x16x32_bf16 v[132:135], a[240:243], v[64:67], 0
v_mfma_f32_16x16x32_bf16 v[132:135], a[244:247], v[80:83], v[132:135]
v_mfma_f32_16x16x32_bf16 v[132:135], a[248:251], v[96:99], v[132:135]
v_mfma_f32_16x16x32_bf16 v[132:135], a[252:255], v[112:115], v[132:135]
v_mfma_f32_16x16x32_bf16 v[140:143], a[252:255], v[116:119], 0
v_mfma_f32_16x16x32_bf16 v[140:143], a[248:251], v[100:103], v[140:143]
v_mfma_f32_16x16x32_bf16 v[140:143], a[244:247], v[84:87], v[140:143]
v_mfma_f32_16x16x32_bf16 v[140:143], a[240:243], v[68:71], v[140:143]
v_mfma_f32_16x16x32_bf16 v[148:151], a[240:243], v[72:75], 0
v_mfma_f32_16x16x32_bf16 v[148:151], a[244:247], v[88:91], v[148:151]
v_mfma_f32_16x16x32_bf16 v[148:151], a[248:251], v[104:107], v[148:151]
v_mfma_f32_16x16x32_bf16 v[148:151], a[252:255], v[120:123], v[148:151]
v_mfma_f32_16x16x32_bf16 v[156:159], a[252:255], v[124:127], 0
v_mfma_f32_16x16x32_bf16 v[156:159], a[248:251], v[108:111], v[156:159]
v_mfma_f32_16x16x32_bf16 v[156:159], a[244:247], v[92:95], v[156:159]
v_mfma_f32_16x16x32_bf16 v[156:159], a[240:243], v[76:79], v[156:159]
ds_read_b128 a[224:227], v20 offset:8192
ds_read_b128 a[228:231], v21 offset:8192
ds_read_b128 a[232:235], v22 offset:8192
ds_read_b128 a[236:239], v23 offset:8192
ds_read_b128 a[240:243], v20 offset:12288
ds_read_b128 a[244:247], v21 offset:12288
ds_read_b128 a[248:251], v22 offset:12288
ds_read_b128 a[252:255], v23 offset:12288
s_branch ATT_START
LIGHT:
s_mov_b32 s72, 0
buffer_load_dwordx4 a[64:67], v2, s[8:11], s72 offen offset:0 sc1
buffer_load_dwordx4 a[68:71], v2, s[8:11], s72 offen offset:1024 sc1
buffer_load_dwordx4 a[72:75], v2, s[8:11], s72 offen offset:2048 sc1
buffer_load_dwordx4 a[76:79], v2, s[8:11], s72 offen offset:3072 sc1
s_add_u32 s72, s72, 4096
buffer_load_dwordx4 a[80:83], v2, s[8:11], s72 offen offset:0 sc1
buffer_load_dwordx4 a[84:87], v2, s[8:11], s72 offen offset:1024 sc1
buffer_load_dwordx4 a[88:91], v2, s[8:11], s72 offen offset:2048 sc1
buffer_load_dwordx4 a[92:95], v2, s[8:11], s72 offen offset:3072 sc1
s_add_u32 s72, s72, 4096
buffer_load_dwordx4 a[96:99], v2, s[8:11], s72 offen offset:0 sc1
buffer_load_dwordx4 a[100:103], v2, s[8:11], s72 offen offset:1024 sc1
buffer_load_dwordx4 a[104:107], v2, s[8:11], s72 offen offset:2048 sc1
buffer_load_dwordx4 a[108:111], v2, s[8:11], s72 offen offset:3072 sc1
s_add_u32 s72, s72, 4096
ds_read_b64_tr_b16 a[192:193], v44 offset:0
ds_read_b64_tr_b16 a[194:195], v44 offset:1024
ds_read_b64_tr_b16 a[196:197], v44 offset:8
ds_read_b64_tr_b16 a[198:199], v44 offset:1032
ds_read_b64_tr_b16 a[200:201], v45 offset:0
ds_read_b64_tr_b16 a[202:203], v45 offset:1024
ds_read_b64_tr_b16 a[204:205], v45 offset:8
ds_read_b64_tr_b16 a[206:207], v45 offset:1032
ds_read_b64_tr_b16 a[208:209], v46 offset:0
ds_read_b64_tr_b16 a[210:211], v46 offset:1024
ds_read_b64_tr_b16 a[212:213], v46 offset:8
ds_read_b64_tr_b16 a[214:215], v46 offset:1032
s_waitcnt vmcnt(8) lgkmcnt(0)
v_mfma_f32_16x16x32_bf16 v[64:67], a[192:195], a[64:67], 0
ds_read_b64_tr_b16 a[216:217], v47 offset:0
v_mfma_f32_16x16x32_bf16 v[68:71], a[192:195], a[68:71], 0
buffer_load_dwordx4 a[112:115], v2, s[8:11], s72 offen offset:0 sc1
v_mfma_f32_16x16x32_bf16 v[72:75], a[192:195], a[72:75], 0
ds_read_b64_tr_b16 a[218:219], v47 offset:1024
v_mfma_f32_16x16x32_bf16 v[76:79], a[192:195], a[76:79], 0
v_mfma_f32_16x16x32_bf16 v[140:143], a[196:199], a[76:79], 0
ds_read_b64_tr_b16 a[220:221], v47 offset:8
v_mfma_f32_16x16x32_bf16 v[136:139], a[196:199], a[72:75], 0
buffer_load_dwordx4 a[116:119], v2, s[8:11], s72 offen offset:1024 sc1
v_mfma_f32_16x16x32_bf16 v[132:135], a[196:199], a[68:71], 0
ds_read_b64_tr_b16 a[222:223], v47 offset:1032
v_mfma_f32_16x16x32_bf16 v[128:131], a[196:199], a[64:67], 0
s_waitcnt vmcnt(6)
s_barrier
v_mfma_f32_16x16x32_bf16 v[80:83], a[200:203], a[64:67], 0
ds_read_b64_tr_b16 a[192:193], v44 offset:16384
v_mfma_f32_16x16x32_bf16 v[84:87], a[200:203], a[68:71], 0
buffer_load_dwordx4 a[120:123], v2, s[8:11], s72 offen offset:2048 sc1
v_mfma_f32_16x16x32_bf16 v[88:91], a[200:203], a[72:75], 0
ds_read_b64_tr_b16 a[194:195], v44 offset:17408
v_mfma_f32_16x16x32_bf16 v[92:95], a[200:203], a[76:79], 0
v_mfma_f32_16x16x32_bf16 v[156:159], a[204:207], a[76:79], 0
ds_read_b64_tr_b16 a[196:197], v44 offset:16392
v_mfma_f32_16x16x32_bf16 v[152:155], a[204:207], a[72:75], 0
buffer_load_dwordx4 a[124:127], v2, s[8:11], s72 offen offset:3072 sc1
v_mfma_f32_16x16x32_bf16 v[148:151], a[204:207], a[68:71], 0
s_add_u32 s72, s72, 4096
ds_read_b64_tr_b16 a[198:199], v44 offset:17416
v_mfma_f32_16x16x32_bf16 v[144:147], a[204:207], a[64:67], 0
v_mfma_f32_16x16x32_bf16 v[96:99], a[208:211], a[64:67], 0
ds_read_b64_tr_b16 a[200:201], v45 offset:16384
v_mfma_f32_16x16x32_bf16 v[100:103], a[208:211], a[68:71], 0
buffer_load_dwordx4 a[128:131], v2, s[8:11], s72 offen offset:0 sc1
v_mfma_f32_16x16x32_bf16 v[104:107], a[208:211], a[72:75], 0
ds_read_b64_tr_b16 a[202:203], v45 offset:17408
v_mfma_f32_16x16x32_bf16 v[108:111], a[208:211], a[76:79], 0
v_mfma_f32_16x16x32_bf16 v[172:175], a[212:215], a[76:79], 0
ds_read_b64_tr_b16 a[204:205], v45 offset:16392
v_mfma_f32_16x16x32_bf16 v[168:171], a[212:215], a[72:75], 0
buffer_load_dwordx4 a[132:135], v2, s[8:11], s72 offen offset:1024 sc1
v_mfma_f32_16x16x32_bf16 v[164:167], a[212:215], a[68:71], 0
ds_read_b64_tr_b16 a[206:207], v45 offset:17416
v_mfma_f32_16x16x32_bf16 v[160:163], a[212:215], a[64:67], 0
s_waitcnt lgkmcnt(4)
v_mfma_f32_16x16x32_bf16 v[112:115], a[216:219], a[64:67], 0
ds_read_b64_tr_b16 a[208:209], v46 offset:16384
v_mfma_f32_16x16x32_bf16 v[116:119], a[216:219], a[68:71], 0
buffer_load_dwordx4 a[136:139], v2, s[8:11], s72 offen offset:2048 sc1
v_mfma_f32_16x16x32_bf16 v[120:123], a[216:219], a[72:75], 0
ds_read_b64_tr_b16 a[210:211], v46 offset:17408
v_mfma_f32_16x16x32_bf16 v[124:127], a[216:219], a[76:79], 0
v_mfma_f32_16x16x32_bf16 v[188:191], a[220:223], a[76:79], 0
ds_read_b64_tr_b16 a[212:213], v46 offset:16392
v_mfma_f32_16x16x32_bf16 v[184:187], a[220:223], a[72:75], 0
buffer_load_dwordx4 a[140:143], v2, s[8:11], s72 offen offset:3072 sc1
v_mfma_f32_16x16x32_bf16 v[180:183], a[220:223], a[68:71], 0
s_add_u32 s72, s72, 4096
ds_read_b64_tr_b16 a[214:215], v46 offset:17416
v_mfma_f32_16x16x32_bf16 v[176:179], a[220:223], a[64:67], 0
s_mov_b32 s80, 1048576
v_mfma_f32_16x16x32_bf16 v[64:67], a[192:195], a[80:83], v[64:67]
ds_read_b64_tr_b16 a[216:217], v47 offset:16384
v_mfma_f32_16x16x32_bf16 v[68:71], a[192:195], a[84:87], v[68:71]
buffer_load_dword v18, v63, s[12:15], s80 offen
v_mfma_f32_16x16x32_bf16 v[72:75], a[192:195], a[88:91], v[72:75]
s_add_u32 m0, s75, 16384
ds_read_b64_tr_b16 a[218:219], v47 offset:17408
v_mfma_f32_16x16x32_bf16 v[76:79], a[192:195], a[92:95], v[76:79]
v_mfma_f32_16x16x32_bf16 v[140:143], a[196:199], a[92:95], v[140:143]
ds_read_b64_tr_b16 a[220:221], v47 offset:16392
v_mfma_f32_16x16x32_bf16 v[136:139], a[196:199], a[88:91], v[136:139]
buffer_load_dwordx4 v3, s[12:15], s73 offen lds
v_mfma_f32_16x16x32_bf16 v[132:135], a[196:199], a[84:87], v[132:135]
s_waitcnt lgkmcnt(4)
ds_read_b64_tr_b16 a[222:223], v47 offset:17416
v_mfma_f32_16x16x32_bf16 v[128:131], a[196:199], a[80:83], v[128:131]
s_waitcnt vmcnt(10)
s_barrier
v_mfma_f32_16x16x32_bf16 v[80:83], a[200:203], a[80:83], v[80:83]
ds_read_b64_tr_b16 a[192:193], v44 offset:32768
v_mfma_f32_16x16x32_bf16 v[84:87], a[200:203], a[84:87], v[84:87]
buffer_load_dwordx4 v4, s[12:15], s73 offen offset:1024 lds
v_mfma_f32_16x16x32_bf16 v[88:91], a[200:203], a[88:91], v[88:91]
s_add_u32 s73, s73, 262144
s_add_u32 s74, s74, 110592
ds_read_b64_tr_b16 a[194:195], v44 offset:33792
v_mfma_f32_16x16x32_bf16 v[92:95], a[200:203], a[92:95], v[92:95]
v_mfma_f32_16x16x32_bf16 v[156:159], a[204:207], a[92:95], v[156:159]
ds_read_b64_tr_b16 a[196:197], v44 offset:32776
v_mfma_f32_16x16x32_bf16 v[152:155], a[204:207], a[88:91], v[152:155]
buffer_load_dwordx4 a[144:147], v2, s[8:11], s72 offen offset:0 sc1
v_mfma_f32_16x16x32_bf16 v[148:151], a[204:207], a[84:87], v[148:151]
ds_read_b64_tr_b16 a[198:199], v44 offset:33800
v_mfma_f32_16x16x32_bf16 v[144:147], a[204:207], a[80:83], v[144:147]
v_mfma_f32_16x16x32_bf16 v[96:99], a[208:211], a[80:83], v[96:99]
ds_read_b64_tr_b16 a[200:201], v45 offset:32768
v_mfma_f32_16x16x32_bf16 v[100:103], a[208:211], a[84:87], v[100:103]
buffer_load_dwordx4 a[148:151], v2, s[8:11], s72 offen offset:1024 sc1
v_mfma_f32_16x16x32_bf16 v[104:107], a[208:211], a[88:91], v[104:107]
ds_read_b64_tr_b16 a[202:203], v45 offset:33792
v_mfma_f32_16x16x32_bf16 v[108:111], a[208:211], a[92:95], v[108:111]
s_waitcnt lgkmcnt(4)
v_mfma_f32_16x16x32_bf16 v[172:175], a[212:215], a[92:95], v[172:175]
ds_read_b64_tr_b16 a[204:205], v45 offset:32776
v_mfma_f32_16x16x32_bf16 v[168:171], a[212:215], a[88:91], v[168:171]
buffer_load_dwordx4 a[152:155], v2, s[8:11], s72 offen offset:2048 sc1
v_mfma_f32_16x16x32_bf16 v[164:167], a[212:215], a[84:87], v[164:167]
ds_read_b64_tr_b16 a[206:207], v45 offset:33800
v_mfma_f32_16x16x32_bf16 v[160:163], a[212:215], a[80:83], v[160:163]
v_mfma_f32_16x16x32_bf16 v[112:115], a[216:219], a[80:83], v[112:115]
ds_read_b64_tr_b16 a[208:209], v46 offset:32768
v_mfma_f32_16x16x32_bf16 v[116:119], a[216:219], a[84:87], v[116:119]
buffer_load_dwordx4 a[156:159], v2, s[8:11], s72 offen offset:3072 sc1
v_mfma_f32_16x16x32_bf16 v[120:123], a[216:219], a[88:91], v[120:123]
s_add_u32 s72, s72, 4096
ds_read_b64_tr_b16 a[210:211], v46 offset:33792
v_mfma_f32_16x16x32_bf16 v[124:127], a[216:219], a[92:95], v[124:127]
s_add_u32 m0, s75, 32768
v_mfma_f32_16x16x32_bf16 v[188:191], a[220:223], a[92:95], v[188:191]
ds_read_b64_tr_b16 a[212:213], v46 offset:32776
v_mfma_f32_16x16x32_bf16 v[184:187], a[220:223], a[88:91], v[184:187]
buffer_load_dwordx4 v3, s[12:15], s73 offen lds
v_mfma_f32_16x16x32_bf16 v[180:183], a[220:223], a[84:87], v[180:183]
ds_read_b64_tr_b16 a[214:215], v46 offset:33800
v_mfma_f32_16x16x32_bf16 v[176:179], a[220:223], a[80:83], v[176:179]
v_mfma_f32_16x16x32_bf16 v[64:67], a[192:195], a[96:99], v[64:67]
s_waitcnt lgkmcnt(4)
ds_read_b64_tr_b16 a[216:217], v47 offset:32768
v_mfma_f32_16x16x32_bf16 v[68:71], a[192:195], a[100:103], v[68:71]
buffer_load_dwordx4 v4, s[12:15], s73 offen offset:1024 lds
v_mfma_f32_16x16x32_bf16 v[72:75], a[192:195], a[104:107], v[72:75]
s_add_u32 s73, s73, 262144
s_add_u32 s74, s74, 110592
ds_read_b64_tr_b16 a[218:219], v47 offset:33792
v_mfma_f32_16x16x32_bf16 v[76:79], a[192:195], a[108:111], v[76:79]
s_mov_b32 s80, 2097152
v_mfma_f32_16x16x32_bf16 v[140:143], a[196:199], a[108:111], v[140:143]
ds_read_b64_tr_b16 a[220:221], v47 offset:32776
v_mfma_f32_16x16x32_bf16 v[136:139], a[196:199], a[104:107], v[136:139]
buffer_load_dword v18, v63, s[12:15], s80 offen
v_mfma_f32_16x16x32_bf16 v[132:135], a[196:199], a[100:103], v[132:135]
ds_read_b64_tr_b16 a[222:223], v47 offset:33800
v_mfma_f32_16x16x32_bf16 v[128:131], a[196:199], a[96:99], v[128:131]
s_waitcnt vmcnt(14)
s_barrier
v_mfma_f32_16x16x32_bf16 v[80:83], a[200:203], a[96:99], v[80:83]
ds_read_b64_tr_b16 a[192:193], v44 offset:49152
v_mfma_f32_16x16x32_bf16 v[84:87], a[200:203], a[100:103], v[84:87]
buffer_load_dwordx4 a[160:163], v2, s[8:11], s72 offen offset:0 sc1
v_mfma_f32_16x16x32_bf16 v[88:91], a[200:203], a[104:107], v[88:91]
ds_read_b64_tr_b16 a[194:195], v44 offset:50176
v_mfma_f32_16x16x32_bf16 v[92:95], a[200:203], a[108:111], v[92:95]
v_mfma_f32_16x16x32_bf16 v[156:159], a[204:207], a[108:111], v[156:159]
ds_read_b64_tr_b16 a[196:197], v44 offset:49160
v_mfma_f32_16x16x32_bf16 v[152:155], a[204:207], a[104:107], v[152:155]
buffer_load_dwordx4 a[164:167], v2, s[8:11], s72 offen offset:1024 sc1
v_mfma_f32_16x16x32_bf16 v[148:151], a[204:207], a[100:103], v[148:151]
ds_read_b64_tr_b16 a[198:199], v44 offset:50184
v_mfma_f32_16x16x32_bf16 v[144:147], a[204:207], a[96:99], v[144:147]
s_waitcnt lgkmcnt(4)
v_mfma_f32_16x16x32_bf16 v[96:99], a[208:211], a[96:99], v[96:99]
ds_read_b64_tr_b16 a[200:201], v45 offset:49152
v_mfma_f32_16x16x32_bf16 v[100:103], a[208:211], a[100:103], v[100:103]
buffer_load_dwordx4 a[168:171], v2, s[8:11], s72 offen offset:2048 sc1
v_mfma_f32_16x16x32_bf16 v[104:107], a[208:211], a[104:107], v[104:107]
ds_read_b64_tr_b16 a[202:203], v45 offset:50176
v_mfma_f32_16x16x32_bf16 v[108:111], a[208:211], a[108:111], v[108:111]
v_mfma_f32_16x16x32_bf16 v[172:175], a[212:215], a[108:111], v[172:175]
ds_read_b64_tr_b16 a[204:205], v45 offset:49160
v_mfma_f32_16x16x32_bf16 v[168:171], a[212:215], a[104:107], v[168:171]
buffer_load_dwordx4 a[172:175], v2, s[8:11], s72 offen offset:3072 sc1
v_mfma_f32_16x16x32_bf16 v[164:167], a[212:215], a[100:103], v[164:167]
s_add_u32 s72, s72, 4096
ds_read_b64_tr_b16 a[206:207], v45 offset:50184
v_mfma_f32_16x16x32_bf16 v[160:163], a[212:215], a[96:99], v[160:163]
s_add_u32 m0, s75, 49152
v_mfma_f32_16x16x32_bf16 v[112:115], a[216:219], a[96:99], v[112:115]
ds_read_b64_tr_b16 a[208:209], v46 offset:49152
v_mfma_f32_16x16x32_bf16 v[116:119], a[216:219], a[100:103], v[116:119]
buffer_load_dwordx4 v3, s[12:15], s73 offen lds
v_mfma_f32_16x16x32_bf16 v[120:123], a[216:219], a[104:107], v[120:123]
ds_read_b64_tr_b16 a[210:211], v46 offset:50176
v_mfma_f32_16x16x32_bf16 v[124:127], a[216:219], a[108:111], v[124:127]
v_mfma_f32_16x16x32_bf16 v[188:191], a[220:223], a[108:111], v[188:191]
ds_read_b64_tr_b16 a[212:213], v46 offset:49160
v_mfma_f32_16x16x32_bf16 v[184:187], a[220:223], a[104:107], v[184:187]
buffer_load_dwordx4 v4, s[12:15], s73 offen offset:1024 lds
v_mfma_f32_16x16x32_bf16 v[180:183], a[220:223], a[100:103], v[180:183]
s_add_u32 s73, s73, 262144
s_add_u32 s74, s74, 110592
ds_read_b64_tr_b16 a[214:215], v46 offset:50184
v_mfma_f32_16x16x32_bf16 v[176:179], a[220:223], a[96:99], v[176:179]
s_waitcnt lgkmcnt(4)
v_mfma_f32_16x16x32_bf16 v[64:67], a[192:195], a[112:115], v[64:67]
ds_read_b64_tr_b16 a[216:217], v47 offset:49152
v_mfma_f32_16x16x32_bf16 v[68:71], a[192:195], a[116:119], v[68:71]
buffer_load_dwordx4 a[176:179], v2, s[8:11], s72 offen offset:0 sc1
v_mfma_f32_16x16x32_bf16 v[72:75], a[192:195], a[120:123], v[72:75]
ds_read_b64_tr_b16 a[218:219], v47 offset:50176
v_mfma_f32_16x16x32_bf16 v[76:79], a[192:195], a[124:127], v[76:79]
v_mfma_f32_16x16x32_bf16 v[140:143], a[196:199], a[124:127], v[140:143]
ds_read_b64_tr_b16 a[220:221], v47 offset:49160
v_mfma_f32_16x16x32_bf16 v[136:139], a[196:199], a[120:123], v[136:139]
buffer_load_dwordx4 a[180:183], v2, s[8:11], s72 offen offset:1024 sc1
v_mfma_f32_16x16x32_bf16 v[132:135], a[196:199], a[116:119], v[132:135]
ds_read_b64_tr_b16 a[222:223], v47 offset:50184
v_mfma_f32_16x16x32_bf16 v[128:131], a[196:199], a[112:115], v[128:131]
s_waitcnt vmcnt(11)
s_barrier
v_mfma_f32_16x16x32_bf16 v[80:83], a[200:203], a[112:115], v[80:83]
ds_read_b64_tr_b16 a[192:193], v10 offset:0
v_mfma_f32_16x16x32_bf16 v[84:87], a[200:203], a[116:119], v[84:87]
buffer_load_dwordx4 a[184:187], v2, s[8:11], s72 offen offset:2048 sc1
v_mfma_f32_16x16x32_bf16 v[88:91], a[200:203], a[120:123], v[88:91]
ds_read_b64_tr_b16 a[194:195], v10 offset:1024
v_mfma_f32_16x16x32_bf16 v[92:95], a[200:203], a[124:127], v[92:95]
v_mfma_f32_16x16x32_bf16 v[156:159], a[204:207], a[124:127], v[156:159]
s_waitcnt lgkmcnt(4)
ds_read_b64_tr_b16 a[196:197], v10 offset:16384
v_mfma_f32_16x16x32_bf16 v[152:155], a[204:207], a[120:123], v[152:155]
buffer_load_dwordx4 a[188:191], v2, s[8:11], s72 offen offset:3072 sc1
v_mfma_f32_16x16x32_bf16 v[148:151], a[204:207], a[116:119], v[148:151]
s_add_u32 s72, s72, 4096
ds_read_b64_tr_b16 a[198:199], v10 offset:17408
v_mfma_f32_16x16x32_bf16 v[144:147], a[204:207], a[112:115], v[144:147]
s_add_u32 m0, s75, 65536
v_mfma_f32_16x16x32_bf16 v[96:99], a[208:211], a[112:115], v[96:99]
ds_read_b64_tr_b16 a[200:201], v10 offset:8
v_mfma_f32_16x16x32_bf16 v[100:103], a[208:211], a[116:119], v[100:103]
buffer_load_dwordx4 v3, s[12:15], s73 offen lds
v_mfma_f32_16x16x32_bf16 v[104:107], a[208:211], a[120:123], v[104:107]
ds_read_b64_tr_b16 a[202:203], v10 offset:1032
v_mfma_f32_16x16x32_bf16 v[108:111], a[208:211], a[124:127], v[108:111]
v_mfma_f32_16x16x32_bf16 v[172:175], a[212:215], a[124:127], v[172:175]
ds_read_b64_tr_b16 a[204:205], v10 offset:16392
v_mfma_f32_16x16x32_bf16 v[168:171], a[212:215], a[120:123], v[168:171]
buffer_load_dwordx4 v4, s[12:15], s73 offen offset:1024 lds
v_mfma_f32_16x16x32_bf16 v[164:167], a[212:215], a[116:119], v[164:167]
s_add_u32 s73, s73, 262144
s_add_u32 s74, s74, 110592
ds_read_b64_tr_b16 a[206:207], v10 offset:17416
v_mfma_f32_16x16x32_bf16 v[160:163], a[212:215], a[112:115], v[160:163]
v_mfma_f32_16x16x32_bf16 v[112:115], a[216:219], a[112:115], v[112:115]
ds_read_b64_tr_b16 a[208:209], v11 offset:0
v_mfma_f32_16x16x32_bf16 v[116:119], a[216:219], a[116:119], v[116:119]
buffer_load_dwordx4 a[64:67], v2, s[8:11], s72 offen offset:0 sc1
v_mfma_f32_16x16x32_bf16 v[120:123], a[216:219], a[120:123], v[120:123]
ds_read_b64_tr_b16 a[210:211], v11 offset:1024
v_mfma_f32_16x16x32_bf16 v[124:127], a[216:219], a[124:127], v[124:127]
s_waitcnt lgkmcnt(4)
v_mfma_f32_16x16x32_bf16 v[188:191], a[220:223], a[124:127], v[188:191]
ds_read_b64_tr_b16 a[212:213], v11 offset:16384
v_mfma_f32_16x16x32_bf16 v[184:187], a[220:223], a[120:123], v[184:187]
buffer_load_dwordx4 a[68:71], v2, s[8:11], s72 offen offset:1024 sc1
v_mfma_f32_16x16x32_bf16 v[180:183], a[220:223], a[116:119], v[180:183]
ds_read_b64_tr_b16 a[214:215], v11 offset:17408
v_mfma_f32_16x16x32_bf16 v[176:179], a[220:223], a[112:115], v[176:179]
v_mfma_f32_16x16x32_bf16 v[64:67], a[192:195], a[128:131], v[64:67]
ds_read_b64_tr_b16 a[216:217], v11 offset:8
v_mfma_f32_16x16x32_bf16 v[64:67], a[196:199], a[144:147], v[64:67]
buffer_load_dwordx4 a[72:75], v2, s[8:11], s72 offen offset:2048 sc1
v_mfma_f32_16x16x32_bf16 v[68:71], a[196:199], a[148:151], v[68:71]
ds_read_b64_tr_b16 a[218:219], v11 offset:1032
v_mfma_f32_16x16x32_bf16 v[68:71], a[192:195], a[132:135], v[68:71]
v_mfma_f32_16x16x32_bf16 v[72:75], a[192:195], a[136:139], v[72:75]
s_waitcnt lgkmcnt(4)
ds_read_b64_tr_b16 a[220:221], v11 offset:16392
v_mfma_f32_16x16x32_bf16 v[72:75], a[196:199], a[152:155], v[72:75]
buffer_load_dwordx4 a[76:79], v2, s[8:11], s72 offen offset:3072 sc1
v_mfma_f32_16x16x32_bf16 v[76:79], a[196:199], a[156:159], v[76:79]
s_add_u32 s72, s72, 4096
ds_read_b64_tr_b16 a[222:223], v11 offset:17416
v_mfma_f32_16x16x32_bf16 v[76:79], a[192:195], a[140:143], v[76:79]
s_add_u32 m0, s75, 81920
v_mfma_f32_16x16x32_bf16 v[140:143], a[204:207], a[156:159], v[140:143]
ds_read_b64_tr_b16 a[192:193], v12 offset:0
v_mfma_f32_16x16x32_bf16 v[140:143], a[200:203], a[140:143], v[140:143]
buffer_load_dwordx4 v3, s[12:15], s73 offen lds
v_mfma_f32_16x16x32_bf16 v[136:139], a[200:203], a[136:139], v[136:139]
ds_read_b64_tr_b16 a[194:195], v12 offset:1024
v_mfma_f32_16x16x32_bf16 v[136:139], a[204:207], a[152:155], v[136:139]
v_mfma_f32_16x16x32_bf16 v[132:135], a[204:207], a[148:151], v[132:135]
ds_read_b64_tr_b16 a[196:197], v12 offset:16384
v_mfma_f32_16x16x32_bf16 v[132:135], a[200:203], a[132:135], v[132:135]
buffer_load_dwordx4 v4, s[12:15], s73 offen offset:1024 lds
v_mfma_f32_16x16x32_bf16 v[128:131], a[200:203], a[128:131], v[128:131]
s_add_u32 s73, s73, 262144
s_add_u32 s74, s74, 110592
ds_read_b64_tr_b16 a[198:199], v12 offset:17408
v_mfma_f32_16x16x32_bf16 v[128:131], a[204:207], a[144:147], v[128:131]
v_mfma_f32_16x16x32_bf16 v[80:83], a[208:211], a[128:131], v[80:83]
s_waitcnt lgkmcnt(4)
ds_read_b64_tr_b16 a[200:201], v12 offset:8
v_mfma_f32_16x16x32_bf16 v[80:83], a[212:215], a[144:147], v[80:83]
buffer_load_dwordx4 a[80:83], v2, s[8:11], s72 offen offset:0 sc1
v_mfma_f32_16x16x32_bf16 v[84:87], a[212:215], a[148:151], v[84:87]
ds_read_b64_tr_b16 a[202:203], v12 offset:1032
v_mfma_f32_16x16x32_bf16 v[84:87], a[208:211], a[132:135], v[84:87]
v_mfma_f32_16x16x32_bf16 v[88:91], a[208:211], a[136:139], v[88:91]
ds_read_b64_tr_b16 a[204:205], v12 offset:16392
v_mfma_f32_16x16x32_bf16 v[88:91], a[212:215], a[152:155], v[88:91]
buffer_load_dwordx4 a[84:87], v2, s[8:11], s72 offen offset:1024 sc1
v_mfma_f32_16x16x32_bf16 v[92:95], a[212:215], a[156:159], v[92:95]
ds_read_b64_tr_b16 a[206:207], v12 offset:17416
v_mfma_f32_16x16x32_bf16 v[92:95], a[208:211], a[140:143], v[92:95]
v_mfma_f32_16x16x32_bf16 v[156:159], a[220:223], a[156:159], v[156:159]
ds_read_b64_tr_b16 a[208:209], v13 offset:0
v_mfma_f32_16x16x32_bf16 v[156:159], a[216:219], a[140:143], v[156:159]
buffer_load_dwordx4 a[88:91], v2, s[8:11], s72 offen offset:2048 sc1
v_mfma_f32_16x16x32_bf16 v[152:155], a[216:219], a[136:139], v[152:155]
ds_read_b64_tr_b16 a[210:211], v13 offset:1024
v_mfma_f32_16x16x32_bf16 v[152:155], a[220:223], a[152:155], v[152:155]
v_mfma_f32_16x16x32_bf16 v[148:151], a[220:223], a[148:151], v[148:151]
s_waitcnt lgkmcnt(4)
ds_read_b64_tr_b16 a[212:213], v13 offset:16384
v_mfma_f32_16x16x32_bf16 v[148:151], a[216:219], a[132:135], v[148:151]
buffer_load_dwordx4 a[92:95], v2, s[8:11], s72 offen offset:3072 sc1
v_mfma_f32_16x16x32_bf16 v[144:147], a[216:219], a[128:131], v[144:147]
s_add_u32 s72, s72, 4096
ds_read_b64_tr_b16 a[214:215], v13 offset:17408
v_mfma_f32_16x16x32_bf16 v[144:147], a[220:223], a[144:147], v[144:147]
s_mov_b32 s80, 3145728
v_mfma_f32_16x16x32_bf16 v[96:99], a[192:195], a[128:131], v[96:99]
ds_read_b64_tr_b16 a[216:217], v13 offset:8
v_mfma_f32_16x16x32_bf16 v[96:99], a[196:199], a[144:147], v[96:99]
buffer_load_dword v18, v63, s[12:15], s80 offen
v_mfma_f32_16x16x32_bf16 v[100:103], a[196:199], a[148:151], v[100:103]
s_add_u32 m0, s75, 98304
ds_read_b64_tr_b16 a[218:219], v13 offset:1032
v_mfma_f32_16x16x32_bf16 v[100:103], a[192:195], a[132:135], v[100:103]
v_mfma_f32_16x16x32_bf16 v[104:107], a[192:195], a[136:139], v[104:107]
ds_read_b64_tr_b16 a[220:221], v13 offset:16392
v_mfma_f32_16x16x32_bf16 v[104:107], a[196:199], a[152:155], v[104:107]
buffer_load_dwordx4 v3, s[12:15], s73 offen lds
v_mfma_f32_16x16x32_bf16 v[108:111], a[196:199], a[156:159], v[108:111]
s_waitcnt lgkmcnt(4)
ds_read_b64_tr_b16 a[222:223], v13 offset:17416
v_mfma_f32_16x16x32_bf16 v[108:111], a[192:195], a[140:143], v[108:111]
s_waitcnt vmcnt(14)
s_barrier
v_mfma_f32_16x16x32_bf16 v[172:175], a[204:207], a[156:159], v[172:175]
ds_read_b64_tr_b16 a[192:193], v10 offset:32768
v_mfma_f32_16x16x32_bf16 v[172:175], a[200:203], a[140:143], v[172:175]
buffer_load_dwordx4 v4, s[12:15], s73 offen offset:1024 lds
v_mfma_f32_16x16x32_bf16 v[168:171], a[200:203], a[136:139], v[168:171]
s_add_u32 s73, s73, 262144
s_add_u32 s74, s74, 110592
ds_read_b64_tr_b16 a[194:195], v10 offset:33792
v_mfma_f32_16x16x32_bf16 v[168:171], a[204:207], a[152:155], v[168:171]
v_mfma_f32_16x16x32_bf16 v[164:167], a[204:207], a[148:151], v[164:167]
ds_read_b64_tr_b16 a[196:197], v10 offset:49152
v_mfma_f32_16x16x32_bf16 v[164:167], a[200:203], a[132:135], v[164:167]
buffer_load_dwordx4 a[96:99], v2, s[8:11], s72 offen offset:0 sc1
v_mfma_f32_16x16x32_bf16 v[160:163], a[200:203], a[128:131], v[160:163]
ds_read_b64_tr_b16 a[198:199], v10 offset:50176
v_mfma_f32_16x16x32_bf16 v[160:163], a[204:207], a[144:147], v[160:163]
v_mfma_f32_16x16x32_bf16 v[112:115], a[208:211], a[128:131], v[112:115]
s_waitcnt lgkmcnt(4)
ds_read_b64_tr_b16 a[200:201], v10 offset:32776
v_mfma_f32_16x16x32_bf16 v[112:115], a[212:215], a[144:147], v[112:115]
buffer_load_dwordx4 a[100:103], v2, s[8:11], s72 offen offset:1024 sc1
v_mfma_f32_16x16x32_bf16 v[116:119], a[212:215], a[148:151], v[116:119]
ds_read_b64_tr_b16 a[202:203], v10 offset:33800
v_mfma_f32_16x16x32_bf16 v[116:119], a[208:211], a[132:135], v[116:119]
v_mfma_f32_16x16x32_bf16 v[120:123], a[208:211], a[136:139], v[120:123]
ds_read_b64_tr_b16 a[204:205], v10 offset:49160
v_mfma_f32_16x16x32_bf16 v[120:123], a[212:215], a[152:155], v[120:123]
buffer_load_dwordx4 a[104:107], v2, s[8:11], s72 offen offset:2048 sc1
v_mfma_f32_16x16x32_bf16 v[124:127], a[212:215], a[156:159], v[124:127]
ds_read_b64_tr_b16 a[206:207], v10 offset:50184
v_mfma_f32_16x16x32_bf16 v[124:127], a[208:211], a[140:143], v[124:127]
v_mfma_f32_16x16x32_bf16 v[188:191], a[220:223], a[156:159], v[188:191]
ds_read_b64_tr_b16 a[208:209], v11 offset:32768
v_mfma_f32_16x16x32_bf16 v[188:191], a[216:219], a[140:143], v[188:191]
buffer_load_dwordx4 a[108:111], v2, s[8:11], s72 offen offset:3072 sc1
v_mfma_f32_16x16x32_bf16 v[184:187], a[216:219], a[136:139], v[184:187]
s_add_u32 s72, s72, 4096
ds_read_b64_tr_b16 a[210:211], v11 offset:33792
v_mfma_f32_16x16x32_bf16 v[184:187], a[220:223], a[152:155], v[184:187]
s_add_u32 m0, s75, 114688
v_mfma_f32_16x16x32_bf16 v[180:183], a[220:223], a[148:151], v[180:183]
ds_read_b64_tr_b16 a[212:213], v11 offset:49152
v_mfma_f32_16x16x32_bf16 v[180:183], a[216:219], a[132:135], v[180:183]
buffer_load_dwordx4 v3, s[12:15], s73 offen lds
v_mfma_f32_16x16x32_bf16 v[176:179], a[216:219], a[128:131], v[176:179]
ds_read_b64_tr_b16 a[214:215], v11 offset:50176
v_mfma_f32_16x16x32_bf16 v[176:179], a[220:223], a[144:147], v[176:179]
s_waitcnt lgkmcnt(4)
v_mfma_f32_16x16x32_bf16 v[64:67], a[192:195], a[160:163], v[64:67]
ds_read_b64_tr_b16 a[216:217], v11 offset:32776
v_mfma_f32_16x16x32_bf16 v[64:67], a[196:199], a[176:179], v[64:67]
buffer_load_dwordx4 v4, s[12:15], s73 offen offset:1024 lds
v_mfma_f32_16x16x32_bf16 v[68:71], a[196:199], a[180:183], v[68:71]
s_add_u32 s73, s73, 262144
s_add_u32 s74, s74, 110592
ds_read_b64_tr_b16 a[218:219], v11 offset:33800
v_mfma_f32_16x16x32_bf16 v[68:71], a[192:195], a[164:167], v[68:71]
v_mfma_f32_16x16x32_bf16 v[72:75], a[192:195], a[168:171], v[72:75]
ds_read_b64_tr_b16 a[220:221], v11 offset:49160
v_mfma_f32_16x16x32_bf16 v[72:75], a[196:199], a[184:187], v[72:75]
buffer_load_dwordx4 a[112:115], v2, s[8:11], s72 offen offset:0 sc1
v_mfma_f32_16x16x32_bf16 v[76:79], a[196:199], a[188:191], v[76:79]
ds_read_b64_tr_b16 a[222:223], v11 offset:50184
v_mfma_f32_16x16x32_bf16 v[76:79], a[192:195], a[172:175], v[76:79]
v_mfma_f32_16x16x32_bf16 v[140:143], a[204:207], a[188:191], v[140:143]
ds_read_b64_tr_b16 a[192:193], v12 offset:32768
v_mfma_f32_16x16x32_bf16 v[140:143], a[200:203], a[172:175], v[140:143]
buffer_load_dwordx4 a[116:119], v2, s[8:11], s72 offen offset:1024 sc1
v_mfma_f32_16x16x32_bf16 v[136:139], a[200:203], a[168:171], v[136:139]
ds_read_b64_tr_b16 a[194:195], v12 offset:33792
v_mfma_f32_16x16x32_bf16 v[136:139], a[204:207], a[184:187], v[136:139]
v_mfma_f32_16x16x32_bf16 v[132:135], a[204:207], a[180:183], v[132:135]
ds_read_b64_tr_b16 a[196:197], v12 offset:49152
v_mfma_f32_16x16x32_bf16 v[132:135], a[200:203], a[164:167], v[132:135]
buffer_load_dwordx4 a[120:123], v2, s[8:11], s72 offen offset:2048 sc1
v_mfma_f32_16x16x32_bf16 v[128:131], a[200:203], a[160:163], v[128:131]
ds_read_b64_tr_b16 a[198:199], v12 offset:50176
v_mfma_f32_16x16x32_bf16 v[128:131], a[204:207], a[176:179], v[128:131]
s_waitcnt lgkmcnt(4)
v_mfma_f32_16x16x32_bf16 v[80:83], a[208:211], a[160:163], v[80:83]
ds_read_b64_tr_b16 a[200:201], v12 offset:32776
v_mfma_f32_16x16x32_bf16 v[80:83], a[212:215], a[176:179], v[80:83]
buffer_load_dwordx4 a[124:127], v2, s[8:11], s72 offen offset:3072 sc1
v_mfma_f32_16x16x32_bf16 v[84:87], a[212:215], a[180:183], v[84:87]
s_add_u32 s72, s72, 4096
ds_read_b64_tr_b16 a[202:203], v12 offset:33800
v_mfma_f32_16x16x32_bf16 v[84:87], a[208:211], a[164:167], v[84:87]
v_mfma_f32_16x16x32_bf16 v[88:91], a[208:211], a[168:171], v[88:91]
ds_read_b64_tr_b16 a[204:205], v12 offset:49160
v_mfma_f32_16x16x32_bf16 v[88:91], a[212:215], a[184:187], v[88:91]
v_mfma_f32_16x16x32_bf16 v[92:95], a[212:215], a[188:191], v[92:95]
ds_read_b64_tr_b16 a[206:207], v12 offset:50184
v_mfma_f32_16x16x32_bf16 v[92:95], a[208:211], a[172:175], v[92:95]
v_mfma_f32_16x16x32_bf16 v[156:159], a[220:223], a[188:191], v[156:159]
ds_read_b64_tr_b16 a[208:209], v13 offset:32768
v_mfma_f32_16x16x32_bf16 v[156:159], a[216:219], a[172:175], v[156:159]
v_mfma_f32_16x16x32_bf16 v[152:155], a[216:219], a[168:171], v[152:155]
ds_read_b64_tr_b16 a[210:211], v13 offset:33792
v_mfma_f32_16x16x32_bf16 v[152:155], a[220:223], a[184:187], v[152:155]
v_mfma_f32_16x16x32_bf16 v[148:151], a[220:223], a[180:183], v[148:151]
ds_read_b64_tr_b16 a[212:213], v13 offset:49152
v_mfma_f32_16x16x32_bf16 v[148:151], a[216:219], a[164:167], v[148:151]
v_mfma_f32_16x16x32_bf16 v[144:147], a[216:219], a[160:163], v[144:147]
ds_read_b64_tr_b16 a[214:215], v13 offset:50176
v_mfma_f32_16x16x32_bf16 v[144:147], a[220:223], a[176:179], v[144:147]
s_waitcnt lgkmcnt(4)
v_mfma_f32_16x16x32_bf16 v[96:99], a[192:195], a[160:163], v[96:99]
ds_read_b64_tr_b16 a[216:217], v13 offset:32776
v_mfma_f32_16x16x32_bf16 v[96:99], a[196:199], a[176:179], v[96:99]
v_mfma_f32_16x16x32_bf16 v[100:103], a[196:199], a[180:183], v[100:103]
ds_read_b64_tr_b16 a[218:219], v13 offset:33800
v_mfma_f32_16x16x32_bf16 v[100:103], a[192:195], a[164:167], v[100:103]
v_mfma_f32_16x16x32_bf16 v[104:107], a[192:195], a[168:171], v[104:107]
ds_read_b64_tr_b16 a[220:221], v13 offset:49160
v_mfma_f32_16x16x32_bf16 v[104:107], a[196:199], a[184:187], v[104:107]
v_mfma_f32_16x16x32_bf16 v[108:111], a[196:199], a[188:191], v[108:111]
ds_read_b64_tr_b16 a[222:223], v13 offset:50184
v_mfma_f32_16x16x32_bf16 v[108:111], a[192:195], a[172:175], v[108:111]
s_waitcnt vmcnt(13)
s_barrier
v_mfma_f32_16x16x32_bf16 v[172:175], a[204:207], a[188:191], v[172:175]
s_add_u32 m0, s75, 0
ds_read_b64_tr_b16 a[192:193], v44 offset:0
v_mfma_f32_16x16x32_bf16 v[172:175], a[200:203], a[172:175], v[172:175]
buffer_load_dwordx4 v3, s[12:15], s73 offen lds
v_mfma_f32_16x16x32_bf16 v[168:171], a[200:203], a[168:171], v[168:171]
ds_read_b64_tr_b16 a[194:195], v44 offset:1024
v_mfma_f32_16x16x32_bf16 v[168:171], a[204:207], a[184:187], v[168:171]
v_mfma_f32_16x16x32_bf16 v[164:167], a[204:207], a[180:183], v[164:167]
ds_read_b64_tr_b16 a[196:197], v44 offset:16384
v_mfma_f32_16x16x32_bf16 v[164:167], a[200:203], a[164:167], v[164:167]
buffer_load_dwordx4 v4, s[12:15], s73 offen offset:1024 lds
v_mfma_f32_16x16x32_bf16 v[160:163], a[200:203], a[160:163], v[160:163]
s_add_u32 s73, s73, 262144
s_add_u32 s74, s74, 110592
ds_read_b64_tr_b16 a[198:199], v44 offset:17408
v_mfma_f32_16x16x32_bf16 v[160:163], a[204:207], a[176:179], v[160:163]
s_waitcnt lgkmcnt(4)
v_mfma_f32_16x16x32_bf16 v[112:115], a[208:211], a[160:163], v[112:115]
ds_read_b64_tr_b16 a[200:201], v44 offset:8
v_mfma_f32_16x16x32_bf16 v[112:115], a[212:215], a[176:179], v[112:115]
buffer_load_dwordx4 a[128:131], v2, s[8:11], s72 offen offset:0 sc1
v_mfma_f32_16x16x32_bf16 v[116:119], a[212:215], a[180:183], v[116:119]
ds_read_b64_tr_b16 a[202:203], v44 offset:1032
v_mfma_f32_16x16x32_bf16 v[116:119], a[208:211], a[164:167], v[116:119]
v_mfma_f32_16x16x32_bf16 v[120:123], a[208:211], a[168:171], v[120:123]
ds_read_b64_tr_b16 a[204:205], v44 offset:16392
v_mfma_f32_16x16x32_bf16 v[120:123], a[212:215], a[184:187], v[120:123]
buffer_load_dwordx4 a[132:135], v2, s[8:11], s72 offen offset:1024 sc1
v_mfma_f32_16x16x32_bf16 v[124:127], a[212:215], a[188:191], v[124:127]
ds_read_b64_tr_b16 a[206:207], v44 offset:17416
v_mfma_f32_16x16x32_bf16 v[124:127], a[208:211], a[172:175], v[124:127]
v_mfma_f32_16x16x32_bf16 v[188:191], a[220:223], a[188:191], v[188:191]
ds_read_b64_tr_b16 a[208:209], v45 offset:0
v_mfma_f32_16x16x32_bf16 v[188:191], a[216:219], a[172:175], v[188:191]
buffer_load_dwordx4 a[136:139], v2, s[8:11], s72 offen offset:2048 sc1
v_mfma_f32_16x16x32_bf16 v[184:187], a[216:219], a[168:171], v[184:187]
ds_read_b64_tr_b16 a[210:211], v45 offset:1024
v_mfma_f32_16x16x32_bf16 v[184:187], a[220:223], a[184:187], v[184:187]
v_mfma_f32_16x16x32_bf16 v[180:183], a[220:223], a[180:183], v[180:183]
s_waitcnt lgkmcnt(4)
ds_read_b64_tr_b16 a[212:213], v45 offset:16384
v_mfma_f32_16x16x32_bf16 v[180:183], a[216:219], a[164:167], v[180:183]
buffer_load_dwordx4 a[140:143], v2, s[8:11], s72 offen offset:3072 sc1
v_mfma_f32_16x16x32_bf16 v[176:179], a[216:219], a[160:163], v[176:179]
s_add_u32 s72, s72, 4096
ds_read_b64_tr_b16 a[214:215], v45 offset:17408
v_mfma_f32_16x16x32_bf16 v[176:179], a[220:223], a[176:179], v[176:179]
s_mov_b32 s80, 4194304
v_mfma_f32_16x16x32_bf16 v[64:67], a[192:195], a[64:67], v[64:67]
ds_read_b64_tr_b16 a[216:217], v45 offset:8
v_mfma_f32_16x16x32_bf16 v[64:67], a[196:199], a[80:83], v[64:67]
buffer_load_dword v18, v63, s[12:15], s80 offen
v_mfma_f32_16x16x32_bf16 v[68:71], a[196:199], a[84:87], v[68:71]
s_add_u32 m0, s75, 16384
ds_read_b64_tr_b16 a[218:219], v45 offset:1032
v_mfma_f32_16x16x32_bf16 v[68:71], a[192:195], a[68:71], v[68:71]
v_mfma_f32_16x16x32_bf16 v[72:75], a[192:195], a[72:75], v[72:75]
ds_read_b64_tr_b16 a[220:221], v45 offset:16392
v_mfma_f32_16x16x32_bf16 v[72:75], a[196:199], a[88:91], v[72:75]
buffer_load_dwordx4 v3, s[12:15], s73 offen lds
v_mfma_f32_16x16x32_bf16 v[76:79], a[196:199], a[92:95], v[76:79]
ds_read_b64_tr_b16 a[222:223], v45 offset:17416
v_mfma_f32_16x16x32_bf16 v[76:79], a[192:195], a[76:79], v[76:79]
s_waitcnt lgkmcnt(4)
v_mfma_f32_16x16x32_bf16 v[140:143], a[204:207], a[92:95], v[140:143]
ds_read_b64_tr_b16 a[192:193], v46 offset:0
v_mfma_f32_16x16x32_bf16 v[140:143], a[200:203], a[76:79], v[140:143]
buffer_load_dwordx4 v4, s[12:15], s73 offen offset:1024 lds
v_mfma_f32_16x16x32_bf16 v[136:139], a[200:203], a[72:75], v[136:139]
s_add_u32 s73, s73, 262144
s_add_u32 s74, s74, 110592
ds_read_b64_tr_b16 a[194:195], v46 offset:1024
v_mfma_f32_16x16x32_bf16 v[136:139], a[204:207], a[88:91], v[136:139]
v_mfma_f32_16x16x32_bf16 v[132:135], a[204:207], a[84:87], v[132:135]
ds_read_b64_tr_b16 a[196:197], v46 offset:16384
v_mfma_f32_16x16x32_bf16 v[132:135], a[200:203], a[68:71], v[132:135]
buffer_load_dwordx4 a[144:147], v2, s[8:11], s72 offen offset:0 sc1
v_mfma_f32_16x16x32_bf16 v[128:131], a[200:203], a[64:67], v[128:131]
ds_read_b64_tr_b16 a[198:199], v46 offset:17408
v_mfma_f32_16x16x32_bf16 v[128:131], a[204:207], a[80:83], v[128:131]
v_mfma_f32_16x16x32_bf16 v[80:83], a[208:211], a[64:67], v[80:83]
ds_read_b64_tr_b16 a[200:201], v46 offset:8
v_mfma_f32_16x16x32_bf16 v[80:83], a[212:215], a[80:83], v[80:83]
buffer_load_dwordx4 a[148:151], v2, s[8:11], s72 offen offset:1024 sc1
v_mfma_f32_16x16x32_bf16 v[84:87], a[212:215], a[84:87], v[84:87]
ds_read_b64_tr_b16 a[202:203], v46 offset:1032
v_mfma_f32_16x16x32_bf16 v[84:87], a[208:211], a[68:71], v[84:87]
v_mfma_f32_16x16x32_bf16 v[88:91], a[208:211], a[72:75], v[88:91]
ds_read_b64_tr_b16 a[204:205], v46 offset:16392
v_mfma_f32_16x16x32_bf16 v[88:91], a[212:215], a[88:91], v[88:91]
buffer_load_dwordx4 a[152:155], v2, s[8:11], s72 offen offset:2048 sc1
v_mfma_f32_16x16x32_bf16 v[92:95], a[212:215], a[92:95], v[92:95]
ds_read_b64_tr_b16 a[206:207], v46 offset:17416
v_mfma_f32_16x16x32_bf16 v[92:95], a[208:211], a[76:79], v[92:95]
s_waitcnt lgkmcnt(4)
v_mfma_f32_16x16x32_bf16 v[156:159], a[220:223], a[92:95], v[156:159]
ds_read_b64_tr_b16 a[208:209], v47 offset:0
v_mfma_f32_16x16x32_bf16 v[156:159], a[216:219], a[76:79], v[156:159]
buffer_load_dwordx4 a[156:159], v2, s[8:11], s72 offen offset:3072 sc1
v_mfma_f32_16x16x32_bf16 v[152:155], a[216:219], a[72:75], v[152:155]
s_add_u32 s72, s72, 4096
ds_read_b64_tr_b16 a[210:211], v47 offset:1024
v_mfma_f32_16x16x32_bf16 v[152:155], a[220:223], a[88:91], v[152:155]
v_mfma_f32_16x16x32_bf16 v[148:151], a[220:223], a[84:87], v[148:151]
ds_read_b64_tr_b16 a[212:213], v47 offset:16384
v_mfma_f32_16x16x32_bf16 v[148:151], a[216:219], a[68:71], v[148:151]
v_mfma_f32_16x16x32_bf16 v[144:147], a[216:219], a[64:67], v[144:147]
ds_read_b64_tr_b16 a[214:215], v47 offset:17408
v_mfma_f32_16x16x32_bf16 v[144:147], a[220:223], a[80:83], v[144:147]
v_mfma_f32_16x16x32_bf16 v[96:99], a[192:195], a[64:67], v[96:99]
ds_read_b64_tr_b16 a[216:217], v47 offset:8
v_mfma_f32_16x16x32_bf16 v[96:99], a[196:199], a[80:83], v[96:99]
v_mfma_f32_16x16x32_bf16 v[100:103], a[196:199], a[84:87], v[100:103]
ds_read_b64_tr_b16 a[218:219], v47 offset:1032
v_mfma_f32_16x16x32_bf16 v[100:103], a[192:195], a[68:71], v[100:103]
v_mfma_f32_16x16x32_bf16 v[104:107], a[192:195], a[72:75], v[104:107]
ds_read_b64_tr_b16 a[220:221], v47 offset:16392
v_mfma_f32_16x16x32_bf16 v[104:107], a[196:199], a[88:91], v[104:107]
v_mfma_f32_16x16x32_bf16 v[108:111], a[196:199], a[92:95], v[108:111]
s_waitcnt lgkmcnt(4)
ds_read_b64_tr_b16 a[222:223], v47 offset:17416
v_mfma_f32_16x16x32_bf16 v[108:111], a[192:195], a[76:79], v[108:111]
s_waitcnt vmcnt(13)
s_barrier
v_mfma_f32_16x16x32_bf16 v[172:175], a[204:207], a[92:95], v[172:175]
s_add_u32 m0, s75, 32768
ds_read_b64_tr_b16 a[192:193], v44 offset:32768
v_mfma_f32_16x16x32_bf16 v[172:175], a[200:203], a[76:79], v[172:175]
buffer_load_dwordx4 v3, s[12:15], s73 offen lds
v_mfma_f32_16x16x32_bf16 v[168:171], a[200:203], a[72:75], v[168:171]
ds_read_b64_tr_b16 a[194:195], v44 offset:33792
v_mfma_f32_16x16x32_bf16 v[168:171], a[204:207], a[88:91], v[168:171]
v_mfma_f32_16x16x32_bf16 v[164:167], a[204:207], a[84:87], v[164:167]
ds_read_b64_tr_b16 a[196:197], v44 offset:49152
v_lshrrev_b32 v8, 4, v1
v_mfma_f32_16x16x32_bf16 v[164:167], a[200:203], a[68:71], v[164:167]
buffer_load_dwordx4 v4, s[12:15], s73 offen offset:1024 lds
v_mfma_f32_16x16x32_bf16 v[160:163], a[200:203], a[64:67], v[160:163]
s_add_u32 s73, s73, 262144
s_add_u32 s74, s74, 110592
ds_read_b64_tr_b16 a[198:199], v44 offset:50176
v_xor_b32 v8, v8, v1
v_mfma_f32_16x16x32_bf16 v[160:163], a[204:207], a[80:83], v[160:163]
v_bfe_u32 v8, v8, 1, 1
v_subrev_u32 v8, 1, v8
v_mfma_f32_16x16x32_bf16 v[112:115], a[208:211], a[64:67], v[112:115]
s_waitcnt lgkmcnt(4)
ds_read_b64_tr_b16 a[200:201], v44 offset:32776
v_and_b32 v8, 0x3f803f80, v8
v_mfma_f32_16x16x32_bf16 v[112:115], a[212:215], a[80:83], v[112:115]
buffer_load_dwordx4 a[160:163], v2, s[8:11], s72 offen offset:0 sc1
v_mfma_f32_16x16x32_bf16 v[116:119], a[212:215], a[84:87], v[116:119]
ds_read_b64_tr_b16 a[202:203], v44 offset:33800
v_mov_b32 v56, v8
v_mfma_f32_16x16x32_bf16 v[116:119], a[208:211], a[68:71], v[116:119]
v_mov_b32 v57, v8
v_mov_b32 v58, v8
v_mfma_f32_16x16x32_bf16 v[120:123], a[208:211], a[72:75], v[120:123]
ds_read_b64_tr_b16 a[204:205], v44 offset:49160
v_mov_b32 v59, v8
v_mfma_f32_16x16x32_bf16 v[120:123], a[212:215], a[88:91], v[120:123]
buffer_load_dwordx4 a[164:167], v2, s[8:11], s72 offen offset:1024 sc1
v_mfma_f32_16x16x32_bf16 v[124:127], a[212:215], a[92:95], v[124:127]
ds_read_b64_tr_b16 a[206:207], v44 offset:50184
v_and_b32 v7, 1, v1
v_mfma_f32_16x16x32_bf16 v[124:127], a[208:211], a[76:79], v[124:127]
v_mul_u32_u24 v7, 0xaaaa, v7
v_or_b32 v7, 0x4444, v7
v_mfma_f32_16x16x32_bf16 v[188:191], a[220:223], a[92:95], v[188:191]
ds_read_b64_tr_b16 a[208:209], v45 offset:32768
v_mfma_f32_16x16x32_bf16 v[188:191], a[216:219], a[76:79], v[188:191]
buffer_load_dwordx4 a[168:171], v2, s[8:11], s72 offen offset:2048 sc1
v_mfma_f32_16x16x32_bf16 v[184:187], a[216:219], a[72:75], v[184:187]
ds_read_b64_tr_b16 a[210:211], v45 offset:33792
v_mfma_f32_16x16x32_bf16 v[184:187], a[220:223], a[88:91], v[184:187]
v_mfma_f32_16x16x32_bf16 v[180:183], a[220:223], a[84:87], v[180:183]
s_waitcnt lgkmcnt(4)
ds_read_b64_tr_b16 a[212:213], v45 offset:49152
v_mfma_f32_16x16x32_bf16 v[180:183], a[216:219], a[68:71], v[180:183]
buffer_load_dwordx4 a[172:175], v2, s[8:11], s72 offen offset:3072 sc1
v_mfma_f32_16x16x32_bf16 v[176:179], a[216:219], a[64:67], v[176:179]
s_add_u32 s72, s72, 4096
ds_read_b64_tr_b16 a[214:215], v45 offset:50176
v_mfma_f32_16x16x32_bf16 v[176:179], a[220:223], a[80:83], v[176:179]
s_add_u32 m0, s75, 49152
v_mfma_f32_16x16x32_bf16 v[64:67], a[192:195], a[96:99], v[64:67]
ds_read_b64_tr_b16 a[216:217], v45 offset:32776
v_mfma_f32_16x16x32_bf16 v[64:67], a[196:199], a[112:115], v[64:67]
buffer_load_dwordx4 v3, s[12:15], s73 offen lds
v_mfma_f32_16x16x32_bf16 v[68:71], a[196:199], a[116:119], v[68:71]
ds_read_b64_tr_b16 a[218:219], v45 offset:33800
v_mfma_f32_16x16x32_bf16 v[68:71], a[192:195], a[100:103], v[68:71]
v_mfma_f32_16x16x32_bf16 v[72:75], a[192:195], a[104:107], v[72:75]
ds_read_b64_tr_b16 a[220:221], v45 offset:49160
v_mfma_f32_16x16x32_bf16 v[72:75], a[196:199], a[120:123], v[72:75]
buffer_load_dwordx4 v4, s[12:15], s73 offen offset:1024 lds
v_mfma_f32_16x16x32_bf16 v[76:79], a[196:199], a[124:127], v[76:79]
s_add_u32 s73, s73, 262144
s_add_u32 s74, s74, 110592
ds_read_b64_tr_b16 a[222:223], v45 offset:50184
v_mfma_f32_16x16x32_bf16 v[76:79], a[192:195], a[108:111], v[76:79]
s_waitcnt lgkmcnt(4)
v_mfma_f32_16x16x32_bf16 v[140:143], a[204:207], a[124:127], v[140:143]
ds_read_b64_tr_b16 a[192:193], v46 offset:32768
v_mfma_f32_16x16x32_bf16 v[140:143], a[200:203], a[108:111], v[140:143]
buffer_load_dwordx4 a[176:179], v2, s[8:11], s72 offen offset:0 sc1
v_mfma_f32_16x16x32_bf16 v[136:139], a[200:203], a[104:107], v[136:139]
ds_read_b64_tr_b16 a[194:195], v46 offset:33792
v_mfma_f32_16x16x32_bf16 v[136:139], a[204:207], a[120:123], v[136:139]
v_mfma_f32_16x16x32_bf16 v[132:135], a[204:207], a[116:119], v[132:135]
ds_read_b64_tr_b16 a[196:197], v46 offset:49152
v_mfma_f32_16x16x32_bf16 v[132:135], a[200:203], a[100:103], v[132:135]
buffer_load_dwordx4 a[180:183], v2, s[8:11], s72 offen offset:1024 sc1
v_mfma_f32_16x16x32_bf16 v[128:131], a[200:203], a[96:99], v[128:131]
ds_read_b64_tr_b16 a[198:199], v46 offset:50176
v_mfma_f32_16x16x32_bf16 v[128:131], a[204:207], a[112:115], v[128:131]
v_mfma_f32_16x16x32_bf16 v[80:83], a[208:211], a[96:99], v[80:83]
ds_read_b64_tr_b16 a[200:201], v46 offset:32776
v_mfma_f32_16x16x32_bf16 v[80:83], a[212:215], a[112:115], v[80:83]
buffer_load_dwordx4 a[184:187], v2, s[8:11], s72 offen offset:2048 sc1
v_mfma_f32_16x16x32_bf16 v[84:87], a[212:215], a[116:119], v[84:87]
ds_read_b64_tr_b16 a[202:203], v46 offset:33800
v_mfma_f32_16x16x32_bf16 v[84:87], a[208:211], a[100:103], v[84:87]
v_mfma_f32_16x16x32_bf16 v[88:91], a[208:211], a[104:107], v[88:91]
ds_read_b64_tr_b16 a[204:205], v46 offset:49160
v_mfma_f32_16x16x32_bf16 v[88:91], a[212:215], a[120:123], v[88:91]
buffer_load_dwordx4 a[188:191], v2, s[8:11], s72 offen offset:3072 sc1
v_mfma_f32_16x16x32_bf16 v[92:95], a[212:215], a[124:127], v[92:95]
s_add_u32 s72, s72, 4096
ds_read_b64_tr_b16 a[206:207], v46 offset:50184
v_mfma_f32_16x16x32_bf16 v[92:95], a[208:211], a[108:111], v[92:95]
s_waitcnt lgkmcnt(4)
v_mfma_f32_16x16x32_bf16 v[156:159], a[220:223], a[124:127], v[156:159]
ds_read_b64_tr_b16 a[208:209], v47 offset:32768
v_mfma_f32_16x16x32_bf16 v[156:159], a[216:219], a[108:111], v[156:159]
v_mfma_f32_16x16x32_bf16 v[152:155], a[216:219], a[104:107], v[152:155]
ds_read_b64_tr_b16 a[210:211], v47 offset:33792
v_mfma_f32_16x16x32_bf16 v[152:155], a[220:223], a[120:123], v[152:155]
v_mfma_f32_16x16x32_bf16 v[148:151], a[220:223], a[116:119], v[148:151]
ds_read_b64_tr_b16 a[212:213], v47 offset:49152
v_mfma_f32_16x16x32_bf16 v[148:151], a[216:219], a[100:103], v[148:151]
v_mfma_f32_16x16x32_bf16 v[144:147], a[216:219], a[96:99], v[144:147]
ds_read_b64_tr_b16 a[214:215], v47 offset:50176
v_mfma_f32_16x16x32_bf16 v[144:147], a[220:223], a[112:115], v[144:147]
v_mfma_f32_16x16x32_bf16 v[96:99], a[192:195], a[96:99], v[96:99]
ds_read_b64_tr_b16 a[216:217], v47 offset:32776
v_mfma_f32_16x16x32_bf16 v[96:99], a[196:199], a[112:115], v[96:99]
v_mfma_f32_16x16x32_bf16 v[100:103], a[196:199], a[116:119], v[100:103]
ds_read_b64_tr_b16 a[218:219], v47 offset:33800
v_mfma_f32_16x16x32_bf16 v[100:103], a[192:195], a[100:103], v[100:103]
v_mfma_f32_16x16x32_bf16 v[104:107], a[192:195], a[104:107], v[104:107]
ds_read_b64_tr_b16 a[220:221], v47 offset:49160
v_mfma_f32_16x16x32_bf16 v[104:107], a[196:199], a[120:123], v[104:107]
v_mfma_f32_16x16x32_bf16 v[108:111], a[196:199], a[124:127], v[108:111]
s_waitcnt lgkmcnt(4)
ds_read_b64_tr_b16 a[222:223], v47 offset:50184
v_mfma_f32_16x16x32_bf16 v[108:111], a[192:195], a[108:111], v[108:111]
s_waitcnt vmcnt(12)
s_barrier
v_mfma_f32_16x16x32_bf16 v[172:175], a[204:207], a[124:127], v[172:175]
s_add_u32 m0, s75, 65536
ds_read_b64_tr_b16 a[192:193], v10 offset:0
v_mfma_f32_16x16x32_bf16 v[172:175], a[200:203], a[108:111], v[172:175]
buffer_load_dwordx4 v3, s[12:15], s73 offen lds
v_mfma_f32_16x16x32_bf16 v[168:171], a[200:203], a[104:107], v[168:171]
ds_read_b64_tr_b16 a[194:195], v10 offset:1024
v_mfma_f32_16x16x32_bf16 v[168:171], a[204:207], a[120:123], v[168:171]
v_mfma_f32_16x16x32_bf16 v[164:167], a[204:207], a[116:119], v[164:167]
ds_read_b64_tr_b16 a[196:197], v10 offset:16384
v_mfma_f32_16x16x32_bf16 v[164:167], a[200:203], a[100:103], v[164:167]
buffer_load_dwordx4 v4, s[12:15], s73 offen offset:1024 lds
v_mfma_f32_16x16x32_bf16 v[160:163], a[200:203], a[96:99], v[160:163]
s_add_u32 s73, s73, 262144
s_add_u32 s74, s74, 110592
ds_read_b64_tr_b16 a[198:199], v10 offset:17408
v_mfma_f32_16x16x32_bf16 v[160:163], a[204:207], a[112:115], v[160:163]
v_mfma_f32_16x16x32_bf16 v[112:115], a[208:211], a[96:99], v[112:115]
s_waitcnt lgkmcnt(4)
ds_read_b64_tr_b16 a[200:201], v10 offset:8
v_mfma_f32_16x16x32_bf16 v[112:115], a[212:215], a[112:115], v[112:115]
buffer_load_dwordx4 a[64:67], v2, s[8:11], s72 offen offset:0 sc1
v_mfma_f32_16x16x32_bf16 v[116:119], a[212:215], a[116:119], v[116:119]
ds_read_b64_tr_b16 a[202:203], v10 offset:1032
v_mfma_f32_16x16x32_bf16 v[116:119], a[208:211], a[100:103], v[116:119]
v_mfma_f32_16x16x32_bf16 v[120:123], a[208:211], a[104:107], v[120:123]
ds_read_b64_tr_b16 a[204:205], v10 offset:16392
v_mfma_f32_16x16x32_bf16 v[120:123], a[212:215], a[120:123], v[120:123]
buffer_load_dwordx4 a[68:71], v2, s[8:11], s72 offen offset:1024 sc1
v_mfma_f32_16x16x32_bf16 v[124:127], a[212:215], a[124:127], v[124:127]
ds_read_b64_tr_b16 a[206:207], v10 offset:17416
v_mfma_f32_16x16x32_bf16 v[124:127], a[208:211], a[108:111], v[124:127]
v_mfma_f32_16x16x32_bf16 v[188:191], a[220:223], a[124:127], v[188:191]
ds_read_b64_tr_b16 a[208:209], v11 offset:0
v_mfma_f32_16x16x32_bf16 v[188:191], a[216:219], a[108:111], v[188:191]
buffer_load_dwordx4 a[72:75], v2, s[8:11], s72 offen offset:2048 sc1
v_mfma_f32_16x16x32_bf16 v[184:187], a[216:219], a[104:107], v[184:187]
ds_read_b64_tr_b16 a[210:211], v11 offset:1024
v_mfma_f32_16x16x32_bf16 v[184:187], a[220:223], a[120:123], v[184:187]
v_mfma_f32_16x16x32_bf16 v[180:183], a[220:223], a[116:119], v[180:183]
s_waitcnt lgkmcnt(4)
ds_read_b64_tr_b16 a[212:213], v11 offset:16384
v_mfma_f32_16x16x32_bf16 v[180:183], a[216:219], a[100:103], v[180:183]
buffer_load_dwordx4 a[76:79], v2, s[8:11], s72 offen offset:3072 sc1
v_mfma_f32_16x16x32_bf16 v[176:179], a[216:219], a[96:99], v[176:179]
s_add_u32 s72, s72, 4096
ds_read_b64_tr_b16 a[214:215], v11 offset:17408
v_mfma_f32_16x16x32_bf16 v[176:179], a[220:223], a[112:115], v[176:179]
s_add_u32 m0, s75, 81920
v_mfma_f32_16x16x32_bf16 v[64:67], a[192:195], a[128:131], v[64:67]
ds_read_b64_tr_b16 a[216:217], v11 offset:8
v_mfma_f32_16x16x32_bf16 v[64:67], a[196:199], a[144:147], v[64:67]
buffer_load_dwordx4 v3, s[12:15], s73 offen lds
v_mfma_f32_16x16x32_bf16 v[68:71], a[196:199], a[148:151], v[68:71]
ds_read_b64_tr_b16 a[218:219], v11 offset:1032
v_mfma_f32_16x16x32_bf16 v[68:71], a[192:195], a[132:135], v[68:71]
v_mfma_f32_16x16x32_bf16 v[72:75], a[192:195], a[136:139], v[72:75]
ds_read_b64_tr_b16 a[220:221], v11 offset:16392
v_mfma_f32_16x16x32_bf16 v[72:75], a[196:199], a[152:155], v[72:75]
buffer_load_dwordx4 v4, s[12:15], s73 offen offset:1024 lds
v_mfma_f32_16x16x32_bf16 v[76:79], a[196:199], a[156:159], v[76:79]
s_add_u32 s73, s73, 262144
s_add_u32 s74, s74, 110592
ds_read_b64_tr_b16 a[222:223], v11 offset:17416
v_mfma_f32_16x16x32_bf16 v[76:79], a[192:195], a[140:143], v[76:79]
s_waitcnt lgkmcnt(4)
v_min_u32 v9, 15, v1
v_mfma_f32_16x16x32_bf16 v[140:143], a[204:207], a[156:159], v[140:143]
ds_read_b64_tr_b16 a[192:193], v12 offset:0
v_lshlrev_b32 v9, 7, v9
v_mfma_f32_16x16x32_bf16 v[140:143], a[200:203], a[140:143], v[140:143]
s_lshl2_add_u32 s80, s70, s68
s_lshl_b32 s80, s80, 11
v_mfma_f32_16x16x32_bf16 v[136:139], a[200:203], a[136:139], v[136:139]
ds_read_b64_tr_b16 a[194:195], v12 offset:1024
v_mfma_f32_16x16x32_bf16 v[136:139], a[204:207], a[152:155], v[136:139]
buffer_load_dword v18, v9, s[24:27], s80 offen
v_mfma_f32_16x16x32_bf16 v[132:135], a[204:207], a[148:151], v[132:135]
s_add_u32 s80, s80, 32768
ds_read_b64_tr_b16 a[196:197], v12 offset:16384
v_mfma_f32_16x16x32_bf16 v[132:135], a[200:203], a[132:135], v[132:135]
v_mfma_f32_16x16x32_bf16 v[128:131], a[200:203], a[128:131], v[128:131]
ds_read_b64_tr_b16 a[198:199], v12 offset:17408
v_mfma_f32_16x16x32_bf16 v[128:131], a[204:207], a[144:147], v[128:131]
buffer_load_dword v18, v9, s[28:31], s80 offen
v_mfma_f32_16x16x32_bf16 v[80:83], a[208:211], a[128:131], v[80:83]
ds_read_b64_tr_b16 a[200:201], v12 offset:8
v_mfma_f32_16x16x32_bf16 v[80:83], a[212:215], a[144:147], v[80:83]
v_mfma_f32_16x16x32_bf16 v[84:87], a[212:215], a[148:151], v[84:87]
ds_read_b64_tr_b16 a[202:203], v12 offset:1032
v_mfma_f32_16x16x32_bf16 v[84:87], a[208:211], a[132:135], v[84:87]
buffer_load_dwordx4 a[80:83], v2, s[8:11], s72 offen offset:0 sc1
v_mfma_f32_16x16x32_bf16 v[88:91], a[208:211], a[136:139], v[88:91]
ds_read_b64_tr_b16 a[204:205], v12 offset:16392
v_mfma_f32_16x16x32_bf16 v[88:91], a[212:215], a[152:155], v[88:91]
v_mfma_f32_16x16x32_bf16 v[92:95], a[212:215], a[156:159], v[92:95]
s_waitcnt lgkmcnt(4)
ds_read_b64_tr_b16 a[206:207], v12 offset:17416
v_mfma_f32_16x16x32_bf16 v[92:95], a[208:211], a[140:143], v[92:95]
buffer_load_dwordx4 a[84:87], v2, s[8:11], s72 offen offset:1024 sc1
v_mfma_f32_16x16x32_bf16 v[156:159], a[220:223], a[156:159], v[156:159]
ds_read_b64_tr_b16 a[208:209], v13 offset:0
v_mfma_f32_16x16x32_bf16 v[156:159], a[216:219], a[140:143], v[156:159]
v_mfma_f32_16x16x32_bf16 v[152:155], a[216:219], a[136:139], v[152:155]
ds_read_b64_tr_b16 a[210:211], v13 offset:1024
v_mfma_f32_16x16x32_bf16 v[152:155], a[220:223], a[152:155], v[152:155]
buffer_load_dwordx4 a[88:91], v2, s[8:11], s72 offen offset:2048 sc1
v_mfma_f32_16x16x32_bf16 v[148:151], a[220:223], a[148:151], v[148:151]
ds_read_b64_tr_b16 a[212:213], v13 offset:16384
v_mfma_f32_16x16x32_bf16 v[148:151], a[216:219], a[132:135], v[148:151]
v_mfma_f32_16x16x32_bf16 v[144:147], a[216:219], a[128:131], v[144:147]
s_waitcnt lgkmcnt(4)
ds_read_b64_tr_b16 a[214:215], v13 offset:17408
v_mfma_f32_16x16x32_bf16 v[144:147], a[220:223], a[144:147], v[144:147]
buffer_load_dwordx4 a[92:95], v2, s[8:11], s72 offen offset:3072 sc1
v_mfma_f32_16x16x32_bf16 v[96:99], a[192:195], a[128:131], v[96:99]
s_add_u32 s72, s72, 4096
ds_read_b64_tr_b16 a[216:217], v13 offset:8
v_mfma_f32_16x16x32_bf16 v[96:99], a[196:199], a[144:147], v[96:99]
v_mfma_f32_16x16x32_bf16 v[100:103], a[196:199], a[148:151], v[100:103]
ds_read_b64_tr_b16 a[218:219], v13 offset:1032
v_mfma_f32_16x16x32_bf16 v[100:103], a[192:195], a[132:135], v[100:103]
v_mfma_f32_16x16x32_bf16 v[104:107], a[192:195], a[136:139], v[104:107]
ds_read_b64_tr_b16 a[220:221], v13 offset:16392
v_mfma_f32_16x16x32_bf16 v[104:107], a[196:199], a[152:155], v[104:107]
v_mfma_f32_16x16x32_bf16 v[108:111], a[196:199], a[156:159], v[108:111]
s_waitcnt lgkmcnt(4)
ds_read_b64_tr_b16 a[222:223], v13 offset:17416
v_mfma_f32_16x16x32_bf16 v[108:111], a[192:195], a[140:143], v[108:111]
s_waitcnt vmcnt(14)
s_barrier
v_mfma_f32_16x16x32_bf16 v[172:175], a[204:207], a[156:159], v[172:175]
s_add_u32 m0, s75, 98304
ds_read_b64_tr_b16 a[192:193], v10 offset:32768
v_mfma_f32_16x16x32_bf16 v[172:175], a[200:203], a[140:143], v[172:175]
buffer_load_dwordx4 v3, s[12:15], s73 offen lds
v_mfma_f32_16x16x32_bf16 v[168:171], a[200:203], a[136:139], v[168:171]
ds_read_b64_tr_b16 a[194:195], v10 offset:33792
v_mfma_f32_16x16x32_bf16 v[168:171], a[204:207], a[152:155], v[168:171]
v_mfma_f32_16x16x32_bf16 v[164:167], a[204:207], a[148:151], v[164:167]
ds_read_b64_tr_b16 a[196:197], v10 offset:49152
v_mfma_f32_16x16x32_bf16 v[164:167], a[200:203], a[132:135], v[164:167]
buffer_load_dwordx4 v4, s[12:15], s73 offen offset:1024 lds
v_mfma_f32_16x16x32_bf16 v[160:163], a[200:203], a[128:131], v[160:163]
s_add_u32 s73, s73, 262144
s_add_u32 s74, s74, 110592
ds_read_b64_tr_b16 a[198:199], v10 offset:50176
v_mfma_f32_16x16x32_bf16 v[160:163], a[204:207], a[144:147], v[160:163]
v_mfma_f32_16x16x32_bf16 v[112:115], a[208:211], a[128:131], v[112:115]
s_waitcnt lgkmcnt(4)
ds_read_b64_tr_b16 a[200:201], v10 offset:32776
v_mfma_f32_16x16x32_bf16 v[112:115], a[212:215], a[144:147], v[112:115]
buffer_load_dwordx4 a[96:99], v2, s[8:11], s72 offen offset:0 sc1
v_mfma_f32_16x16x32_bf16 v[116:119], a[212:215], a[148:151], v[116:119]
ds_read_b64_tr_b16 a[202:203], v10 offset:33800
v_mfma_f32_16x16x32_bf16 v[116:119], a[208:211], a[132:135], v[116:119]
v_mfma_f32_16x16x32_bf16 v[120:123], a[208:211], a[136:139], v[120:123]
ds_read_b64_tr_b16 a[204:205], v10 offset:49160
v_mfma_f32_16x16x32_bf16 v[120:123], a[212:215], a[152:155], v[120:123]
buffer_load_dwordx4 a[100:103], v2, s[8:11], s72 offen offset:1024 sc1
v_mfma_f32_16x16x32_bf16 v[124:127], a[212:215], a[156:159], v[124:127]
ds_read_b64_tr_b16 a[206:207], v10 offset:50184
v_mfma_f32_16x16x32_bf16 v[124:127], a[208:211], a[140:143], v[124:127]
v_mfma_f32_16x16x32_bf16 v[188:191], a[220:223], a[156:159], v[188:191]
ds_read_b64_tr_b16 a[208:209], v11 offset:32768
v_mfma_f32_16x16x32_bf16 v[188:191], a[216:219], a[140:143], v[188:191]
buffer_load_dwordx4 a[104:107], v2, s[8:11], s72 offen offset:2048 sc1
v_mfma_f32_16x16x32_bf16 v[184:187], a[216:219], a[136:139], v[184:187]
ds_read_b64_tr_b16 a[210:211], v11 offset:33792
v_mfma_f32_16x16x32_bf16 v[184:187], a[220:223], a[152:155], v[184:187]
v_mfma_f32_16x16x32_bf16 v[180:183], a[220:223], a[148:151], v[180:183]
s_waitcnt lgkmcnt(4)
ds_read_b64_tr_b16 a[212:213], v11 offset:49152
v_mfma_f32_16x16x32_bf16 v[180:183], a[216:219], a[132:135], v[180:183]
buffer_load_dwordx4 a[108:111], v2, s[8:11], s72 offen offset:3072 sc1
v_mfma_f32_16x16x32_bf16 v[176:179], a[216:219], a[128:131], v[176:179]
s_add_u32 s72, s72, 4096
ds_read_b64_tr_b16 a[214:215], v11 offset:50176
v_mfma_f32_16x16x32_bf16 v[176:179], a[220:223], a[144:147], v[176:179]
s_add_u32 m0, s75, 114688
v_mfma_f32_16x16x32_bf16 v[64:67], a[192:195], a[160:163], v[64:67]
ds_read_b64_tr_b16 a[216:217], v11 offset:32776
v_accvgpr_write_b32 a128, 0
v_mfma_f32_16x16x32_bf16 v[64:67], a[196:199], a[176:179], v[64:67]
buffer_load_dwordx4 v3, s[12:15], s73 offen lds
v_mfma_f32_16x16x32_bf16 v[68:71], a[196:199], a[180:183], v[68:71]
ds_read_b64_tr_b16 a[218:219], v11 offset:33800
v_accvgpr_write_b32 a129, 0
v_mfma_f32_16x16x32_bf16 v[68:71], a[192:195], a[164:167], v[68:71]
v_accvgpr_write_b32 a130, 0
v_accvgpr_write_b32 a131, 0
v_mfma_f32_16x16x32_bf16 v[72:75], a[192:195], a[168:171], v[72:75]
ds_read_b64_tr_b16 a[220:221], v11 offset:49160
v_accvgpr_write_b32 a132, 0
v_mfma_f32_16x16x32_bf16 v[72:75], a[196:199], a[184:187], v[72:75]
buffer_load_dwordx4 v4, s[12:15], s73 offen offset:1024 lds
v_mfma_f32_16x16x32_bf16 v[76:79], a[196:199], a[188:191], v[76:79]
s_add_u32 s73, s73, 262144
s_add_u32 s74, s74, 110592
ds_read_b64_tr_b16 a[222:223], v11 offset:50184
v_accvgpr_write_b32 a133, 0
v_mfma_f32_16x16x32_bf16 v[76:79], a[192:195], a[172:175], v[76:79]
s_waitcnt lgkmcnt(4)
v_accvgpr_write_b32 a134, 0
v_accvgpr_write_b32 a135, 0
v_mfma_f32_16x16x32_bf16 v[140:143], a[204:207], a[188:191], v[140:143]
ds_read_b64_tr_b16 a[192:193], v12 offset:32768
v_accvgpr_write_b32 a136, 0
v_mfma_f32_16x16x32_bf16 v[140:143], a[200:203], a[172:175], v[140:143]
buffer_load_dwordx4 a[112:115], v2, s[8:11], s72 offen offset:0 sc1
v_mfma_f32_16x16x32_bf16 v[136:139], a[200:203], a[168:171], v[136:139]
ds_read_b64_tr_b16 a[194:195], v12 offset:33792
v_accvgpr_write_b32 a137, 0
v_mfma_f32_16x16x32_bf16 v[136:139], a[204:207], a[184:187], v[136:139]
v_accvgpr_write_b32 a138, 0
v_accvgpr_write_b32 a139, 0
v_mfma_f32_16x16x32_bf16 v[132:135], a[204:207], a[180:183], v[132:135]
ds_read_b64_tr_b16 a[196:197], v12 offset:49152
v_accvgpr_write_b32 a140, 0
v_mfma_f32_16x16x32_bf16 v[132:135], a[200:203], a[164:167], v[132:135]
buffer_load_dwordx4 a[116:119], v2, s[8:11], s72 offen offset:1024 sc1
v_mfma_f32_16x16x32_bf16 v[128:131], a[200:203], a[160:163], v[128:131]
ds_read_b64_tr_b16 a[198:199], v12 offset:50176
v_accvgpr_write_b32 a141, 0
v_mfma_f32_16x16x32_bf16 v[128:131], a[204:207], a[176:179], v[128:131]
v_accvgpr_write_b32 a142, 0
v_accvgpr_write_b32 a143, 0
v_mfma_f32_16x16x32_bf16 v[80:83], a[208:211], a[160:163], v[80:83]
ds_read_b64_tr_b16 a[200:201], v12 offset:32776
v_accvgpr_write_b32 a144, 0
v_mfma_f32_16x16x32_bf16 v[80:83], a[212:215], a[176:179], v[80:83]
buffer_load_dwordx4 a[120:123], v2, s[8:11], s72 offen offset:2048 sc1
v_mfma_f32_16x16x32_bf16 v[84:87], a[212:215], a[180:183], v[84:87]
ds_read_b64_tr_b16 a[202:203], v12 offset:33800
v_accvgpr_write_b32 a145, 0
v_mfma_f32_16x16x32_bf16 v[84:87], a[208:211], a[164:167], v[84:87]
v_accvgpr_write_b32 a146, 0
v_accvgpr_write_b32 a147, 0
v_mfma_f32_16x16x32_bf16 v[88:91], a[208:211], a[168:171], v[88:91]
ds_read_b64_tr_b16 a[204:205], v12 offset:49160
v_accvgpr_write_b32 a148, 0
v_mfma_f32_16x16x32_bf16 v[88:91], a[212:215], a[184:187], v[88:91]
buffer_load_dwordx4 a[124:127], v2, s[8:11], s72 offen offset:3072 sc1
v_mfma_f32_16x16x32_bf16 v[92:95], a[212:215], a[188:191], v[92:95]
s_add_u32 s72, s72, 4096
ds_read_b64_tr_b16 a[206:207], v12 offset:50184
v_accvgpr_write_b32 a149, 0
v_mfma_f32_16x16x32_bf16 v[92:95], a[208:211], a[172:175], v[92:95]
s_waitcnt lgkmcnt(4)
v_accvgpr_write_b32 a150, 0
v_accvgpr_write_b32 a151, 0
v_mfma_f32_16x16x32_bf16 v[156:159], a[220:223], a[188:191], v[156:159]
s_bfe_u32 s83, s2, 0x10002
ds_read_b64_tr_b16 a[208:209], v13 offset:32768
v_accvgpr_write_b32 a152, 0
v_mfma_f32_16x16x32_bf16 v[156:159], a[216:219], a[172:175], v[156:159]
s_lshl_b32 s83, s83, 3
v_accvgpr_write_b32 a153, 0
v_accvgpr_write_b32 a154, 0
v_mfma_f32_16x16x32_bf16 v[152:155], a[216:219], a[168:171], v[152:155]
s_lshr_b32 s80, s2, 5
ds_read_b64_tr_b16 a[210:211], v13 offset:33792
v_accvgpr_write_b32 a155, 0
v_mfma_f32_16x16x32_bf16 v[152:155], a[220:223], a[184:187], v[152:155]
s_add_u32 s83, s83, s80
v_accvgpr_write_b32 a156, 0
v_accvgpr_write_b32 a157, 0
v_mfma_f32_16x16x32_bf16 v[148:151], a[220:223], a[180:183], v[148:151]
s_bfe_u32 s84, s2, 0x20003
ds_read_b64_tr_b16 a[212:213], v13 offset:49152
v_accvgpr_write_b32 a158, 0
v_mfma_f32_16x16x32_bf16 v[148:151], a[216:219], a[164:167], v[148:151]
s_and_b32 s85, s2, 3
v_accvgpr_write_b32 a159, 0
v_mfma_f32_16x16x32_bf16 v[144:147], a[216:219], a[160:163], v[144:147]
s_lshr_b32 s80, s85, 1
ds_read_b64_tr_b16 a[214:215], v13 offset:50176
v_mfma_f32_16x16x32_bf16 v[144:147], a[220:223], a[176:179], v[144:147]
s_lshl1_add_u32 s80, s83, s80
v_mfma_f32_16x16x32_bf16 v[96:99], a[192:195], a[160:163], v[96:99]
s_lshl2_add_u32 s80, s80, s68
ds_read_b64_tr_b16 a[216:217], v13 offset:32776
v_mfma_f32_16x16x32_bf16 v[96:99], a[196:199], a[176:179], v[96:99]
s_mul_i32 s80, s80, 20480
v_mfma_f32_16x16x32_bf16 v[100:103], a[196:199], a[180:183], v[100:103]
s_and_b32 s81, s85, 1
ds_read_b64_tr_b16 a[218:219], v13 offset:33800
v_mfma_f32_16x16x32_bf16 v[100:103], a[192:195], a[164:167], v[100:103]
s_lshl1_add_u32 s81, s84, s81
v_mfma_f32_16x16x32_bf16 v[104:107], a[192:195], a[168:171], v[104:107]
s_mul_i32 s81, s81, 160
ds_read_b64_tr_b16 a[220:221], v13 offset:49160
v_mfma_f32_16x16x32_bf16 v[104:107], a[196:199], a[184:187], v[104:107]
s_add_u32 s80, s80, s81
v_mfma_f32_16x16x32_bf16 v[108:111], a[196:199], a[188:191], v[108:111]
s_waitcnt lgkmcnt(4)
ds_read_b64_tr_b16 a[222:223], v13 offset:50184
v_mfma_f32_16x16x32_bf16 v[108:111], a[192:195], a[172:175], v[108:111]
s_waitcnt vmcnt(12)
s_barrier
v_mfma_f32_16x16x32_bf16 v[172:175], a[204:207], a[188:191], v[172:175]
s_add_u32 m0, s77, 0
s_mov_b32 s76, 0
ds_read_b64_tr_b16 a[192:193], v44 offset:0
v_mfma_f32_16x16x32_bf16 v[172:175], a[200:203], a[172:175], v[172:175]
buffer_load_dwordx4 v32, s[24:27], s76 offen offset:0 sc1 lds
v_mfma_f32_16x16x32_bf16 v[168:171], a[200:203], a[168:171], v[168:171]
s_add_u32 s20, s44, s80
s_addc_u32 s21, s45, 0
ds_read_b64_tr_b16 a[194:195], v44 offset:1024
v_mfma_f32_16x16x32_bf16 v[168:171], a[204:207], a[184:187], v[168:171]
s_mov_b32 s22, 19360
v_mfma_f32_16x16x32_bf16 v[164:167], a[204:207], a[180:183], v[164:167]
s_mov_b32 s23, 0x20000
ds_read_b64_tr_b16 a[196:197], v44 offset:16384
v_mfma_f32_16x16x32_bf16 v[164:167], a[200:203], a[164:167], v[164:167]
buffer_load_dwordx4 v33, s[24:27], s76 offen offset:1024 sc1 lds
v_mfma_f32_16x16x32_bf16 v[160:163], a[200:203], a[160:163], v[160:163]
s_add_u32 m0, s77, 8192
s_mov_b32 s76, 8192
ds_read_b64_tr_b16 a[198:199], v44 offset:17408
v_mfma_f32_16x16x32_bf16 v[160:163], a[204:207], a[176:179], v[160:163]
s_add_u32 s8, s62, s80
s_addc_u32 s9, s63, 0
v_mfma_f32_16x16x32_bf16 v[112:115], a[208:211], a[160:163], v[112:115]
s_waitcnt lgkmcnt(4)
ds_read_b64_tr_b16 a[200:201], v44 offset:8
v_mfma_f32_16x16x32_bf16 v[112:115], a[212:215], a[176:179], v[112:115]
buffer_load_dwordx4 v32, s[24:27], s76 offen offset:0 sc1 lds
v_mfma_f32_16x16x32_bf16 v[116:119], a[212:215], a[180:183], v[116:119]
s_mov_b32 s10, 19360
ds_read_b64_tr_b16 a[202:203], v44 offset:1032
v_mfma_f32_16x16x32_bf16 v[116:119], a[208:211], a[164:167], v[116:119]
s_mov_b32 s11, 0x20000
v_mfma_f32_16x16x32_bf16 v[120:123], a[208:211], a[168:171], v[120:123]
ds_read_b64_tr_b16 a[204:205], v44 offset:16392
v_and_b32 v63, 15, v1
v_mfma_f32_16x16x32_bf16 v[120:123], a[212:215], a[184:187], v[120:123]
buffer_load_dwordx4 v33, s[24:27], s76 offen offset:1024 sc1 lds
v_mfma_f32_16x16x32_bf16 v[124:127], a[212:215], a[188:191], v[124:127]
s_add_u32 m0, s77, 16384
s_mov_b32 s76, 16384
ds_read_b64_tr_b16 a[206:207], v44 offset:17416
v_mul_u32_u24 v63, 1280, v63
v_mfma_f32_16x16x32_bf16 v[124:127], a[208:211], a[172:175], v[124:127]
v_lshrrev_b32 v52, 4, v1
v_mfma_f32_16x16x32_bf16 v[188:191], a[220:223], a[188:191], v[188:191]
ds_read_b64_tr_b16 a[208:209], v45 offset:0
v_lshl_add_u32 v63, v52, 3, v63
v_mfma_f32_16x16x32_bf16 v[188:191], a[216:219], a[172:175], v[188:191]
buffer_load_dwordx4 v32, s[24:27], s76 offen offset:0 sc1 lds
v_mfma_f32_16x16x32_bf16 v[184:187], a[216:219], a[168:171], v[184:187]
s_lshr_b32 s95, s83, 1
ds_read_b64_tr_b16 a[210:211], v45 offset:1024
v_mfma_f32_16x16x32_bf16 v[184:187], a[220:223], a[184:187], v[184:187]
s_lshl2_add_u32 s95, s95, s85
v_mfma_f32_16x16x32_bf16 v[180:183], a[220:223], a[180:183], v[180:183]
s_lshl_b32 s95, s95, 10
ds_read_b64_tr_b16 a[212:213], v45 offset:16384
v_mfma_f32_16x16x32_bf16 v[180:183], a[216:219], a[164:167], v[180:183]
buffer_load_dwordx4 v33, s[24:27], s76 offen offset:1024 sc1 lds
v_mfma_f32_16x16x32_bf16 v[176:179], a[216:219], a[160:163], v[176:179]
s_add_u32 m0, s77, 24576
s_mov_b32 s76, 24576
ds_read_b64_tr_b16 a[214:215], v45 offset:17408
v_mfma_f32_16x16x32_bf16 v[176:179], a[220:223], a[176:179], v[176:179]
s_waitcnt lgkmcnt(4)
v_mfma_f32_16x16x32_bf16 v[64:67], a[192:195], a[64:67], v[64:67]
s_mul_i32 s80, s85, 7
ds_read_b64_tr_b16 a[216:217], v45 offset:8
v_accvgpr_write_b32 a160, 0
v_mfma_f32_16x16x32_bf16 v[64:67], a[196:199], a[80:83], v[64:67]
buffer_load_dwordx4 v32, s[24:27], s76 offen offset:0 sc1 lds
v_mfma_f32_16x16x32_bf16 v[68:71], a[196:199], a[84:87], v[68:71]
s_add_u32 s80, s80, 64
ds_read_b64_tr_b16 a[218:219], v45 offset:1032
v_accvgpr_write_b32 a161, 0
v_mfma_f32_16x16x32_bf16 v[68:71], a[192:195], a[68:71], v[68:71]
s_lshl_b32 s72, s80, 13
v_accvgpr_write_b32 a162, 0
v_accvgpr_write_b32 a163, 0
v_mfma_f32_16x16x32_bf16 v[72:75], a[192:195], a[72:75], v[72:75]
s_mul_i32 s74, s80, 20480
ds_read_b64_tr_b16 a[220:221], v45 offset:16392
v_accvgpr_write_b32 a164, 0
v_mfma_f32_16x16x32_bf16 v[72:75], a[196:199], a[88:91], v[72:75]
buffer_load_dwordx4 v33, s[24:27], s76 offen offset:1024 sc1 lds
v_mfma_f32_16x16x32_bf16 v[76:79], a[196:199], a[92:95], v[76:79]
s_lshl_b32 s73, s85, 17
ds_read_b64_tr_b16 a[222:223], v45 offset:17416
v_accvgpr_write_b32 a165, 0
v_mfma_f32_16x16x32_bf16 v[76:79], a[192:195], a[76:79], v[76:79]
s_mul_i32 s75, s85, 327680
v_accvgpr_write_b32 a166, 0
v_accvgpr_write_b32 a167, 0
v_mfma_f32_16x16x32_bf16 v[140:143], a[204:207], a[92:95], v[140:143]
s_lshl2_add_u32 s80, s83, s84
ds_read_b64_tr_b16 a[192:193], v46 offset:0
v_accvgpr_write_b32 a168, 0
v_mfma_f32_16x16x32_bf16 v[140:143], a[200:203], a[76:79], v[140:143]
s_mul_i32 s80, s80, 159744
v_accvgpr_write_b32 a169, 0
v_accvgpr_write_b32 a170, 0
v_mfma_f32_16x16x32_bf16 v[136:139], a[200:203], a[72:75], v[136:139]
s_add_u32 s80, s80, 37748736
ds_read_b64_tr_b16 a[194:195], v46 offset:1024
v_accvgpr_write_b32 a171, 0
v_mfma_f32_16x16x32_bf16 v[136:139], a[204:207], a[88:91], v[136:139]
s_add_u32 s12, s66, s80
s_addc_u32 s13, s67, 0
v_accvgpr_write_b32 a172, 0
v_accvgpr_write_b32 a173, 0
v_mfma_f32_16x16x32_bf16 v[132:135], a[204:207], a[84:87], v[132:135]
s_mov_b32 s14, 147456
ds_read_b64_tr_b16 a[196:197], v46 offset:16384
v_accvgpr_write_b32 a174, 0
v_mfma_f32_16x16x32_bf16 v[132:135], a[200:203], a[68:71], v[132:135]
s_mov_b32 s15, 0x20000
v_accvgpr_write_b32 a175, 0
v_accvgpr_write_b32 a176, 0
v_mfma_f32_16x16x32_bf16 v[128:131], a[200:203], a[64:67], v[128:131]
s_and_b32 s80, s68, 2
ds_read_b64_tr_b16 a[198:199], v46 offset:17408
v_accvgpr_write_b32 a177, 0
v_mfma_f32_16x16x32_bf16 v[128:131], a[204:207], a[80:83], v[128:131]
s_waitcnt lgkmcnt(4)
v_accvgpr_write_b32 a178, 0
v_accvgpr_write_b32 a179, 0
v_mfma_f32_16x16x32_bf16 v[80:83], a[208:211], a[64:67], v[80:83]
s_add_u32 s80, s80, 0
ds_read_b64_tr_b16 a[200:201], v46 offset:8
v_accvgpr_write_b32 a180, 0
v_mfma_f32_16x16x32_bf16 v[80:83], a[212:215], a[80:83], v[80:83]
s_xor_b32 s81, s80, s85
v_accvgpr_write_b32 a181, 0
v_accvgpr_write_b32 a182, 0
v_mfma_f32_16x16x32_bf16 v[84:87], a[212:215], a[84:87], v[84:87]
s_mul_i32 s80, s80, 3
ds_read_b64_tr_b16 a[202:203], v46 offset:1032
v_accvgpr_write_b32 a183, 0
v_mfma_f32_16x16x32_bf16 v[84:87], a[208:211], a[68:71], v[84:87]
s_add_u32 s80, s80, s81
v_accvgpr_write_b32 a184, 0
v_accvgpr_write_b32 a185, 0
v_mfma_f32_16x16x32_bf16 v[88:91], a[208:211], a[72:75], v[88:91]
s_sub_u32 s80, s80, 1
ds_read_b64_tr_b16 a[204:205], v46 offset:16392
v_accvgpr_write_b32 a186, 0
v_mfma_f32_16x16x32_bf16 v[88:91], a[212:215], a[88:91], v[88:91]
s_mul_i32 s80, s80, 12288
v_accvgpr_write_b32 a187, 0
v_accvgpr_write_b32 a188, 0
v_mfma_f32_16x16x32_bf16 v[92:95], a[212:215], a[92:95], v[92:95]
s_and_b32 s16, s68, 1
ds_read_b64_tr_b16 a[206:207], v46 offset:17416
v_accvgpr_write_b32 a189, 0
v_mfma_f32_16x16x32_bf16 v[92:95], a[208:211], a[76:79], v[92:95]
s_mul_i32 s16, s16, 6144
v_accvgpr_write_b32 a190, 0
v_accvgpr_write_b32 a191, 0
v_mfma_f32_16x16x32_bf16 v[156:159], a[220:223], a[92:95], v[156:159]
s_add_u32 s16, s16, s80
ds_read_b64_tr_b16 a[208:209], v47 offset:0
v_mfma_f32_16x16x32_bf16 v[156:159], a[216:219], a[76:79], v[156:159]
s_cmp_eq_u32 s81, 0
s_cselect_b32 s16, 0x1000000, s16
v_mfma_f32_16x16x32_bf16 v[152:155], a[216:219], a[72:75], v[152:155]
s_and_b32 s80, s68, 2
ds_read_b64_tr_b16 a[210:211], v47 offset:1024
v_mfma_f32_16x16x32_bf16 v[152:155], a[220:223], a[88:91], v[152:155]
s_add_u32 s80, s80, 1
v_mfma_f32_16x16x32_bf16 v[148:151], a[220:223], a[84:87], v[148:151]
s_xor_b32 s81, s80, s85
ds_read_b64_tr_b16 a[212:213], v47 offset:16384
v_mfma_f32_16x16x32_bf16 v[148:151], a[216:219], a[68:71], v[148:151]
s_mul_i32 s80, s80, 3
v_mfma_f32_16x16x32_bf16 v[144:147], a[216:219], a[64:67], v[144:147]
s_add_u32 s80, s80, s81
ds_read_b64_tr_b16 a[214:215], v47 offset:17408
v_mfma_f32_16x16x32_bf16 v[144:147], a[220:223], a[80:83], v[144:147]
s_waitcnt lgkmcnt(4)
v_mfma_f32_16x16x32_bf16 v[96:99], a[192:195], a[64:67], v[96:99]
s_sub_u32 s80, s80, 1
ds_read_b64_tr_b16 a[216:217], v47 offset:8
v_mfma_f32_16x16x32_bf16 v[96:99], a[196:199], a[80:83], v[96:99]
s_mul_i32 s80, s80, 12288
v_mfma_f32_16x16x32_bf16 v[100:103], a[196:199], a[84:87], v[100:103]
s_and_b32 s17, s68, 1
ds_read_b64_tr_b16 a[218:219], v47 offset:1032
v_mfma_f32_16x16x32_bf16 v[100:103], a[192:195], a[68:71], v[100:103]
s_mul_i32 s17, s17, 6144
v_mfma_f32_16x16x32_bf16 v[104:107], a[192:195], a[72:75], v[104:107]
s_add_u32 s17, s17, s80
ds_read_b64_tr_b16 a[220:221], v47 offset:16392
v_mfma_f32_16x16x32_bf16 v[104:107], a[196:199], a[88:91], v[104:107]
s_cmp_eq_u32 s81, 0
s_cselect_b32 s17, 0x1000000, s17
v_mfma_f32_16x16x32_bf16 v[108:111], a[196:199], a[92:95], v[108:111]
s_mul_i32 s18, s85, 36864
ds_read_b64_tr_b16 a[222:223], v47 offset:17416
v_mfma_f32_16x16x32_bf16 v[108:111], a[192:195], a[76:79], v[108:111]
s_waitcnt vmcnt(8)
s_barrier
v_mfma_f32_16x16x32_bf16 v[172:175], a[204:207], a[92:95], v[172:175]
s_add_u32 m0, s77, 32768
s_mov_b32 s76, 32768
ds_read_b64_tr_b16 a[192:193], v44 offset:32768
v_mfma_f32_16x16x32_bf16 v[172:175], a[200:203], a[76:79], v[172:175]
buffer_load_dwordx4 v32, s[24:27], s76 offen offset:0 sc1 lds
v_mfma_f32_16x16x32_bf16 v[168:171], a[200:203], a[72:75], v[168:171]
s_mul_i32 s80, s68, 3072
ds_read_b64_tr_b16 a[194:195], v44 offset:33792
v_mfma_f32_16x16x32_bf16 v[168:171], a[204:207], a[88:91], v[168:171]
s_add_u32 s18, s18, s80
v_mfma_f32_16x16x32_bf16 v[164:167], a[204:207], a[84:87], v[164:167]
s_add_u32 s80, s92, 0x10000
ds_read_b64_tr_b16 a[196:197], v44 offset:49152
v_mfma_f32_16x16x32_bf16 v[164:167], a[200:203], a[68:71], v[164:167]
buffer_load_dwordx4 v33, s[24:27], s76 offen offset:1024 sc1 lds
v_mfma_f32_16x16x32_bf16 v[160:163], a[200:203], a[64:67], v[160:163]
s_add_u32 m0, s77, 40960
s_mov_b32 s76, 40960
ds_read_b64_tr_b16 a[198:199], v44 offset:50176
v_mfma_f32_16x16x32_bf16 v[160:163], a[204:207], a[80:83], v[160:163]
s_waitcnt lgkmcnt(4)
v_mfma_f32_16x16x32_bf16 v[112:115], a[208:211], a[64:67], v[112:115]
s_and_b32 s80, s80, 0x1fff0000
ds_read_b64_tr_b16 a[200:201], v44 offset:32776
v_mfma_f32_16x16x32_bf16 v[112:115], a[212:215], a[80:83], v[112:115]
buffer_load_dwordx4 v32, s[24:27], s76 offen offset:0 sc1 lds
v_mfma_f32_16x16x32_bf16 v[116:119], a[212:215], a[84:87], v[116:119]
s_or_b32 s19, s80, 0x40000000
ds_read_b64_tr_b16 a[202:203], v44 offset:33800
v_mfma_f32_16x16x32_bf16 v[116:119], a[208:211], a[68:71], v[116:119]
v_mov_b32 v62, s19
v_mfma_f32_16x16x32_bf16 v[120:123], a[208:211], a[72:75], v[120:123]
s_and_b32 s80, s68, 1
ds_read_b64_tr_b16 a[204:205], v44 offset:49160
v_mfma_f32_16x16x32_bf16 v[120:123], a[212:215], a[88:91], v[120:123]
buffer_load_dwordx4 v33, s[24:27], s76 offen offset:1024 sc1 lds
v_mfma_f32_16x16x32_bf16 v[124:127], a[212:215], a[92:95], v[124:127]
s_add_u32 m0, s77, 49152
s_mov_b32 s76, 49152
ds_read_b64_tr_b16 a[206:207], v44 offset:50184
v_mfma_f32_16x16x32_bf16 v[124:127], a[208:211], a[76:79], v[124:127]
s_mul_i32 s80, s80, 10240
v_mfma_f32_16x16x32_bf16 v[188:191], a[220:223], a[92:95], v[188:191]
ds_read_b64_tr_b16 a[208:209], v45 offset:32768
v_add_u32 v3, s80, v2
v_mfma_f32_16x16x32_bf16 v[188:191], a[216:219], a[76:79], v[188:191]
buffer_load_dwordx4 v32, s[24:27], s76 offen offset:0 sc1 lds
v_mfma_f32_16x16x32_bf16 v[184:187], a[216:219], a[72:75], v[184:187]
s_mul_i32 s80, s68, 5120
ds_read_b64_tr_b16 a[210:211], v45 offset:33792
v_mfma_f32_16x16x32_bf16 v[184:187], a[220:223], a[88:91], v[184:187]
v_add_u32 v4, s80, v2
v_mfma_f32_16x16x32_bf16 v[180:183], a[220:223], a[84:87], v[180:183]
s_lshr_b32 s80, s68, 1
ds_read_b64_tr_b16 a[212:213], v45 offset:49152
v_mfma_f32_16x16x32_bf16 v[180:183], a[216:219], a[68:71], v[180:183]
buffer_load_dwordx4 v33, s[24:27], s76 offen offset:1024 sc1 lds
v_mfma_f32_16x16x32_bf16 v[176:179], a[216:219], a[64:67], v[176:179]
s_add_u32 m0, s77, 57344
s_mov_b32 s76, 57344
ds_read_b64_tr_b16 a[214:215], v45 offset:50176
v_mfma_f32_16x16x32_bf16 v[176:179], a[220:223], a[80:83], v[176:179]
s_waitcnt lgkmcnt(4)
v_mfma_f32_16x16x32_bf16 v[64:67], a[192:195], a[96:99], v[64:67]
s_lshl1_add_u32 s80, s83, s80
ds_read_b64_tr_b16 a[216:217], v45 offset:32776
v_accvgpr_write_b32 a64, 0
v_mfma_f32_16x16x32_bf16 v[64:67], a[196:199], a[112:115], v[64:67]
buffer_load_dwordx4 v32, s[24:27], s76 offen offset:0 sc1 lds
v_mfma_f32_16x16x32_bf16 v[68:71], a[196:199], a[116:119], v[68:71]
s_mul_i32 s80, s80, 749568
ds_read_b64_tr_b16 a[218:219], v45 offset:33800
v_accvgpr_write_b32 a65, 0
v_mfma_f32_16x16x32_bf16 v[68:71], a[192:195], a[100:103], v[68:71]
s_waitcnt vmcnt(63)
s_barrier
v_mfma_f32_16x16x32_bf16 v[72:75], a[192:195], a[104:107], v[72:75]
s_and_b32 s81, s68, 1
ds_read_b64_tr_b16 a[220:221], v45 offset:49160
v_accvgpr_write_b32 a66, 0
v_mfma_f32_16x16x32_bf16 v[72:75], a[196:199], a[120:123], v[72:75]
buffer_load_dwordx4 v33, s[24:27], s76 offen offset:1024 sc1 lds
v_mfma_f32_16x16x32_bf16 v[76:79], a[196:199], a[124:127], v[76:79]
s_add_u32 m0, s77, 65536
s_mov_b32 s76, 32768
ds_read_b64_tr_b16 a[222:223], v45 offset:50184
v_accvgpr_write_b32 a67, 0
v_mfma_f32_16x16x32_bf16 v[76:79], a[192:195], a[108:111], v[76:79]
s_lshl_b32 s81, s81, 11
v_accvgpr_write_b32 a68, 0
v_accvgpr_write_b32 a69, 0
v_mfma_f32_16x16x32_bf16 v[140:143], a[204:207], a[124:127], v[140:143]
s_add_u32 s80, s80, s81
ds_read_b64_tr_b16 a[192:193], v46 offset:32768
v_accvgpr_write_b32 a70, 0
v_mfma_f32_16x16x32_bf16 v[140:143], a[200:203], a[108:111], v[140:143]
buffer_load_dwordx4 v34, s[28:31], s76 offen offset:0 sc1 lds
v_mfma_f32_16x16x32_bf16 v[136:139], a[200:203], a[104:107], v[136:139]
s_add_u32 s36, s66, s80
s_addc_u32 s37, s67, 0
ds_read_b64_tr_b16 a[194:195], v46 offset:33792
v_accvgpr_write_b32 a71, 0
v_mfma_f32_16x16x32_bf16 v[136:139], a[204:207], a[120:123], v[136:139]
s_mov_b32 s38, 743424
v_accvgpr_write_b32 a72, 0
v_accvgpr_write_b32 a73, 0
v_mfma_f32_16x16x32_bf16 v[132:135], a[204:207], a[116:119], v[132:135]
s_mov_b32 s39, 0x20000
ds_read_b64_tr_b16 a[196:197], v46 offset:49152
v_accvgpr_write_b32 a74, 0
v_mfma_f32_16x16x32_bf16 v[132:135], a[200:203], a[100:103], v[132:135]
buffer_load_dwordx4 v35, s[28:31], s76 offen offset:1024 sc1 lds
v_mfma_f32_16x16x32_bf16 v[128:131], a[200:203], a[96:99], v[128:131]
s_add_u32 m0, s77, 73728
s_mov_b32 s76, 40960
ds_read_b64_tr_b16 a[198:199], v46 offset:50176
v_accvgpr_write_b32 a75, 0
v_mfma_f32_16x16x32_bf16 v[128:131], a[204:207], a[112:115], v[128:131]
s_waitcnt lgkmcnt(4)
v_accvgpr_write_b32 a76, 0
v_accvgpr_write_b32 a77, 0
v_mfma_f32_16x16x32_bf16 v[80:83], a[208:211], a[96:99], v[80:83]
s_mul_i32 s88, s68, 5120
ds_read_b64_tr_b16 a[200:201], v46 offset:32776
v_accvgpr_write_b32 a78, 0
v_mfma_f32_16x16x32_bf16 v[80:83], a[212:215], a[112:115], v[80:83]
buffer_load_dwordx4 v34, s[28:31], s76 offen offset:0 sc1 lds
v_mfma_f32_16x16x32_bf16 v[84:87], a[212:215], a[116:119], v[84:87]
s_mul_i32 s80, s84, 1867776
ds_read_b64_tr_b16 a[202:203], v46 offset:33800
v_accvgpr_write_b32 a79, 0
v_mfma_f32_16x16x32_bf16 v[84:87], a[208:211], a[100:103], v[84:87]
s_add_u32 s80, s80, s88
v_accvgpr_write_b32 a80, 0
v_accvgpr_write_b32 a81, 0
v_mfma_f32_16x16x32_bf16 v[88:91], a[208:211], a[104:107], v[88:91]
s_add_u32 s80, s80, 25165824
ds_read_b64_tr_b16 a[204:205], v46 offset:49160
v_accvgpr_write_b32 a82, 0
v_mfma_f32_16x16x32_bf16 v[88:91], a[212:215], a[120:123], v[88:91]
buffer_load_dwordx4 v35, s[28:31], s76 offen offset:1024 sc1 lds
v_mfma_f32_16x16x32_bf16 v[92:95], a[212:215], a[124:127], v[92:95]
s_add_u32 m0, s77, 81920
s_mov_b32 s76, 49152
ds_read_b64_tr_b16 a[206:207], v46 offset:50184
v_accvgpr_write_b32 a83, 0
v_mfma_f32_16x16x32_bf16 v[92:95], a[208:211], a[108:111], v[92:95]
s_add_u32 s40, s66, s80
s_addc_u32 s41, s67, 0
v_cvt_pk_bf16_f32 v64, v64, v65
v_cvt_pk_bf16_f32 v65, v66, v67
v_mfma_f32_16x16x32_bf16 v[156:159], a[220:223], a[124:127], v[156:159]
s_mov_b32 s42, 1848320
ds_read_b64_tr_b16 a[208:209], v47 offset:32768
v_cvt_pk_bf16_f32 v66, v128, v129
v_mfma_f32_16x16x32_bf16 v[156:159], a[216:219], a[108:111], v[156:159]
buffer_load_dwordx4 v34, s[28:31], s76 offen offset:0 sc1 lds
v_mfma_f32_16x16x32_bf16 v[152:155], a[216:219], a[104:107], v[152:155]
s_mov_b32 s43, 0x20000
ds_read_b64_tr_b16 a[210:211], v47 offset:33792
v_cvt_pk_bf16_f32 v67, v130, v131
v_mfma_f32_16x16x32_bf16 v[152:155], a[220:223], a[120:123], v[152:155]
v_mov_b32 v60, v2
v_cvt_pk_bf16_f32 v68, v68, v69
v_mfma_f32_16x16x32_bf16 v[148:151], a[220:223], a[116:119], v[148:151]
ds_read_b64_tr_b16 a[212:213], v47 offset:49152
v_add_u32 v61, 4096, v2
v_mfma_f32_16x16x32_bf16 v[148:151], a[216:219], a[100:103], v[148:151]
buffer_load_dwordx4 v35, s[28:31], s76 offen offset:1024 sc1 lds
v_mfma_f32_16x16x32_bf16 v[144:147], a[216:219], a[96:99], v[144:147]
s_add_u32 m0, s77, 90112
s_mov_b32 s76, 57344
ds_read_b64_tr_b16 a[214:215], v47 offset:50176
v_cvt_pk_bf16_f32 v69, v70, v71
v_mfma_f32_16x16x32_bf16 v[144:147], a[220:223], a[112:115], v[144:147]
s_waitcnt lgkmcnt(4)
v_cvt_pk_bf16_f32 v70, v132, v133
v_cvt_pk_bf16_f32 v71, v134, v135
v_mfma_f32_16x16x32_bf16 v[96:99], a[192:195], a[96:99], v[96:99]
ds_read_b64_tr_b16 a[216:217], v47 offset:32776
v_cvt_pk_bf16_f32 v72, v72, v73
v_mfma_f32_16x16x32_bf16 v[96:99], a[196:199], a[112:115], v[96:99]
buffer_load_dwordx4 v34, s[28:31], s76 offen offset:0 sc1 lds
v_mfma_f32_16x16x32_bf16 v[100:103], a[196:199], a[116:119], v[100:103]
ds_read_b64_tr_b16 a[218:219], v47 offset:33800
v_cvt_pk_bf16_f32 v73, v74, v75
v_mfma_f32_16x16x32_bf16 v[100:103], a[192:195], a[100:103], v[100:103]
v_cvt_pk_bf16_f32 v74, v136, v137
v_cvt_pk_bf16_f32 v75, v138, v139
v_mfma_f32_16x16x32_bf16 v[104:107], a[192:195], a[104:107], v[104:107]
ds_read_b64_tr_b16 a[220:221], v47 offset:49160
v_cvt_pk_bf16_f32 v76, v76, v77
v_mfma_f32_16x16x32_bf16 v[104:107], a[196:199], a[120:123], v[104:107]
buffer_load_dwordx4 v35, s[28:31], s76 offen offset:1024 sc1 lds
v_mfma_f32_16x16x32_bf16 v[108:111], a[196:199], a[124:127], v[108:111]
ds_read_b64_tr_b16 a[222:223], v47 offset:50184
v_cvt_pk_bf16_f32 v77, v78, v79
v_mfma_f32_16x16x32_bf16 v[108:111], a[192:195], a[108:111], v[108:111]
v_cvt_pk_bf16_f32 v78, v140, v141
v_cvt_pk_bf16_f32 v79, v142, v143
v_mfma_f32_16x16x32_bf16 v[172:175], a[204:207], a[124:127], v[172:175]
s_waitcnt vmcnt(20)
s_barrier
v_mfma_f32_16x16x32_bf16 v[172:175], a[200:203], a[108:111], v[172:175]
ds_read_b128 a[224:227], v20 offset:0
v_cvt_pk_bf16_f32 v80, v80, v81
v_mfma_f32_16x16x32_bf16 v[168:171], a[200:203], a[104:107], v[168:171]
ds_read_b128 a[240:243], v20 offset:4096
v_cvt_pk_bf16_f32 v81, v82, v83
v_mfma_f32_16x16x32_bf16 v[168:171], a[204:207], a[120:123], v[168:171]
ds_read_b128 a[228:231], v21 offset:0
v_cvt_pk_bf16_f32 v82, v144, v145
v_mfma_f32_16x16x32_bf16 v[164:167], a[204:207], a[116:119], v[164:167]
ds_read_b128 a[244:247], v21 offset:4096
v_cvt_pk_bf16_f32 v83, v146, v147
v_mfma_f32_16x16x32_bf16 v[164:167], a[200:203], a[100:103], v[164:167]
ds_read_b128 a[232:235], v22 offset:0
v_cvt_pk_bf16_f32 v84, v84, v85
v_mfma_f32_16x16x32_bf16 v[160:163], a[200:203], a[96:99], v[160:163]
ds_read_b128 a[248:251], v22 offset:4096
v_cvt_pk_bf16_f32 v85, v86, v87
v_mfma_f32_16x16x32_bf16 v[160:163], a[204:207], a[112:115], v[160:163]
s_waitcnt lgkmcnt(6)
ds_read_b128 a[236:239], v23 offset:0
v_cvt_pk_bf16_f32 v86, v148, v149
v_mfma_f32_16x16x32_bf16 v[112:115], a[208:211], a[96:99], v[112:115]
ds_read_b128 a[252:255], v23 offset:4096
v_cvt_pk_bf16_f32 v87, v150, v151
v_mfma_f32_16x16x32_bf16 v[112:115], a[212:215], a[112:115], v[112:115]
v_cvt_pk_bf16_f32 v88, v88, v89
v_cvt_pk_bf16_f32 v89, v90, v91
v_mfma_f32_16x16x32_bf16 v[116:119], a[212:215], a[116:119], v[116:119]
v_cvt_pk_bf16_f32 v90, v152, v153
v_cvt_pk_bf16_f32 v91, v154, v155
v_mfma_f32_16x16x32_bf16 v[116:119], a[208:211], a[100:103], v[116:119]
v_cvt_pk_bf16_f32 v92, v92, v93
v_cvt_pk_bf16_f32 v93, v94, v95
v_mfma_f32_16x16x32_bf16 v[120:123], a[208:211], a[104:107], v[120:123]
v_cvt_pk_bf16_f32 v94, v156, v157
v_cvt_pk_bf16_f32 v95, v158, v159
v_mfma_f32_16x16x32_bf16 v[120:123], a[212:215], a[120:123], v[120:123]
v_accvgpr_write_b32 a84, 0
v_accvgpr_write_b32 a85, 0
v_mfma_f32_16x16x32_bf16 v[124:127], a[212:215], a[124:127], v[124:127]
v_accvgpr_write_b32 a86, 0
v_accvgpr_write_b32 a87, 0
v_mfma_f32_16x16x32_bf16 v[124:127], a[208:211], a[108:111], v[124:127]
v_cvt_pk_bf16_f32 v96, v96, v97
v_cvt_pk_bf16_f32 v97, v98, v99
v_mfma_f32_16x16x32_bf16 v[188:191], a[220:223], a[124:127], v[188:191]
v_cvt_pk_bf16_f32 v98, v160, v161
v_cvt_pk_bf16_f32 v99, v162, v163
v_mfma_f32_16x16x32_bf16 v[188:191], a[216:219], a[108:111], v[188:191]
v_cvt_pk_bf16_f32 v100, v100, v101
v_cvt_pk_bf16_f32 v101, v102, v103
v_mfma_f32_16x16x32_bf16 v[184:187], a[216:219], a[104:107], v[184:187]
v_cvt_pk_bf16_f32 v102, v164, v165
v_cvt_pk_bf16_f32 v103, v166, v167
v_mfma_f32_16x16x32_bf16 v[184:187], a[220:223], a[120:123], v[184:187]
v_cvt_pk_bf16_f32 v104, v104, v105
v_cvt_pk_bf16_f32 v105, v106, v107
v_mfma_f32_16x16x32_bf16 v[180:183], a[220:223], a[116:119], v[180:183]
v_cvt_pk_bf16_f32 v106, v168, v169
v_cvt_pk_bf16_f32 v107, v170, v171
v_mfma_f32_16x16x32_bf16 v[180:183], a[216:219], a[100:103], v[180:183]
v_cvt_pk_bf16_f32 v108, v108, v109
v_cvt_pk_bf16_f32 v109, v110, v111
v_mfma_f32_16x16x32_bf16 v[176:179], a[216:219], a[96:99], v[176:179]
v_cvt_pk_bf16_f32 v110, v172, v173
v_cvt_pk_bf16_f32 v111, v174, v175
v_mfma_f32_16x16x32_bf16 v[176:179], a[220:223], a[112:115], v[176:179]
s_waitcnt lgkmcnt(0)
v_accvgpr_write_b32 a88, 0
v_accvgpr_write_b32 a89, 0
v_mfma_f32_16x16x32_bf16 v[128:131], a[224:227], v[64:67], 0
s_waitcnt vmcnt(63)
s_barrier
v_mfma_f32_16x16x32_bf16 v[136:139], a[224:227], v[68:71], 0
s_add_u32 m0, s77, 98304
s_mov_b32 s76, 65536
v_accvgpr_write_b32 a90, 0
v_accvgpr_write_b32 a91, 0
v_mfma_f32_16x16x32_bf16 v[144:147], a[224:227], v[72:75], 0
buffer_load_dwordx4 v34, s[28:31], s76 offen offset:0 sc1 lds
v_mfma_f32_16x16x32_bf16 v[152:155], a[224:227], v[76:79], 0
ds_read_b128 a[224:227], v20 offset:8192
v_accvgpr_write_b32 a92, 0
v_mfma_f32_16x16x32_bf16 v[132:135], a[240:243], v[64:67], 0
v_accvgpr_write_b32 a93, 0
v_accvgpr_write_b32 a94, 0
v_mfma_f32_16x16x32_bf16 v[140:143], a[240:243], v[68:71], 0
v_accvgpr_write_b32 a95, 0
v_accvgpr_write_b32 a96, 0
v_mfma_f32_16x16x32_bf16 v[148:151], a[240:243], v[72:75], 0
buffer_load_dwordx4 v35, s[28:31], s76 offen offset:1024 sc1 lds
v_mfma_f32_16x16x32_bf16 v[156:159], a[240:243], v[76:79], 0
ds_read_b128 a[240:243], v20 offset:12288
v_cvt_pk_bf16_f32 v112, v112, v113
v_mfma_f32_16x16x32_bf16 v[128:131], a[228:231], v[80:83], v[128:131]
v_cvt_pk_bf16_f32 v113, v114, v115
v_cvt_pk_bf16_f32 v114, v176, v177
v_mfma_f32_16x16x32_bf16 v[136:139], a[228:231], v[84:87], v[136:139]
v_cvt_pk_bf16_f32 v115, v178, v179
v_cvt_pk_bf16_f32 v116, v116, v117
v_mfma_f32_16x16x32_bf16 v[144:147], a[228:231], v[88:91], v[144:147]
v_cvt_pk_bf16_f32 v117, v118, v119
v_cvt_pk_bf16_f32 v118, v180, v181
v_mfma_f32_16x16x32_bf16 v[152:155], a[228:231], v[92:95], v[152:155]
ds_read_b128 a[228:231], v21 offset:8192
v_cvt_pk_bf16_f32 v119, v182, v183
v_mfma_f32_16x16x32_bf16 v[132:135], a[244:247], v[80:83], v[132:135]
v_cvt_pk_bf16_f32 v120, v120, v121
v_cvt_pk_bf16_f32 v121, v122, v123
v_mfma_f32_16x16x32_bf16 v[140:143], a[244:247], v[84:87], v[140:143]
v_cvt_pk_bf16_f32 v122, v184, v185
v_cvt_pk_bf16_f32 v123, v186, v187
v_mfma_f32_16x16x32_bf16 v[148:151], a[244:247], v[88:91], v[148:151]
v_cvt_pk_bf16_f32 v124, v124, v125
v_cvt_pk_bf16_f32 v125, v126, v127
v_mfma_f32_16x16x32_bf16 v[156:159], a[244:247], v[92:95], v[156:159]
ds_read_b128 a[244:247], v21 offset:12288
v_cvt_pk_bf16_f32 v126, v188, v189
v_mfma_f32_16x16x32_bf16 v[128:131], a[232:235], v[96:99], v[128:131]
v_cvt_pk_bf16_f32 v127, v190, v191
v_accvgpr_write_b32 a97, 0
v_mfma_f32_16x16x32_bf16 v[136:139], a[232:235], v[100:103], v[136:139]
v_accvgpr_write_b32 a98, 0
v_accvgpr_write_b32 a99, 0
v_mfma_f32_16x16x32_bf16 v[144:147], a[232:235], v[104:107], v[144:147]
v_accvgpr_write_b32 a100, 0
v_accvgpr_write_b32 a101, 0
v_mfma_f32_16x16x32_bf16 v[152:155], a[232:235], v[108:111], v[152:155]
ds_read_b128 a[232:235], v22 offset:8192
v_accvgpr_write_b32 a102, 0
v_mfma_f32_16x16x32_bf16 v[132:135], a[248:251], v[96:99], v[132:135]
v_accvgpr_write_b32 a103, 0
v_accvgpr_write_b32 a104, 0
v_mfma_f32_16x16x32_bf16 v[140:143], a[248:251], v[100:103], v[140:143]
v_accvgpr_write_b32 a105, 0
v_accvgpr_write_b32 a106, 0
v_mfma_f32_16x16x32_bf16 v[148:151], a[248:251], v[104:107], v[148:151]
v_accvgpr_write_b32 a107, 0
v_accvgpr_write_b32 a108, 0
v_mfma_f32_16x16x32_bf16 v[156:159], a[248:251], v[108:111], v[156:159]
ds_read_b128 a[248:251], v22 offset:12288
v_accvgpr_write_b32 a109, 0
v_mfma_f32_16x16x32_bf16 v[128:131], a[236:239], v[112:115], v[128:131]
v_accvgpr_write_b32 a110, 0
v_accvgpr_write_b32 a111, 0
v_mfma_f32_16x16x32_bf16 v[136:139], a[236:239], v[116:119], v[136:139]
v_accvgpr_write_b32 a112, 0
v_accvgpr_write_b32 a113, 0
v_mfma_f32_16x16x32_bf16 v[144:147], a[236:239], v[120:123], v[144:147]
v_accvgpr_write_b32 a114, 0
v_accvgpr_write_b32 a115, 0
v_mfma_f32_16x16x32_bf16 v[152:155], a[236:239], v[124:127], v[152:155]
ds_read_b128 a[236:239], v23 offset:8192
v_accvgpr_write_b32 a116, 0
v_mfma_f32_16x16x32_bf16 v[132:135], a[252:255], v[112:115], v[132:135]
v_accvgpr_write_b32 a117, 0
v_accvgpr_write_b32 a118, 0
v_mfma_f32_16x16x32_bf16 v[140:143], a[252:255], v[116:119], v[140:143]
v_accvgpr_write_b32 a119, 0
v_accvgpr_write_b32 a120, 0
v_mfma_f32_16x16x32_bf16 v[148:151], a[252:255], v[120:123], v[148:151]
v_accvgpr_write_b32 a121, 0
v_accvgpr_write_b32 a122, 0
v_mfma_f32_16x16x32_bf16 v[156:159], a[252:255], v[124:127], v[156:159]
ds_read_b128 a[252:255], v23 offset:12288
v_accvgpr_write_b32 a123, 0
v_accvgpr_write_b32 a124, 0
v_accvgpr_write_b32 a125, 0
v_accvgpr_write_b32 a126, 0
v_accvgpr_write_b32 a127, 0
s_mov_b32 s76, 65536
s_nop 1
v_mov_b32 v240, 0
v_mov_b32 v241, 0
v_mov_b32 v242, 0
v_mov_b32 v243, 0
v_mov_b32 v244, 0
v_mov_b32 v245, 0
v_mov_b32 v246, 0
v_mov_b32 v247, 0
v_mov_b32 v224, 0xff800000
v_mov_b32 v228, 0xff800000
v_mov_b32 v232, 0xff800000
v_mov_b32 v236, 0xff800000
s_waitcnt vmcnt(18)
s_branch PROJ_DONE
CODE1:
.section .rodata,"a"
.p2align 6
.amdhsa_kernel recurrent_scan__mha_block_cached__glu_gated_reglu__prompt_kernel
.amdhsa_next_free_vgpr 512
.amdhsa_next_free_sgpr 102
.amdhsa_accum_offset 256
.amdhsa_group_segment_fixed_size 0
.amdhsa_kernarg_size 96
.amdhsa_user_sgpr_count 2
.amdhsa_user_sgpr_kernarg_segment_ptr 1
.amdhsa_system_sgpr_workgroup_id_x 1
.end_amdhsa_kernel
```
